```python
import torch

def _softmax(x, axis=-1):
    return torch.softmax(x, dim=axis)
def _gelu(x):
    return torch.nn.functional.gelu(x, approximate="tanh")
def _silu(x):
    return torch.nn.functional.silu(x)
def _sigmoid(x):
    return torch.sigmoid(x)
def _layernorm(x, axis=-1, eps=1e-5):
    m = x.mean(dim=axis, keepdim=True)
    v = x.var(dim=axis, keepdim=True, unbiased=False)
    return (x - m) / torch.sqrt(v + eps)
def _scatter_add(tgt, idx, src, axis=0):
    return tgt.clone().index_add_(axis, idx, src)
def _segment_sum(src, seg, n):
    out = torch.zeros((n,) + src.shape[1:], dtype=src.dtype)
    return out.index_add_(0, seg, src)
def _pad(x, pw):
    flat = tuple(v for pair in reversed(pw) for v in pair)
    return torch.nn.functional.pad(x, flat)

kernel_name = 'interleave_layers__sliding_block__sliding_local_dilated__prompt'

def setup_inputs():

    _w = (lambda a: (lambda t: t.to(torch.bfloat16) if t.is_floating_point() else t)(torch.as_tensor(a)))
    def _A_setup():
        B, S, D = 1, 2048, 1024
        return {
            "x": _w((lambda *s: torch.randn(*s, dtype=torch.bfloat16) * 0.05)(B, S, D)),
            "wqkv": _w((lambda *s: torch.randn(*s, dtype=torch.bfloat16) * 0.05)(D, 3 * D)),
            "wo": _w((lambda *s: torch.randn(*s, dtype=torch.bfloat16) * 0.05)(D, D)),
        }
    _A_in = _A_setup()

    def _B_setup():
        B, S, D = 1, 2048, 1024
        return {
            "x": _w((lambda *s: torch.randn(*s, dtype=torch.bfloat16) * 0.05)(B, S, D)),
            "wqkv": _w((lambda *s: torch.randn(*s, dtype=torch.bfloat16) * 0.05)(D, 3 * D)),
            "wo": _w((lambda *s: torch.randn(*s, dtype=torch.bfloat16) * 0.05)(D, D)),
        }
    _B_in = _B_setup()

    return {
        "A_x": _A_in["x"],
        "A_wqkv": _A_in["wqkv"],
        "A_wo": _A_in["wo"],
        "B_x": _B_in["x"],
        "B_wqkv": _B_in["wqkv"],
        "B_wo": _B_in["wo"],
    }

def reference(A_x, A_wqkv, A_wo, B_x, B_wqkv, B_wo):
    def _A_ref(x, wqkv, wo):
        B, S, D = x.shape
        H = 32; Dh = D // H; W = 256
        qkv = (lambda x, *d: x.permute(*d))((x @ wqkv).reshape(B, S, 3, H, Dh), 2, 0, 3, 1, 4)
        q, k, v = qkv[0], qkv[1], qkv[2]
        scores = torch.einsum("bhqd,bhkd->bhqk", q, k) * (Dh ** -0.5)
        idx = torch.arange(S)
        mask = (idx[:, None] - idx[None, :] >= 0) & (idx[:, None] - idx[None, :] < W)
        scores = torch.where(mask[None, None], scores, -1e9)
        p = _softmax(scores, axis=-1)
        o = torch.einsum("bhqk,bhkd->bhqd", p, v)
        return (lambda x, *d: x.permute(*d))(o, 0, 2, 1, 3).reshape(B, S, D) @ wo

    def _B_ref(x, wqkv, wo):
        B, S, D = x.shape
        H = 32; Dh = D // H
        W, dil = 8, 2
        qkv = (lambda x, *d: x.permute(*d))((x @ wqkv).reshape(B, S, 3, H, Dh), 2, 0, 3, 1, 4)
        q, k, v = qkv[0], qkv[1], qkv[2]
        scale = Dh ** -0.5
        pos = torch.arange(S)
        off = torch.arange(W) * dil
        idx = pos[:, None] - off[None, :]
        mask = idx >= 0
        idx_c = torch.where(mask, idx, 0).reshape(-1)
        kg = k[:, :, idx_c, :].reshape(B, H, S, W, Dh)
        vg = v[:, :, idx_c, :].reshape(B, H, S, W, Dh)
        logits = torch.einsum("bhsd,bhswd->bhsw", q, kg) * scale
        logits = torch.where(mask[None, None, :, :], logits, -1e9)
        attn = _softmax(logits, axis=-1)
        o = torch.einsum("bhsw,bhswd->bhsd", attn, vg)
        return (lambda x, *d: x.permute(*d))(o, 0, 2, 1, 3).reshape(B, S, D) @ wo

    x = A_x
    x = x + _A_ref(_layernorm(x, axis=-1), A_wqkv, A_wo)
    x = x + _B_ref(_layernorm(x, axis=-1), B_wqkv, B_wo)
    x = x + _A_ref(_layernorm(x, axis=-1), A_wqkv, A_wo)
    x = x + _B_ref(_layernorm(x, axis=-1), B_wqkv, B_wo)
    return x
```

```asm
; @launch grid=(256,1,1) block=(512,1,1) lds=163840
.amdgcn_target "amdgcn-amd-amdhsa--gfx950"
.text
.globl interleave_layers__sliding_block__sliding_local_dilated__prompt_kernel
.p2align 8
.type interleave_layers__sliding_block__sliding_local_dilated__prompt_kernel,@function
interleave_layers__sliding_block__sliding_local_dilated__prompt_kernel:
    s_cmp_ge_u32 s2, 256
    s_cbranch_scc1 L_end
    s_load_dwordx16 s[48:63], s[0:1], 0
    s_load_dwordx2 s[64:65], s[0:1], 64
    v_lshrrev_b32 v1, 6, v0
    s_nop 0
    v_readfirstlane_b32 s3, v1
    v_and_b32 v1, 63, v0
    v_lshlrev_b32 v0, 4, v1
    s_cmp_eq_u32 s3, 3
    s_cbranch_scc0 Lw_1
    s_getpc_b64 s[40:41]
L_pc:
    s_lshr_b32 s27, s2, 3
    s_mul_i32 s27, s27, 1920
    v_lshlrev_b32 v28, 7, v1
    v_add_u32 v28, s27, v28
    s_mov_b32 s27, L_end - L_pc
    v_min_u32 v28, s27, v28
    v_mov_b32 v29, s41
    v_add_co_u32 v28, vcc, s40, v28
    s_nop 1
    v_addc_co_u32 v29, vcc, 0, v29, vcc
    s_mov_b64 exec, 32767
    global_load_dword v255, v[28:29], off
    s_mov_b64 exec, -1
Lw_1:
    s_and_b32 s27, s2, 7
    s_lshr_b32 s28, s2, 3
    s_lshl_b32 s20, s27, 1
    s_and_b32 s27, s28, 1
    s_add_u32 s20, s20, s27
    s_lshr_b32 s21, s28, 1
    s_and_b32 s75, s3, 3
    v_lshrrev_b32 v16, 4, v1
    v_lshlrev_b32 v16, 1, v16
    v_and_b32 v17, 7, v1
    v_xor_b32 v16, v16, v17
    v_lshlrev_b32 v173, 4, v16
    s_cmp_lt_u32 s3, 4
    s_cbranch_scc1 L_cstart
    s_lshl_b32 s78, s75, 12
    s_mul_i32 s79, s75, 6144
    v_lshrrev_b32 v12, 3, v1
    v_lshrrev_b32 v13, 5, v1
    v_lshl_add_u32 v12, v13, 2, v12
    s_lshr_b32 s27, s75, 1
    s_lshl_b32 s27, s27, 3
    s_and_b32 s28, s75, 1
    s_add_u32 s27, s27, s28
    s_mul_i32 s27, s27, 24576
    v_mul_u32_u24 v12, 6144, v12
    s_lshl_b32 s28, s21, 7
    s_add_u32 s27, s27, s28
    v_add3_u32 v12, v12, v173, s27
    v_add_u32 v13, 1024, v12
    v_add_u32 v14, 2048, v12
    v_add_u32 v15, 98304, v12
    v_add_u32 v16, 99328, v12
    v_add_u32 v17, 100352, v12
    s_lshl_b32 s27, s20, 2
    s_add_u32 s27, s27, s75
    s_lshl_b32 s27, s27, 16
    v_lshrrev_b32 v9, 4, v1
    v_and_b32 v10, 7, v1
    v_xor_b32 v9, v9, v10
    v_lshlrev_b32 v9, 4, v9
    v_lshrrev_b32 v10, 3, v1
    v_lshlrev_b32 v10, 11, v10
    v_add3_u32 v8, v9, v10, s27
    v_xor_b32 v9, 64, v8
    v_add_u32 v10, 30720, v8
    v_add_u32 v11, 46080, v9
    v_add_u32 v9, 15360, v9
    s_waitcnt lgkmcnt(0)
    s_mov_b32 s88, s48
    s_mov_b32 s89, s49
    s_mov_b32 s90, 4194304
    s_mov_b32 s91, 0x00020000
    s_mov_b32 s4, s50
    s_mov_b32 s5, s51
    s_mov_b32 s6, 6291456
    s_mov_b32 s7, 0x00020000
    s_andn2_b32 s55, s20, 0
    s_and_b32 s54, s20, 0
    s_lshr_b32 s27, s2, 3
    s_mul_i32 s27, s27, 12
    s_mul_i32 s28, s75, 3
    s_add_u32 s27, s27, s28
    v_mul_u32_u24 v19, 21846, v1
    v_lshrrev_b32 v19, 16, v19
    v_mul_u32_u24 v28, 3, v19
    v_sub_u32 v28, v1, v28
    v_add_u32 v28, s27, v28
    s_lshr_b32 s30, s4, 7
    s_sub_u32 s30, 3, s30
    s_and_b32 s30, s30, 7
    s_lshl_b32 s30, s30, 7
    v_and_b32 v18, 1, v28
    v_lshlrev_b32 v18, 10, v18
    v_lshrrev_b32 v28, 1, v28
    v_lshlrev_b32 v28, 11, v28
    v_add3_u32 v18, v18, v28, s30
    s_and_b32 s27, s20, 14
    v_add_u32 v19, s27, v19
    v_add_u32 v28, 0, v19
    v_and_b32 v28, 15, v28
    s_mov_b32 s27, 393216
    v_mad_u32_u24 v28, v28, s27, v18
    s_mov_b64 exec, 32767
    buffer_load_dword v255, v28, s[4:7], 0 offen
    s_mov_b64 exec, -1
    s_add_u32 s76, s55, 0
    s_and_b32 s76, s76, 15
    s_mul_i32 s77, s76, 393216
    s_lshl_b32 s76, s76, 7
    s_add_u32 m0, s79, 139264
    s_nop 0
    buffer_load_dwordx4 v12, s[4:7], s77 offen offset:0 lds
    buffer_load_dwordx4 v13, s[4:7], s77 offen offset:1024 lds
    buffer_load_dwordx4 v14, s[4:7], s77 offen offset:2048 lds
    s_add_u32 m0, s79, 142336
    s_nop 0
    buffer_load_dwordx4 v15, s[4:7], s77 offen offset:0 lds
    buffer_load_dwordx4 v16, s[4:7], s77 offen offset:1024 lds
    buffer_load_dwordx4 v17, s[4:7], s77 offen offset:2048 lds
    s_add_u32 m0, s78, 49152
    s_nop 0
    buffer_load_dwordx4 v8, s[88:91], s76 offen offset:0 sc1 lds
    buffer_load_dwordx4 v9, s[88:91], s76 offen offset:1024 sc1 lds
    buffer_load_dwordx4 v10, s[88:91], s76 offen offset:2048 sc1 lds
    buffer_load_dwordx4 v11, s[88:91], s76 offen offset:3072 sc1 lds
    s_andn2_b32 s84, 2, s75
    s_mov_b32 s12, s64
    s_mov_b32 s13, s65
    s_mov_b32 s14, 75497472
    s_mov_b32 s15, 0x00020000
    v_mov_b32 v28, 843776
    buffer_load_dwordx2 v[26:27], v28, s[12:15], 0 offen sc1
    s_mov_b32 s8, s52
    s_mov_b32 s9, s53
    s_mov_b32 s10, 2097152
    s_mov_b32 s11, 0x00020000
    s_mov_b32 s22, 0
    s_mov_b32 s23, 0
    v_mov_b32 v6, 0
    v_bfe_u32 v28, v1, 2, 3
    v_bfe_u32 v29, v1, 3, 2
    v_and_b32 v30, 3, v1
    v_lshlrev_b32 v28, 7, v28
    v_lshlrev_b32 v29, 5, v29
    v_lshlrev_b32 v30, 3, v30
    v_add3_u32 v2, v28, v29, v30
    v_and_b32 v28, 15, v1
    v_lshrrev_b32 v29, 4, v1
    v_lshlrev_b32 v29, 2, v29
    v_sub_u32 v4, v28, v29
    s_lshl_b32 s85, s75, 10
    s_lshl_b32 s86, s21, 17
    s_lshl_b32 s27, s75, 14
    s_lshl_b32 s28, s21, 7
    s_add_u32 s27, s27, s28
    v_lshrrev_b32 v3, 3, v1
    v_lshlrev_b32 v3, 11, v3
    v_add3_u32 v3, v3, v173, s27
    s_lshl_b32 s27, s20, 18
    s_lshl_b32 s28, s21, 12
    s_add_u32 s27, s27, s28
    s_lshl_b32 s28, s75, 16
    s_add_u32 s71, s27, s28
    s_lshl_b32 s28, s84, 16
    s_add_u32 s27, s27, s28
    s_and_b32 s28, s75, 1
    s_lshl_b32 s29, s28, 11
    s_add_u32 s27, s27, s29
    s_add_u32 s72, s27, 2097152
    s_lshl_b32 s27, s20, 4
    s_add_u32 s27, s27, s21
    s_lshl_b32 s27, s27, 2
    s_and_b32 s29, s75, 2
    s_add_u32 s27, s27, s29
    s_lshl_b32 s27, s27, 1
    s_add_u32 s27, s27, s28
    s_lshl_b32 s27, s27, 12
    s_add_u32 s73, s27, 14680064
    v_mov_b32 v176, -1
    v_mov_b32 v177, -1
    v_mov_b32 v178, -1
    v_mov_b32 v179, -1
    v_subrev_u32 v222, 0, v4
    v_ashrrev_i32 v222, 31, v222
    v_and_b32 v222, 4048155338, v222
    v_subrev_u32 v223, 1, v4
    v_ashrrev_i32 v223, 31, v223
    v_and_b32 v223, 4048155338, v223
    v_subrev_u32 v224, 2, v4
    v_ashrrev_i32 v224, 31, v224
    v_and_b32 v224, 4048155338, v224
    v_subrev_u32 v225, 3, v4
    v_ashrrev_i32 v225, 31, v225
    v_and_b32 v225, 4048155338, v225
    s_lshl_b32 s27, s21, 4
    s_add_u32 s27, s27, s20
    s_lshl_b32 s27, s27, 5
    s_add_u32 s27, s27, s75
    s_lshl_b32 s27, s27, 3
    s_add_u32 s87, s27, 851968
    s_mov_b32 s16, s60
    s_mov_b32 s17, s61
    s_mov_b32 s18, 4194304
    s_mov_b32 s19, 0x00020000
    s_add_u32 s76, s55, 1
    s_and_b32 s76, s76, 15
    s_mul_i32 s77, s76, 393216
    s_lshl_b32 s76, s76, 7
    s_add_u32 m0, s79, 0
    s_nop 0
    buffer_load_dwordx4 v12, s[4:7], s77 offen offset:0 lds
    buffer_load_dwordx4 v13, s[4:7], s77 offen offset:1024 lds
    buffer_load_dwordx4 v14, s[4:7], s77 offen offset:2048 lds
    s_add_u32 m0, s79, 3072
    s_nop 0
    buffer_load_dwordx4 v15, s[4:7], s77 offen offset:0 lds
    buffer_load_dwordx4 v16, s[4:7], s77 offen offset:1024 lds
    buffer_load_dwordx4 v17, s[4:7], s77 offen offset:2048 lds
    s_add_u32 m0, s78, 65536
    s_nop 0
    buffer_load_dwordx4 v8, s[88:91], s76 offen offset:0 sc1 lds
    buffer_load_dwordx4 v9, s[88:91], s76 offen offset:1024 sc1 lds
    buffer_load_dwordx4 v10, s[88:91], s76 offen offset:2048 sc1 lds
    buffer_load_dwordx4 v11, s[88:91], s76 offen offset:3072 sc1 lds
    s_add_u32 s76, s55, 2
    s_and_b32 s76, s76, 15
    s_mul_i32 s77, s76, 393216
    s_lshl_b32 s76, s76, 7
    s_add_u32 m0, s79, 24576
    s_nop 0
    buffer_load_dwordx4 v12, s[4:7], s77 offen offset:0 lds
    buffer_load_dwordx4 v13, s[4:7], s77 offen offset:1024 lds
    buffer_load_dwordx4 v14, s[4:7], s77 offen offset:2048 lds
    s_add_u32 m0, s79, 27648
    s_nop 0
    buffer_load_dwordx4 v15, s[4:7], s77 offen offset:0 lds
    buffer_load_dwordx4 v16, s[4:7], s77 offen offset:1024 lds
    buffer_load_dwordx4 v17, s[4:7], s77 offen offset:2048 lds
    s_lshr_b32 s27, s71, 16
    s_lshl_b32 s27, s27, 7
    s_add_u32 s27, s27, 786432
    v_and_b32 v28, 15, v1
    v_lshl_add_u32 v168, v28, 3, s27
    s_add_u32 s27, s78, 49152
    v_add_u32 v169, s27, v0
    s_lshl_b32 s27, s75, 7
    s_add_u32 s27, s27, 131072
    v_lshrrev_b32 v29, 5, v1
    v_lshl_add_u32 v29, v29, 4, v28
    v_lshl_add_u32 v170, v29, 2, s27
    s_min_u32 s27, s75, 2
    s_lshl_b32 s27, s27, 8
    s_add_u32 s27, s27, 132096
    v_lshrrev_b32 v29, 4, v1
    v_lshl_add_u32 v29, v28, 2, v29
    v_lshl_add_u32 v171, v29, 2, s27
    s_waitcnt vmcnt(16)
    v_readfirstlane_b32 s24, v26
    v_readfirstlane_b32 s25, v27
    s_add_u32 s24, s24, 1
    s_add_u32 s25, s25, 16
    s_and_b32 s25, s25, 0xfffffff0
    s_getreg_b32 s27, hwreg(HW_REG_XCC_ID, 0, 4)
    s_or_b32 s25, s25, s27
    s_barrier
    s_add_u32 s76, s55, 2
    s_and_b32 s76, s76, 15
    s_lshl_b32 s76, s76, 7
    s_add_u32 m0, s78, 81920
    s_nop 0
    buffer_load_dwordx4 v8, s[88:91], s76 offen offset:0 sc1 lds
    v_add_u32 v45, 5, v19
    v_and_b32 v45, 15, v45
    s_mov_b32 s27, 393216
    v_mad_u32_u24 v45, v45, s27, v18
    buffer_load_dwordx4 v9, s[88:91], s76 offen offset:1024 sc1 lds
    s_mov_b64 exec, 4095
    buffer_load_dword v255, v45, s[4:7], 0 offen
    s_mov_b64 exec, -1
    buffer_load_dwordx4 v10, s[88:91], s76 offen offset:2048 sc1 lds
    s_cmp_eq_u32 s54, 0
    s_cbranch_scc0 Lw_2
    v_lshrrev_b32 v116, 5, v1
    v_mul_u32_u24 v116, 3072, v116
    s_add_u32 s27, s79, 139264
    v_add3_u32 v116, v116, v2, s27
    v_xor_b32 v117, 32, v116
    v_xor_b32 v118, 64, v116
    v_xor_b32 v119, 96, v116
    ds_read_b64_tr_b16 v[80:81], v116 offset:0
    ds_read_b64_tr_b16 v[82:83], v117 offset:0
    ds_read_b64_tr_b16 v[84:85], v118 offset:0
    ds_read_b64_tr_b16 v[86:87], v119 offset:0
    ds_read_b64_tr_b16 v[88:89], v116 offset:1024
    ds_read_b64_tr_b16 v[90:91], v117 offset:1024
    ds_read_b64_tr_b16 v[92:93], v118 offset:1024
    ds_read_b64_tr_b16 v[94:95], v119 offset:1024
    ds_read_b64_tr_b16 v[96:97], v116 offset:2048
    ds_read_b64_tr_b16 v[98:99], v117 offset:2048
    ds_read_b64_tr_b16 v[100:101], v118 offset:2048
    ds_read_b64_tr_b16 v[102:103], v119 offset:2048
Lw_2:
    buffer_load_dwordx4 v11, s[88:91], s76 offen offset:3072 sc1 lds
    s_waitcnt lgkmcnt(0)
    s_add_u32 s76, s55, 3
    s_and_b32 s76, s76, 15
    s_mul_i32 s77, s76, 393216
    s_lshl_b32 s76, s76, 7
    s_add_u32 m0, s78, 49152
    s_waitcnt vmcnt(11)
    s_barrier
    buffer_load_dwordx4 v8, s[88:91], s76 offen offset:0 sc1 lds
    s_mov_b32 s40, s62
    s_mov_b32 s41, s63
    s_mov_b32 s42, 256
    s_mov_b32 s43, 0x00020000
    s_lshl_b32 s27, s75, 20
    v_mov_b32 v44, s27
    v_mov_b32 v45, 1
    buffer_load_dwordx4 v9, s[88:91], s76 offen offset:1024 sc1 lds
    s_mov_b64 exec, 1
    buffer_atomic_add v45, v44, s[40:43], 0 offen
    s_mov_b64 exec, -1
    buffer_load_dwordx4 v10, s[88:91], s76 offen offset:2048 sc1 lds
    v_bfe_u32 v104, v1, 2, 2
    v_lshlrev_b32 v104, v104, 1
    v_bfe_i32 v120, v104, 0, 1
    v_and_b32 v120, 0x3f803f80, v120
    buffer_load_dwordx4 v11, s[88:91], s76 offen offset:3072 sc1 lds
    v_mov_b32 v121, v120
    v_bfe_i32 v122, v104, 1, 1
    v_and_b32 v122, 0x3f803f80, v122
    v_mov_b32 v123, v122
    s_add_u32 m0, s79, 139264
    s_nop 0
    buffer_load_dwordx4 v12, s[4:7], s77 offen offset:0 lds
    v_bfe_i32 v124, v104, 2, 1
    v_and_b32 v124, 0x3f803f80, v124
    v_mov_b32 v125, v124
    v_bfe_i32 v126, v104, 3, 1
    buffer_load_dwordx4 v13, s[4:7], s77 offen offset:1024 lds
    v_and_b32 v126, 0x3f803f80, v126
    v_mov_b32 v127, v126
    s_waitcnt lgkmcnt(0)
    v_mfma_f32_16x16x32_bf16 v[104:107], v[120:123], v[80:83], 0
    buffer_load_dwordx4 v14, s[4:7], s77 offen offset:2048 lds
    v_mfma_f32_16x16x32_bf16 v[108:111], v[120:123], v[88:91], 0
    v_mfma_f32_16x16x32_bf16 v[112:115], v[120:123], v[96:99], 0
    v_mfma_f32_16x16x32_bf16 v[104:107], v[124:127], v[84:87], v[104:107]
    v_mfma_f32_16x16x32_bf16 v[108:111], v[124:127], v[92:95], v[108:111]
    s_add_u32 m0, s79, 142336
    s_nop 0
    buffer_load_dwordx4 v15, s[4:7], s77 offen offset:0 lds
    v_mfma_f32_16x16x32_bf16 v[112:115], v[124:127], v[100:103], v[112:115]
    s_mul_i32 s27, s75, 768
    s_add_u32 s27, s27, 133120
    v_lshl_add_u32 v116, v1, 2, s27
    buffer_load_dwordx4 v16, s[4:7], s77 offen offset:1024 lds
    ds_write_b32 v116, v104 offset:0
    ds_write_b32 v116, v108 offset:256
    s_nop 1
    ds_write_b32 v116, v112 offset:512
    s_waitcnt lgkmcnt(0)
    buffer_load_dwordx4 v17, s[4:7], s77 offen offset:2048 lds
    s_add_u32 s76, s55, 4
    s_and_b32 s76, s76, 15
    s_mul_i32 s77, s76, 393216
    s_lshl_b32 s76, s76, 7
    s_add_u32 m0, s78, 65536
    s_waitcnt vmcnt(11)
    s_barrier
    buffer_load_dwordx4 v8, s[88:91], s76 offen offset:0 sc1 lds
    s_min_u32 s27, s75, 2
    s_lshl_b32 s27, s27, 8
    s_add_u32 s27, s27, 133120
    v_lshl_add_u32 v80, v1, 2, s27
    buffer_load_dwordx4 v9, s[88:91], s76 offen offset:1024 sc1 lds
    ds_read_b32 v81, v80 offset:0
    ds_read_b32 v82, v80 offset:768
    ds_read_b32 v83, v80 offset:1536
    ds_read_b32 v84, v80 offset:2304
    buffer_load_dwordx4 v10, s[88:91], s76 offen offset:2048 sc1 lds
    buffer_load_dwordx4 v11, s[88:91], s76 offen offset:3072 sc1 lds
    s_lshl_b32 s27, s21, 2
    s_add_u32 s27, s27, s75
    s_mul_i32 s27, s27, 4096
    s_add_u32 s27, s27, 262144
    s_add_u32 m0, s79, 0
    s_nop 0
    buffer_load_dwordx4 v12, s[4:7], s77 offen offset:0 lds
    s_lshl_b32 s28, s20, 8
    s_add_u32 s27, s27, s28
    v_lshlrev_b32 v80, 2, v1
    s_waitcnt lgkmcnt(0)
    buffer_load_dwordx4 v13, s[4:7], s77 offen offset:1024 lds
    buffer_load_dwordx4 v14, s[4:7], s77 offen offset:2048 lds
    v_add_f32 v81, v81, v82
    s_add_u32 m0, s79, 3072
    s_nop 0
    buffer_load_dwordx4 v15, s[4:7], s77 offen offset:0 lds
    v_add_f32 v83, v83, v84
    v_add_f32 v81, v81, v83
    buffer_store_dword v81, v80, s[12:15], s27 offen sc1
    buffer_load_dwordx4 v16, s[4:7], s77 offen offset:1024 lds
    buffer_load_dwordx4 v17, s[4:7], s77 offen offset:2048 lds
    s_add_u32 s76, s55, 5
    s_and_b32 s76, s76, 15
    s_mul_i32 s77, s76, 393216
    s_lshl_b32 s76, s76, 7
    s_add_u32 m0, s78, 81920
    s_waitcnt vmcnt(17)
    s_waitcnt vmcnt(11)
    s_barrier
    buffer_load_dwordx4 v8, s[88:91], s76 offen offset:0 sc1 lds
    buffer_load_dwordx4 v9, s[88:91], s76 offen offset:1024 sc1 lds
    buffer_load_dwordx4 v10, s[88:91], s76 offen offset:2048 sc1 lds
    buffer_load_dwordx4 v11, s[88:91], s76 offen offset:3072 sc1 lds
    s_add_u32 m0, s79, 24576
    s_nop 0
    buffer_load_dwordx4 v12, s[4:7], s77 offen offset:0 lds
    buffer_load_dwordx4 v13, s[4:7], s77 offen offset:1024 lds
    buffer_load_dwordx4 v14, s[4:7], s77 offen offset:2048 lds
    s_add_u32 m0, s79, 27648
    s_nop 0
    buffer_load_dwordx4 v15, s[4:7], s77 offen offset:0 lds
    buffer_load_dwordx4 v16, s[4:7], s77 offen offset:1024 lds
    buffer_load_dwordx4 v17, s[4:7], s77 offen offset:2048 lds
    s_add_u32 s76, s55, 6
    s_and_b32 s76, s76, 15
    s_mul_i32 s77, s76, 393216
    s_lshl_b32 s76, s76, 7
    s_add_u32 m0, s78, 49152
    s_waitcnt vmcnt(17)
    s_waitcnt vmcnt(10)
    s_barrier
    buffer_load_dwordx4 v8, s[88:91], s76 offen offset:0 sc1 lds
    v_add_u32 v45, 9, v19
    v_and_b32 v45, 15, v45
    s_mov_b32 s27, 393216
    v_mad_u32_u24 v45, v45, s27, v18
    buffer_load_dwordx4 v9, s[88:91], s76 offen offset:1024 sc1 lds
    s_mov_b64 exec, 4095
    buffer_load_dword v255, v45, s[4:7], 0 offen
    s_mov_b64 exec, -1
    buffer_load_dwordx4 v10, s[88:91], s76 offen offset:2048 sc1 lds
    buffer_load_dwordx4 v11, s[88:91], s76 offen offset:3072 sc1 lds
    s_lshl_b32 s27, s21, 2
    s_add_u32 s27, s27, s75
    s_mul_i32 s27, s27, 128
    s_add_u32 s27, s27, 819200
    s_add_u32 m0, s79, 139264
    s_nop 0
    buffer_load_dwordx4 v12, s[4:7], s77 offen offset:0 lds
    buffer_load_dwordx4 v13, s[4:7], s77 offen offset:1024 lds
    v_and_b32 v172, 15, v1
    v_lshl_add_u32 v172, v172, 3, s27
    s_lshl_b32 s28, s20, 3
    s_add_u32 s27, s27, s28
    buffer_load_dwordx4 v14, s[4:7], s77 offen offset:2048 lds
    v_mov_b32 v46, s27
    v_mov_b32 v44, s24
    v_mov_b32 v45, s25
    s_add_u32 m0, s79, 142336
    s_nop 0
    buffer_load_dwordx4 v15, s[4:7], s77 offen offset:0 lds
    s_mov_b64 exec, 1
    buffer_store_dwordx2 v[44:45], v46, s[12:15], 0 offen offset:0 sc1
    s_mov_b64 exec, -1
    buffer_load_dwordx4 v16, s[4:7], s77 offen offset:1024 lds
    buffer_load_dwordx4 v17, s[4:7], s77 offen offset:2048 lds
    s_add_u32 s76, s55, 7
    s_and_b32 s76, s76, 15
    s_mul_i32 s77, s76, 393216
    s_lshl_b32 s76, s76, 7
    s_add_u32 m0, s78, 65536
    s_waitcnt vmcnt(18)
    s_waitcnt vmcnt(12)
    s_barrier
    buffer_load_dwordx4 v8, s[88:91], s76 offen offset:0 sc1 lds
    buffer_load_dwordx2 v[24:25], v168, s[12:15], 0 offen offset:0 sc1
    buffer_load_dwordx4 v9, s[88:91], s76 offen offset:1024 sc1 lds
    buffer_load_dwordx4 v10, s[88:91], s76 offen offset:2048 sc1 lds
    buffer_load_dwordx4 v11, s[88:91], s76 offen offset:3072 sc1 lds
    s_add_u32 m0, s79, 0
    s_nop 0
    buffer_load_dwordx4 v12, s[4:7], s77 offen offset:0 lds
    buffer_load_dwordx4 v13, s[4:7], s77 offen offset:1024 lds
    buffer_load_dwordx4 v14, s[4:7], s77 offen offset:2048 lds
    s_add_u32 m0, s79, 3072
    s_nop 0
    buffer_load_dwordx4 v15, s[4:7], s77 offen offset:0 lds
    buffer_load_dwordx4 v16, s[4:7], s77 offen offset:1024 lds
    buffer_load_dwordx4 v17, s[4:7], s77 offen offset:2048 lds
    s_add_u32 s76, s55, 8
    s_and_b32 s76, s76, 15
    s_mul_i32 s77, s76, 393216
    s_lshl_b32 s76, s76, 7
    s_add_u32 m0, s78, 81920
    s_waitcnt vmcnt(18)
    s_waitcnt vmcnt(11)
    s_barrier
    buffer_load_dwordx4 v8, s[88:91], s76 offen offset:0 sc1 lds
    s_waitcnt vmcnt(10)
    v_xor_b32 v26, s24, v24
    v_xor_b32 v27, s25, v25
    v_lshrrev_b32 v27, 4, v27
    v_or_b32 v26, v26, v27
    v_cmp_ne_u32 vcc, 0, v26
    s_nop 0
    s_cbranch_vccz Lsok_3
    s_mov_b32 s26, 0
Lpoll_4:
    buffer_load_dwordx2 v[24:25], v168, s[12:15], 0 offen offset:0 sc1
    s_waitcnt vmcnt(0)
    v_xor_b32 v26, s24, v24
    v_xor_b32 v27, s25, v25
    v_lshrrev_b32 v27, 4, v27
    v_or_b32 v26, v26, v27
    v_cmp_ne_u32 vcc, 0, v26
    s_nop 0
    s_cbranch_vccz Lok_5
    s_add_u32 s26, s26, 1
    s_cmp_lt_u32 s26, 262144
    s_cbranch_scc1 Lpoll_4
Lok_5:
Lsok_3:
    buffer_load_dwordx4 v9, s[88:91], s76 offen offset:1024 sc1 lds
    v_cmp_ne_u32 vcc, s25, v25
    s_nop 0
    s_cmp_eq_u64 vcc, 0
    s_cselect_b32 s23, 1, 0
    v_mov_b32 v42, s23
    v_mov_b32 v43, 132864
    ds_write_b32 v43, v42
    buffer_load_dwordx4 v10, s[88:91], s76 offen offset:2048 sc1 lds
    s_lshl_b32 s27, s2, 2
    s_add_u32 s27, s27, s75
    buffer_load_dwordx4 v11, s[88:91], s76 offen offset:3072 sc1 lds
    s_mul_i32 s27, s27, 2048
    s_nop 0
    s_add_u32 m0, s79, 24576
    s_nop 0
    buffer_load_dwordx4 v12, s[4:7], s77 offen offset:0 lds
    s_add_u32 s44, s52, s27
    s_addc_u32 s45, s53, 0
    buffer_load_dwordx4 v13, s[4:7], s77 offen offset:1024 lds
    s_load_dword s46, s[44:45], 0
    s_load_dword s46, s[44:45], 64
    buffer_load_dwordx4 v14, s[4:7], s77 offen offset:2048 lds
    s_load_dword s46, s[44:45], 128
    s_load_dword s46, s[44:45], 192
    s_add_u32 m0, s79, 27648
    s_nop 0
    buffer_load_dwordx4 v15, s[4:7], s77 offen offset:0 lds
    s_load_dword s46, s[44:45], 256
    s_load_dword s46, s[44:45], 320
    buffer_load_dwordx4 v16, s[4:7], s77 offen offset:1024 lds
    s_load_dword s46, s[44:45], 384
    s_load_dword s46, s[44:45], 448
    buffer_load_dwordx4 v17, s[4:7], s77 offen offset:2048 lds
    s_add_u32 s76, s55, 9
    s_and_b32 s76, s76, 15
    s_mul_i32 s77, s76, 393216
    s_lshl_b32 s76, s76, 7
    s_add_u32 m0, s78, 49152
    s_waitcnt vmcnt(16)
    s_waitcnt vmcnt(10)
    s_barrier
    buffer_load_dwordx4 v8, s[88:91], s76 offen offset:0 sc1 lds
    s_lshr_b32 s27, s71, 16
    s_lshl_b32 s27, s27, 12
    buffer_load_dwordx4 v[24:27], v0, s[12:15], s27 offen offset:0 sc1
    buffer_load_dwordx4 v9, s[88:91], s76 offen offset:1024 sc1 lds
    s_lshl_b32 s27, s2, 2
    s_add_u32 s27, s27, s75
    buffer_load_dwordx4 v10, s[88:91], s76 offen offset:2048 sc1 lds
    s_mul_i32 s27, s27, 2048
    s_nop 0
    buffer_load_dwordx4 v11, s[88:91], s76 offen offset:3072 sc1 lds
    s_add_u32 s44, s52, s27
    s_addc_u32 s45, s53, 0
    s_add_u32 m0, s79, 139264
    s_nop 0
    buffer_load_dwordx4 v12, s[4:7], s77 offen offset:0 lds
    s_load_dword s46, s[44:45], 512
    s_load_dword s46, s[44:45], 576
    buffer_load_dwordx4 v13, s[4:7], s77 offen offset:1024 lds
    s_load_dword s46, s[44:45], 640
    s_load_dword s46, s[44:45], 704
    buffer_load_dwordx4 v14, s[4:7], s77 offen offset:2048 lds
    s_load_dword s46, s[44:45], 768
    s_load_dword s46, s[44:45], 832
    s_add_u32 m0, s79, 142336
    s_nop 0
    buffer_load_dwordx4 v15, s[4:7], s77 offen offset:0 lds
    s_load_dword s46, s[44:45], 896
    s_load_dword s46, s[44:45], 960
    buffer_load_dwordx4 v16, s[4:7], s77 offen offset:1024 lds
    buffer_load_dwordx4 v17, s[4:7], s77 offen offset:2048 lds
    s_add_u32 s76, s55, 10
    s_and_b32 s76, s76, 15
    s_mul_i32 s77, s76, 393216
    s_lshl_b32 s76, s76, 7
    s_add_u32 m0, s78, 65536
    s_waitcnt vmcnt(17)
    s_waitcnt vmcnt(11)
    s_barrier
    buffer_load_dwordx4 v8, s[88:91], s76 offen offset:0 sc1 lds
    s_lshr_b32 s27, s71, 16
    s_lshl_b32 s27, s27, 12
    buffer_load_dwordx4 v[28:31], v0, s[12:15], s27 offen offset:1024 sc1
    v_add_u32 v45, 13, v19
    v_and_b32 v45, 15, v45
    s_mov_b32 s27, 393216
    v_mad_u32_u24 v45, v45, s27, v18
    buffer_load_dwordx4 v9, s[88:91], s76 offen offset:1024 sc1 lds
    s_mov_b64 exec, 4095
    buffer_load_dword v255, v45, s[4:7], 0 offen
    s_mov_b64 exec, -1
    buffer_load_dwordx4 v10, s[88:91], s76 offen offset:2048 sc1 lds
    s_lshl_b32 s27, s2, 2
    s_add_u32 s27, s27, s75
    buffer_load_dwordx4 v11, s[88:91], s76 offen offset:3072 sc1 lds
    s_mul_i32 s27, s27, 2048
    s_nop 0
    s_add_u32 m0, s79, 0
    s_nop 0
    buffer_load_dwordx4 v12, s[4:7], s77 offen offset:0 lds
    s_add_u32 s44, s52, s27
    s_addc_u32 s45, s53, 0
    buffer_load_dwordx4 v13, s[4:7], s77 offen offset:1024 lds
    s_load_dword s46, s[44:45], 1024
    s_load_dword s46, s[44:45], 1088
    buffer_load_dwordx4 v14, s[4:7], s77 offen offset:2048 lds
    s_load_dword s46, s[44:45], 1152
    s_load_dword s46, s[44:45], 1216
    s_add_u32 m0, s79, 3072
    s_nop 0
    buffer_load_dwordx4 v15, s[4:7], s77 offen offset:0 lds
    s_load_dword s46, s[44:45], 1280
    s_load_dword s46, s[44:45], 1344
    buffer_load_dwordx4 v16, s[4:7], s77 offen offset:1024 lds
    s_load_dword s46, s[44:45], 1408
    s_load_dword s46, s[44:45], 1472
    buffer_load_dwordx4 v17, s[4:7], s77 offen offset:2048 lds
    s_add_u32 s76, s55, 11
    s_and_b32 s76, s76, 15
    s_mul_i32 s77, s76, 393216
    s_lshl_b32 s76, s76, 7
    s_add_u32 m0, s78, 81920
    s_waitcnt vmcnt(18)
    s_waitcnt vmcnt(12)
    s_barrier
    buffer_load_dwordx4 v8, s[88:91], s76 offen offset:0 sc1 lds
    s_lshr_b32 s27, s71, 16
    s_lshl_b32 s27, s27, 12
    buffer_load_dwordx4 v[32:35], v0, s[12:15], s27 offen offset:2048 sc1
    buffer_load_dwordx4 v9, s[88:91], s76 offen offset:1024 sc1 lds
    s_lshl_b32 s27, s2, 2
    s_add_u32 s27, s27, s75
    buffer_load_dwordx4 v10, s[88:91], s76 offen offset:2048 sc1 lds
    s_mul_i32 s27, s27, 2048
    s_nop 0
    buffer_load_dwordx4 v11, s[88:91], s76 offen offset:3072 sc1 lds
    s_add_u32 s44, s52, s27
    s_addc_u32 s45, s53, 0
    s_add_u32 m0, s79, 24576
    s_nop 0
    buffer_load_dwordx4 v12, s[4:7], s77 offen offset:0 lds
    s_load_dword s46, s[44:45], 1536
    s_load_dword s46, s[44:45], 1600
    buffer_load_dwordx4 v13, s[4:7], s77 offen offset:1024 lds
    s_load_dword s46, s[44:45], 1664
    s_load_dword s46, s[44:45], 1728
    buffer_load_dwordx4 v14, s[4:7], s77 offen offset:2048 lds
    s_load_dword s46, s[44:45], 1792
    s_load_dword s46, s[44:45], 1856
    s_add_u32 m0, s79, 27648
    s_nop 0
    buffer_load_dwordx4 v15, s[4:7], s77 offen offset:0 lds
    s_load_dword s46, s[44:45], 1920
    s_load_dword s46, s[44:45], 1984
    buffer_load_dwordx4 v16, s[4:7], s77 offen offset:1024 lds
    buffer_load_dwordx4 v17, s[4:7], s77 offen offset:2048 lds
    s_add_u32 s76, s55, 12
    s_and_b32 s76, s76, 15
    s_mul_i32 s77, s76, 393216
    s_lshl_b32 s76, s76, 7
    s_add_u32 m0, s78, 49152
    s_waitcnt vmcnt(17)
    s_waitcnt vmcnt(11)
    s_barrier
    buffer_load_dwordx4 v8, s[88:91], s76 offen offset:0 sc1 lds
    buffer_load_dwordx2 v[64:65], v172, s[12:15], 0 offen offset:0 sc1
    buffer_load_dwordx4 v9, s[88:91], s76 offen offset:1024 sc1 lds
    buffer_load_dwordx4 v10, s[88:91], s76 offen offset:2048 sc1 lds
    buffer_load_dwordx4 v11, s[88:91], s76 offen offset:3072 sc1 lds
    s_add_u32 m0, s79, 139264
    s_nop 0
    buffer_load_dwordx4 v12, s[4:7], s77 offen offset:0 lds
    s_lshr_b32 s27, s71, 16
    s_lshl_b32 s27, s27, 12
    buffer_load_dwordx4 v[36:39], v0, s[12:15], s27 offen offset:3072 sc1
    buffer_load_dwordx4 v13, s[4:7], s77 offen offset:1024 lds
    buffer_load_dwordx4 v14, s[4:7], s77 offen offset:2048 lds
    s_add_u32 m0, s79, 142336
    s_nop 0
    buffer_load_dwordx4 v15, s[4:7], s77 offen offset:0 lds
    buffer_load_dwordx4 v16, s[4:7], s77 offen offset:1024 lds
    buffer_load_dwordx4 v17, s[4:7], s77 offen offset:2048 lds
    s_add_u32 s76, s55, 13
    s_and_b32 s76, s76, 15
    s_mul_i32 s77, s76, 393216
    s_lshl_b32 s76, s76, 7
    s_add_u32 m0, s78, 65536
    s_waitcnt vmcnt(18)
    s_waitcnt vmcnt(12)
    s_barrier
    buffer_load_dwordx4 v8, s[88:91], s76 offen offset:0 sc1 lds
    s_lshl_b32 s27, s20, 4
    s_add_u32 s27, s27, s21
    s_lshl_b32 s27, s27, 2
    s_add_u32 s27, s27, s75
    buffer_load_dwordx4 v9, s[88:91], s76 offen offset:1024 sc1 lds
    s_lshl_b32 s27, s27, 10
    s_add_u32 s27, s27, 31457280
    buffer_store_dwordx4 v[176:179], v0, s[12:15], s27 offen sc1
    buffer_load_dwordx4 v10, s[88:91], s76 offen offset:2048 sc1 lds
    s_waitcnt vmcnt(14)
    v_xor_b32 v66, s24, v64
    v_xor_b32 v67, s25, v65
    v_lshrrev_b32 v67, 4, v67
    v_or_b32 v66, v66, v67
    v_cmp_ne_u32 vcc, 0, v66
    s_nop 0
    s_cbranch_vccz Lcsok_6
    s_mov_b32 s26, 0
Lpoll_7:
    buffer_load_dwordx2 v[64:65], v172, s[12:15], 0 offen offset:0 sc1
    s_waitcnt vmcnt(0)
    v_xor_b32 v66, s24, v64
    v_xor_b32 v67, s25, v65
    v_lshrrev_b32 v67, 4, v67
    v_or_b32 v66, v66, v67
    v_cmp_ne_u32 vcc, 0, v66
    s_nop 0
    s_cbranch_vccz Lok_8
    s_add_u32 s26, s26, 1
    s_cmp_lt_u32 s26, 262144
    s_cbranch_scc1 Lpoll_7
Lok_8:
Lcsok_6:
    buffer_load_dwordx4 v11, s[88:91], s76 offen offset:3072 sc1 lds
    s_lshl_b32 s31, s21, 2
    s_add_u32 s31, s31, s75
    s_mul_i32 s31, s31, 4096
    s_add_u32 s31, s31, 262144
    s_add_u32 m0, s79, 0
    s_nop 0
    buffer_load_dwordx4 v12, s[4:7], s77 offen offset:0 lds
    buffer_load_dwordx4 v[48:51], v0, s[12:15], s31 offen offset:0 sc1
    buffer_load_dwordx4 v13, s[4:7], s77 offen offset:1024 lds
    buffer_load_dwordx4 v[52:55], v0, s[12:15], s31 offen offset:1024 sc1
    buffer_load_dwordx4 v14, s[4:7], s77 offen offset:2048 lds
    buffer_load_dwordx4 v[56:59], v0, s[12:15], s31 offen offset:2048 sc1
    s_add_u32 m0, s79, 3072
    s_nop 0
    buffer_load_dwordx4 v15, s[4:7], s77 offen offset:0 lds
    buffer_load_dwordx4 v[60:63], v0, s[12:15], s31 offen offset:3072 sc1
    buffer_load_dwordx4 v16, s[4:7], s77 offen offset:1024 lds
    buffer_load_dwordx4 v17, s[4:7], s77 offen offset:2048 lds
    s_add_u32 s76, s55, 14
    s_and_b32 s76, s76, 15
    s_mul_i32 s77, s76, 393216
    s_lshl_b32 s76, s76, 7
    s_add_u32 m0, s78, 81920
    s_waitcnt vmcnt(22)
    s_waitcnt vmcnt(15)
    s_barrier
    buffer_load_dwordx4 v8, s[88:91], s76 offen offset:0 sc1 lds
    v_add_f32 v24, v24, v32
    v_add_f32 v25, v25, v33
    v_add_f32 v26, v26, v34
    buffer_load_dwordx4 v9, s[88:91], s76 offen offset:1024 sc1 lds
    v_add_f32 v27, v27, v35
    v_add_f32 v28, v28, v36
    v_add_f32 v29, v29, v37
    v_add_f32 v30, v30, v38
    v_add_f32 v31, v31, v39
    v_add_f32 v24, v24, v28
    buffer_load_dwordx4 v10, s[88:91], s76 offen offset:2048 sc1 lds
    v_add_f32 v25, v25, v29
    v_add_f32 v26, v26, v30
    v_add_f32 v27, v27, v31
    buffer_load_dwordx4 v11, s[88:91], s76 offen offset:3072 sc1 lds
    v_permlane32_swap_b32 v24, v26
    v_permlane32_swap_b32 v25, v27
    v_add_f32 v24, v24, v26
    v_add_f32 v25, v25, v27
    v_mov_b32 v26, v24
    v_mov_b32 v27, v25
    s_add_u32 m0, s79, 24576
    s_nop 0
    buffer_load_dwordx4 v12, s[4:7], s77 offen offset:0 lds
    s_lshr_b32 s27, s2, 3
    s_lshl_b32 s27, s27, 6
    s_lshl_b32 s28, s75, 4
    s_add_u32 s27, s27, s28
    buffer_load_dwordx4 v13, s[4:7], s77 offen offset:1024 lds
    v_add_u32 v44, s27, v1
    s_lshr_b32 s30, s8, 7
    s_sub_u32 s30, 3, s30
    s_and_b32 s30, s30, 7
    s_lshl_b32 s30, s30, 7
    v_and_b32 v45, 1, v44
    v_lshlrev_b32 v45, 10, v45
    v_lshrrev_b32 v44, 1, v44
    buffer_load_dwordx4 v14, s[4:7], s77 offen offset:2048 lds
    v_lshlrev_b32 v44, 11, v44
    v_add3_u32 v45, v45, v44, s30
    s_add_u32 m0, s79, 27648
    s_nop 0
    buffer_load_dwordx4 v15, s[4:7], s77 offen offset:0 lds
    s_mov_b64 exec, 0xffff
    buffer_load_dword v255, v45, s[8:11], 0 offen
    s_mov_b64 exec, -1
    s_lshl_b32 s27, s20, 4
    s_add_u32 s27, s27, s21
    s_lshl_b32 s27, s27, 2
    s_add_u32 s27, s27, s75
    buffer_load_dwordx4 v16, s[4:7], s77 offen offset:1024 lds
    s_lshl_b32 s27, s27, 10
    s_add_u32 s27, s27, 32505856
    buffer_store_dwordx4 v[176:179], v0, s[12:15], s27 offen sc1
    buffer_load_dwordx4 v17, s[4:7], s77 offen offset:2048 lds
    s_add_u32 s76, s55, 15
    s_and_b32 s76, s76, 15
    s_mul_i32 s77, s76, 393216
    s_lshl_b32 s76, s76, 7
    s_add_u32 m0, s78, 49152
    s_waitcnt vmcnt(22)
    s_waitcnt vmcnt(12)
    s_barrier
    buffer_load_dwordx4 v8, s[88:91], s76 offen offset:0 sc1 lds
    v_permlane16_swap_b32 v24, v26
    v_permlane16_swap_b32 v25, v27
    v_add_f32 v24, v24, v26
    v_add_f32 v25, v25, v27
    buffer_load_dwordx4 v9, s[88:91], s76 offen offset:1024 sc1 lds
    v_mul_f32 v24, 0xba800000, v24
    v_mul_f32 v25, 0x3a800000, v25
    v_fma_f32 v25, -v24, v24, v25
    v_max_f32 v25, 0, v25
    buffer_load_dwordx4 v10, s[88:91], s76 offen offset:2048 sc1 lds
    v_add_f32 v25, 0x3727c5ac, v25
    v_rsq_f32 v25, v25
    buffer_load_dwordx4 v11, s[88:91], s76 offen offset:3072 sc1 lds
    v_mul_f32 v24, v24, v25
    ds_write_b32 v170, v25
    ds_write_b32 v170, v24 offset:512
    s_add_u32 m0, s79, 139264
    s_nop 0
    buffer_load_dwordx4 v12, s[4:7], s77 offen offset:0 lds
    v_add_f32 v48, v48, v56
    v_add_f32 v49, v49, v57
    v_add_f32 v50, v50, v58
    buffer_load_dwordx4 v13, s[4:7], s77 offen offset:1024 lds
    v_add_f32 v51, v51, v59
    v_add_f32 v52, v52, v60
    v_add_f32 v53, v53, v61
    buffer_load_dwordx4 v14, s[4:7], s77 offen offset:2048 lds
    v_add_f32 v54, v54, v62
    v_add_f32 v55, v55, v63
    v_add_f32 v48, v48, v52
    v_add_f32 v49, v49, v53
    v_add_f32 v50, v50, v54
    v_add_f32 v51, v51, v55
    s_add_u32 m0, s79, 142336
    s_nop 0
    buffer_load_dwordx4 v15, s[4:7], s77 offen offset:0 lds
    v_permlane32_swap_b32 v48, v50
    v_permlane32_swap_b32 v49, v51
    v_add_f32 v48, v48, v50
    v_add_f32 v49, v49, v51
    s_nop 1
    v_permlane16_swap_b32 v48, v49
    v_add_f32 v20, v48, v49
    buffer_load_dwordx4 v16, s[4:7], s77 offen offset:1024 lds
    ds_write_b32 v171, v20
    buffer_load_dwordx4 v17, s[4:7], s77 offen offset:2048 lds
    s_waitcnt vmcnt(18)
    s_waitcnt vmcnt(10)
    s_barrier
    s_add_u32 m0, s85, 0
    s_add_u32 s36, s86, 0
    s_and_b32 s36, s36, 0x1fffff
    buffer_load_dwordx4 v3, s[8:11], s36 offen lds
    s_add_u32 s27, s71, 0
    s_cmp_eq_u32 s23, 0
    s_cbranch_scc1 Lslow_9
    buffer_store_dwordx4 v[176:179], v0, s[16:19], s27 offen offset:0
Lback_10:
    s_add_u32 m0, s85, 4096
    s_add_u32 s36, s86, 65536
    s_and_b32 s36, s36, 0x1fffff
    buffer_load_dwordx4 v3, s[8:11], s36 offen lds
    s_add_u32 s27, s71, 0
    s_cmp_eq_u32 s23, 0
    s_cbranch_scc1 Lslow_11
    buffer_store_dwordx4 v[176:179], v0, s[16:19], s27 offen offset:1024
Lback_12:
    s_add_u32 m0, s85, 8192
    s_add_u32 s36, s86, 131072
    s_and_b32 s36, s36, 0x1fffff
    buffer_load_dwordx4 v3, s[8:11], s36 offen lds
    s_add_u32 s27, s71, 0
    s_cmp_eq_u32 s23, 0
    s_cbranch_scc1 Lslow_13
    buffer_store_dwordx4 v[176:179], v0, s[16:19], s27 offen offset:2048
Lback_14:
    s_add_u32 m0, s85, 12288
    s_add_u32 s36, s86, 196608
    s_and_b32 s36, s36, 0x1fffff
    buffer_load_dwordx4 v3, s[8:11], s36 offen lds
    s_add_u32 s27, s71, 0
    s_cmp_eq_u32 s23, 0
    s_cbranch_scc1 Lslow_15
    buffer_store_dwordx4 v[176:179], v0, s[16:19], s27 offen offset:3072
Lback_16:
    s_add_u32 m0, s85, 16384
    s_add_u32 s36, s86, 262144
    s_and_b32 s36, s36, 0x1fffff
    buffer_load_dwordx4 v3, s[8:11], s36 offen lds
    s_add_u32 m0, s85, 20480
    s_add_u32 s36, s86, 327680
    s_and_b32 s36, s36, 0x1fffff
    buffer_load_dwordx4 v3, s[8:11], s36 offen lds
    s_waitcnt vmcnt(16)
    s_waitcnt vmcnt(10)
    s_waitcnt lgkmcnt(0)
    s_barrier
    s_add_u32 m0, s85, 24576
    s_add_u32 s36, s86, 393216
    s_and_b32 s36, s36, 0x1fffff
    buffer_load_dwordx4 v3, s[8:11], s36 offen lds
    s_add_u32 m0, s85, 28672
    s_add_u32 s36, s86, 458752
    s_and_b32 s36, s36, 0x1fffff
    buffer_load_dwordx4 v3, s[8:11], s36 offen lds
    s_add_u32 m0, s85, 32768
    s_add_u32 s36, s86, 524288
    s_and_b32 s36, s36, 0x1fffff
    buffer_load_dwordx4 v3, s[8:11], s36 offen lds
    s_add_u32 m0, s85, 36864
    s_add_u32 s36, s86, 589824
    s_and_b32 s36, s36, 0x1fffff
    buffer_load_dwordx4 v3, s[8:11], s36 offen lds
    s_add_u32 m0, s85, 40960
    s_add_u32 s36, s86, 655360
    s_and_b32 s36, s36, 0x1fffff
    buffer_load_dwordx4 v3, s[8:11], s36 offen lds
    s_add_u32 m0, s85, 45056
    s_add_u32 s36, s86, 720896
    s_and_b32 s36, s36, 0x1fffff
    buffer_load_dwordx4 v3, s[8:11], s36 offen lds
    s_barrier
    s_branch L_attL
L_between0:
    s_add_u32 m0, s85, 122880
    s_add_u32 s36, s86, 1966080
    s_and_b32 s36, s36, 0x1fffff
    buffer_load_dwordx4 v3, s[8:11], s36 offen lds
    s_add_u32 m0, s85, 126976
    s_add_u32 s36, s86, 2031616
    s_and_b32 s36, s36, 0x1fffff
    buffer_load_dwordx4 v3, s[8:11], s36 offen lds
    s_mov_b32 s22, 1
    s_mov_b32 s4, s56
    s_mov_b32 s5, s57
    v_lshrrev_b32 v12, 3, v1
    s_mul_i32 s27, s75, 98304
    v_mul_u32_u24 v12, 6144, v12
    s_lshl_b32 s28, s21, 7
    s_add_u32 s27, s27, s28
    v_add3_u32 v12, v12, v173, s27
    v_add_u32 v13, 1024, v12
    v_add_u32 v14, 2048, v12
    v_add_u32 v15, 49152, v12
    v_add_u32 v16, 50176, v12
    v_add_u32 v17, 51200, v12
    s_lshl_b32 s27, s20, 2
    s_add_u32 s27, s27, s75
    s_lshl_b32 s27, s27, 16
    v_add_u32 v8, s27, v0
    s_andn2_b32 s55, s20, 0
    s_cmp_eq_u32 s55, 15
    s_cselect_b32 s55, 0, s55
    s_and_b32 s54, s20, 0
    s_add_u32 s54, s54, 1
    s_cmp_eq_u32 s20, 15
    s_cselect_b32 s54, 0, s54
    v_add_u32 v168, 8192, v168
    s_lshr_b32 s27, s2, 3
    s_mul_i32 s27, s27, 12
    s_mul_i32 s28, s75, 3
    s_add_u32 s27, s27, s28
    v_mul_u32_u24 v19, 21846, v1
    v_lshrrev_b32 v19, 16, v19
    v_mul_u32_u24 v24, 3, v19
    v_sub_u32 v24, v1, v24
    v_add_u32 v24, s27, v24
    s_lshr_b32 s30, s4, 7
    s_sub_u32 s30, 3, s30
    s_and_b32 s30, s30, 7
    s_lshl_b32 s30, s30, 7
    v_and_b32 v18, 1, v24
    v_lshlrev_b32 v18, 10, v18
    v_lshrrev_b32 v24, 1, v24
    v_lshlrev_b32 v24, 11, v24
    v_add3_u32 v18, v18, v24, s30
    s_and_b32 s27, s20, 14
    v_add_u32 v19, s27, v19
    v_add_u32 v24, 1, v19
    v_lshrrev_b32 v25, 4, v24
    v_lshrrev_b32 v26, 7, v18
    v_add3_u32 v24, v24, v25, v26
    v_and_b32 v24, 15, v24
    s_mov_b32 s27, 393216
    v_mad_u32_u24 v24, v24, s27, v18
    s_mov_b64 exec, 32767
    buffer_load_dword v255, v24, s[4:7], 0 offen
    s_mov_b64 exec, -1
    s_add_u32 s77, s21, 0
    s_and_b32 s77, s77, 15
    s_mul_i32 s77, s77, 393216
    s_add_u32 m0, s79, 139264
    s_waitcnt vmcnt(2)
    buffer_load_dwordx4 v12, s[4:7], s77 offen offset:0 lds
    s_waitcnt vmcnt(2)
    buffer_load_dwordx4 v13, s[4:7], s77 offen offset:1024 lds
    s_waitcnt vmcnt(2)
    buffer_load_dwordx4 v14, s[4:7], s77 offen offset:2048 lds
    s_add_u32 m0, s79, 142336
    s_waitcnt vmcnt(2)
    buffer_load_dwordx4 v15, s[4:7], s77 offen offset:0 lds
    s_waitcnt vmcnt(2)
    buffer_load_dwordx4 v16, s[4:7], s77 offen offset:1024 lds
    s_waitcnt vmcnt(2)
    buffer_load_dwordx4 v17, s[4:7], s77 offen offset:2048 lds
    s_barrier
    s_add_u32 s77, s55, 1
    s_cmp_ge_u32 s77, 16
    s_addc_u32 s77, s77, s21
    s_and_b32 s77, s77, 15
    s_mul_i32 s77, s77, 393216
    s_add_u32 m0, s79, 0
    s_waitcnt vmcnt(2)
    buffer_load_dwordx4 v12, s[4:7], s77 offen offset:0 lds
    s_waitcnt vmcnt(2)
    buffer_load_dwordx4 v13, s[4:7], s77 offen offset:1024 lds
    s_waitcnt vmcnt(2)
    buffer_load_dwordx4 v14, s[4:7], s77 offen offset:2048 lds
    s_add_u32 m0, s79, 3072
    s_waitcnt vmcnt(2)
    buffer_load_dwordx4 v15, s[4:7], s77 offen offset:0 lds
    s_waitcnt vmcnt(2)
    buffer_load_dwordx4 v16, s[4:7], s77 offen offset:1024 lds
    s_waitcnt vmcnt(2)
    buffer_load_dwordx4 v17, s[4:7], s77 offen offset:2048 lds
    s_waitcnt vmcnt(13)
    s_mov_b32 s8, s58
    s_mov_b32 s9, s59
    s_barrier
    s_add_u32 s77, s55, 2
    s_cmp_ge_u32 s77, 16
    s_addc_u32 s77, s77, s21
    s_and_b32 s77, s77, 15
    s_mul_i32 s77, s77, 393216
    s_add_u32 m0, s79, 24576
    s_waitcnt vmcnt(2)
    buffer_load_dwordx4 v12, s[4:7], s77 offen offset:0 lds
    s_waitcnt vmcnt(2)
    buffer_load_dwordx4 v13, s[4:7], s77 offen offset:1024 lds
    s_waitcnt vmcnt(2)
    buffer_load_dwordx4 v14, s[4:7], s77 offen offset:2048 lds
    s_add_u32 m0, s79, 27648
    s_waitcnt vmcnt(2)
    buffer_load_dwordx4 v15, s[4:7], s77 offen offset:0 lds
    s_waitcnt vmcnt(2)
    buffer_load_dwordx4 v16, s[4:7], s77 offen offset:1024 lds
    s_waitcnt vmcnt(2)
    buffer_load_dwordx4 v17, s[4:7], s77 offen offset:2048 lds
    s_waitcnt vmcnt(12)
    s_add_u32 s76, s55, 1
    s_cmp_ge_u32 s76, 16
    s_addc_u32 s76, s76, s21
    s_and_b32 s76, s76, 15
    s_lshl_b32 s76, s76, 12
    s_barrier
    s_add_u32 m0, s78, 65536
    s_nop 0
    buffer_load_dwordx4 v8, s[16:19], s76 offen offset:0 sc1 lds
    buffer_load_dwordx4 v8, s[16:19], s76 offen offset:1024 sc1 lds
    buffer_load_dwordx4 v8, s[16:19], s76 offen offset:2048 sc1 lds
    buffer_load_dwordx4 v8, s[16:19], s76 offen offset:3072 sc1 lds
    s_add_u32 s76, s55, 2
    s_cmp_ge_u32 s76, 16
    s_addc_u32 s76, s76, s21
    s_and_b32 s76, s76, 15
    s_lshl_b32 s76, s76, 12
    s_add_u32 m0, s78, 81920
    s_nop 0
    buffer_load_dwordx4 v8, s[16:19], s76 offen offset:0 sc1 lds
    v_add_u32 v45, 5, v19
    v_lshrrev_b32 v46, 4, v45
    v_lshrrev_b32 v47, 7, v18
    v_add3_u32 v45, v45, v46, v47
    v_and_b32 v45, 15, v45
    s_mov_b32 s27, 393216
    v_mad_u32_u24 v45, v45, s27, v18
    buffer_load_dwordx4 v8, s[16:19], s76 offen offset:1024 sc1 lds
    s_mov_b64 exec, 4095
    buffer_load_dword v255, v45, s[4:7], 0 offen
    s_mov_b64 exec, -1
    buffer_load_dwordx4 v8, s[16:19], s76 offen offset:2048 sc1 lds
    s_cmp_eq_u32 s54, 0
    s_cbranch_scc0 Lw_19
    v_lshrrev_b32 v116, 5, v1
    v_mul_u32_u24 v116, 3072, v116
    s_add_u32 s27, s79, 139264
    v_add3_u32 v116, v116, v2, s27
    v_xor_b32 v117, 32, v116
    v_xor_b32 v118, 64, v116
    v_xor_b32 v119, 96, v116
    ds_read_b64_tr_b16 v[80:81], v116 offset:0
    ds_read_b64_tr_b16 v[82:83], v117 offset:0
    ds_read_b64_tr_b16 v[84:85], v118 offset:0
    ds_read_b64_tr_b16 v[86:87], v119 offset:0
    ds_read_b64_tr_b16 v[88:89], v116 offset:1024
    ds_read_b64_tr_b16 v[90:91], v117 offset:1024
    ds_read_b64_tr_b16 v[92:93], v118 offset:1024
    ds_read_b64_tr_b16 v[94:95], v119 offset:1024
    ds_read_b64_tr_b16 v[96:97], v116 offset:2048
    ds_read_b64_tr_b16 v[98:99], v117 offset:2048
    ds_read_b64_tr_b16 v[100:101], v118 offset:2048
    ds_read_b64_tr_b16 v[102:103], v119 offset:2048
Lw_19:
    buffer_load_dwordx4 v8, s[16:19], s76 offen offset:3072 sc1 lds
    s_waitcnt lgkmcnt(0)
    s_waitcnt vmcnt(5)
    ds_read_b32 v40, v169 offset:16384
    ds_read_b32 v41, v169 offset:17408
    ds_read_b32 v42, v169 offset:18432
    ds_read_b32 v43, v169 offset:19456
    s_waitcnt lgkmcnt(0)
    v_or3_b32 v40, v40, v41, v42
    v_bitop3_b32 v40, v40, v43, 1 bitop3:0xa8
    v_cmp_ne_u32 vcc, 0, v40
    s_nop 0
    s_cbranch_vccnz Lxrt_18
Lxok_17:
    s_add_u32 s76, s55, 3
    s_cmp_ge_u32 s76, 16
    s_addc_u32 s76, s76, s21
    s_and_b32 s76, s76, 15
    s_mul_i32 s77, s76, 393216
    s_lshl_b32 s76, s76, 12
    s_add_u32 m0, s78, 49152
    s_barrier
    buffer_load_dwordx4 v8, s[16:19], s76 offen offset:0 sc1 lds
    s_cmp_eq_u32 s54, 1
    s_cbranch_scc0 Lw_22
    v_lshrrev_b32 v116, 5, v1
    v_mul_u32_u24 v116, 3072, v116
    s_add_u32 s27, s79, 0
    v_add3_u32 v116, v116, v2, s27
    v_xor_b32 v117, 32, v116
    v_xor_b32 v118, 64, v116
    v_xor_b32 v119, 96, v116
    ds_read_b64_tr_b16 v[80:81], v116 offset:0
    ds_read_b64_tr_b16 v[82:83], v117 offset:0
    ds_read_b64_tr_b16 v[84:85], v118 offset:0
    ds_read_b64_tr_b16 v[86:87], v119 offset:0
    ds_read_b64_tr_b16 v[88:89], v116 offset:1024
    ds_read_b64_tr_b16 v[90:91], v117 offset:1024
    ds_read_b64_tr_b16 v[92:93], v118 offset:1024
    ds_read_b64_tr_b16 v[94:95], v119 offset:1024
    ds_read_b64_tr_b16 v[96:97], v116 offset:2048
    ds_read_b64_tr_b16 v[98:99], v117 offset:2048
    ds_read_b64_tr_b16 v[100:101], v118 offset:2048
    ds_read_b64_tr_b16 v[102:103], v119 offset:2048
Lw_22:
    buffer_load_dwordx4 v8, s[16:19], s76 offen offset:1024 sc1 lds
    s_waitcnt vmcnt(2)
    ds_read_b32 v40, v169 offset:32768
    ds_read_b32 v41, v169 offset:33792
    ds_read_b32 v42, v169 offset:34816
    ds_read_b32 v43, v169 offset:35840
    buffer_load_dwordx4 v8, s[16:19], s76 offen offset:2048 sc1 lds
    buffer_load_dwordx4 v8, s[16:19], s76 offen offset:3072 sc1 lds
    s_add_u32 m0, s79, 139264
    s_nop 0
    buffer_load_dwordx4 v12, s[4:7], s77 offen offset:0 lds
    buffer_load_dwordx4 v13, s[4:7], s77 offen offset:1024 lds
    s_waitcnt lgkmcnt(0)
    v_or3_b32 v40, v40, v41, v42
    v_bitop3_b32 v40, v40, v43, 1 bitop3:0xa8
    v_cmp_ne_u32 vcc, 0, v40
    buffer_load_dwordx4 v14, s[4:7], s77 offen offset:2048 lds
    s_cbranch_vccnz Lxrt_21
Lxok_20:
    s_add_u32 m0, s79, 142336
    s_nop 0
    buffer_load_dwordx4 v15, s[4:7], s77 offen offset:0 lds
    buffer_load_dwordx4 v16, s[4:7], s77 offen offset:1024 lds
    buffer_load_dwordx4 v17, s[4:7], s77 offen offset:2048 lds
    s_waitcnt lgkmcnt(0)
    s_add_u32 s76, s55, 4
    s_cmp_ge_u32 s76, 16
    s_addc_u32 s76, s76, s21
    s_and_b32 s76, s76, 15
    s_mul_i32 s77, s76, 393216
    s_lshl_b32 s76, s76, 12
    s_add_u32 m0, s78, 65536
    s_barrier
    buffer_load_dwordx4 v8, s[16:19], s76 offen offset:0 sc1 lds
    v_bfe_u32 v104, v1, 2, 2
    v_lshlrev_b32 v104, v104, 1
    v_bfe_i32 v120, v104, 0, 1
    v_and_b32 v120, 0x3f803f80, v120
    buffer_load_dwordx4 v8, s[16:19], s76 offen offset:1024 sc1 lds
    s_waitcnt vmcnt(8)
    ds_read_b32 v40, v169 offset:0
    ds_read_b32 v41, v169 offset:1024
    ds_read_b32 v42, v169 offset:2048
    ds_read_b32 v43, v169 offset:3072
    v_mov_b32 v121, v120
    v_bfe_i32 v122, v104, 1, 1
    v_and_b32 v122, 0x3f803f80, v122
    v_mov_b32 v123, v122
    buffer_load_dwordx4 v8, s[16:19], s76 offen offset:2048 sc1 lds
    v_bfe_i32 v124, v104, 2, 1
    v_and_b32 v124, 0x3f803f80, v124
    v_mov_b32 v125, v124
    v_bfe_i32 v126, v104, 3, 1
    buffer_load_dwordx4 v8, s[16:19], s76 offen offset:3072 sc1 lds
    v_and_b32 v126, 0x3f803f80, v126
    v_mov_b32 v127, v126
    s_waitcnt lgkmcnt(0)
    v_mfma_f32_16x16x32_bf16 v[104:107], v[120:123], v[80:83], 0
    s_add_u32 m0, s79, 0
    s_nop 0
    buffer_load_dwordx4 v12, s[4:7], s77 offen offset:0 lds
    v_mfma_f32_16x16x32_bf16 v[108:111], v[120:123], v[88:91], 0
    v_mfma_f32_16x16x32_bf16 v[112:115], v[120:123], v[96:99], 0
    v_mfma_f32_16x16x32_bf16 v[104:107], v[124:127], v[84:87], v[104:107]
    v_mfma_f32_16x16x32_bf16 v[108:111], v[124:127], v[92:95], v[108:111]
    buffer_load_dwordx4 v13, s[4:7], s77 offen offset:1024 lds
    s_waitcnt lgkmcnt(0)
    v_or3_b32 v40, v40, v41, v42
    v_bitop3_b32 v40, v40, v43, 1 bitop3:0xa8
    v_cmp_ne_u32 vcc, 0, v40
    buffer_load_dwordx4 v14, s[4:7], s77 offen offset:2048 lds
    s_cbranch_vccnz Lxrt_24
Lxok_23:
    s_add_u32 m0, s79, 3072
    s_nop 0
    buffer_load_dwordx4 v15, s[4:7], s77 offen offset:0 lds
    v_mfma_f32_16x16x32_bf16 v[112:115], v[124:127], v[100:103], v[112:115]
    s_mul_i32 s27, s75, 768
    s_add_u32 s27, s27, 133120
    v_lshl_add_u32 v116, v1, 2, s27
    buffer_load_dwordx4 v16, s[4:7], s77 offen offset:1024 lds
    ds_write_b32 v116, v104 offset:0
    ds_write_b32 v116, v108 offset:256
    s_nop 1
    ds_write_b32 v116, v112 offset:512
    s_waitcnt lgkmcnt(0)
    buffer_load_dwordx4 v17, s[4:7], s77 offen offset:2048 lds
    s_add_u32 s76, s55, 5
    s_cmp_ge_u32 s76, 16
    s_addc_u32 s76, s76, s21
    s_and_b32 s76, s76, 15
    s_mul_i32 s77, s76, 393216
    s_lshl_b32 s76, s76, 12
    s_add_u32 m0, s78, 81920
    s_waitcnt vmcnt(10)
    s_barrier
    buffer_load_dwordx4 v8, s[16:19], s76 offen offset:0 sc1 lds
    s_min_u32 s27, s75, 2
    s_lshl_b32 s27, s27, 8
    s_add_u32 s27, s27, 133120
    v_lshl_add_u32 v80, v1, 2, s27
    buffer_load_dwordx4 v8, s[16:19], s76 offen offset:1024 sc1 lds
    s_waitcnt vmcnt(8)
    ds_read_b32 v40, v169 offset:16384
    ds_read_b32 v41, v169 offset:17408
    ds_read_b32 v42, v169 offset:18432
    ds_read_b32 v43, v169 offset:19456
    ds_read_b32 v81, v80 offset:0
    ds_read_b32 v82, v80 offset:768
    ds_read_b32 v83, v80 offset:1536
    ds_read_b32 v84, v80 offset:2304
    buffer_load_dwordx4 v8, s[16:19], s76 offen offset:2048 sc1 lds
    s_lshl_b32 s27, s21, 2
    s_add_u32 s27, s27, s75
    s_mul_i32 s27, s27, 4096
    s_add_u32 s27, s27, 524288
    buffer_load_dwordx4 v8, s[16:19], s76 offen offset:3072 sc1 lds
    s_lshl_b32 s28, s20, 8
    s_add_u32 s27, s27, s28
    v_lshlrev_b32 v80, 2, v1
    s_waitcnt lgkmcnt(0)
    s_add_u32 m0, s79, 24576
    s_nop 0
    buffer_load_dwordx4 v12, s[4:7], s77 offen offset:0 lds
    v_add_f32 v81, v81, v82
    buffer_load_dwordx4 v13, s[4:7], s77 offen offset:1024 lds
    s_waitcnt lgkmcnt(0)
    v_or3_b32 v40, v40, v41, v42
    v_bitop3_b32 v40, v40, v43, 1 bitop3:0xa8
    v_cmp_ne_u32 vcc, 0, v40
    buffer_load_dwordx4 v14, s[4:7], s77 offen offset:2048 lds
    s_cbranch_vccnz Lxrt_26
Lxok_25:
    s_add_u32 m0, s79, 27648
    s_nop 0
    buffer_load_dwordx4 v15, s[4:7], s77 offen offset:0 lds
    v_add_f32 v83, v83, v84
    v_add_f32 v81, v81, v83
    buffer_store_dword v81, v80, s[12:15], s27 offen sc1
    buffer_load_dwordx4 v16, s[4:7], s77 offen offset:1024 lds
    buffer_load_dwordx4 v17, s[4:7], s77 offen offset:2048 lds
    s_add_u32 s76, s55, 6
    s_cmp_ge_u32 s76, 16
    s_addc_u32 s76, s76, s21
    s_and_b32 s76, s76, 15
    s_mul_i32 s77, s76, 393216
    s_lshl_b32 s76, s76, 12
    s_add_u32 m0, s78, 49152
    s_waitcnt vmcnt(11)
    s_barrier
    buffer_load_dwordx4 v8, s[16:19], s76 offen offset:0 sc1 lds
    v_add_u32 v45, 9, v19
    v_lshrrev_b32 v46, 4, v45
    v_lshrrev_b32 v47, 7, v18
    v_add3_u32 v45, v45, v46, v47
    buffer_load_dwordx4 v8, s[16:19], s76 offen offset:1024 sc1 lds
    s_waitcnt vmcnt(9)
    ds_read_b32 v40, v169 offset:32768
    ds_read_b32 v41, v169 offset:33792
    ds_read_b32 v42, v169 offset:34816
    ds_read_b32 v43, v169 offset:35840
    buffer_load_dwordx4 v8, s[16:19], s76 offen offset:2048 sc1 lds
    v_and_b32 v45, 15, v45
    s_mov_b32 s27, 393216
    v_mad_u32_u24 v45, v45, s27, v18
    buffer_load_dwordx4 v8, s[16:19], s76 offen offset:3072 sc1 lds
    s_add_u32 m0, s79, 139264
    s_nop 0
    buffer_load_dwordx4 v12, s[4:7], s77 offen offset:0 lds
    s_mov_b64 exec, 4095
    buffer_load_dword v255, v45, s[4:7], 0 offen
    s_mov_b64 exec, -1
    buffer_load_dwordx4 v13, s[4:7], s77 offen offset:1024 lds
    s_waitcnt lgkmcnt(0)
    v_or3_b32 v40, v40, v41, v42
    v_bitop3_b32 v40, v40, v43, 1 bitop3:0xa8
    v_cmp_ne_u32 vcc, 0, v40
    buffer_load_dwordx4 v14, s[4:7], s77 offen offset:2048 lds
    s_cbranch_vccnz Lxrt_28
Lxok_27:
    s_add_u32 m0, s79, 142336
    s_nop 0
    buffer_load_dwordx4 v15, s[4:7], s77 offen offset:0 lds
    buffer_load_dwordx4 v16, s[4:7], s77 offen offset:1024 lds
    buffer_load_dwordx4 v17, s[4:7], s77 offen offset:2048 lds
    s_add_u32 s76, s55, 7
    s_cmp_ge_u32 s76, 16
    s_addc_u32 s76, s76, s21
    s_and_b32 s76, s76, 15
    s_mul_i32 s77, s76, 393216
    s_lshl_b32 s76, s76, 12
    s_add_u32 m0, s78, 65536
    s_waitcnt vmcnt(11)
    s_barrier
    buffer_load_dwordx4 v8, s[16:19], s76 offen offset:0 sc1 lds
    buffer_load_dwordx2 v[24:25], v168, s[12:15], 0 offen offset:0 sc1
    buffer_load_dwordx4 v8, s[16:19], s76 offen offset:1024 sc1 lds
    s_waitcnt vmcnt(10)
    ds_read_b32 v40, v169 offset:0
    ds_read_b32 v41, v169 offset:1024
    ds_read_b32 v42, v169 offset:2048
    ds_read_b32 v43, v169 offset:3072
    buffer_load_dwordx4 v8, s[16:19], s76 offen offset:2048 sc1 lds
    s_lshl_b32 s27, s21, 2
    s_add_u32 s27, s27, s75
    s_mul_i32 s27, s27, 128
    s_add_u32 s27, s27, 827392
    buffer_load_dwordx4 v8, s[16:19], s76 offen offset:3072 sc1 lds
    v_and_b32 v172, 15, v1
    v_lshl_add_u32 v172, v172, 3, s27
    s_lshl_b32 s28, s20, 3
    s_add_u32 s27, s27, s28
    s_add_u32 m0, s79, 0
    s_nop 0
    buffer_load_dwordx4 v12, s[4:7], s77 offen offset:0 lds
    v_mov_b32 v46, s27
    v_mov_b32 v44, s24
    v_mov_b32 v45, s25
    buffer_load_dwordx4 v13, s[4:7], s77 offen offset:1024 lds
    s_waitcnt lgkmcnt(0)
    v_or3_b32 v40, v40, v41, v42
    v_bitop3_b32 v40, v40, v43, 1 bitop3:0xa8
    v_cmp_ne_u32 vcc, 0, v40
    buffer_load_dwordx4 v14, s[4:7], s77 offen offset:2048 lds
    s_cbranch_vccnz Lxrt_30
Lxok_29:
    s_add_u32 m0, s79, 3072
    s_nop 0
    buffer_load_dwordx4 v15, s[4:7], s77 offen offset:0 lds
    s_mov_b64 exec, 1
    buffer_store_dwordx2 v[44:45], v46, s[12:15], 0 offen offset:0 sc1
    s_mov_b64 exec, -1
    buffer_load_dwordx4 v16, s[4:7], s77 offen offset:1024 lds
    buffer_load_dwordx4 v17, s[4:7], s77 offen offset:2048 lds
    s_add_u32 s76, s55, 8
    s_cmp_ge_u32 s76, 16
    s_addc_u32 s76, s76, s21
    s_and_b32 s76, s76, 15
    s_mul_i32 s77, s76, 393216
    s_lshl_b32 s76, s76, 12
    s_add_u32 m0, s78, 81920
    s_waitcnt vmcnt(12)
    s_barrier
    buffer_load_dwordx4 v8, s[16:19], s76 offen offset:0 sc1 lds
    s_waitcnt vmcnt(11)
    v_xor_b32 v26, s24, v24
    v_xor_b32 v27, s25, v25
    v_lshrrev_b32 v27, 4, v27
    v_or_b32 v26, v26, v27
    v_cmp_ne_u32 vcc, 0, v26
    s_nop 0
    s_cbranch_vccz Lsok_33
    s_mov_b32 s26, 0
Lpoll_34:
    buffer_load_dwordx2 v[24:25], v168, s[12:15], 0 offen offset:0 sc1
    s_waitcnt vmcnt(0)
    v_xor_b32 v26, s24, v24
    v_xor_b32 v27, s25, v25
    v_lshrrev_b32 v27, 4, v27
    v_or_b32 v26, v26, v27
    v_cmp_ne_u32 vcc, 0, v26
    s_nop 0
    s_cbranch_vccz Lok_35
    s_add_u32 s26, s26, 1
    s_cmp_lt_u32 s26, 262144
    s_cbranch_scc1 Lpoll_34
Lok_35:
Lsok_33:
    buffer_load_dwordx4 v8, s[16:19], s76 offen offset:1024 sc1 lds
    s_waitcnt vmcnt(9)
    ds_read_b32 v40, v169 offset:16384
    ds_read_b32 v41, v169 offset:17408
    ds_read_b32 v42, v169 offset:18432
    ds_read_b32 v43, v169 offset:19456
    buffer_load_dwordx4 v8, s[16:19], s76 offen offset:2048 sc1 lds
    buffer_load_dwordx4 v8, s[16:19], s76 offen offset:3072 sc1 lds
    s_add_u32 m0, s79, 24576
    s_nop 0
    buffer_load_dwordx4 v12, s[4:7], s77 offen offset:0 lds
    buffer_load_dwordx4 v13, s[4:7], s77 offen offset:1024 lds
    s_waitcnt lgkmcnt(0)
    v_or3_b32 v40, v40, v41, v42
    v_bitop3_b32 v40, v40, v43, 1 bitop3:0xa8
    v_cmp_ne_u32 vcc, 0, v40
    buffer_load_dwordx4 v14, s[4:7], s77 offen offset:2048 lds
    s_cbranch_vccnz Lxrt_32
Lxok_31:
    s_add_u32 m0, s79, 27648
    s_nop 0
    buffer_load_dwordx4 v15, s[4:7], s77 offen offset:0 lds
    buffer_load_dwordx4 v16, s[4:7], s77 offen offset:1024 lds
    buffer_load_dwordx4 v17, s[4:7], s77 offen offset:2048 lds
    s_add_u32 s76, s55, 9
    s_cmp_ge_u32 s76, 16
    s_addc_u32 s76, s76, s21
    s_and_b32 s76, s76, 15
    s_mul_i32 s77, s76, 393216
    s_lshl_b32 s76, s76, 12
    s_add_u32 m0, s78, 49152
    s_waitcnt vmcnt(10)
    s_barrier
    buffer_load_dwordx4 v8, s[16:19], s76 offen offset:0 sc1 lds
    s_lshr_b32 s27, s71, 16
    s_lshl_b32 s27, s27, 12
    buffer_load_dwordx4 v[24:27], v0, s[12:15], s27 offen offset:0 sc1
    buffer_load_dwordx4 v8, s[16:19], s76 offen offset:1024 sc1 lds
    s_waitcnt vmcnt(9)
    ds_read_b32 v40, v169 offset:32768
    ds_read_b32 v41, v169 offset:33792
    ds_read_b32 v42, v169 offset:34816
    ds_read_b32 v43, v169 offset:35840
    buffer_load_dwordx4 v8, s[16:19], s76 offen offset:2048 sc1 lds
    buffer_load_dwordx4 v8, s[16:19], s76 offen offset:3072 sc1 lds
    s_add_u32 m0, s79, 139264
    s_nop 0
    buffer_load_dwordx4 v12, s[4:7], s77 offen offset:0 lds
    buffer_load_dwordx4 v13, s[4:7], s77 offen offset:1024 lds
    s_waitcnt lgkmcnt(0)
    v_or3_b32 v40, v40, v41, v42
    v_bitop3_b32 v40, v40, v43, 1 bitop3:0xa8
    v_cmp_ne_u32 vcc, 0, v40
    buffer_load_dwordx4 v14, s[4:7], s77 offen offset:2048 lds
    s_cbranch_vccnz Lxrt_37
Lxok_36:
    s_add_u32 m0, s79, 142336
    s_nop 0
    buffer_load_dwordx4 v15, s[4:7], s77 offen offset:0 lds
    buffer_load_dwordx4 v16, s[4:7], s77 offen offset:1024 lds
    buffer_load_dwordx4 v17, s[4:7], s77 offen offset:2048 lds
    s_add_u32 s76, s55, 10
    s_cmp_ge_u32 s76, 16
    s_addc_u32 s76, s76, s21
    s_and_b32 s76, s76, 15
    s_mul_i32 s77, s76, 393216
    s_lshl_b32 s76, s76, 12
    s_add_u32 m0, s78, 65536
    s_waitcnt vmcnt(11)
    s_barrier
    buffer_load_dwordx4 v8, s[16:19], s76 offen offset:0 sc1 lds
    s_lshr_b32 s27, s71, 16
    s_lshl_b32 s27, s27, 12
    buffer_load_dwordx4 v[28:31], v0, s[12:15], s27 offen offset:1024 sc1
    v_add_u32 v45, 13, v19
    v_lshrrev_b32 v46, 4, v45
    v_lshrrev_b32 v47, 7, v18
    v_add3_u32 v45, v45, v46, v47
    buffer_load_dwordx4 v8, s[16:19], s76 offen offset:1024 sc1 lds
    v_and_b32 v45, 15, v45
    s_mov_b32 s27, 393216
    v_mad_u32_u24 v45, v45, s27, v18
    buffer_load_dwordx4 v8, s[16:19], s76 offen offset:2048 sc1 lds
    s_mov_b64 exec, 4095
    buffer_load_dword v255, v45, s[4:7], 0 offen
    s_mov_b64 exec, -1
    buffer_load_dwordx4 v8, s[16:19], s76 offen offset:3072 sc1 lds
    s_lshl_b32 s27, s2, 2
    s_add_u32 s27, s27, s75
    s_add_u32 m0, s79, 0
    s_nop 0
    buffer_load_dwordx4 v12, s[4:7], s77 offen offset:0 lds
    s_mul_i32 s27, s27, 2048
    s_nop 0
    s_add_u32 s44, s58, s27
    s_addc_u32 s45, s59, 0
    buffer_load_dwordx4 v13, s[4:7], s77 offen offset:1024 lds
    s_load_dword s46, s[44:45], 0
    s_load_dword s46, s[44:45], 64
    buffer_load_dwordx4 v14, s[4:7], s77 offen offset:2048 lds
    s_load_dword s46, s[44:45], 128
    s_load_dword s46, s[44:45], 192
    s_add_u32 m0, s79, 3072
    s_nop 0
    buffer_load_dwordx4 v15, s[4:7], s77 offen offset:0 lds
    s_load_dword s46, s[44:45], 256
    s_load_dword s46, s[44:45], 320
    buffer_load_dwordx4 v16, s[4:7], s77 offen offset:1024 lds
    s_load_dword s46, s[44:45], 384
    s_load_dword s46, s[44:45], 448
    buffer_load_dwordx4 v17, s[4:7], s77 offen offset:2048 lds
    s_add_u32 s76, s55, 11
    s_cmp_ge_u32 s76, 16
    s_addc_u32 s76, s76, s21
    s_and_b32 s76, s76, 15
    s_mul_i32 s77, s76, 393216
    s_lshl_b32 s76, s76, 12
    s_add_u32 m0, s78, 81920
    s_waitcnt vmcnt(18)
    s_waitcnt vmcnt(12)
    s_barrier
    buffer_load_dwordx4 v8, s[16:19], s76 offen offset:0 sc1 lds
    s_lshr_b32 s27, s71, 16
    s_lshl_b32 s27, s27, 12
    buffer_load_dwordx4 v[32:35], v0, s[12:15], s27 offen offset:2048 sc1
    buffer_load_dwordx4 v8, s[16:19], s76 offen offset:1024 sc1 lds
    s_lshl_b32 s27, s2, 2
    s_add_u32 s27, s27, s75
    buffer_load_dwordx4 v8, s[16:19], s76 offen offset:2048 sc1 lds
    s_mul_i32 s27, s27, 2048
    s_nop 0
    buffer_load_dwordx4 v8, s[16:19], s76 offen offset:3072 sc1 lds
    s_add_u32 s44, s58, s27
    s_addc_u32 s45, s59, 0
    s_add_u32 m0, s79, 24576
    s_nop 0
    buffer_load_dwordx4 v12, s[4:7], s77 offen offset:0 lds
    s_load_dword s46, s[44:45], 512
    s_load_dword s46, s[44:45], 576
    buffer_load_dwordx4 v13, s[4:7], s77 offen offset:1024 lds
    s_load_dword s46, s[44:45], 640
    s_load_dword s46, s[44:45], 704
    buffer_load_dwordx4 v14, s[4:7], s77 offen offset:2048 lds
    s_load_dword s46, s[44:45], 768
    s_load_dword s46, s[44:45], 832
    s_add_u32 m0, s79, 27648
    s_nop 0
    buffer_load_dwordx4 v15, s[4:7], s77 offen offset:0 lds
    s_load_dword s46, s[44:45], 896
    s_load_dword s46, s[44:45], 960
    buffer_load_dwordx4 v16, s[4:7], s77 offen offset:1024 lds
    buffer_load_dwordx4 v17, s[4:7], s77 offen offset:2048 lds
    s_add_u32 s76, s55, 12
    s_cmp_ge_u32 s76, 16
    s_addc_u32 s76, s76, s21
    s_and_b32 s76, s76, 15
    s_mul_i32 s77, s76, 393216
    s_lshl_b32 s76, s76, 12
    s_add_u32 m0, s78, 49152
    s_waitcnt vmcnt(17)
    s_waitcnt vmcnt(11)
    s_barrier
    buffer_load_dwordx4 v8, s[16:19], s76 offen offset:0 sc1 lds
    buffer_load_dwordx2 v[64:65], v172, s[12:15], 0 offen offset:0 sc1
    buffer_load_dwordx4 v8, s[16:19], s76 offen offset:1024 sc1 lds
    s_lshr_b32 s27, s71, 16
    s_lshl_b32 s27, s27, 12
    buffer_load_dwordx4 v[36:39], v0, s[12:15], s27 offen offset:3072 sc1
    buffer_load_dwordx4 v8, s[16:19], s76 offen offset:2048 sc1 lds
    s_lshl_b32 s27, s2, 2
    s_add_u32 s27, s27, s75
    buffer_load_dwordx4 v8, s[16:19], s76 offen offset:3072 sc1 lds
    s_mul_i32 s27, s27, 2048
    s_nop 0
    s_add_u32 m0, s79, 139264
    s_nop 0
    buffer_load_dwordx4 v12, s[4:7], s77 offen offset:0 lds
    s_add_u32 s44, s58, s27
    s_addc_u32 s45, s59, 0
    buffer_load_dwordx4 v13, s[4:7], s77 offen offset:1024 lds
    s_load_dword s46, s[44:45], 1024
    s_load_dword s46, s[44:45], 1088
    buffer_load_dwordx4 v14, s[4:7], s77 offen offset:2048 lds
    s_load_dword s46, s[44:45], 1152
    s_load_dword s46, s[44:45], 1216
    s_add_u32 m0, s79, 142336
    s_nop 0
    buffer_load_dwordx4 v15, s[4:7], s77 offen offset:0 lds
    s_load_dword s46, s[44:45], 1280
    s_load_dword s46, s[44:45], 1344
    buffer_load_dwordx4 v16, s[4:7], s77 offen offset:1024 lds
    s_load_dword s46, s[44:45], 1408
    s_load_dword s46, s[44:45], 1472
    buffer_load_dwordx4 v17, s[4:7], s77 offen offset:2048 lds
    s_add_u32 s76, s55, 13
    s_cmp_ge_u32 s76, 16
    s_addc_u32 s76, s76, s21
    s_and_b32 s76, s76, 15
    s_mul_i32 s77, s76, 393216
    s_lshl_b32 s76, s76, 12
    s_add_u32 m0, s78, 65536
    s_waitcnt vmcnt(18)
    s_waitcnt vmcnt(12)
    s_barrier
    buffer_load_dwordx4 v8, s[16:19], s76 offen offset:0 sc1 lds
    s_lshl_b32 s27, s2, 2
    s_add_u32 s27, s27, s75
    s_mul_i32 s27, s27, 2048
    s_nop 0
    buffer_load_dwordx4 v8, s[16:19], s76 offen offset:1024 sc1 lds
    s_add_u32 s44, s58, s27
    s_addc_u32 s45, s59, 0
    buffer_load_dwordx4 v8, s[16:19], s76 offen offset:2048 sc1 lds
    s_load_dword s46, s[44:45], 1536
    s_load_dword s46, s[44:45], 1600
    s_load_dword s46, s[44:45], 1664
    s_load_dword s46, s[44:45], 1728
    buffer_load_dwordx4 v8, s[16:19], s76 offen offset:3072 sc1 lds
    s_load_dword s46, s[44:45], 1792
    s_load_dword s46, s[44:45], 1856
    s_add_u32 m0, s79, 0
    s_nop 0
    buffer_load_dwordx4 v12, s[4:7], s77 offen offset:0 lds
    s_load_dword s46, s[44:45], 1920
    s_load_dword s46, s[44:45], 1984
    s_waitcnt vmcnt(15)
    v_xor_b32 v66, s24, v64
    v_xor_b32 v67, s25, v65
    v_lshrrev_b32 v67, 4, v67
    v_or_b32 v66, v66, v67
    v_cmp_ne_u32 vcc, 0, v66
    s_nop 0
    s_cbranch_vccz Lcsok_38
    s_mov_b32 s26, 0
Lpoll_39:
    buffer_load_dwordx2 v[64:65], v172, s[12:15], 0 offen offset:0 sc1
    s_waitcnt vmcnt(0)
    v_xor_b32 v66, s24, v64
    v_xor_b32 v67, s25, v65
    v_lshrrev_b32 v67, 4, v67
    v_or_b32 v66, v66, v67
    v_cmp_ne_u32 vcc, 0, v66
    s_nop 0
    s_cbranch_vccz Lok_40
    s_add_u32 s26, s26, 1
    s_cmp_lt_u32 s26, 262144
    s_cbranch_scc1 Lpoll_39
Lok_40:
Lcsok_38:
    buffer_load_dwordx4 v13, s[4:7], s77 offen offset:1024 lds
    s_lshl_b32 s31, s21, 2
    s_add_u32 s31, s31, s75
    s_mul_i32 s31, s31, 4096
    s_add_u32 s31, s31, 524288
    buffer_load_dwordx4 v14, s[4:7], s77 offen offset:2048 lds
    buffer_load_dwordx4 v[48:51], v0, s[12:15], s31 offen offset:0 sc1
    buffer_load_dwordx4 v[52:55], v0, s[12:15], s31 offen offset:1024 sc1
    s_add_u32 m0, s79, 3072
    s_nop 0
    buffer_load_dwordx4 v15, s[4:7], s77 offen offset:0 lds
    buffer_load_dwordx4 v[56:59], v0, s[12:15], s31 offen offset:2048 sc1
    buffer_load_dwordx4 v16, s[4:7], s77 offen offset:1024 lds
    buffer_load_dwordx4 v[60:63], v0, s[12:15], s31 offen offset:3072 sc1
    buffer_load_dwordx4 v17, s[4:7], s77 offen offset:2048 lds
    s_add_u32 s76, s55, 14
    s_cmp_ge_u32 s76, 16
    s_addc_u32 s76, s76, s21
    s_and_b32 s76, s76, 15
    s_mul_i32 s77, s76, 393216
    s_lshl_b32 s76, s76, 12
    s_add_u32 m0, s78, 81920
    s_waitcnt vmcnt(20)
    s_waitcnt vmcnt(14)
    s_barrier
    buffer_load_dwordx4 v8, s[16:19], s76 offen offset:0 sc1 lds
    v_add_f32 v24, v24, v32
    v_add_f32 v25, v25, v33
    v_add_f32 v26, v26, v34
    buffer_load_dwordx4 v8, s[16:19], s76 offen offset:1024 sc1 lds
    v_add_f32 v27, v27, v35
    v_add_f32 v28, v28, v36
    v_add_f32 v29, v29, v37
    buffer_load_dwordx4 v8, s[16:19], s76 offen offset:2048 sc1 lds
    v_add_f32 v30, v30, v38
    v_add_f32 v31, v31, v39
    v_add_f32 v24, v24, v28
    buffer_load_dwordx4 v8, s[16:19], s76 offen offset:3072 sc1 lds
    v_add_f32 v25, v25, v29
    v_add_f32 v26, v26, v30
    v_add_f32 v27, v27, v31
    s_nop 0
    v_permlane32_swap_b32 v24, v26
    v_permlane32_swap_b32 v25, v27
    v_add_f32 v24, v24, v26
    s_add_u32 m0, s79, 24576
    s_nop 0
    buffer_load_dwordx4 v12, s[4:7], s77 offen offset:0 lds
    v_add_f32 v25, v25, v27
    v_mov_b32 v26, v24
    v_mov_b32 v27, v25
    buffer_load_dwordx4 v13, s[4:7], s77 offen offset:1024 lds
    s_lshr_b32 s27, s2, 3
    s_lshl_b32 s27, s27, 6
    s_lshl_b32 s28, s75, 4
    s_add_u32 s27, s27, s28
    buffer_load_dwordx4 v14, s[4:7], s77 offen offset:2048 lds
    v_add_u32 v44, s27, v1
    s_lshr_b32 s30, s8, 7
    s_sub_u32 s30, 3, s30
    s_and_b32 s30, s30, 7
    s_lshl_b32 s30, s30, 7
    v_and_b32 v45, 1, v44
    v_lshlrev_b32 v45, 10, v45
    v_lshrrev_b32 v44, 1, v44
    s_add_u32 m0, s79, 27648
    s_nop 0
    buffer_load_dwordx4 v15, s[4:7], s77 offen offset:0 lds
    v_lshlrev_b32 v44, 11, v44
    v_add3_u32 v45, v45, v44, s30
    buffer_load_dwordx4 v16, s[4:7], s77 offen offset:1024 lds
    s_mov_b64 exec, 0xffff
    buffer_load_dword v255, v45, s[8:11], 0 offen
    s_mov_b64 exec, -1
    buffer_load_dwordx4 v17, s[4:7], s77 offen offset:2048 lds
    s_add_u32 s76, s55, 15
    s_cmp_ge_u32 s76, 16
    s_addc_u32 s76, s76, s21
    s_and_b32 s76, s76, 15
    s_mul_i32 s77, s76, 393216
    s_lshl_b32 s76, s76, 12
    s_add_u32 m0, s78, 49152
    s_waitcnt vmcnt(21)
    s_waitcnt vmcnt(11)
    s_barrier
    buffer_load_dwordx4 v8, s[16:19], s76 offen offset:0 sc1 lds
    v_permlane16_swap_b32 v24, v26
    v_permlane16_swap_b32 v25, v27
    v_add_f32 v24, v24, v26
    v_add_f32 v25, v25, v27
    buffer_load_dwordx4 v8, s[16:19], s76 offen offset:1024 sc1 lds
    v_mul_f32 v24, 0xba800000, v24
    v_mul_f32 v25, 0x3a800000, v25
    v_fma_f32 v25, -v24, v24, v25
    v_max_f32 v25, 0, v25
    buffer_load_dwordx4 v8, s[16:19], s76 offen offset:2048 sc1 lds
    v_add_f32 v25, 0x3727c5ac, v25
    v_rsq_f32 v25, v25
    buffer_load_dwordx4 v8, s[16:19], s76 offen offset:3072 sc1 lds
    v_mul_f32 v24, v24, v25
    ds_write_b32 v170, v25
    ds_write_b32 v170, v24 offset:512
    s_add_u32 m0, s79, 139264
    s_nop 0
    buffer_load_dwordx4 v12, s[4:7], s77 offen offset:0 lds
    v_add_f32 v48, v48, v56
    v_add_f32 v49, v49, v57
    v_add_f32 v50, v50, v58
    buffer_load_dwordx4 v13, s[4:7], s77 offen offset:1024 lds
    v_add_f32 v51, v51, v59
    v_add_f32 v52, v52, v60
    v_add_f32 v53, v53, v61
    buffer_load_dwordx4 v14, s[4:7], s77 offen offset:2048 lds
    v_add_f32 v54, v54, v62
    v_add_f32 v55, v55, v63
    v_add_f32 v48, v48, v52
    v_add_f32 v49, v49, v53
    v_add_f32 v50, v50, v54
    v_add_f32 v51, v51, v55
    s_add_u32 m0, s79, 142336
    s_nop 0
    buffer_load_dwordx4 v15, s[4:7], s77 offen offset:0 lds
    v_permlane32_swap_b32 v48, v50
    v_permlane32_swap_b32 v49, v51
    v_add_f32 v48, v48, v50
    v_add_f32 v49, v49, v51
    s_nop 1
    v_permlane16_swap_b32 v48, v49
    v_add_f32 v21, v48, v49
    buffer_load_dwordx4 v16, s[4:7], s77 offen offset:1024 lds
    ds_write_b32 v171, v21
    buffer_load_dwordx4 v17, s[4:7], s77 offen offset:2048 lds
    s_waitcnt vmcnt(17)
    s_waitcnt vmcnt(10)
    s_barrier
    s_add_u32 m0, s85, 0
    s_add_u32 s36, s86, 0
    s_and_b32 s36, s36, 0x1fffff
    buffer_load_dwordx4 v3, s[8:11], s36 offen lds
    s_add_u32 m0, s85, 4096
    s_add_u32 s36, s86, 65536
    s_and_b32 s36, s36, 0x1fffff
    buffer_load_dwordx4 v3, s[8:11], s36 offen lds
    s_add_u32 m0, s85, 8192
    s_add_u32 s36, s86, 131072
    s_and_b32 s36, s36, 0x1fffff
    buffer_load_dwordx4 v3, s[8:11], s36 offen lds
    s_add_u32 m0, s85, 12288
    s_add_u32 s36, s86, 196608
    s_and_b32 s36, s36, 0x1fffff
    buffer_load_dwordx4 v3, s[8:11], s36 offen lds
    s_add_u32 m0, s85, 16384
    s_add_u32 s36, s86, 262144
    s_and_b32 s36, s36, 0x1fffff
    buffer_load_dwordx4 v3, s[8:11], s36 offen lds
    s_add_u32 m0, s85, 20480
    s_add_u32 s36, s86, 327680
    s_and_b32 s36, s36, 0x1fffff
    buffer_load_dwordx4 v3, s[8:11], s36 offen lds
    s_add_u32 m0, s85, 65536
    s_add_u32 s36, s86, 1048576
    s_and_b32 s36, s36, 0x1fffff
    buffer_load_dwordx4 v3, s[8:11], s36 offen lds
    s_add_u32 m0, s85, 69632
    s_add_u32 s36, s86, 1114112
    s_and_b32 s36, s36, 0x1fffff
    buffer_load_dwordx4 v3, s[8:11], s36 offen lds
    s_add_u32 m0, s85, 73728
    s_add_u32 s36, s86, 1179648
    s_and_b32 s36, s36, 0x1fffff
    buffer_load_dwordx4 v3, s[8:11], s36 offen lds
    s_add_u32 m0, s85, 77824
    s_add_u32 s36, s86, 1245184
    s_and_b32 s36, s36, 0x1fffff
    buffer_load_dwordx4 v3, s[8:11], s36 offen lds
    s_waitcnt vmcnt(16)
    s_waitcnt vmcnt(10)
    s_waitcnt lgkmcnt(0)
    s_barrier
    s_add_u32 m0, s85, 24576
    s_add_u32 s36, s86, 393216
    s_and_b32 s36, s36, 0x1fffff
    buffer_load_dwordx4 v3, s[8:11], s36 offen lds
    s_add_u32 m0, s85, 28672
    s_add_u32 s36, s86, 458752
    s_and_b32 s36, s36, 0x1fffff
    buffer_load_dwordx4 v3, s[8:11], s36 offen lds
    s_add_u32 m0, s85, 32768
    s_add_u32 s36, s86, 524288
    s_and_b32 s36, s36, 0x1fffff
    buffer_load_dwordx4 v3, s[8:11], s36 offen lds
    s_add_u32 m0, s85, 36864
    s_add_u32 s36, s86, 589824
    s_and_b32 s36, s36, 0x1fffff
    buffer_load_dwordx4 v3, s[8:11], s36 offen lds
    s_add_u32 m0, s85, 40960
    s_add_u32 s36, s86, 655360
    s_and_b32 s36, s36, 0x1fffff
    buffer_load_dwordx4 v3, s[8:11], s36 offen lds
    s_add_u32 m0, s85, 45056
    s_add_u32 s36, s86, 720896
    s_and_b32 s36, s36, 0x1fffff
    buffer_load_dwordx4 v3, s[8:11], s36 offen lds
    s_add_u32 m0, s85, 81920
    s_add_u32 s36, s86, 1310720
    s_and_b32 s36, s36, 0x1fffff
    buffer_load_dwordx4 v3, s[8:11], s36 offen lds
    s_add_u32 m0, s85, 86016
    s_add_u32 s36, s86, 1376256
    s_and_b32 s36, s36, 0x1fffff
    buffer_load_dwordx4 v3, s[8:11], s36 offen lds
    s_add_u32 m0, s85, 90112
    s_add_u32 s36, s86, 1441792
    s_and_b32 s36, s36, 0x1fffff
    buffer_load_dwordx4 v3, s[8:11], s36 offen lds
    s_add_u32 m0, s85, 94208
    s_add_u32 s36, s86, 1507328
    s_and_b32 s36, s36, 0x1fffff
    buffer_load_dwordx4 v3, s[8:11], s36 offen lds
    s_barrier
    s_add_u32 m0, s85, 49152
    s_add_u32 s36, s86, 786432
    s_and_b32 s36, s36, 0x1fffff
    buffer_load_dwordx4 v3, s[8:11], s36 offen lds
    s_add_u32 m0, s85, 53248
    s_add_u32 s36, s86, 851968
    s_and_b32 s36, s36, 0x1fffff
    buffer_load_dwordx4 v3, s[8:11], s36 offen lds
    s_add_u32 m0, s85, 57344
    s_add_u32 s36, s86, 917504
    s_and_b32 s36, s36, 0x1fffff
    buffer_load_dwordx4 v3, s[8:11], s36 offen lds
    s_add_u32 m0, s85, 61440
    s_add_u32 s36, s86, 983040
    s_and_b32 s36, s36, 0x1fffff
    buffer_load_dwordx4 v3, s[8:11], s36 offen lds
    s_add_u32 m0, s85, 98304
    s_add_u32 s36, s86, 1572864
    s_and_b32 s36, s36, 0x1fffff
    buffer_load_dwordx4 v3, s[8:11], s36 offen lds
    s_add_u32 m0, s85, 102400
    s_add_u32 s36, s86, 1638400
    s_and_b32 s36, s36, 0x1fffff
    buffer_load_dwordx4 v3, s[8:11], s36 offen lds
    s_add_u32 m0, s85, 106496
    s_add_u32 s36, s86, 1703936
    s_and_b32 s36, s36, 0x1fffff
    buffer_load_dwordx4 v3, s[8:11], s36 offen lds
    s_add_u32 m0, s85, 110592
    s_add_u32 s36, s86, 1769472
    s_and_b32 s36, s36, 0x1fffff
    buffer_load_dwordx4 v3, s[8:11], s36 offen lds
    s_add_u32 m0, s85, 114688
    s_add_u32 s36, s86, 1835008
    s_and_b32 s36, s36, 0x1fffff
    buffer_load_dwordx4 v3, s[8:11], s36 offen lds
    s_add_u32 m0, s85, 118784
    s_add_u32 s36, s86, 1900544
    s_and_b32 s36, s36, 0x1fffff
    buffer_load_dwordx4 v3, s[8:11], s36 offen lds
    s_add_u32 m0, s85, 122880
    s_add_u32 s36, s86, 1966080
    s_and_b32 s36, s36, 0x1fffff
    buffer_load_dwordx4 v3, s[8:11], s36 offen lds
    s_add_u32 m0, s85, 126976
    s_add_u32 s36, s86, 2031616
    s_and_b32 s36, s36, 0x1fffff
    buffer_load_dwordx4 v3, s[8:11], s36 offen lds
    s_waitcnt vmcnt(16)
    s_barrier
    s_mov_b32 s22, 2
    s_mov_b32 s4, s50
    s_mov_b32 s5, s51
    v_add_u32 v168, 8192, v168
    s_lshr_b32 s27, s2, 3
    s_mul_i32 s27, s27, 12
    s_mul_i32 s28, s75, 3
    s_add_u32 s27, s27, s28
    v_mul_u32_u24 v19, 21846, v1
    v_lshrrev_b32 v19, 16, v19
    v_mul_u32_u24 v24, 3, v19
    v_sub_u32 v24, v1, v24
    v_add_u32 v24, s27, v24
    s_lshr_b32 s30, s4, 7
    s_sub_u32 s30, 3, s30
    s_and_b32 s30, s30, 7
    s_lshl_b32 s30, s30, 7
    v_and_b32 v18, 1, v24
    v_lshlrev_b32 v18, 10, v18
    v_lshrrev_b32 v24, 1, v24
    v_lshlrev_b32 v24, 11, v24
    v_add3_u32 v18, v18, v24, s30
    v_bfe_u32 v24, v18, 7, 4
    v_add_u32 v19, v19, v24
    s_waitcnt vmcnt(0)
    s_barrier
    v_add_u32 v24, 0, v19
    v_and_b32 v24, 15, v24
    s_mov_b32 s27, 393216
    v_mad_u32_u24 v24, v24, s27, v18
    s_mov_b64 exec, 32767
    buffer_load_dword v255, v24, s[4:7], 0 offen
    s_mov_b64 exec, -1
    s_add_u32 s77, s21, 0
    s_and_b32 s77, s77, 15
    s_mul_i32 s77, s77, 393216
    s_add_u32 m0, s79, 139264
    s_waitcnt vmcnt(3)
    buffer_load_dwordx4 v12, s[4:7], s77 offen offset:0 lds
    s_waitcnt vmcnt(3)
    buffer_load_dwordx4 v13, s[4:7], s77 offen offset:1024 lds
    s_waitcnt vmcnt(3)
    buffer_load_dwordx4 v14, s[4:7], s77 offen offset:2048 lds
    s_add_u32 m0, s79, 142336
    s_waitcnt vmcnt(3)
    buffer_load_dwordx4 v15, s[4:7], s77 offen offset:0 lds
    s_waitcnt vmcnt(3)
    buffer_load_dwordx4 v16, s[4:7], s77 offen offset:1024 lds
    s_waitcnt vmcnt(3)
    buffer_load_dwordx4 v17, s[4:7], s77 offen offset:2048 lds
    s_add_u32 s77, s21, 1
    s_and_b32 s77, s77, 15
    s_mul_i32 s77, s77, 393216
    s_add_u32 m0, s79, 0
    s_waitcnt vmcnt(3)
    buffer_load_dwordx4 v12, s[4:7], s77 offen offset:0 lds
    s_waitcnt vmcnt(3)
    buffer_load_dwordx4 v13, s[4:7], s77 offen offset:1024 lds
    s_waitcnt vmcnt(3)
    buffer_load_dwordx4 v14, s[4:7], s77 offen offset:2048 lds
    s_add_u32 m0, s79, 3072
    s_waitcnt vmcnt(3)
    buffer_load_dwordx4 v15, s[4:7], s77 offen offset:0 lds
    s_waitcnt vmcnt(3)
    buffer_load_dwordx4 v16, s[4:7], s77 offen offset:1024 lds
    s_waitcnt vmcnt(3)
    buffer_load_dwordx4 v17, s[4:7], s77 offen offset:2048 lds
    s_mov_b32 s8, s52
    s_mov_b32 s9, s53
    s_barrier
    s_add_u32 s77, s21, 2
    s_and_b32 s77, s77, 15
    s_mul_i32 s77, s77, 393216
    s_add_u32 m0, s79, 24576
    s_waitcnt vmcnt(3)
    buffer_load_dwordx4 v12, s[4:7], s77 offen offset:0 lds
    s_waitcnt vmcnt(3)
    buffer_load_dwordx4 v13, s[4:7], s77 offen offset:1024 lds
    s_waitcnt vmcnt(3)
    buffer_load_dwordx4 v14, s[4:7], s77 offen offset:2048 lds
    s_add_u32 m0, s79, 27648
    s_waitcnt vmcnt(3)
    buffer_load_dwordx4 v15, s[4:7], s77 offen offset:0 lds
    s_waitcnt vmcnt(3)
    buffer_load_dwordx4 v16, s[4:7], s77 offen offset:1024 lds
    s_waitcnt vmcnt(3)
    buffer_load_dwordx4 v17, s[4:7], s77 offen offset:2048 lds
    s_waitcnt vmcnt(12)
    s_add_u32 s76, s21, 1
    s_and_b32 s76, s76, 15
    s_lshl_b32 s76, s76, 12
    s_barrier
    s_add_u32 m0, s78, 65536
    s_nop 0
    buffer_load_dwordx4 v8, s[16:19], s76 offen offset:0 sc1 lds
    buffer_load_dwordx4 v8, s[16:19], s76 offen offset:1024 sc1 lds
    buffer_load_dwordx4 v8, s[16:19], s76 offen offset:2048 sc1 lds
    buffer_load_dwordx4 v8, s[16:19], s76 offen offset:3072 sc1 lds
    s_add_u32 s76, s21, 2
    s_and_b32 s76, s76, 15
    s_lshl_b32 s76, s76, 12
    s_add_u32 m0, s78, 81920
    s_nop 0
    buffer_load_dwordx4 v8, s[16:19], s76 offen offset:0 sc1 lds
    v_add_u32 v45, 5, v19
    v_and_b32 v45, 15, v45
    s_mov_b32 s27, 393216
    v_mad_u32_u24 v45, v45, s27, v18
    buffer_load_dwordx4 v8, s[16:19], s76 offen offset:1024 sc1 lds
    s_mov_b64 exec, 4095
    buffer_load_dword v255, v45, s[4:7], 0 offen
    s_mov_b64 exec, -1
    buffer_load_dwordx4 v8, s[16:19], s76 offen offset:2048 sc1 lds
    buffer_load_dwordx4 v8, s[16:19], s76 offen offset:3072 sc1 lds
    s_waitcnt vmcnt(5)
    ds_read_b32 v40, v169 offset:16384
    ds_read_b32 v41, v169 offset:17408
    ds_read_b32 v42, v169 offset:18432
    ds_read_b32 v43, v169 offset:19456
    s_waitcnt lgkmcnt(0)
    v_bitop3_b32 v40, v40, v41, v42 bitop3:0x80
    v_bitop3_b32 v40, v40, v43, 1 bitop3:0x80
    v_cmp_eq_u32 vcc, 0, v40
    s_nop 0
    s_cbranch_vccnz Lxrt_42
Lxok_41:
    s_add_u32 s76, s21, 3
    s_and_b32 s76, s76, 15
    s_mul_i32 s77, s76, 393216
    s_lshl_b32 s76, s76, 12
    s_add_u32 m0, s78, 49152
    s_barrier
    buffer_load_dwordx4 v8, s[16:19], s76 offen offset:0 sc1 lds
    buffer_load_dwordx4 v8, s[16:19], s76 offen offset:1024 sc1 lds
    s_waitcnt vmcnt(2)
    ds_read_b32 v40, v169 offset:32768
    ds_read_b32 v41, v169 offset:33792
    ds_read_b32 v42, v169 offset:34816
    ds_read_b32 v43, v169 offset:35840
    buffer_load_dwordx4 v8, s[16:19], s76 offen offset:2048 sc1 lds
    buffer_load_dwordx4 v8, s[16:19], s76 offen offset:3072 sc1 lds
    s_add_u32 m0, s79, 139264
    s_nop 0
    buffer_load_dwordx4 v12, s[4:7], s77 offen offset:0 lds
    buffer_load_dwordx4 v13, s[4:7], s77 offen offset:1024 lds
    s_waitcnt lgkmcnt(0)
    v_bitop3_b32 v40, v40, v41, v42 bitop3:0x80
    v_bitop3_b32 v40, v40, v43, 1 bitop3:0x80
    v_cmp_eq_u32 vcc, 0, v40
    buffer_load_dwordx4 v14, s[4:7], s77 offen offset:2048 lds
    s_cbranch_vccnz Lxrt_44
Lxok_43:
    s_add_u32 m0, s79, 142336
    s_nop 0
    buffer_load_dwordx4 v15, s[4:7], s77 offen offset:0 lds
    buffer_load_dwordx4 v16, s[4:7], s77 offen offset:1024 lds
    buffer_load_dwordx4 v17, s[4:7], s77 offen offset:2048 lds
    s_add_u32 s76, s21, 4
    s_and_b32 s76, s76, 15
    s_mul_i32 s77, s76, 393216
    s_lshl_b32 s76, s76, 12
    s_add_u32 m0, s78, 65536
    s_barrier
    buffer_load_dwordx4 v8, s[16:19], s76 offen offset:0 sc1 lds
    buffer_load_dwordx4 v8, s[16:19], s76 offen offset:1024 sc1 lds
    s_waitcnt vmcnt(8)
    ds_read_b32 v40, v169 offset:0
    ds_read_b32 v41, v169 offset:1024
    ds_read_b32 v42, v169 offset:2048
    ds_read_b32 v43, v169 offset:3072
    buffer_load_dwordx4 v8, s[16:19], s76 offen offset:2048 sc1 lds
    buffer_load_dwordx4 v8, s[16:19], s76 offen offset:3072 sc1 lds
    s_add_u32 m0, s79, 0
    s_nop 0
    buffer_load_dwordx4 v12, s[4:7], s77 offen offset:0 lds
    buffer_load_dwordx4 v13, s[4:7], s77 offen offset:1024 lds
    s_waitcnt lgkmcnt(0)
    v_bitop3_b32 v40, v40, v41, v42 bitop3:0x80
    v_bitop3_b32 v40, v40, v43, 1 bitop3:0x80
    v_cmp_eq_u32 vcc, 0, v40
    buffer_load_dwordx4 v14, s[4:7], s77 offen offset:2048 lds
    s_cbranch_vccnz Lxrt_46
Lxok_45:
    s_add_u32 m0, s79, 3072
    s_nop 0
    buffer_load_dwordx4 v15, s[4:7], s77 offen offset:0 lds
    buffer_load_dwordx4 v16, s[4:7], s77 offen offset:1024 lds
    buffer_load_dwordx4 v17, s[4:7], s77 offen offset:2048 lds
    s_add_u32 s76, s21, 5
    s_and_b32 s76, s76, 15
    s_mul_i32 s77, s76, 393216
    s_lshl_b32 s76, s76, 12
    s_add_u32 m0, s78, 81920
    s_waitcnt vmcnt(10)
    s_barrier
    buffer_load_dwordx4 v8, s[16:19], s76 offen offset:0 sc1 lds
    buffer_load_dwordx4 v8, s[16:19], s76 offen offset:1024 sc1 lds
    s_waitcnt vmcnt(8)
    ds_read_b32 v40, v169 offset:16384
    ds_read_b32 v41, v169 offset:17408
    ds_read_b32 v42, v169 offset:18432
    ds_read_b32 v43, v169 offset:19456
    buffer_load_dwordx4 v8, s[16:19], s76 offen offset:2048 sc1 lds
    buffer_load_dwordx4 v8, s[16:19], s76 offen offset:3072 sc1 lds
    s_add_u32 m0, s79, 24576
    s_nop 0
    buffer_load_dwordx4 v12, s[4:7], s77 offen offset:0 lds
    buffer_load_dwordx4 v13, s[4:7], s77 offen offset:1024 lds
    s_waitcnt lgkmcnt(0)
    v_bitop3_b32 v40, v40, v41, v42 bitop3:0x80
    v_bitop3_b32 v40, v40, v43, 1 bitop3:0x80
    v_cmp_eq_u32 vcc, 0, v40
    buffer_load_dwordx4 v14, s[4:7], s77 offen offset:2048 lds
    s_cbranch_vccnz Lxrt_48
Lxok_47:
    s_add_u32 m0, s79, 27648
    s_nop 0
    buffer_load_dwordx4 v15, s[4:7], s77 offen offset:0 lds
    buffer_load_dwordx4 v16, s[4:7], s77 offen offset:1024 lds
    buffer_load_dwordx4 v17, s[4:7], s77 offen offset:2048 lds
    s_add_u32 s76, s21, 6
    s_and_b32 s76, s76, 15
    s_mul_i32 s77, s76, 393216
    s_lshl_b32 s76, s76, 12
    s_add_u32 m0, s78, 49152
    s_waitcnt vmcnt(10)
    s_barrier
    buffer_load_dwordx4 v8, s[16:19], s76 offen offset:0 sc1 lds
    v_add_u32 v45, 9, v19
    v_and_b32 v45, 15, v45
    s_mov_b32 s27, 393216
    v_mad_u32_u24 v45, v45, s27, v18
    buffer_load_dwordx4 v8, s[16:19], s76 offen offset:1024 sc1 lds
    s_waitcnt vmcnt(8)
    ds_read_b32 v40, v169 offset:32768
    ds_read_b32 v41, v169 offset:33792
    ds_read_b32 v42, v169 offset:34816
    ds_read_b32 v43, v169 offset:35840
    buffer_load_dwordx4 v8, s[16:19], s76 offen offset:2048 sc1 lds
    buffer_load_dwordx4 v8, s[16:19], s76 offen offset:3072 sc1 lds
    s_mov_b64 exec, 4095
    buffer_load_dword v255, v45, s[4:7], 0 offen
    s_mov_b64 exec, -1
    s_add_u32 m0, s79, 139264
    s_nop 0
    buffer_load_dwordx4 v12, s[4:7], s77 offen offset:0 lds
    buffer_load_dwordx4 v13, s[4:7], s77 offen offset:1024 lds
    s_waitcnt lgkmcnt(0)
    v_bitop3_b32 v40, v40, v41, v42 bitop3:0x80
    v_bitop3_b32 v40, v40, v43, 1 bitop3:0x80
    v_cmp_eq_u32 vcc, 0, v40
    buffer_load_dwordx4 v14, s[4:7], s77 offen offset:2048 lds
    s_cbranch_vccnz Lxrt_50
Lxok_49:
    s_add_u32 m0, s79, 142336
    s_nop 0
    buffer_load_dwordx4 v15, s[4:7], s77 offen offset:0 lds
    buffer_load_dwordx4 v16, s[4:7], s77 offen offset:1024 lds
    buffer_load_dwordx4 v17, s[4:7], s77 offen offset:2048 lds
    s_add_u32 s76, s21, 7
    s_and_b32 s76, s76, 15
    s_mul_i32 s77, s76, 393216
    s_lshl_b32 s76, s76, 12
    s_add_u32 m0, s78, 65536
    s_waitcnt vmcnt(11)
    s_barrier
    buffer_load_dwordx4 v8, s[16:19], s76 offen offset:0 sc1 lds
    buffer_load_dwordx2 v[24:25], v168, s[12:15], 0 offen offset:0 sc1
    buffer_load_dwordx4 v8, s[16:19], s76 offen offset:1024 sc1 lds
    s_waitcnt vmcnt(10)
    ds_read_b32 v40, v169 offset:0
    ds_read_b32 v41, v169 offset:1024
    ds_read_b32 v42, v169 offset:2048
    ds_read_b32 v43, v169 offset:3072
    buffer_load_dwordx4 v8, s[16:19], s76 offen offset:2048 sc1 lds
    buffer_load_dwordx4 v8, s[16:19], s76 offen offset:3072 sc1 lds
    s_add_u32 m0, s79, 0
    s_nop 0
    buffer_load_dwordx4 v12, s[4:7], s77 offen offset:0 lds
    buffer_load_dwordx4 v13, s[4:7], s77 offen offset:1024 lds
    s_waitcnt lgkmcnt(0)
    v_bitop3_b32 v40, v40, v41, v42 bitop3:0x80
    v_bitop3_b32 v40, v40, v43, 1 bitop3:0x80
    v_cmp_eq_u32 vcc, 0, v40
    buffer_load_dwordx4 v14, s[4:7], s77 offen offset:2048 lds
    s_cbranch_vccnz Lxrt_52
Lxok_51:
    s_add_u32 m0, s79, 3072
    s_nop 0
    buffer_load_dwordx4 v15, s[4:7], s77 offen offset:0 lds
    buffer_load_dwordx4 v16, s[4:7], s77 offen offset:1024 lds
    buffer_load_dwordx4 v17, s[4:7], s77 offen offset:2048 lds
    s_add_u32 s76, s21, 8
    s_and_b32 s76, s76, 15
    s_mul_i32 s77, s76, 393216
    s_lshl_b32 s76, s76, 12
    s_add_u32 m0, s78, 81920
    s_waitcnt vmcnt(11)
    s_barrier
    buffer_load_dwordx4 v8, s[16:19], s76 offen offset:0 sc1 lds
    s_waitcnt vmcnt(10)
    v_xor_b32 v26, s24, v24
    v_xor_b32 v27, s25, v25
    v_lshrrev_b32 v27, 4, v27
    v_or_b32 v26, v26, v27
    v_cmp_ne_u32 vcc, 0, v26
    s_nop 0
    s_cbranch_vccz Lsok_55
    s_mov_b32 s26, 0
Lpoll_56:
    buffer_load_dwordx2 v[24:25], v168, s[12:15], 0 offen offset:0 sc1
    s_waitcnt vmcnt(0)
    v_xor_b32 v26, s24, v24
    v_xor_b32 v27, s25, v25
    v_lshrrev_b32 v27, 4, v27
    v_or_b32 v26, v26, v27
    v_cmp_ne_u32 vcc, 0, v26
    s_nop 0
    s_cbranch_vccz Lok_57
    s_add_u32 s26, s26, 1
    s_cmp_lt_u32 s26, 262144
    s_cbranch_scc1 Lpoll_56
Lok_57:
Lsok_55:
    buffer_load_dwordx4 v8, s[16:19], s76 offen offset:1024 sc1 lds
    s_waitcnt vmcnt(8)
    ds_read_b32 v40, v169 offset:16384
    ds_read_b32 v41, v169 offset:17408
    ds_read_b32 v42, v169 offset:18432
    ds_read_b32 v43, v169 offset:19456
    buffer_load_dwordx4 v8, s[16:19], s76 offen offset:2048 sc1 lds
    buffer_load_dwordx4 v8, s[16:19], s76 offen offset:3072 sc1 lds
    s_add_u32 m0, s79, 24576
    s_nop 0
    buffer_load_dwordx4 v12, s[4:7], s77 offen offset:0 lds
    buffer_load_dwordx4 v13, s[4:7], s77 offen offset:1024 lds
    s_waitcnt lgkmcnt(0)
    v_bitop3_b32 v40, v40, v41, v42 bitop3:0x80
    v_bitop3_b32 v40, v40, v43, 1 bitop3:0x80
    v_cmp_eq_u32 vcc, 0, v40
    buffer_load_dwordx4 v14, s[4:7], s77 offen offset:2048 lds
    s_cbranch_vccnz Lxrt_54
Lxok_53:
    s_add_u32 m0, s79, 27648
    s_nop 0
    buffer_load_dwordx4 v15, s[4:7], s77 offen offset:0 lds
    buffer_load_dwordx4 v16, s[4:7], s77 offen offset:1024 lds
    buffer_load_dwordx4 v17, s[4:7], s77 offen offset:2048 lds
    s_add_u32 s76, s21, 9
    s_and_b32 s76, s76, 15
    s_mul_i32 s77, s76, 393216
    s_lshl_b32 s76, s76, 12
    s_add_u32 m0, s78, 49152
    s_waitcnt vmcnt(10)
    s_barrier
    buffer_load_dwordx4 v8, s[16:19], s76 offen offset:0 sc1 lds
    s_lshr_b32 s27, s71, 16
    s_lshl_b32 s27, s27, 12
    buffer_load_dwordx4 v[24:27], v0, s[12:15], s27 offen offset:0 sc1
    buffer_load_dwordx4 v8, s[16:19], s76 offen offset:1024 sc1 lds
    s_waitcnt vmcnt(9)
    ds_read_b32 v40, v169 offset:32768
    ds_read_b32 v41, v169 offset:33792
    ds_read_b32 v42, v169 offset:34816
    ds_read_b32 v43, v169 offset:35840
    buffer_load_dwordx4 v8, s[16:19], s76 offen offset:2048 sc1 lds
    buffer_load_dwordx4 v8, s[16:19], s76 offen offset:3072 sc1 lds
    s_add_u32 m0, s79, 139264
    s_nop 0
    buffer_load_dwordx4 v12, s[4:7], s77 offen offset:0 lds
    buffer_load_dwordx4 v13, s[4:7], s77 offen offset:1024 lds
    s_waitcnt lgkmcnt(0)
    v_bitop3_b32 v40, v40, v41, v42 bitop3:0x80
    v_bitop3_b32 v40, v40, v43, 1 bitop3:0x80
    v_cmp_eq_u32 vcc, 0, v40
    buffer_load_dwordx4 v14, s[4:7], s77 offen offset:2048 lds
    s_cbranch_vccnz Lxrt_59
Lxok_58:
    s_add_u32 m0, s79, 142336
    s_nop 0
    buffer_load_dwordx4 v15, s[4:7], s77 offen offset:0 lds
    buffer_load_dwordx4 v16, s[4:7], s77 offen offset:1024 lds
    buffer_load_dwordx4 v17, s[4:7], s77 offen offset:2048 lds
    s_add_u32 s76, s21, 10
    s_and_b32 s76, s76, 15
    s_mul_i32 s77, s76, 393216
    s_lshl_b32 s76, s76, 12
    s_add_u32 m0, s78, 65536
    s_waitcnt vmcnt(11)
    s_barrier
    buffer_load_dwordx4 v8, s[16:19], s76 offen offset:0 sc1 lds
    s_lshr_b32 s27, s71, 16
    s_lshl_b32 s27, s27, 12
    buffer_load_dwordx4 v[28:31], v0, s[12:15], s27 offen offset:1024 sc1
    buffer_load_dwordx4 v8, s[16:19], s76 offen offset:1024 sc1 lds
    buffer_load_dwordx4 v8, s[16:19], s76 offen offset:2048 sc1 lds
    buffer_load_dwordx4 v8, s[16:19], s76 offen offset:3072 sc1 lds
    v_add_u32 v45, 13, v19
    v_and_b32 v45, 15, v45
    s_mov_b32 s27, 393216
    v_mad_u32_u24 v45, v45, s27, v18
    s_add_u32 m0, s79, 0
    s_nop 0
    buffer_load_dwordx4 v12, s[4:7], s77 offen offset:0 lds
    buffer_load_dwordx4 v13, s[4:7], s77 offen offset:1024 lds
    buffer_load_dwordx4 v14, s[4:7], s77 offen offset:2048 lds
    s_mov_b64 exec, 4095
    buffer_load_dword v255, v45, s[4:7], 0 offen
    s_mov_b64 exec, -1
    s_add_u32 m0, s79, 3072
    s_nop 0
    buffer_load_dwordx4 v15, s[4:7], s77 offen offset:0 lds
    buffer_load_dwordx4 v16, s[4:7], s77 offen offset:1024 lds
    buffer_load_dwordx4 v17, s[4:7], s77 offen offset:2048 lds
    s_add_u32 s76, s21, 11
    s_and_b32 s76, s76, 15
    s_mul_i32 s77, s76, 393216
    s_lshl_b32 s76, s76, 12
    s_add_u32 m0, s78, 81920
    s_waitcnt vmcnt(18)
    s_waitcnt vmcnt(12)
    s_barrier
    buffer_load_dwordx4 v8, s[16:19], s76 offen offset:0 sc1 lds
    s_lshr_b32 s27, s71, 16
    s_lshl_b32 s27, s27, 12
    buffer_load_dwordx4 v[32:35], v0, s[12:15], s27 offen offset:2048 sc1
    buffer_load_dwordx4 v8, s[16:19], s76 offen offset:1024 sc1 lds
    buffer_load_dwordx4 v8, s[16:19], s76 offen offset:2048 sc1 lds
    buffer_load_dwordx4 v8, s[16:19], s76 offen offset:3072 sc1 lds
    s_add_u32 m0, s79, 24576
    s_nop 0
    buffer_load_dwordx4 v12, s[4:7], s77 offen offset:0 lds
    buffer_load_dwordx4 v13, s[4:7], s77 offen offset:1024 lds
    buffer_load_dwordx4 v14, s[4:7], s77 offen offset:2048 lds
    s_add_u32 m0, s79, 27648
    s_nop 0
    buffer_load_dwordx4 v15, s[4:7], s77 offen offset:0 lds
    buffer_load_dwordx4 v16, s[4:7], s77 offen offset:1024 lds
    buffer_load_dwordx4 v17, s[4:7], s77 offen offset:2048 lds
    s_add_u32 s76, s21, 12
    s_and_b32 s76, s76, 15
    s_mul_i32 s77, s76, 393216
    s_lshl_b32 s76, s76, 12
    s_add_u32 m0, s78, 49152
    s_waitcnt vmcnt(18)
    s_waitcnt vmcnt(11)
    s_barrier
    buffer_load_dwordx4 v8, s[16:19], s76 offen offset:0 sc1 lds
    s_lshr_b32 s27, s71, 16
    s_lshl_b32 s27, s27, 12
    buffer_load_dwordx4 v[36:39], v0, s[12:15], s27 offen offset:3072 sc1
    buffer_load_dwordx4 v8, s[16:19], s76 offen offset:1024 sc1 lds
    buffer_load_dwordx4 v8, s[16:19], s76 offen offset:2048 sc1 lds
    buffer_load_dwordx4 v8, s[16:19], s76 offen offset:3072 sc1 lds
    s_add_u32 m0, s79, 139264
    s_nop 0
    buffer_load_dwordx4 v12, s[4:7], s77 offen offset:0 lds
    buffer_load_dwordx4 v13, s[4:7], s77 offen offset:1024 lds
    buffer_load_dwordx4 v14, s[4:7], s77 offen offset:2048 lds
    s_add_u32 m0, s79, 142336
    s_nop 0
    buffer_load_dwordx4 v15, s[4:7], s77 offen offset:0 lds
    buffer_load_dwordx4 v16, s[4:7], s77 offen offset:1024 lds
    buffer_load_dwordx4 v17, s[4:7], s77 offen offset:2048 lds
    s_add_u32 s76, s21, 13
    s_and_b32 s76, s76, 15
    s_mul_i32 s77, s76, 393216
    s_lshl_b32 s76, s76, 12
    s_add_u32 m0, s78, 65536
    s_waitcnt vmcnt(17)
    s_waitcnt vmcnt(11)
    s_barrier
    buffer_load_dwordx4 v8, s[16:19], s76 offen offset:0 sc1 lds
    buffer_load_dwordx4 v8, s[16:19], s76 offen offset:1024 sc1 lds
    buffer_load_dwordx4 v8, s[16:19], s76 offen offset:2048 sc1 lds
    buffer_load_dwordx4 v8, s[16:19], s76 offen offset:3072 sc1 lds
    s_add_u32 m0, s79, 0
    s_nop 0
    buffer_load_dwordx4 v12, s[4:7], s77 offen offset:0 lds
    buffer_load_dwordx4 v13, s[4:7], s77 offen offset:1024 lds
    buffer_load_dwordx4 v14, s[4:7], s77 offen offset:2048 lds
    s_add_u32 m0, s79, 3072
    s_nop 0
    buffer_load_dwordx4 v15, s[4:7], s77 offen offset:0 lds
    buffer_load_dwordx4 v16, s[4:7], s77 offen offset:1024 lds
    buffer_load_dwordx4 v17, s[4:7], s77 offen offset:2048 lds
    s_add_u32 s76, s21, 14
    s_and_b32 s76, s76, 15
    s_mul_i32 s77, s76, 393216
    s_lshl_b32 s76, s76, 12
    s_add_u32 m0, s78, 81920
    s_waitcnt vmcnt(16)
    s_waitcnt vmcnt(10)
    s_barrier
    buffer_load_dwordx4 v8, s[16:19], s76 offen offset:0 sc1 lds
    v_add_f32 v24, v24, v32
    v_add_f32 v25, v25, v33
    v_add_f32 v26, v26, v34
    buffer_load_dwordx4 v8, s[16:19], s76 offen offset:1024 sc1 lds
    v_add_f32 v27, v27, v35
    v_add_f32 v28, v28, v36
    v_add_f32 v29, v29, v37
    buffer_load_dwordx4 v8, s[16:19], s76 offen offset:2048 sc1 lds
    v_add_f32 v30, v30, v38
    v_add_f32 v31, v31, v39
    v_add_f32 v24, v24, v28
    buffer_load_dwordx4 v8, s[16:19], s76 offen offset:3072 sc1 lds
    v_add_f32 v25, v25, v29
    v_add_f32 v26, v26, v30
    v_add_f32 v27, v27, v31
    s_nop 0
    v_permlane32_swap_b32 v24, v26
    v_permlane32_swap_b32 v25, v27
    v_add_f32 v24, v24, v26
    s_add_u32 m0, s79, 24576
    s_nop 0
    buffer_load_dwordx4 v12, s[4:7], s77 offen offset:0 lds
    v_add_f32 v25, v25, v27
    v_mov_b32 v26, v24
    v_mov_b32 v27, v25
    buffer_load_dwordx4 v13, s[4:7], s77 offen offset:1024 lds
    s_lshr_b32 s27, s2, 3
    s_lshl_b32 s27, s27, 6
    s_lshl_b32 s28, s75, 4
    s_add_u32 s27, s27, s28
    buffer_load_dwordx4 v14, s[4:7], s77 offen offset:2048 lds
    v_add_u32 v44, s27, v1
    s_lshr_b32 s30, s8, 7
    s_sub_u32 s30, 3, s30
    s_and_b32 s30, s30, 7
    s_lshl_b32 s30, s30, 7
    v_and_b32 v45, 1, v44
    v_lshlrev_b32 v45, 10, v45
    v_lshrrev_b32 v44, 1, v44
    s_add_u32 m0, s79, 27648
    s_nop 0
    buffer_load_dwordx4 v15, s[4:7], s77 offen offset:0 lds
    v_lshlrev_b32 v44, 11, v44
    v_add3_u32 v45, v45, v44, s30
    buffer_load_dwordx4 v16, s[4:7], s77 offen offset:1024 lds
    s_mov_b64 exec, 0xffff
    buffer_load_dword v255, v45, s[8:11], 0 offen
    s_mov_b64 exec, -1
    buffer_load_dwordx4 v17, s[4:7], s77 offen offset:2048 lds
    s_add_u32 s76, s21, 15
    s_and_b32 s76, s76, 15
    s_mul_i32 s77, s76, 393216
    s_lshl_b32 s76, s76, 12
    s_add_u32 m0, s78, 49152
    s_waitcnt vmcnt(17)
    s_waitcnt vmcnt(11)
    s_barrier
    buffer_load_dwordx4 v8, s[16:19], s76 offen offset:0 sc1 lds
    v_permlane16_swap_b32 v24, v26
    v_permlane16_swap_b32 v25, v27
    buffer_load_dwordx4 v8, s[16:19], s76 offen offset:1024 sc1 lds
    v_add_f32 v24, v24, v26
    v_add_f32 v25, v25, v27
    buffer_load_dwordx4 v8, s[16:19], s76 offen offset:2048 sc1 lds
    v_mul_f32 v24, 0xba800000, v24
    v_mul_f32 v25, 0x3a800000, v25
    buffer_load_dwordx4 v8, s[16:19], s76 offen offset:3072 sc1 lds
    v_fma_f32 v25, -v24, v24, v25
    v_max_f32 v25, 0, v25
    s_add_u32 m0, s79, 139264
    s_nop 0
    buffer_load_dwordx4 v12, s[4:7], s77 offen offset:0 lds
    buffer_load_dwordx4 v13, s[4:7], s77 offen offset:1024 lds
    v_add_f32 v25, 0x3727c5ac, v25
    v_rsq_f32 v25, v25
    buffer_load_dwordx4 v14, s[4:7], s77 offen offset:2048 lds
    v_mul_f32 v24, v24, v25
    ds_write_b32 v170, v25
    s_add_u32 m0, s79, 142336
    s_nop 0
    buffer_load_dwordx4 v15, s[4:7], s77 offen offset:0 lds
    ds_write_b32 v170, v24 offset:512
    ds_write_b32 v171, v20
    buffer_load_dwordx4 v16, s[4:7], s77 offen offset:1024 lds
    buffer_load_dwordx4 v17, s[4:7], s77 offen offset:2048 lds
    s_waitcnt vmcnt(17)
    s_waitcnt vmcnt(10)
    s_barrier
    s_add_u32 m0, s85, 0
    s_add_u32 s36, s86, 0
    s_and_b32 s36, s36, 0x1fffff
    buffer_load_dwordx4 v3, s[8:11], s36 offen lds
    s_add_u32 m0, s85, 4096
    s_add_u32 s36, s86, 65536
    s_and_b32 s36, s36, 0x1fffff
    buffer_load_dwordx4 v3, s[8:11], s36 offen lds
    s_add_u32 m0, s85, 8192
    s_add_u32 s36, s86, 131072
    s_and_b32 s36, s36, 0x1fffff
    buffer_load_dwordx4 v3, s[8:11], s36 offen lds
    s_add_u32 m0, s85, 12288
    s_add_u32 s36, s86, 196608
    s_and_b32 s36, s36, 0x1fffff
    buffer_load_dwordx4 v3, s[8:11], s36 offen lds
    s_add_u32 m0, s85, 16384
    s_add_u32 s36, s86, 262144
    s_and_b32 s36, s36, 0x1fffff
    buffer_load_dwordx4 v3, s[8:11], s36 offen lds
    s_add_u32 m0, s85, 20480
    s_add_u32 s36, s86, 327680
    s_and_b32 s36, s36, 0x1fffff
    buffer_load_dwordx4 v3, s[8:11], s36 offen lds
    s_waitcnt vmcnt(12)
    s_waitcnt vmcnt(6)
    s_waitcnt lgkmcnt(0)
    s_barrier
    s_add_u32 m0, s85, 24576
    s_add_u32 s36, s86, 393216
    s_and_b32 s36, s36, 0x1fffff
    buffer_load_dwordx4 v3, s[8:11], s36 offen lds
    s_add_u32 m0, s85, 28672
    s_add_u32 s36, s86, 458752
    s_and_b32 s36, s36, 0x1fffff
    buffer_load_dwordx4 v3, s[8:11], s36 offen lds
    s_add_u32 m0, s85, 32768
    s_add_u32 s36, s86, 524288
    s_and_b32 s36, s36, 0x1fffff
    buffer_load_dwordx4 v3, s[8:11], s36 offen lds
    s_add_u32 m0, s85, 36864
    s_add_u32 s36, s86, 589824
    s_and_b32 s36, s36, 0x1fffff
    buffer_load_dwordx4 v3, s[8:11], s36 offen lds
    s_add_u32 m0, s85, 40960
    s_add_u32 s36, s86, 655360
    s_and_b32 s36, s36, 0x1fffff
    buffer_load_dwordx4 v3, s[8:11], s36 offen lds
    s_add_u32 m0, s85, 45056
    s_add_u32 s36, s86, 720896
    s_and_b32 s36, s36, 0x1fffff
    buffer_load_dwordx4 v3, s[8:11], s36 offen lds
    s_barrier
    s_branch L_attL
L_between2:
    s_add_u32 m0, s85, 122880
    s_add_u32 s36, s86, 1966080
    s_and_b32 s36, s36, 0x1fffff
    buffer_load_dwordx4 v3, s[8:11], s36 offen lds
    s_add_u32 m0, s85, 126976
    s_add_u32 s36, s86, 2031616
    s_and_b32 s36, s36, 0x1fffff
    buffer_load_dwordx4 v3, s[8:11], s36 offen lds
    s_mov_b32 s22, 3
    s_mov_b32 s4, s56
    s_mov_b32 s5, s57
    v_add_u32 v168, 8192, v168
    s_lshr_b32 s27, s2, 3
    s_mul_i32 s27, s27, 12
    s_mul_i32 s28, s75, 3
    s_add_u32 s27, s27, s28
    v_mul_u32_u24 v19, 21846, v1
    v_lshrrev_b32 v19, 16, v19
    v_mul_u32_u24 v24, 3, v19
    v_sub_u32 v24, v1, v24
    v_add_u32 v24, s27, v24
    s_lshr_b32 s30, s4, 7
    s_sub_u32 s30, 3, s30
    s_and_b32 s30, s30, 7
    s_lshl_b32 s30, s30, 7
    v_and_b32 v18, 1, v24
    v_lshlrev_b32 v18, 10, v18
    v_lshrrev_b32 v24, 1, v24
    v_lshlrev_b32 v24, 11, v24
    v_add3_u32 v18, v18, v24, s30
    v_bfe_u32 v24, v18, 7, 4
    v_add_u32 v19, v19, v24
    v_add_u32 v24, 0, v19
    v_and_b32 v24, 15, v24
    s_mov_b32 s27, 393216
    v_mad_u32_u24 v24, v24, s27, v18
    s_mov_b64 exec, 32767
    buffer_load_dword v255, v24, s[4:7], 0 offen
    s_mov_b64 exec, -1
    s_add_u32 s77, s21, 0
    s_and_b32 s77, s77, 15
    s_mul_i32 s77, s77, 393216
    s_add_u32 m0, s79, 139264
    s_waitcnt vmcnt(2)
    buffer_load_dwordx4 v12, s[4:7], s77 offen offset:0 lds
    s_waitcnt vmcnt(2)
    buffer_load_dwordx4 v13, s[4:7], s77 offen offset:1024 lds
    s_waitcnt vmcnt(2)
    buffer_load_dwordx4 v14, s[4:7], s77 offen offset:2048 lds
    s_add_u32 m0, s79, 142336
    s_waitcnt vmcnt(2)
    buffer_load_dwordx4 v15, s[4:7], s77 offen offset:0 lds
    s_waitcnt vmcnt(2)
    buffer_load_dwordx4 v16, s[4:7], s77 offen offset:1024 lds
    s_waitcnt vmcnt(2)
    buffer_load_dwordx4 v17, s[4:7], s77 offen offset:2048 lds
    s_barrier
    s_add_u32 s77, s21, 1
    s_and_b32 s77, s77, 15
    s_mul_i32 s77, s77, 393216
    s_add_u32 m0, s79, 0
    s_waitcnt vmcnt(2)
    buffer_load_dwordx4 v12, s[4:7], s77 offen offset:0 lds
    s_waitcnt vmcnt(2)
    buffer_load_dwordx4 v13, s[4:7], s77 offen offset:1024 lds
    s_waitcnt vmcnt(2)
    buffer_load_dwordx4 v14, s[4:7], s77 offen offset:2048 lds
    s_add_u32 m0, s79, 3072
    s_waitcnt vmcnt(2)
    buffer_load_dwordx4 v15, s[4:7], s77 offen offset:0 lds
    s_waitcnt vmcnt(2)
    buffer_load_dwordx4 v16, s[4:7], s77 offen offset:1024 lds
    s_waitcnt vmcnt(2)
    buffer_load_dwordx4 v17, s[4:7], s77 offen offset:2048 lds
    s_waitcnt vmcnt(13)
    s_mov_b32 s8, s58
    s_mov_b32 s9, s59
    s_barrier
    s_add_u32 s77, s21, 2
    s_and_b32 s77, s77, 15
    s_mul_i32 s77, s77, 393216
    s_add_u32 m0, s79, 24576
    s_waitcnt vmcnt(2)
    buffer_load_dwordx4 v12, s[4:7], s77 offen offset:0 lds
    s_waitcnt vmcnt(2)
    buffer_load_dwordx4 v13, s[4:7], s77 offen offset:1024 lds
    s_waitcnt vmcnt(2)
    buffer_load_dwordx4 v14, s[4:7], s77 offen offset:2048 lds
    s_add_u32 m0, s79, 27648
    s_waitcnt vmcnt(2)
    buffer_load_dwordx4 v15, s[4:7], s77 offen offset:0 lds
    s_waitcnt vmcnt(2)
    buffer_load_dwordx4 v16, s[4:7], s77 offen offset:1024 lds
    s_waitcnt vmcnt(2)
    buffer_load_dwordx4 v17, s[4:7], s77 offen offset:2048 lds
    s_waitcnt vmcnt(12)
    s_add_u32 s76, s21, 1
    s_and_b32 s76, s76, 15
    s_lshl_b32 s76, s76, 12
    s_barrier
    s_add_u32 m0, s78, 65536
    s_nop 0
    buffer_load_dwordx4 v8, s[16:19], s76 offen offset:0 sc1 lds
    buffer_load_dwordx4 v8, s[16:19], s76 offen offset:1024 sc1 lds
    buffer_load_dwordx4 v8, s[16:19], s76 offen offset:2048 sc1 lds
    buffer_load_dwordx4 v8, s[16:19], s76 offen offset:3072 sc1 lds
    s_add_u32 s76, s21, 2
    s_and_b32 s76, s76, 15
    s_lshl_b32 s76, s76, 12
    s_add_u32 m0, s78, 81920
    s_nop 0
    buffer_load_dwordx4 v8, s[16:19], s76 offen offset:0 sc1 lds
    v_add_u32 v45, 5, v19
    v_and_b32 v45, 15, v45
    s_mov_b32 s27, 393216
    v_mad_u32_u24 v45, v45, s27, v18
    buffer_load_dwordx4 v8, s[16:19], s76 offen offset:1024 sc1 lds
    s_mov_b64 exec, 4095
    buffer_load_dword v255, v45, s[4:7], 0 offen
    s_mov_b64 exec, -1
    buffer_load_dwordx4 v8, s[16:19], s76 offen offset:2048 sc1 lds
    buffer_load_dwordx4 v8, s[16:19], s76 offen offset:3072 sc1 lds
    s_waitcnt vmcnt(5)
    ds_read_b32 v40, v169 offset:16384
    ds_read_b32 v41, v169 offset:17408
    ds_read_b32 v42, v169 offset:18432
    ds_read_b32 v43, v169 offset:19456
    s_waitcnt lgkmcnt(0)
    v_or3_b32 v40, v40, v41, v42
    v_bitop3_b32 v40, v40, v43, 1 bitop3:0xa8
    v_cmp_ne_u32 vcc, 0, v40
    s_nop 0
    s_cbranch_vccnz Lxrt_61
Lxok_60:
    s_add_u32 s76, s21, 3
    s_and_b32 s76, s76, 15
    s_mul_i32 s77, s76, 393216
    s_lshl_b32 s76, s76, 12
    s_add_u32 m0, s78, 49152
    s_barrier
    buffer_load_dwordx4 v8, s[16:19], s76 offen offset:0 sc1 lds
    buffer_load_dwordx4 v8, s[16:19], s76 offen offset:1024 sc1 lds
    s_waitcnt vmcnt(2)
    ds_read_b32 v40, v169 offset:32768
    ds_read_b32 v41, v169 offset:33792
    ds_read_b32 v42, v169 offset:34816
    ds_read_b32 v43, v169 offset:35840
    buffer_load_dwordx4 v8, s[16:19], s76 offen offset:2048 sc1 lds
    buffer_load_dwordx4 v8, s[16:19], s76 offen offset:3072 sc1 lds
    s_add_u32 m0, s79, 139264
    s_nop 0
    buffer_load_dwordx4 v12, s[4:7], s77 offen offset:0 lds
    buffer_load_dwordx4 v13, s[4:7], s77 offen offset:1024 lds
    s_waitcnt lgkmcnt(0)
    v_or3_b32 v40, v40, v41, v42
    v_bitop3_b32 v40, v40, v43, 1 bitop3:0xa8
    v_cmp_ne_u32 vcc, 0, v40
    buffer_load_dwordx4 v14, s[4:7], s77 offen offset:2048 lds
    s_cbranch_vccnz Lxrt_63
Lxok_62:
    s_add_u32 m0, s79, 142336
    s_nop 0
    buffer_load_dwordx4 v15, s[4:7], s77 offen offset:0 lds
    buffer_load_dwordx4 v16, s[4:7], s77 offen offset:1024 lds
    buffer_load_dwordx4 v17, s[4:7], s77 offen offset:2048 lds
    s_add_u32 s76, s21, 4
    s_and_b32 s76, s76, 15
    s_mul_i32 s77, s76, 393216
    s_lshl_b32 s76, s76, 12
    s_add_u32 m0, s78, 65536
    s_barrier
    buffer_load_dwordx4 v8, s[16:19], s76 offen offset:0 sc1 lds
    buffer_load_dwordx4 v8, s[16:19], s76 offen offset:1024 sc1 lds
    s_waitcnt vmcnt(8)
    ds_read_b32 v40, v169 offset:0
    ds_read_b32 v41, v169 offset:1024
    ds_read_b32 v42, v169 offset:2048
    ds_read_b32 v43, v169 offset:3072
    buffer_load_dwordx4 v8, s[16:19], s76 offen offset:2048 sc1 lds
    buffer_load_dwordx4 v8, s[16:19], s76 offen offset:3072 sc1 lds
    s_add_u32 m0, s79, 0
    s_nop 0
    buffer_load_dwordx4 v12, s[4:7], s77 offen offset:0 lds
    buffer_load_dwordx4 v13, s[4:7], s77 offen offset:1024 lds
    s_waitcnt lgkmcnt(0)
    v_or3_b32 v40, v40, v41, v42
    v_bitop3_b32 v40, v40, v43, 1 bitop3:0xa8
    v_cmp_ne_u32 vcc, 0, v40
    buffer_load_dwordx4 v14, s[4:7], s77 offen offset:2048 lds
    s_cbranch_vccnz Lxrt_65
Lxok_64:
    s_add_u32 m0, s79, 3072
    s_nop 0
    buffer_load_dwordx4 v15, s[4:7], s77 offen offset:0 lds
    buffer_load_dwordx4 v16, s[4:7], s77 offen offset:1024 lds
    buffer_load_dwordx4 v17, s[4:7], s77 offen offset:2048 lds
    s_add_u32 s76, s21, 5
    s_and_b32 s76, s76, 15
    s_mul_i32 s77, s76, 393216
    s_lshl_b32 s76, s76, 12
    s_add_u32 m0, s78, 81920
    s_waitcnt vmcnt(10)
    s_barrier
    buffer_load_dwordx4 v8, s[16:19], s76 offen offset:0 sc1 lds
    buffer_load_dwordx4 v8, s[16:19], s76 offen offset:1024 sc1 lds
    s_waitcnt vmcnt(8)
    ds_read_b32 v40, v169 offset:16384
    ds_read_b32 v41, v169 offset:17408
    ds_read_b32 v42, v169 offset:18432
    ds_read_b32 v43, v169 offset:19456
    buffer_load_dwordx4 v8, s[16:19], s76 offen offset:2048 sc1 lds
    buffer_load_dwordx4 v8, s[16:19], s76 offen offset:3072 sc1 lds
    s_add_u32 m0, s79, 24576
    s_nop 0
    buffer_load_dwordx4 v12, s[4:7], s77 offen offset:0 lds
    buffer_load_dwordx4 v13, s[4:7], s77 offen offset:1024 lds
    s_waitcnt lgkmcnt(0)
    v_or3_b32 v40, v40, v41, v42
    v_bitop3_b32 v40, v40, v43, 1 bitop3:0xa8
    v_cmp_ne_u32 vcc, 0, v40
    buffer_load_dwordx4 v14, s[4:7], s77 offen offset:2048 lds
    s_cbranch_vccnz Lxrt_67
Lxok_66:
    s_add_u32 m0, s79, 27648
    s_nop 0
    buffer_load_dwordx4 v15, s[4:7], s77 offen offset:0 lds
    buffer_load_dwordx4 v16, s[4:7], s77 offen offset:1024 lds
    buffer_load_dwordx4 v17, s[4:7], s77 offen offset:2048 lds
    s_add_u32 s76, s21, 6
    s_and_b32 s76, s76, 15
    s_mul_i32 s77, s76, 393216
    s_lshl_b32 s76, s76, 12
    s_add_u32 m0, s78, 49152
    s_waitcnt vmcnt(10)
    s_barrier
    buffer_load_dwordx4 v8, s[16:19], s76 offen offset:0 sc1 lds
    v_add_u32 v45, 9, v19
    v_and_b32 v45, 15, v45
    s_mov_b32 s27, 393216
    v_mad_u32_u24 v45, v45, s27, v18
    buffer_load_dwordx4 v8, s[16:19], s76 offen offset:1024 sc1 lds
    s_waitcnt vmcnt(8)
    ds_read_b32 v40, v169 offset:32768
    ds_read_b32 v41, v169 offset:33792
    ds_read_b32 v42, v169 offset:34816
    ds_read_b32 v43, v169 offset:35840
    buffer_load_dwordx4 v8, s[16:19], s76 offen offset:2048 sc1 lds
    buffer_load_dwordx4 v8, s[16:19], s76 offen offset:3072 sc1 lds
    s_mov_b64 exec, 4095
    buffer_load_dword v255, v45, s[4:7], 0 offen
    s_mov_b64 exec, -1
    s_add_u32 m0, s79, 139264
    s_nop 0
    buffer_load_dwordx4 v12, s[4:7], s77 offen offset:0 lds
    buffer_load_dwordx4 v13, s[4:7], s77 offen offset:1024 lds
    s_waitcnt lgkmcnt(0)
    v_or3_b32 v40, v40, v41, v42
    v_bitop3_b32 v40, v40, v43, 1 bitop3:0xa8
    v_cmp_ne_u32 vcc, 0, v40
    buffer_load_dwordx4 v14, s[4:7], s77 offen offset:2048 lds
    s_cbranch_vccnz Lxrt_69
Lxok_68:
    s_add_u32 m0, s79, 142336
    s_nop 0
    buffer_load_dwordx4 v15, s[4:7], s77 offen offset:0 lds
    buffer_load_dwordx4 v16, s[4:7], s77 offen offset:1024 lds
    buffer_load_dwordx4 v17, s[4:7], s77 offen offset:2048 lds
    s_add_u32 s76, s21, 7
    s_and_b32 s76, s76, 15
    s_mul_i32 s77, s76, 393216
    s_lshl_b32 s76, s76, 12
    s_add_u32 m0, s78, 65536
    s_waitcnt vmcnt(11)
    s_barrier
    buffer_load_dwordx4 v8, s[16:19], s76 offen offset:0 sc1 lds
    buffer_load_dwordx2 v[24:25], v168, s[12:15], 0 offen offset:0 sc1
    buffer_load_dwordx4 v8, s[16:19], s76 offen offset:1024 sc1 lds
    s_waitcnt vmcnt(10)
    ds_read_b32 v40, v169 offset:0
    ds_read_b32 v41, v169 offset:1024
    ds_read_b32 v42, v169 offset:2048
    ds_read_b32 v43, v169 offset:3072
    buffer_load_dwordx4 v8, s[16:19], s76 offen offset:2048 sc1 lds
    buffer_load_dwordx4 v8, s[16:19], s76 offen offset:3072 sc1 lds
    s_add_u32 m0, s79, 0
    s_nop 0
    buffer_load_dwordx4 v12, s[4:7], s77 offen offset:0 lds
    buffer_load_dwordx4 v13, s[4:7], s77 offen offset:1024 lds
    s_waitcnt lgkmcnt(0)
    v_or3_b32 v40, v40, v41, v42
    v_bitop3_b32 v40, v40, v43, 1 bitop3:0xa8
    v_cmp_ne_u32 vcc, 0, v40
    buffer_load_dwordx4 v14, s[4:7], s77 offen offset:2048 lds
    s_cbranch_vccnz Lxrt_71
Lxok_70:
    s_add_u32 m0, s79, 3072
    s_nop 0
    buffer_load_dwordx4 v15, s[4:7], s77 offen offset:0 lds
    buffer_load_dwordx4 v16, s[4:7], s77 offen offset:1024 lds
    buffer_load_dwordx4 v17, s[4:7], s77 offen offset:2048 lds
    s_add_u32 s76, s21, 8
    s_and_b32 s76, s76, 15
    s_mul_i32 s77, s76, 393216
    s_lshl_b32 s76, s76, 12
    s_add_u32 m0, s78, 81920
    s_waitcnt vmcnt(11)
    s_barrier
    buffer_load_dwordx4 v8, s[16:19], s76 offen offset:0 sc1 lds
    s_waitcnt vmcnt(10)
    v_xor_b32 v26, s24, v24
    v_xor_b32 v27, s25, v25
    v_lshrrev_b32 v27, 4, v27
    v_or_b32 v26, v26, v27
    v_cmp_ne_u32 vcc, 0, v26
    s_nop 0
    s_cbranch_vccz Lsok_74
    s_mov_b32 s26, 0
Lpoll_75:
    buffer_load_dwordx2 v[24:25], v168, s[12:15], 0 offen offset:0 sc1
    s_waitcnt vmcnt(0)
    v_xor_b32 v26, s24, v24
    v_xor_b32 v27, s25, v25
    v_lshrrev_b32 v27, 4, v27
    v_or_b32 v26, v26, v27
    v_cmp_ne_u32 vcc, 0, v26
    s_nop 0
    s_cbranch_vccz Lok_76
    s_add_u32 s26, s26, 1
    s_cmp_lt_u32 s26, 262144
    s_cbranch_scc1 Lpoll_75
Lok_76:
Lsok_74:
    buffer_load_dwordx4 v8, s[16:19], s76 offen offset:1024 sc1 lds
    s_waitcnt vmcnt(8)
    ds_read_b32 v40, v169 offset:16384
    ds_read_b32 v41, v169 offset:17408
    ds_read_b32 v42, v169 offset:18432
    ds_read_b32 v43, v169 offset:19456
    buffer_load_dwordx4 v8, s[16:19], s76 offen offset:2048 sc1 lds
    buffer_load_dwordx4 v8, s[16:19], s76 offen offset:3072 sc1 lds
    s_add_u32 m0, s79, 24576
    s_nop 0
    buffer_load_dwordx4 v12, s[4:7], s77 offen offset:0 lds
    buffer_load_dwordx4 v13, s[4:7], s77 offen offset:1024 lds
    s_waitcnt lgkmcnt(0)
    v_or3_b32 v40, v40, v41, v42
    v_bitop3_b32 v40, v40, v43, 1 bitop3:0xa8
    v_cmp_ne_u32 vcc, 0, v40
    buffer_load_dwordx4 v14, s[4:7], s77 offen offset:2048 lds
    s_cbranch_vccnz Lxrt_73
Lxok_72:
    s_add_u32 m0, s79, 27648
    s_nop 0
    buffer_load_dwordx4 v15, s[4:7], s77 offen offset:0 lds
    buffer_load_dwordx4 v16, s[4:7], s77 offen offset:1024 lds
    buffer_load_dwordx4 v17, s[4:7], s77 offen offset:2048 lds
    s_add_u32 s76, s21, 9
    s_and_b32 s76, s76, 15
    s_mul_i32 s77, s76, 393216
    s_lshl_b32 s76, s76, 12
    s_add_u32 m0, s78, 49152
    s_waitcnt vmcnt(10)
    s_barrier
    buffer_load_dwordx4 v8, s[16:19], s76 offen offset:0 sc1 lds
    s_lshr_b32 s27, s71, 16
    s_lshl_b32 s27, s27, 12
    buffer_load_dwordx4 v[24:27], v0, s[12:15], s27 offen offset:0 sc1
    buffer_load_dwordx4 v8, s[16:19], s76 offen offset:1024 sc1 lds
    s_waitcnt vmcnt(9)
    ds_read_b32 v40, v169 offset:32768
    ds_read_b32 v41, v169 offset:33792
    ds_read_b32 v42, v169 offset:34816
    ds_read_b32 v43, v169 offset:35840
    buffer_load_dwordx4 v8, s[16:19], s76 offen offset:2048 sc1 lds
    buffer_load_dwordx4 v8, s[16:19], s76 offen offset:3072 sc1 lds
    s_add_u32 m0, s79, 139264
    s_nop 0
    buffer_load_dwordx4 v12, s[4:7], s77 offen offset:0 lds
    buffer_load_dwordx4 v13, s[4:7], s77 offen offset:1024 lds
    s_waitcnt lgkmcnt(0)
    v_or3_b32 v40, v40, v41, v42
    v_bitop3_b32 v40, v40, v43, 1 bitop3:0xa8
    v_cmp_ne_u32 vcc, 0, v40
    buffer_load_dwordx4 v14, s[4:7], s77 offen offset:2048 lds
    s_cbranch_vccnz Lxrt_78
Lxok_77:
    s_add_u32 m0, s79, 142336
    s_nop 0
    buffer_load_dwordx4 v15, s[4:7], s77 offen offset:0 lds
    buffer_load_dwordx4 v16, s[4:7], s77 offen offset:1024 lds
    buffer_load_dwordx4 v17, s[4:7], s77 offen offset:2048 lds
    s_add_u32 s76, s21, 10
    s_and_b32 s76, s76, 15
    s_mul_i32 s77, s76, 393216
    s_lshl_b32 s76, s76, 12
    s_add_u32 m0, s78, 65536
    s_waitcnt vmcnt(11)
    s_barrier
    buffer_load_dwordx4 v8, s[16:19], s76 offen offset:0 sc1 lds
    s_lshr_b32 s27, s71, 16
    s_lshl_b32 s27, s27, 12
    buffer_load_dwordx4 v[28:31], v0, s[12:15], s27 offen offset:1024 sc1
    buffer_load_dwordx4 v8, s[16:19], s76 offen offset:1024 sc1 lds
    buffer_load_dwordx4 v8, s[16:19], s76 offen offset:2048 sc1 lds
    buffer_load_dwordx4 v8, s[16:19], s76 offen offset:3072 sc1 lds
    v_add_u32 v45, 13, v19
    v_and_b32 v45, 15, v45
    s_mov_b32 s27, 393216
    v_mad_u32_u24 v45, v45, s27, v18
    s_add_u32 m0, s79, 0
    s_nop 0
    buffer_load_dwordx4 v12, s[4:7], s77 offen offset:0 lds
    buffer_load_dwordx4 v13, s[4:7], s77 offen offset:1024 lds
    buffer_load_dwordx4 v14, s[4:7], s77 offen offset:2048 lds
    s_mov_b64 exec, 4095
    buffer_load_dword v255, v45, s[4:7], 0 offen
    s_mov_b64 exec, -1
    s_add_u32 m0, s79, 3072
    s_nop 0
    buffer_load_dwordx4 v15, s[4:7], s77 offen offset:0 lds
    buffer_load_dwordx4 v16, s[4:7], s77 offen offset:1024 lds
    buffer_load_dwordx4 v17, s[4:7], s77 offen offset:2048 lds
    s_add_u32 s76, s21, 11
    s_and_b32 s76, s76, 15
    s_mul_i32 s77, s76, 393216
    s_lshl_b32 s76, s76, 12
    s_add_u32 m0, s78, 81920
    s_waitcnt vmcnt(18)
    s_waitcnt vmcnt(12)
    s_barrier
    buffer_load_dwordx4 v8, s[16:19], s76 offen offset:0 sc1 lds
    s_lshr_b32 s27, s71, 16
    s_lshl_b32 s27, s27, 12
    buffer_load_dwordx4 v[32:35], v0, s[12:15], s27 offen offset:2048 sc1
    buffer_load_dwordx4 v8, s[16:19], s76 offen offset:1024 sc1 lds
    buffer_load_dwordx4 v8, s[16:19], s76 offen offset:2048 sc1 lds
    buffer_load_dwordx4 v8, s[16:19], s76 offen offset:3072 sc1 lds
    s_add_u32 m0, s79, 24576
    s_nop 0
    buffer_load_dwordx4 v12, s[4:7], s77 offen offset:0 lds
    buffer_load_dwordx4 v13, s[4:7], s77 offen offset:1024 lds
    buffer_load_dwordx4 v14, s[4:7], s77 offen offset:2048 lds
    s_add_u32 m0, s79, 27648
    s_nop 0
    buffer_load_dwordx4 v15, s[4:7], s77 offen offset:0 lds
    buffer_load_dwordx4 v16, s[4:7], s77 offen offset:1024 lds
    buffer_load_dwordx4 v17, s[4:7], s77 offen offset:2048 lds
    s_add_u32 s76, s21, 12
    s_and_b32 s76, s76, 15
    s_mul_i32 s77, s76, 393216
    s_lshl_b32 s76, s76, 12
    s_add_u32 m0, s78, 49152
    s_waitcnt vmcnt(18)
    s_waitcnt vmcnt(11)
    s_barrier
    buffer_load_dwordx4 v8, s[16:19], s76 offen offset:0 sc1 lds
    s_lshr_b32 s27, s71, 16
    s_lshl_b32 s27, s27, 12
    buffer_load_dwordx4 v[36:39], v0, s[12:15], s27 offen offset:3072 sc1
    buffer_load_dwordx4 v8, s[16:19], s76 offen offset:1024 sc1 lds
    buffer_load_dwordx4 v8, s[16:19], s76 offen offset:2048 sc1 lds
    buffer_load_dwordx4 v8, s[16:19], s76 offen offset:3072 sc1 lds
    s_add_u32 m0, s79, 139264
    s_nop 0
    buffer_load_dwordx4 v12, s[4:7], s77 offen offset:0 lds
    buffer_load_dwordx4 v13, s[4:7], s77 offen offset:1024 lds
    buffer_load_dwordx4 v14, s[4:7], s77 offen offset:2048 lds
    s_add_u32 m0, s79, 142336
    s_nop 0
    buffer_load_dwordx4 v15, s[4:7], s77 offen offset:0 lds
    buffer_load_dwordx4 v16, s[4:7], s77 offen offset:1024 lds
    buffer_load_dwordx4 v17, s[4:7], s77 offen offset:2048 lds
    s_add_u32 s76, s21, 13
    s_and_b32 s76, s76, 15
    s_mul_i32 s77, s76, 393216
    s_lshl_b32 s76, s76, 12
    s_add_u32 m0, s78, 65536
    s_waitcnt vmcnt(17)
    s_waitcnt vmcnt(11)
    s_barrier
    buffer_load_dwordx4 v8, s[16:19], s76 offen offset:0 sc1 lds
    buffer_load_dwordx4 v8, s[16:19], s76 offen offset:1024 sc1 lds
    buffer_load_dwordx4 v8, s[16:19], s76 offen offset:2048 sc1 lds
    buffer_load_dwordx4 v8, s[16:19], s76 offen offset:3072 sc1 lds
    s_add_u32 m0, s79, 0
    s_nop 0
    buffer_load_dwordx4 v12, s[4:7], s77 offen offset:0 lds
    buffer_load_dwordx4 v13, s[4:7], s77 offen offset:1024 lds
    buffer_load_dwordx4 v14, s[4:7], s77 offen offset:2048 lds
    s_add_u32 m0, s79, 3072
    s_nop 0
    buffer_load_dwordx4 v15, s[4:7], s77 offen offset:0 lds
    buffer_load_dwordx4 v16, s[4:7], s77 offen offset:1024 lds
    buffer_load_dwordx4 v17, s[4:7], s77 offen offset:2048 lds
    s_add_u32 s76, s21, 14
    s_and_b32 s76, s76, 15
    s_mul_i32 s77, s76, 393216
    s_lshl_b32 s76, s76, 12
    s_add_u32 m0, s78, 81920
    s_waitcnt vmcnt(16)
    s_waitcnt vmcnt(10)
    s_barrier
    buffer_load_dwordx4 v8, s[16:19], s76 offen offset:0 sc1 lds
    v_add_f32 v24, v24, v32
    v_add_f32 v25, v25, v33
    v_add_f32 v26, v26, v34
    buffer_load_dwordx4 v8, s[16:19], s76 offen offset:1024 sc1 lds
    v_add_f32 v27, v27, v35
    v_add_f32 v28, v28, v36
    v_add_f32 v29, v29, v37
    buffer_load_dwordx4 v8, s[16:19], s76 offen offset:2048 sc1 lds
    v_add_f32 v30, v30, v38
    v_add_f32 v31, v31, v39
    v_add_f32 v24, v24, v28
    buffer_load_dwordx4 v8, s[16:19], s76 offen offset:3072 sc1 lds
    v_add_f32 v25, v25, v29
    v_add_f32 v26, v26, v30
    v_add_f32 v27, v27, v31
    s_nop 0
    v_permlane32_swap_b32 v24, v26
    v_permlane32_swap_b32 v25, v27
    v_add_f32 v24, v24, v26
    s_add_u32 m0, s79, 24576
    s_nop 0
    buffer_load_dwordx4 v12, s[4:7], s77 offen offset:0 lds
    v_add_f32 v25, v25, v27
    v_mov_b32 v26, v24
    v_mov_b32 v27, v25
    buffer_load_dwordx4 v13, s[4:7], s77 offen offset:1024 lds
    s_lshr_b32 s27, s2, 3
    s_lshl_b32 s27, s27, 6
    s_lshl_b32 s28, s75, 4
    s_add_u32 s27, s27, s28
    buffer_load_dwordx4 v14, s[4:7], s77 offen offset:2048 lds
    v_add_u32 v44, s27, v1
    s_lshr_b32 s30, s8, 7
    s_sub_u32 s30, 3, s30
    s_and_b32 s30, s30, 7
    s_lshl_b32 s30, s30, 7
    v_and_b32 v45, 1, v44
    v_lshlrev_b32 v45, 10, v45
    v_lshrrev_b32 v44, 1, v44
    s_add_u32 m0, s79, 27648
    s_nop 0
    buffer_load_dwordx4 v15, s[4:7], s77 offen offset:0 lds
    v_lshlrev_b32 v44, 11, v44
    v_add3_u32 v45, v45, v44, s30
    buffer_load_dwordx4 v16, s[4:7], s77 offen offset:1024 lds
    s_mov_b64 exec, 0xffff
    buffer_load_dword v255, v45, s[8:11], 0 offen
    s_mov_b64 exec, -1
    buffer_load_dwordx4 v17, s[4:7], s77 offen offset:2048 lds
    s_add_u32 s76, s21, 15
    s_and_b32 s76, s76, 15
    s_mul_i32 s77, s76, 393216
    s_lshl_b32 s76, s76, 12
    s_add_u32 m0, s78, 49152
    s_waitcnt vmcnt(17)
    s_waitcnt vmcnt(11)
    s_barrier
    buffer_load_dwordx4 v8, s[16:19], s76 offen offset:0 sc1 lds
    v_permlane16_swap_b32 v24, v26
    v_permlane16_swap_b32 v25, v27
    buffer_load_dwordx4 v8, s[16:19], s76 offen offset:1024 sc1 lds
    v_add_f32 v24, v24, v26
    v_add_f32 v25, v25, v27
    buffer_load_dwordx4 v8, s[16:19], s76 offen offset:2048 sc1 lds
    v_mul_f32 v24, 0xba800000, v24
    v_mul_f32 v25, 0x3a800000, v25
    buffer_load_dwordx4 v8, s[16:19], s76 offen offset:3072 sc1 lds
    v_fma_f32 v25, -v24, v24, v25
    v_max_f32 v25, 0, v25
    s_add_u32 m0, s79, 139264
    s_nop 0
    buffer_load_dwordx4 v12, s[4:7], s77 offen offset:0 lds
    buffer_load_dwordx4 v13, s[4:7], s77 offen offset:1024 lds
    v_add_f32 v25, 0x3727c5ac, v25
    v_rsq_f32 v25, v25
    buffer_load_dwordx4 v14, s[4:7], s77 offen offset:2048 lds
    v_mul_f32 v24, v24, v25
    ds_write_b32 v170, v25
    s_add_u32 m0, s79, 142336
    s_nop 0
    buffer_load_dwordx4 v15, s[4:7], s77 offen offset:0 lds
    ds_write_b32 v170, v24 offset:512
    ds_write_b32 v171, v21
    buffer_load_dwordx4 v16, s[4:7], s77 offen offset:1024 lds
    buffer_load_dwordx4 v17, s[4:7], s77 offen offset:2048 lds
    s_waitcnt vmcnt(17)
    s_waitcnt vmcnt(10)
    s_barrier
    s_add_u32 m0, s85, 0
    s_add_u32 s36, s86, 0
    s_and_b32 s36, s36, 0x1fffff
    buffer_load_dwordx4 v3, s[8:11], s36 offen lds
    s_add_u32 m0, s85, 4096
    s_add_u32 s36, s86, 65536
    s_and_b32 s36, s36, 0x1fffff
    buffer_load_dwordx4 v3, s[8:11], s36 offen lds
    s_add_u32 m0, s85, 8192
    s_add_u32 s36, s86, 131072
    s_and_b32 s36, s36, 0x1fffff
    buffer_load_dwordx4 v3, s[8:11], s36 offen lds
    s_add_u32 m0, s85, 12288
    s_add_u32 s36, s86, 196608
    s_and_b32 s36, s36, 0x1fffff
    buffer_load_dwordx4 v3, s[8:11], s36 offen lds
    s_add_u32 m0, s85, 16384
    s_add_u32 s36, s86, 262144
    s_and_b32 s36, s36, 0x1fffff
    buffer_load_dwordx4 v3, s[8:11], s36 offen lds
    s_add_u32 m0, s85, 20480
    s_add_u32 s36, s86, 327680
    s_and_b32 s36, s36, 0x1fffff
    buffer_load_dwordx4 v3, s[8:11], s36 offen lds
    s_add_u32 m0, s85, 65536
    s_add_u32 s36, s86, 1048576
    s_and_b32 s36, s36, 0x1fffff
    buffer_load_dwordx4 v3, s[8:11], s36 offen lds
    s_add_u32 m0, s85, 69632
    s_add_u32 s36, s86, 1114112
    s_and_b32 s36, s36, 0x1fffff
    buffer_load_dwordx4 v3, s[8:11], s36 offen lds
    s_add_u32 m0, s85, 73728
    s_add_u32 s36, s86, 1179648
    s_and_b32 s36, s36, 0x1fffff
    buffer_load_dwordx4 v3, s[8:11], s36 offen lds
    s_add_u32 m0, s85, 77824
    s_add_u32 s36, s86, 1245184
    s_and_b32 s36, s36, 0x1fffff
    buffer_load_dwordx4 v3, s[8:11], s36 offen lds
    s_waitcnt vmcnt(16)
    s_waitcnt vmcnt(10)
    s_waitcnt lgkmcnt(0)
    s_barrier
    s_add_u32 m0, s85, 24576
    s_add_u32 s36, s86, 393216
    s_and_b32 s36, s36, 0x1fffff
    buffer_load_dwordx4 v3, s[8:11], s36 offen lds
    s_add_u32 m0, s85, 28672
    s_add_u32 s36, s86, 458752
    s_and_b32 s36, s36, 0x1fffff
    buffer_load_dwordx4 v3, s[8:11], s36 offen lds
    s_add_u32 m0, s85, 32768
    s_add_u32 s36, s86, 524288
    s_and_b32 s36, s36, 0x1fffff
    buffer_load_dwordx4 v3, s[8:11], s36 offen lds
    s_add_u32 m0, s85, 36864
    s_add_u32 s36, s86, 589824
    s_and_b32 s36, s36, 0x1fffff
    buffer_load_dwordx4 v3, s[8:11], s36 offen lds
    s_add_u32 m0, s85, 40960
    s_add_u32 s36, s86, 655360
    s_and_b32 s36, s36, 0x1fffff
    buffer_load_dwordx4 v3, s[8:11], s36 offen lds
    s_add_u32 m0, s85, 45056
    s_add_u32 s36, s86, 720896
    s_and_b32 s36, s36, 0x1fffff
    buffer_load_dwordx4 v3, s[8:11], s36 offen lds
    s_add_u32 m0, s85, 81920
    s_add_u32 s36, s86, 1310720
    s_and_b32 s36, s36, 0x1fffff
    buffer_load_dwordx4 v3, s[8:11], s36 offen lds
    s_add_u32 m0, s85, 86016
    s_add_u32 s36, s86, 1376256
    s_and_b32 s36, s36, 0x1fffff
    buffer_load_dwordx4 v3, s[8:11], s36 offen lds
    s_add_u32 m0, s85, 90112
    s_add_u32 s36, s86, 1441792
    s_and_b32 s36, s36, 0x1fffff
    buffer_load_dwordx4 v3, s[8:11], s36 offen lds
    s_add_u32 m0, s85, 94208
    s_add_u32 s36, s86, 1507328
    s_and_b32 s36, s36, 0x1fffff
    buffer_load_dwordx4 v3, s[8:11], s36 offen lds
    s_barrier
    s_add_u32 m0, s85, 49152
    s_add_u32 s36, s86, 786432
    s_and_b32 s36, s36, 0x1fffff
    buffer_load_dwordx4 v3, s[8:11], s36 offen lds
    s_add_u32 m0, s85, 53248
    s_add_u32 s36, s86, 851968
    s_and_b32 s36, s36, 0x1fffff
    buffer_load_dwordx4 v3, s[8:11], s36 offen lds
    s_add_u32 m0, s85, 57344
    s_add_u32 s36, s86, 917504
    s_and_b32 s36, s36, 0x1fffff
    buffer_load_dwordx4 v3, s[8:11], s36 offen lds
    s_add_u32 m0, s85, 61440
    s_add_u32 s36, s86, 983040
    s_and_b32 s36, s36, 0x1fffff
    buffer_load_dwordx4 v3, s[8:11], s36 offen lds
    s_add_u32 m0, s85, 98304
    s_add_u32 s36, s86, 1572864
    s_and_b32 s36, s36, 0x1fffff
    buffer_load_dwordx4 v3, s[8:11], s36 offen lds
    s_add_u32 m0, s85, 102400
    s_add_u32 s36, s86, 1638400
    s_and_b32 s36, s36, 0x1fffff
    buffer_load_dwordx4 v3, s[8:11], s36 offen lds
    s_add_u32 m0, s85, 106496
    s_add_u32 s36, s86, 1703936
    s_and_b32 s36, s36, 0x1fffff
    buffer_load_dwordx4 v3, s[8:11], s36 offen lds
    s_add_u32 m0, s85, 110592
    s_add_u32 s36, s86, 1769472
    s_and_b32 s36, s36, 0x1fffff
    buffer_load_dwordx4 v3, s[8:11], s36 offen lds
    s_add_u32 m0, s85, 114688
    s_add_u32 s36, s86, 1835008
    s_and_b32 s36, s36, 0x1fffff
    buffer_load_dwordx4 v3, s[8:11], s36 offen lds
    s_add_u32 m0, s85, 118784
    s_add_u32 s36, s86, 1900544
    s_and_b32 s36, s36, 0x1fffff
    buffer_load_dwordx4 v3, s[8:11], s36 offen lds
    s_add_u32 m0, s85, 122880
    s_add_u32 s36, s86, 1966080
    s_and_b32 s36, s36, 0x1fffff
    buffer_load_dwordx4 v3, s[8:11], s36 offen lds
    s_add_u32 m0, s85, 126976
    s_add_u32 s36, s86, 2031616
    s_and_b32 s36, s36, 0x1fffff
    buffer_load_dwordx4 v3, s[8:11], s36 offen lds
    s_waitcnt vmcnt(16)
    s_barrier
    s_waitcnt vmcnt(0)
    s_barrier
    s_barrier
    s_or_b32 s27, s2, s75
    s_cmp_lg_u32 s27, 0
    s_cbranch_scc1 L_out
    s_mov_b32 s40, s62
    s_mov_b32 s41, s63
    s_mov_b32 s42, 256
    s_mov_b32 s43, 0x00020000
    v_mov_b32 v22, 0
    s_mov_b32 s27, 0
L_dbgpoll:
    buffer_load_dword v23, v22, s[40:43], 0 offen sc1
    s_waitcnt vmcnt(0)
    v_cmp_gt_u32 vcc, 0x100, v23
    s_nop 0
    s_cbranch_vccz L_dbgok
    s_add_u32 s27, s27, 1
    s_cmp_lt_u32 s27, 262144
    s_cbranch_scc1 L_dbgpoll
L_dbgok:
    v_mov_b32 v22, 843776
    v_mov_b32 v24, s24
    v_mov_b32 v25, s25
    s_mov_b64 exec, 1
    buffer_store_dwordx2 v[24:25], v22, s[12:15], 0 offen offset:0 sc1
    s_mov_b64 exec, -1
    s_branch L_out
L_attL:
    v_mov_b32 v226, 0x3f803f80
    v_mov_b32 v227, 0x3f803f80
    v_mov_b32 v228, 0x3f803f80
    v_mov_b32 v229, 0x3f803f80
    v_mov_b32 v144, 0
    v_mov_b32 v145, 0
    v_mov_b32 v146, 0
    v_mov_b32 v147, 0
    v_mov_b32 v148, 0
    v_mov_b32 v149, 0
    v_mov_b32 v150, 0
    v_mov_b32 v151, 0
    v_mov_b32 v152, 0
    v_mov_b32 v153, 0
    v_mov_b32 v154, 0
    v_mov_b32 v155, 0
    v_mov_b32 v156, 0
    v_mov_b32 v157, 0
    v_mov_b32 v158, 0
    v_mov_b32 v159, 0
    v_mov_b32 v160, 0
    v_mov_b32 v161, 0
    v_mov_b32 v162, 0
    v_mov_b32 v163, 0
    v_mov_b32 v164, 0
    v_mov_b32 v165, 0
    v_mov_b32 v166, 0
    v_mov_b32 v167, 0
    s_lshl_b32 s27, s75, 11
    s_add_u32 s27, s27, 49152
    v_add_u32 v245, s27, v0
    s_lshl_b32 s27, s84, 1
    s_and_b32 s28, s75, 1
    s_add_u32 s27, s27, s28
    s_lshl_b32 s27, s27, 12
    s_add_u32 s27, s27, 40960
    v_add_u32 v244, s27, v0
    s_cmp_eq_u32 s84, 0
    s_cbranch_scc1 L_attA0
    s_barrier
    ds_read_b128 v[40:43], v245 offset:0
    ds_read_b128 v[48:51], v245 offset:1024
    ds_read_b128 v[72:75], v244 offset:24576
    ds_read_b128 v[80:83], v244 offset:25600
    ds_read_b128 v[100:103], v244 offset:26624
    ds_read_b128 v[116:119], v244 offset:27648
    s_waitcnt lgkmcnt(2)
    v_mfma_f32_16x16x32_bf16 v[120:123], v[72:75], v[40:43], v[222:225]
    v_mfma_f32_16x16x32_bf16 v[128:131], v[72:75], v[48:51], 0
    ds_read_b128 v[56:59], v244 offset:16384
    s_nop 5
    v_exp_f32 v120, v120
    v_mfma_f32_16x16x32_bf16 v[132:135], v[80:83], v[48:51], v[222:225]
    ds_read_b128 v[64:67], v244 offset:17408
    v_exp_f32 v121, v121
    v_mov_b32 v139, 0
    v_exp_f32 v122, v122
    v_cvt_pk_bf16_f32 v136, v120, v121
    v_exp_f32 v123, v123
    v_mov_b32 v138, 0
    v_cvt_pk_bf16_f32 v137, v122, v123
    s_waitcnt lgkmcnt(0)
    v_mfma_f32_16x16x32_bf16 v[120:123], v[56:59], v[40:43], 0
    v_exp_f32 v128, v128
    v_exp_f32 v129, v129
    v_mfma_f32_16x16x32_bf16 v[124:127], v[64:67], v[40:43], 0
    v_exp_f32 v130, v130
    v_cvt_pk_bf16_f32 v140, v128, v129
    v_mfma_f32_16x16x32_bf16 v[144:147], v[100:103], v[136:139], v[144:147]
    v_exp_f32 v131, v131
    v_exp_f32 v132, v132
    v_cvt_pk_bf16_f32 v141, v130, v131
    v_mfma_f32_16x16x32_bf16 v[148:151], v[116:119], v[136:139], v[148:151]
    ds_read_b128 v[96:99], v244 offset:18432
    v_exp_f32 v133, v133
    v_exp_f32 v134, v134
    v_cvt_pk_bf16_f32 v142, v132, v133
    v_exp_f32 v135, v135
    v_mfma_f32_16x16x32_bf16 v[160:163], v[226:229], v[136:139], v[160:163]
    ds_read_b128 v[112:115], v244 offset:19456
    v_cvt_pk_bf16_f32 v143, v134, v135
    v_mfma_f32_16x16x32_bf16 v[128:131], v[56:59], v[48:51], 0
    ds_read_b128 v[72:75], v244 offset:8192
    v_exp_f32 v120, v120
    v_exp_f32 v121, v121
    v_mfma_f32_16x16x32_bf16 v[132:135], v[64:67], v[48:51], 0
    ds_read_b128 v[80:83], v244 offset:9216
    v_exp_f32 v122, v122
    v_cvt_pk_bf16_f32 v136, v120, v121
    v_mfma_f32_16x16x32_bf16 v[152:155], v[100:103], v[140:143], v[152:155]
    v_exp_f32 v123, v123
    v_exp_f32 v124, v124
    v_cvt_pk_bf16_f32 v137, v122, v123
    v_mfma_f32_16x16x32_bf16 v[156:159], v[116:119], v[140:143], v[156:159]
    v_exp_f32 v125, v125
    v_exp_f32 v126, v126
    v_cvt_pk_bf16_f32 v138, v124, v125
    v_exp_f32 v127, v127
    v_mfma_f32_16x16x32_bf16 v[164:167], v[226:229], v[140:143], v[164:167]
    v_cvt_pk_bf16_f32 v139, v126, v127
    s_waitcnt lgkmcnt(0)
    v_mfma_f32_16x16x32_bf16 v[120:123], v[72:75], v[40:43], 0
    v_exp_f32 v128, v128
    v_exp_f32 v129, v129
    v_mfma_f32_16x16x32_bf16 v[124:127], v[80:83], v[40:43], 0
    v_exp_f32 v130, v130
    v_cvt_pk_bf16_f32 v140, v128, v129
    v_mfma_f32_16x16x32_bf16 v[144:147], v[96:99], v[136:139], v[144:147]
    v_exp_f32 v131, v131
    v_exp_f32 v132, v132
    v_cvt_pk_bf16_f32 v141, v130, v131
    v_mfma_f32_16x16x32_bf16 v[148:151], v[112:115], v[136:139], v[148:151]
    ds_read_b128 v[100:103], v244 offset:10240
    v_exp_f32 v133, v133
    v_exp_f32 v134, v134
    v_cvt_pk_bf16_f32 v142, v132, v133
    v_exp_f32 v135, v135
    v_mfma_f32_16x16x32_bf16 v[160:163], v[226:229], v[136:139], v[160:163]
    ds_read_b128 v[116:119], v244 offset:11264
    v_cvt_pk_bf16_f32 v143, v134, v135
    s_add_u32 m0, s85, 90112
    s_add_u32 s36, s86, 1441792
    s_and_b32 s36, s36, 0x1fffff
    buffer_load_dwordx4 v3, s[8:11], s36 offen lds
    s_add_u32 m0, s85, 94208
    s_add_u32 s36, s86, 1507328
    s_and_b32 s36, s36, 0x1fffff
    buffer_load_dwordx4 v3, s[8:11], s36 offen lds
    s_add_u32 m0, s85, 57344
    s_add_u32 s36, s86, 917504
    s_and_b32 s36, s36, 0x1fffff
    buffer_load_dwordx4 v3, s[8:11], s36 offen lds
    s_add_u32 m0, s85, 61440
    s_add_u32 s36, s86, 983040
    s_and_b32 s36, s36, 0x1fffff
    buffer_load_dwordx4 v3, s[8:11], s36 offen lds
    v_mfma_f32_16x16x32_bf16 v[128:131], v[72:75], v[48:51], 0
    v_exp_f32 v120, v120
    v_exp_f32 v121, v121
    v_mfma_f32_16x16x32_bf16 v[132:135], v[80:83], v[48:51], 0
    v_exp_f32 v122, v122
    v_cvt_pk_bf16_f32 v136, v120, v121
    v_mfma_f32_16x16x32_bf16 v[152:155], v[96:99], v[140:143], v[152:155]
    v_exp_f32 v123, v123
    v_exp_f32 v124, v124
    v_cvt_pk_bf16_f32 v137, v122, v123
    v_mfma_f32_16x16x32_bf16 v[156:159], v[112:115], v[140:143], v[156:159]
    v_exp_f32 v125, v125
    v_exp_f32 v126, v126
    v_cvt_pk_bf16_f32 v138, v124, v125
    v_exp_f32 v127, v127
    v_mfma_f32_16x16x32_bf16 v[164:167], v[226:229], v[140:143], v[164:167]
    v_cvt_pk_bf16_f32 v139, v126, v127
    s_waitcnt lgkmcnt(0)
    s_nop 0
    v_mfma_f32_16x16x32_bf16 v[144:147], v[100:103], v[136:139], v[144:147]
    v_exp_f32 v128, v128
    v_exp_f32 v129, v129
    v_mfma_f32_16x16x32_bf16 v[148:151], v[116:119], v[136:139], v[148:151]
    v_exp_f32 v130, v130
    v_cvt_pk_bf16_f32 v140, v128, v129
    v_mfma_f32_16x16x32_bf16 v[160:163], v[226:229], v[136:139], v[160:163]
    v_exp_f32 v131, v131
    v_exp_f32 v132, v132
    v_cvt_pk_bf16_f32 v141, v130, v131
    v_exp_f32 v133, v133
    v_exp_f32 v134, v134
    v_cvt_pk_bf16_f32 v142, v132, v133
    v_exp_f32 v135, v135
    s_nop 0
    v_cvt_pk_bf16_f32 v143, v134, v135
    s_and_b32 s27, s73, 4096
    s_add_u32 s27, s27, 98304
    v_add_u32 v244, s27, v0
    v_xor_b32 v236, 4048155338, v222
    v_xor_b32 v237, 4048155338, v223
    v_xor_b32 v238, 4048155338, v224
    v_xor_b32 v239, 4048155338, v225
    s_barrier
    ds_read_b128 v[56:59], v244 offset:0
    ds_read_b128 v[64:67], v244 offset:1024
    ds_read_b128 v[96:99], v244 offset:2048
    ds_read_b128 v[112:115], v244 offset:3072
    s_and_b32 s27, s73, 4294942719
    s_sub_u32 s27, s27, 1048576
    s_cmp_lt_u32 s20, 2
    s_cselect_b32 s27, 1073741824, s27
    v_add_u32 v245, s27, v0
    s_and_b32 s28, s73, 4096
    s_add_u32 m0, s28, 131072
    s_mov_b32 s27, 24576
    buffer_load_dwordx4 v245, s[12:15], s27 offen offset:0 sc1 lds
    buffer_load_dwordx4 v245, s[12:15], s27 offen offset:1024 sc1 lds
    buffer_load_dwordx4 v245, s[12:15], s27 offen offset:2048 sc1 lds
    buffer_load_dwordx4 v245, s[12:15], s27 offen offset:3072 sc1 lds
    s_waitcnt lgkmcnt(2)
    v_mfma_f32_16x16x32_bf16 v[120:123], v[56:59], v[40:43], 0
    v_mfma_f32_16x16x32_bf16 v[124:127], v[64:67], v[40:43], 0
    v_mfma_f32_16x16x32_bf16 v[128:131], v[56:59], v[48:51], 0
    ds_read_b128 v[72:75], v244 offset:8192
    s_nop 4
    v_exp_f32 v120, v120
    v_exp_f32 v121, v121
    v_mfma_f32_16x16x32_bf16 v[132:135], v[64:67], v[48:51], 0
    ds_read_b128 v[80:83], v244 offset:9216
    v_exp_f32 v122, v122
    v_cvt_pk_bf16_f32 v136, v120, v121
    v_mfma_f32_16x16x32_bf16 v[152:155], v[100:103], v[140:143], v[152:155]
    s_add_u32 m0, s28, 147456
    s_mov_b32 s27, 8192
    buffer_load_dwordx4 v245, s[12:15], s27 offen offset:0 sc1 lds
    v_exp_f32 v123, v123
    v_exp_f32 v124, v124
    v_cvt_pk_bf16_f32 v137, v122, v123
    v_mfma_f32_16x16x32_bf16 v[156:159], v[116:119], v[140:143], v[156:159]
    buffer_load_dwordx4 v245, s[12:15], s27 offen offset:1024 sc1 lds
    v_exp_f32 v125, v125
    v_exp_f32 v126, v126
    v_cvt_pk_bf16_f32 v138, v124, v125
    v_exp_f32 v127, v127
    v_mfma_f32_16x16x32_bf16 v[164:167], v[226:229], v[140:143], v[164:167]
    v_cvt_pk_bf16_f32 v139, v126, v127
    s_cmp_eq_u32 s20, 0
    s_cbranch_scc0 Lw_79
    v_mov_b32 v226, 0
    v_mov_b32 v227, 0
    v_mov_b32 v228, 0
    v_mov_b32 v229, 0
Lw_79:
    s_waitcnt lgkmcnt(0)
    v_mfma_f32_16x16x32_bf16 v[120:123], v[72:75], v[40:43], 0
    buffer_load_dwordx4 v245, s[12:15], s27 offen offset:2048 sc1 lds
    v_exp_f32 v128, v128
    v_exp_f32 v129, v129
    v_mfma_f32_16x16x32_bf16 v[124:127], v[80:83], v[40:43], 0
    buffer_load_dwordx4 v245, s[12:15], s27 offen offset:3072 sc1 lds
    v_exp_f32 v130, v130
    v_cvt_pk_bf16_f32 v140, v128, v129
    v_mfma_f32_16x16x32_bf16 v[144:147], v[96:99], v[136:139], v[144:147]
    v_exp_f32 v131, v131
    v_exp_f32 v132, v132
    v_cvt_pk_bf16_f32 v141, v130, v131
    v_mfma_f32_16x16x32_bf16 v[148:151], v[112:115], v[136:139], v[148:151]
    ds_read_b128 v[100:103], v244 offset:10240
    v_exp_f32 v133, v133
    v_exp_f32 v134, v134
    v_cvt_pk_bf16_f32 v142, v132, v133
    v_exp_f32 v135, v135
    v_mfma_f32_16x16x32_bf16 v[160:163], v[226:229], v[136:139], v[160:163]
    ds_read_b128 v[116:119], v244 offset:11264
    v_cvt_pk_bf16_f32 v143, v134, v135
    s_barrier
    v_mfma_f32_16x16x32_bf16 v[128:131], v[72:75], v[48:51], 0
    ds_read_b128 v[56:59], v244 offset:16384
    v_exp_f32 v120, v120
    v_exp_f32 v121, v121
    v_mfma_f32_16x16x32_bf16 v[132:135], v[80:83], v[48:51], 0
    ds_read_b128 v[64:67], v244 offset:17408
    v_exp_f32 v122, v122
    v_cvt_pk_bf16_f32 v136, v120, v121
    v_mfma_f32_16x16x32_bf16 v[152:155], v[96:99], v[140:143], v[152:155]
    s_add_u32 m0, s85, 49152
    s_add_u32 s36, s86, 786432
    s_and_b32 s36, s36, 0x1fffff
    buffer_load_dwordx4 v3, s[8:11], s36 offen lds
    v_exp_f32 v123, v123
    v_exp_f32 v124, v124
    v_cvt_pk_bf16_f32 v137, v122, v123
    v_mfma_f32_16x16x32_bf16 v[156:159], v[112:115], v[140:143], v[156:159]
    s_add_u32 m0, s85, 53248
    s_add_u32 s36, s86, 851968
    s_and_b32 s36, s36, 0x1fffff
    buffer_load_dwordx4 v3, s[8:11], s36 offen lds
    v_exp_f32 v125, v125
    v_exp_f32 v126, v126
    v_cvt_pk_bf16_f32 v138, v124, v125
    v_exp_f32 v127, v127
    v_mfma_f32_16x16x32_bf16 v[164:167], v[226:229], v[140:143], v[164:167]
    s_add_u32 m0, s85, 65536
    s_add_u32 s36, s86, 1048576
    s_and_b32 s36, s36, 0x1fffff
    buffer_load_dwordx4 v3, s[8:11], s36 offen lds
    v_cvt_pk_bf16_f32 v139, v126, v127
    s_waitcnt lgkmcnt(0)
    v_mfma_f32_16x16x32_bf16 v[120:123], v[56:59], v[40:43], 0
    s_add_u32 m0, s85, 69632
    s_add_u32 s36, s86, 1114112
    s_and_b32 s36, s36, 0x1fffff
    buffer_load_dwordx4 v3, s[8:11], s36 offen lds
    v_exp_f32 v128, v128
    v_exp_f32 v129, v129
    v_mfma_f32_16x16x32_bf16 v[124:127], v[64:67], v[40:43], 0
    s_add_u32 m0, s85, 73728
    s_add_u32 s36, s86, 1179648
    s_and_b32 s36, s36, 0x1fffff
    buffer_load_dwordx4 v3, s[8:11], s36 offen lds
    v_exp_f32 v130, v130
    v_cvt_pk_bf16_f32 v140, v128, v129
    v_mfma_f32_16x16x32_bf16 v[144:147], v[100:103], v[136:139], v[144:147]
    v_exp_f32 v131, v131
    v_exp_f32 v132, v132
    v_cvt_pk_bf16_f32 v141, v130, v131
    v_mfma_f32_16x16x32_bf16 v[148:151], v[116:119], v[136:139], v[148:151]
    ds_read_b128 v[96:99], v244 offset:18432
    v_exp_f32 v133, v133
    v_exp_f32 v134, v134
    v_cvt_pk_bf16_f32 v142, v132, v133
    v_exp_f32 v135, v135
    v_mfma_f32_16x16x32_bf16 v[160:163], v[226:229], v[136:139], v[160:163]
    ds_read_b128 v[112:115], v244 offset:19456
    v_cvt_pk_bf16_f32 v143, v134, v135
    v_mfma_f32_16x16x32_bf16 v[128:131], v[56:59], v[48:51], 0
    ds_read_b128 v[72:75], v244 offset:24576
    v_exp_f32 v120, v120
    v_exp_f32 v121, v121
    v_mfma_f32_16x16x32_bf16 v[132:135], v[64:67], v[48:51], 0
    ds_read_b128 v[80:83], v244 offset:25600
    v_exp_f32 v122, v122
    v_cvt_pk_bf16_f32 v136, v120, v121
    v_mfma_f32_16x16x32_bf16 v[152:155], v[100:103], v[140:143], v[152:155]
    s_add_u32 m0, s85, 77824
    s_add_u32 s36, s86, 1245184
    s_and_b32 s36, s36, 0x1fffff
    buffer_load_dwordx4 v3, s[8:11], s36 offen lds
    v_exp_f32 v123, v123
    v_exp_f32 v124, v124
    v_cvt_pk_bf16_f32 v137, v122, v123
    v_mfma_f32_16x16x32_bf16 v[156:159], v[116:119], v[140:143], v[156:159]
    s_add_u32 m0, s85, 81920
    s_add_u32 s36, s86, 1310720
    s_and_b32 s36, s36, 0x1fffff
    buffer_load_dwordx4 v3, s[8:11], s36 offen lds
    v_exp_f32 v125, v125
    v_exp_f32 v126, v126
    v_cvt_pk_bf16_f32 v138, v124, v125
    v_exp_f32 v127, v127
    v_mfma_f32_16x16x32_bf16 v[164:167], v[226:229], v[140:143], v[164:167]
    s_add_u32 m0, s85, 86016
    s_add_u32 s36, s86, 1376256
    s_and_b32 s36, s36, 0x1fffff
    buffer_load_dwordx4 v3, s[8:11], s36 offen lds
    v_cvt_pk_bf16_f32 v139, v126, v127
    s_waitcnt lgkmcnt(0)
    v_mfma_f32_16x16x32_bf16 v[120:123], v[72:75], v[40:43], 0
    s_add_u32 m0, s85, 98304
    s_add_u32 s36, s86, 1572864
    s_and_b32 s36, s36, 0x1fffff
    buffer_load_dwordx4 v3, s[8:11], s36 offen lds
    v_exp_f32 v128, v128
    v_exp_f32 v129, v129
    v_mfma_f32_16x16x32_bf16 v[124:127], v[80:83], v[40:43], 0
    s_add_u32 m0, s85, 102400
    s_add_u32 s36, s86, 1638400
    s_and_b32 s36, s36, 0x1fffff
    buffer_load_dwordx4 v3, s[8:11], s36 offen lds
    v_exp_f32 v130, v130
    v_cvt_pk_bf16_f32 v140, v128, v129
    v_mfma_f32_16x16x32_bf16 v[144:147], v[96:99], v[136:139], v[144:147]
    v_exp_f32 v131, v131
    v_exp_f32 v132, v132
    v_cvt_pk_bf16_f32 v141, v130, v131
    v_mfma_f32_16x16x32_bf16 v[148:151], v[112:115], v[136:139], v[148:151]
    ds_read_b128 v[100:103], v244 offset:26624
    v_exp_f32 v133, v133
    v_exp_f32 v134, v134
    v_cvt_pk_bf16_f32 v142, v132, v133
    v_exp_f32 v135, v135
    v_mfma_f32_16x16x32_bf16 v[160:163], v[226:229], v[136:139], v[160:163]
    ds_read_b128 v[116:119], v244 offset:27648
    v_cvt_pk_bf16_f32 v143, v134, v135
    s_waitcnt vmcnt(10)
    s_barrier
    v_mfma_f32_16x16x32_bf16 v[128:131], v[72:75], v[48:51], 0
    ds_read_b128 v[56:59], v244 offset:32768
    v_exp_f32 v120, v120
    v_exp_f32 v121, v121
    v_mfma_f32_16x16x32_bf16 v[132:135], v[80:83], v[48:51], 0
    ds_read_b128 v[64:67], v244 offset:33792
    v_exp_f32 v122, v122
    v_cvt_pk_bf16_f32 v136, v120, v121
    v_mfma_f32_16x16x32_bf16 v[152:155], v[96:99], v[140:143], v[152:155]
    s_add_u32 m0, s85, 106496
    s_add_u32 s36, s86, 1703936
    s_and_b32 s36, s36, 0x1fffff
    buffer_load_dwordx4 v3, s[8:11], s36 offen lds
    v_exp_f32 v123, v123
    v_exp_f32 v124, v124
    v_cvt_pk_bf16_f32 v137, v122, v123
    v_mfma_f32_16x16x32_bf16 v[156:159], v[112:115], v[140:143], v[156:159]
    s_add_u32 m0, s85, 110592
    s_add_u32 s36, s86, 1769472
    s_and_b32 s36, s36, 0x1fffff
    buffer_load_dwordx4 v3, s[8:11], s36 offen lds
    v_exp_f32 v125, v125
    v_exp_f32 v126, v126
    v_cvt_pk_bf16_f32 v138, v124, v125
    v_exp_f32 v127, v127
    v_mfma_f32_16x16x32_bf16 v[164:167], v[226:229], v[140:143], v[164:167]
    v_cvt_pk_bf16_f32 v139, v126, v127
    s_waitcnt lgkmcnt(0)
    v_mfma_f32_16x16x32_bf16 v[120:123], v[56:59], v[40:43], 0
    s_add_u32 m0, s85, 114688
    s_add_u32 s36, s86, 1835008
    s_and_b32 s36, s36, 0x1fffff
    buffer_load_dwordx4 v3, s[8:11], s36 offen lds
    v_exp_f32 v128, v128
    v_exp_f32 v129, v129
    v_mfma_f32_16x16x32_bf16 v[124:127], v[64:67], v[40:43], 0
    v_exp_f32 v130, v130
    v_cvt_pk_bf16_f32 v140, v128, v129
    v_mfma_f32_16x16x32_bf16 v[144:147], v[100:103], v[136:139], v[144:147]
    v_exp_f32 v131, v131
    v_exp_f32 v132, v132
    v_cvt_pk_bf16_f32 v141, v130, v131
    v_mfma_f32_16x16x32_bf16 v[148:151], v[116:119], v[136:139], v[148:151]
    ds_read_b128 v[96:99], v244 offset:34816
    v_exp_f32 v133, v133
    v_exp_f32 v134, v134
    v_cvt_pk_bf16_f32 v142, v132, v133
    v_exp_f32 v135, v135
    v_mfma_f32_16x16x32_bf16 v[160:163], v[226:229], v[136:139], v[160:163]
    ds_read_b128 v[112:115], v244 offset:35840
    v_cvt_pk_bf16_f32 v143, v134, v135
    v_mfma_f32_16x16x32_bf16 v[128:131], v[56:59], v[48:51], 0
    ds_read_b128 v[72:75], v244 offset:40960
    v_exp_f32 v120, v120
    v_exp_f32 v121, v121
    v_mfma_f32_16x16x32_bf16 v[132:135], v[64:67], v[48:51], 0
    ds_read_b128 v[80:83], v244 offset:41984
    v_exp_f32 v122, v122
    v_cvt_pk_bf16_f32 v136, v120, v121
    v_mfma_f32_16x16x32_bf16 v[152:155], v[100:103], v[140:143], v[152:155]
    s_add_u32 m0, s85, 118784
    s_add_u32 s36, s86, 1900544
    s_and_b32 s36, s36, 0x1fffff
    buffer_load_dwordx4 v3, s[8:11], s36 offen lds
    v_exp_f32 v123, v123
    v_exp_f32 v124, v124
    v_cvt_pk_bf16_f32 v137, v122, v123
    v_mfma_f32_16x16x32_bf16 v[156:159], v[116:119], v[140:143], v[156:159]
    v_exp_f32 v125, v125
    v_exp_f32 v126, v126
    v_cvt_pk_bf16_f32 v138, v124, v125
    v_exp_f32 v127, v127
    v_mfma_f32_16x16x32_bf16 v[164:167], v[226:229], v[140:143], v[164:167]
    v_cvt_pk_bf16_f32 v139, v126, v127
    s_cmp_eq_u32 s20, 1
    s_cbranch_scc0 Lw_80
    v_mov_b32 v226, 0
    v_mov_b32 v227, 0
    v_mov_b32 v228, 0
    v_mov_b32 v229, 0
Lw_80:
    s_waitcnt lgkmcnt(0)
    v_mfma_f32_16x16x32_bf16 v[120:123], v[72:75], v[40:43], v[236:239]
    v_exp_f32 v128, v128
    v_exp_f32 v129, v129
    v_mfma_f32_16x16x32_bf16 v[124:127], v[80:83], v[40:43], 0
    v_exp_f32 v130, v130
    v_cvt_pk_bf16_f32 v140, v128, v129
    v_mfma_f32_16x16x32_bf16 v[144:147], v[96:99], v[136:139], v[144:147]
    v_exp_f32 v131, v131
    v_exp_f32 v132, v132
    v_cvt_pk_bf16_f32 v141, v130, v131
    v_mfma_f32_16x16x32_bf16 v[148:151], v[112:115], v[136:139], v[148:151]
    ds_read_b128 v[100:103], v244 offset:43008
    v_exp_f32 v133, v133
    v_exp_f32 v134, v134
    v_cvt_pk_bf16_f32 v142, v132, v133
    v_exp_f32 v135, v135
    v_mfma_f32_16x16x32_bf16 v[160:163], v[226:229], v[136:139], v[160:163]
    ds_read_b128 v[116:119], v244 offset:44032
    v_cvt_pk_bf16_f32 v143, v134, v135
    v_mfma_f32_16x16x32_bf16 v[132:135], v[80:83], v[48:51], v[236:239]
    v_exp_f32 v120, v120
    v_exp_f32 v121, v121
    v_mfma_f32_16x16x32_bf16 v[152:155], v[96:99], v[140:143], v[152:155]
    v_exp_f32 v122, v122
    v_cvt_pk_bf16_f32 v136, v120, v121
    v_mfma_f32_16x16x32_bf16 v[156:159], v[112:115], v[140:143], v[156:159]
    v_exp_f32 v123, v123
    v_exp_f32 v124, v124
    v_cvt_pk_bf16_f32 v137, v122, v123
    v_mfma_f32_16x16x32_bf16 v[164:167], v[226:229], v[140:143], v[164:167]
    v_exp_f32 v125, v125
    v_exp_f32 v126, v126
    v_cvt_pk_bf16_f32 v138, v124, v125
    v_exp_f32 v127, v127
    s_nop 0
    v_cvt_pk_bf16_f32 v139, v126, v127
    s_waitcnt lgkmcnt(0)
    s_nop 0
    v_mfma_f32_16x16x32_bf16 v[144:147], v[100:103], v[136:139], v[144:147]
    v_exp_f32 v132, v132
    v_mfma_f32_16x16x32_bf16 v[148:151], v[116:119], v[136:139], v[148:151]
    v_exp_f32 v133, v133
    v_mov_b32 v141, 0
    v_mfma_f32_16x16x32_bf16 v[160:163], v[226:229], v[136:139], v[160:163]
    v_exp_f32 v134, v134
    v_cvt_pk_bf16_f32 v142, v132, v133
    v_exp_f32 v135, v135
    v_mov_b32 v140, 0
    v_cvt_pk_bf16_f32 v143, v134, v135
    s_branch L_afin
L_attA0:
    s_setprio 1
    s_and_b32 s27, s87, 0xfffff00f
    s_sub_u32 s27, s27, 256
    v_and_b32 v180, 16, v0
    v_add_u32 v180, s27, v180
    v_bfe_u32 v174, v1, 1, 1
    v_sub_u32 v174, s20, v174
    v_max_i32 v174, 1, v174
    v_lshl_add_u32 v174, v174, 8, v180
    buffer_load_dwordx2 v[180:181], v174, s[12:15], 0 offen offset:0 sc1
    s_barrier
    ds_read_b128 v[40:43], v245 offset:0
    ds_read_b128 v[48:51], v245 offset:1024
    ds_read_b128 v[72:75], v244 offset:24576
    ds_read_b128 v[80:83], v244 offset:25600
    ds_read_b128 v[100:103], v244 offset:26624
    ds_read_b128 v[116:119], v244 offset:27648
    s_waitcnt lgkmcnt(2)
    v_mfma_f32_16x16x32_bf16 v[120:123], v[72:75], v[40:43], v[222:225]
    v_mfma_f32_16x16x32_bf16 v[128:131], v[72:75], v[48:51], 0
    s_nop 6
    v_exp_f32 v120, v120
    v_mfma_f32_16x16x32_bf16 v[132:135], v[80:83], v[48:51], v[222:225]
    v_exp_f32 v121, v121
    v_mov_b32 v139, 0
    v_exp_f32 v122, v122
    v_cvt_pk_bf16_f32 v136, v120, v121
    v_exp_f32 v123, v123
    v_mov_b32 v138, 0
    v_cvt_pk_bf16_f32 v137, v122, v123
    s_waitcnt lgkmcnt(0)
    s_nop 0
    v_mfma_f32_16x16x32_bf16 v[144:147], v[100:103], v[136:139], v[144:147]
    v_exp_f32 v128, v128
    v_exp_f32 v129, v129
    v_mfma_f32_16x16x32_bf16 v[148:151], v[116:119], v[136:139], v[148:151]
    v_exp_f32 v130, v130
    v_cvt_pk_bf16_f32 v140, v128, v129
    v_mfma_f32_16x16x32_bf16 v[160:163], v[226:229], v[136:139], v[160:163]
    v_exp_f32 v131, v131
    v_exp_f32 v132, v132
    v_cvt_pk_bf16_f32 v141, v130, v131
    v_exp_f32 v133, v133
    v_exp_f32 v134, v134
    v_cvt_pk_bf16_f32 v142, v132, v133
    v_exp_f32 v135, v135
    s_nop 0
    v_cvt_pk_bf16_f32 v143, v134, v135
    s_add_u32 m0, s85, 90112
    s_add_u32 s36, s86, 1441792
    s_and_b32 s36, s36, 0x1fffff
    buffer_load_dwordx4 v3, s[8:11], s36 offen lds
    s_add_u32 m0, s85, 94208
    s_add_u32 s36, s86, 1507328
    s_and_b32 s36, s36, 0x1fffff
    buffer_load_dwordx4 v3, s[8:11], s36 offen lds
    s_add_u32 m0, s85, 57344
    s_add_u32 s36, s86, 917504
    s_and_b32 s36, s36, 0x1fffff
    buffer_load_dwordx4 v3, s[8:11], s36 offen lds
    s_add_u32 m0, s85, 61440
    s_add_u32 s36, s86, 983040
    s_and_b32 s36, s36, 0x1fffff
    buffer_load_dwordx4 v3, s[8:11], s36 offen lds
    s_cmp_lg_u32 s20, 0
    s_cbranch_scc0 Lw_81
    s_waitcnt vmcnt(0)
    v_xor_b32 v182, s24, v180
    v_xor_b32 v183, s25, v181
    v_lshrrev_b32 v183, 4, v183
    v_or_b32 v182, v182, v183
    v_cmp_ne_u32 vcc, 0, v182
    s_nop 0
    s_cbranch_vccz Lw_81
    s_mov_b32 s26, 0
Lpoll_82:
    buffer_load_dwordx2 v[180:181], v174, s[12:15], 0 offen offset:0 sc1
    s_waitcnt vmcnt(0)
    v_xor_b32 v182, s24, v180
    v_xor_b32 v183, s25, v181
    v_lshrrev_b32 v183, 4, v183
    v_or_b32 v182, v182, v183
    v_cmp_ne_u32 vcc, 0, v182
    s_nop 0
    s_cbranch_vccz Lok_83
    s_add_u32 s26, s26, 1
    s_cmp_lt_u32 s26, 262144
    s_cbranch_scc1 Lpoll_82
Lok_83:
Lw_81:
    s_and_b32 s27, s73, 4294942719
    s_sub_u32 s27, s27, 524288
    s_cmp_lt_u32 s20, 1
    s_cselect_b32 s27, 1073741824, s27
    v_add_u32 v184, s27, v0
    s_and_b32 s28, s73, 4096
    s_add_u32 m0, s28, 98304
    s_mov_b32 s27, 24576
    buffer_load_dwordx4 v184, s[12:15], s27 offen offset:0 sc1 lds
    buffer_load_dwordx4 v184, s[12:15], s27 offen offset:1024 sc1 lds
    buffer_load_dwordx4 v184, s[12:15], s27 offen offset:2048 sc1 lds
    buffer_load_dwordx4 v184, s[12:15], s27 offen offset:3072 sc1 lds
    s_add_u32 m0, s28, 106496
    s_mov_b32 s27, 16384
    buffer_load_dwordx4 v184, s[12:15], s27 offen offset:0 sc1 lds
    buffer_load_dwordx4 v184, s[12:15], s27 offen offset:1024 sc1 lds
    buffer_load_dwordx4 v184, s[12:15], s27 offen offset:2048 sc1 lds
    buffer_load_dwordx4 v184, s[12:15], s27 offen offset:3072 sc1 lds
    s_add_u32 m0, s28, 114688
    s_mov_b32 s27, 8192
    buffer_load_dwordx4 v184, s[12:15], s27 offen offset:0 sc1 lds
    buffer_load_dwordx4 v184, s[12:15], s27 offen offset:1024 sc1 lds
    buffer_load_dwordx4 v184, s[12:15], s27 offen offset:2048 sc1 lds
    buffer_load_dwordx4 v184, s[12:15], s27 offen offset:3072 sc1 lds
    s_add_u32 m0, s28, 122880
    s_mov_b32 s27, 0
    buffer_load_dwordx4 v184, s[12:15], s27 offen offset:0 sc1 lds
    buffer_load_dwordx4 v184, s[12:15], s27 offen offset:1024 sc1 lds
    buffer_load_dwordx4 v184, s[12:15], s27 offen offset:2048 sc1 lds
    buffer_load_dwordx4 v184, s[12:15], s27 offen offset:3072 sc1 lds
    s_and_b32 s27, s73, 4096
    s_add_u32 s27, s27, 98304
    v_add_u32 v244, s27, v0
    v_xor_b32 v236, 4048155338, v222
    v_xor_b32 v237, 4048155338, v223
    v_xor_b32 v238, 4048155338, v224
    v_xor_b32 v239, 4048155338, v225
    s_waitcnt vmcnt(8)
    s_barrier
    ds_read_b128 v[56:59], v244 offset:0
    ds_read_b128 v[64:67], v244 offset:1024
    ds_read_b128 v[96:99], v244 offset:2048
    ds_read_b128 v[112:115], v244 offset:3072
    s_waitcnt lgkmcnt(2)
    v_mfma_f32_16x16x32_bf16 v[120:123], v[56:59], v[40:43], 0
    v_mfma_f32_16x16x32_bf16 v[124:127], v[64:67], v[40:43], 0
    v_mfma_f32_16x16x32_bf16 v[128:131], v[56:59], v[48:51], 0
    ds_read_b128 v[72:75], v244 offset:8192
    s_nop 4
    v_exp_f32 v120, v120
    v_exp_f32 v121, v121
    v_mfma_f32_16x16x32_bf16 v[132:135], v[64:67], v[48:51], 0
    ds_read_b128 v[80:83], v244 offset:9216
    v_exp_f32 v122, v122
    v_cvt_pk_bf16_f32 v136, v120, v121
    v_mfma_f32_16x16x32_bf16 v[152:155], v[100:103], v[140:143], v[152:155]
    v_exp_f32 v123, v123
    v_exp_f32 v124, v124
    v_cvt_pk_bf16_f32 v137, v122, v123
    v_mfma_f32_16x16x32_bf16 v[156:159], v[116:119], v[140:143], v[156:159]
    v_exp_f32 v125, v125
    v_exp_f32 v126, v126
    v_cvt_pk_bf16_f32 v138, v124, v125
    v_exp_f32 v127, v127
    v_mfma_f32_16x16x32_bf16 v[164:167], v[226:229], v[140:143], v[164:167]
    v_cvt_pk_bf16_f32 v139, v126, v127
    s_cmp_eq_u32 s20, 0
    s_cbranch_scc0 Lw_84
    v_mov_b32 v226, 0
    v_mov_b32 v227, 0
    v_mov_b32 v228, 0
    v_mov_b32 v229, 0
Lw_84:
    s_waitcnt lgkmcnt(0)
    v_mfma_f32_16x16x32_bf16 v[120:123], v[72:75], v[40:43], 0
    v_exp_f32 v128, v128
    v_exp_f32 v129, v129
    v_mfma_f32_16x16x32_bf16 v[124:127], v[80:83], v[40:43], 0
    v_exp_f32 v130, v130
    v_cvt_pk_bf16_f32 v140, v128, v129
    v_mfma_f32_16x16x32_bf16 v[144:147], v[96:99], v[136:139], v[144:147]
    v_exp_f32 v131, v131
    v_exp_f32 v132, v132
    v_cvt_pk_bf16_f32 v141, v130, v131
    v_mfma_f32_16x16x32_bf16 v[148:151], v[112:115], v[136:139], v[148:151]
    ds_read_b128 v[100:103], v244 offset:10240
    v_exp_f32 v133, v133
    v_exp_f32 v134, v134
    v_cvt_pk_bf16_f32 v142, v132, v133
    v_exp_f32 v135, v135
    v_mfma_f32_16x16x32_bf16 v[160:163], v[226:229], v[136:139], v[160:163]
    ds_read_b128 v[116:119], v244 offset:11264
    v_cvt_pk_bf16_f32 v143, v134, v135
    s_waitcnt vmcnt(0)
    s_barrier
    v_mfma_f32_16x16x32_bf16 v[128:131], v[72:75], v[48:51], 0
    ds_read_b128 v[56:59], v244 offset:16384
    v_exp_f32 v120, v120
    v_exp_f32 v121, v121
    v_mfma_f32_16x16x32_bf16 v[132:135], v[80:83], v[48:51], 0
    ds_read_b128 v[64:67], v244 offset:17408
    v_exp_f32 v122, v122
    v_cvt_pk_bf16_f32 v136, v120, v121
    v_mfma_f32_16x16x32_bf16 v[152:155], v[96:99], v[140:143], v[152:155]
    v_exp_f32 v123, v123
    v_exp_f32 v124, v124
    v_cvt_pk_bf16_f32 v137, v122, v123
    v_mfma_f32_16x16x32_bf16 v[156:159], v[112:115], v[140:143], v[156:159]
    v_exp_f32 v125, v125
    v_exp_f32 v126, v126
    v_cvt_pk_bf16_f32 v138, v124, v125
    v_exp_f32 v127, v127
    v_mfma_f32_16x16x32_bf16 v[164:167], v[226:229], v[140:143], v[164:167]
    v_cvt_pk_bf16_f32 v139, v126, v127
    s_waitcnt lgkmcnt(0)
    v_mfma_f32_16x16x32_bf16 v[120:123], v[56:59], v[40:43], 0
    v_exp_f32 v128, v128
    v_exp_f32 v129, v129
    v_mfma_f32_16x16x32_bf16 v[124:127], v[64:67], v[40:43], 0
    v_exp_f32 v130, v130
    v_cvt_pk_bf16_f32 v140, v128, v129
    v_mfma_f32_16x16x32_bf16 v[144:147], v[100:103], v[136:139], v[144:147]
    v_exp_f32 v131, v131
    v_exp_f32 v132, v132
    v_cvt_pk_bf16_f32 v141, v130, v131
    v_mfma_f32_16x16x32_bf16 v[148:151], v[116:119], v[136:139], v[148:151]
    ds_read_b128 v[96:99], v244 offset:18432
    v_exp_f32 v133, v133
    v_exp_f32 v134, v134
    v_cvt_pk_bf16_f32 v142, v132, v133
    v_exp_f32 v135, v135
    v_mfma_f32_16x16x32_bf16 v[160:163], v[226:229], v[136:139], v[160:163]
    ds_read_b128 v[112:115], v244 offset:19456
    v_cvt_pk_bf16_f32 v143, v134, v135
    v_mfma_f32_16x16x32_bf16 v[128:131], v[56:59], v[48:51], 0
    ds_read_b128 v[72:75], v244 offset:24576
    v_exp_f32 v120, v120
    v_exp_f32 v121, v121
    v_mfma_f32_16x16x32_bf16 v[132:135], v[64:67], v[48:51], 0
    ds_read_b128 v[80:83], v244 offset:25600
    v_exp_f32 v122, v122
    v_cvt_pk_bf16_f32 v136, v120, v121
    v_mfma_f32_16x16x32_bf16 v[152:155], v[100:103], v[140:143], v[152:155]
    v_exp_f32 v123, v123
    v_exp_f32 v124, v124
    v_cvt_pk_bf16_f32 v137, v122, v123
    v_mfma_f32_16x16x32_bf16 v[156:159], v[116:119], v[140:143], v[156:159]
    v_exp_f32 v125, v125
    v_exp_f32 v126, v126
    v_cvt_pk_bf16_f32 v138, v124, v125
    v_exp_f32 v127, v127
    v_mfma_f32_16x16x32_bf16 v[164:167], v[226:229], v[140:143], v[164:167]
    v_cvt_pk_bf16_f32 v139, v126, v127
    s_waitcnt lgkmcnt(0)
    v_mfma_f32_16x16x32_bf16 v[120:123], v[72:75], v[40:43], 0
    v_exp_f32 v128, v128
    v_exp_f32 v129, v129
    v_mfma_f32_16x16x32_bf16 v[124:127], v[80:83], v[40:43], 0
    v_exp_f32 v130, v130
    v_cvt_pk_bf16_f32 v140, v128, v129
    v_mfma_f32_16x16x32_bf16 v[144:147], v[96:99], v[136:139], v[144:147]
    v_exp_f32 v131, v131
    v_exp_f32 v132, v132
    v_cvt_pk_bf16_f32 v141, v130, v131
    v_mfma_f32_16x16x32_bf16 v[148:151], v[112:115], v[136:139], v[148:151]
    ds_read_b128 v[100:103], v244 offset:26624
    v_exp_f32 v133, v133
    v_exp_f32 v134, v134
    v_cvt_pk_bf16_f32 v142, v132, v133
    v_exp_f32 v135, v135
    v_mfma_f32_16x16x32_bf16 v[160:163], v[226:229], v[136:139], v[160:163]
    ds_read_b128 v[116:119], v244 offset:27648
    v_cvt_pk_bf16_f32 v143, v134, v135
    s_barrier
    v_mfma_f32_16x16x32_bf16 v[128:131], v[72:75], v[48:51], 0
    ds_read_b128 v[56:59], v244 offset:32768
    v_exp_f32 v120, v120
    v_exp_f32 v121, v121
    v_mfma_f32_16x16x32_bf16 v[132:135], v[80:83], v[48:51], 0
    ds_read_b128 v[64:67], v244 offset:33792
    v_exp_f32 v122, v122
    v_cvt_pk_bf16_f32 v136, v120, v121
    v_mfma_f32_16x16x32_bf16 v[152:155], v[96:99], v[140:143], v[152:155]
    v_exp_f32 v123, v123
    v_exp_f32 v124, v124
    v_cvt_pk_bf16_f32 v137, v122, v123
    v_mfma_f32_16x16x32_bf16 v[156:159], v[112:115], v[140:143], v[156:159]
    v_exp_f32 v125, v125
    v_exp_f32 v126, v126
    v_cvt_pk_bf16_f32 v138, v124, v125
    v_exp_f32 v127, v127
    v_mfma_f32_16x16x32_bf16 v[164:167], v[226:229], v[140:143], v[164:167]
    v_cvt_pk_bf16_f32 v139, v126, v127
    s_waitcnt lgkmcnt(0)
    v_mfma_f32_16x16x32_bf16 v[120:123], v[56:59], v[40:43], 0
    v_exp_f32 v128, v128
    v_exp_f32 v129, v129
    v_mfma_f32_16x16x32_bf16 v[124:127], v[64:67], v[40:43], 0
    v_exp_f32 v130, v130
    v_cvt_pk_bf16_f32 v140, v128, v129
    v_mfma_f32_16x16x32_bf16 v[144:147], v[100:103], v[136:139], v[144:147]
    v_exp_f32 v131, v131
    v_exp_f32 v132, v132
    v_cvt_pk_bf16_f32 v141, v130, v131
    v_mfma_f32_16x16x32_bf16 v[148:151], v[116:119], v[136:139], v[148:151]
    ds_read_b128 v[96:99], v244 offset:34816
    v_exp_f32 v133, v133
    v_exp_f32 v134, v134
    v_cvt_pk_bf16_f32 v142, v132, v133
    v_exp_f32 v135, v135
    v_mfma_f32_16x16x32_bf16 v[160:163], v[226:229], v[136:139], v[160:163]
    ds_read_b128 v[112:115], v244 offset:35840
    v_cvt_pk_bf16_f32 v143, v134, v135
    v_mfma_f32_16x16x32_bf16 v[128:131], v[56:59], v[48:51], 0
    ds_read_b128 v[72:75], v244 offset:40960
    v_exp_f32 v120, v120
    v_exp_f32 v121, v121
    v_mfma_f32_16x16x32_bf16 v[132:135], v[64:67], v[48:51], 0
    ds_read_b128 v[80:83], v244 offset:41984
    v_exp_f32 v122, v122
    v_cvt_pk_bf16_f32 v136, v120, v121
    v_mfma_f32_16x16x32_bf16 v[152:155], v[100:103], v[140:143], v[152:155]
    v_exp_f32 v123, v123
    v_exp_f32 v124, v124
    v_cvt_pk_bf16_f32 v137, v122, v123
    v_mfma_f32_16x16x32_bf16 v[156:159], v[116:119], v[140:143], v[156:159]
    v_exp_f32 v125, v125
    v_exp_f32 v126, v126
    v_cvt_pk_bf16_f32 v138, v124, v125
    v_exp_f32 v127, v127
    v_mfma_f32_16x16x32_bf16 v[164:167], v[226:229], v[140:143], v[164:167]
    v_cvt_pk_bf16_f32 v139, v126, v127
    s_cmp_eq_u32 s20, 1
    s_cbranch_scc0 Lw_85
    v_mov_b32 v226, 0
    v_mov_b32 v227, 0
    v_mov_b32 v228, 0
    v_mov_b32 v229, 0
Lw_85:
    s_waitcnt lgkmcnt(0)
    v_mfma_f32_16x16x32_bf16 v[120:123], v[72:75], v[40:43], 0
    v_exp_f32 v128, v128
    v_exp_f32 v129, v129
    v_mfma_f32_16x16x32_bf16 v[124:127], v[80:83], v[40:43], 0
    v_exp_f32 v130, v130
    v_cvt_pk_bf16_f32 v140, v128, v129
    v_mfma_f32_16x16x32_bf16 v[144:147], v[96:99], v[136:139], v[144:147]
    v_exp_f32 v131, v131
    v_exp_f32 v132, v132
    v_cvt_pk_bf16_f32 v141, v130, v131
    v_mfma_f32_16x16x32_bf16 v[148:151], v[112:115], v[136:139], v[148:151]
    ds_read_b128 v[100:103], v244 offset:43008
    v_exp_f32 v133, v133
    v_exp_f32 v134, v134
    v_cvt_pk_bf16_f32 v142, v132, v133
    v_exp_f32 v135, v135
    v_mfma_f32_16x16x32_bf16 v[160:163], v[226:229], v[136:139], v[160:163]
    ds_read_b128 v[116:119], v244 offset:44032
    v_cvt_pk_bf16_f32 v143, v134, v135
    v_mfma_f32_16x16x32_bf16 v[128:131], v[72:75], v[48:51], 0
    ds_read_b128 v[56:59], v244 offset:49152
    v_exp_f32 v120, v120
    v_exp_f32 v121, v121
    v_mfma_f32_16x16x32_bf16 v[132:135], v[80:83], v[48:51], 0
    ds_read_b128 v[64:67], v244 offset:50176
    v_exp_f32 v122, v122
    v_cvt_pk_bf16_f32 v136, v120, v121
    v_mfma_f32_16x16x32_bf16 v[152:155], v[96:99], v[140:143], v[152:155]
    v_exp_f32 v123, v123
    v_exp_f32 v124, v124
    v_cvt_pk_bf16_f32 v137, v122, v123
    v_mfma_f32_16x16x32_bf16 v[156:159], v[112:115], v[140:143], v[156:159]
    v_exp_f32 v125, v125
    v_exp_f32 v126, v126
    v_cvt_pk_bf16_f32 v138, v124, v125
    v_exp_f32 v127, v127
    v_mfma_f32_16x16x32_bf16 v[164:167], v[226:229], v[140:143], v[164:167]
    v_cvt_pk_bf16_f32 v139, v126, v127
    s_waitcnt lgkmcnt(0)
    v_mfma_f32_16x16x32_bf16 v[120:123], v[56:59], v[40:43], 0
    v_exp_f32 v128, v128
    v_exp_f32 v129, v129
    v_mfma_f32_16x16x32_bf16 v[124:127], v[64:67], v[40:43], 0
    v_exp_f32 v130, v130
    v_cvt_pk_bf16_f32 v140, v128, v129
    v_mfma_f32_16x16x32_bf16 v[144:147], v[100:103], v[136:139], v[144:147]
    v_exp_f32 v131, v131
    v_exp_f32 v132, v132
    v_cvt_pk_bf16_f32 v141, v130, v131
    v_mfma_f32_16x16x32_bf16 v[148:151], v[116:119], v[136:139], v[148:151]
    ds_read_b128 v[96:99], v244 offset:51200
    v_exp_f32 v133, v133
    v_exp_f32 v134, v134
    v_cvt_pk_bf16_f32 v142, v132, v133
    v_exp_f32 v135, v135
    v_mfma_f32_16x16x32_bf16 v[160:163], v[226:229], v[136:139], v[160:163]
    ds_read_b128 v[112:115], v244 offset:52224
    v_cvt_pk_bf16_f32 v143, v134, v135
    v_mfma_f32_16x16x32_bf16 v[128:131], v[56:59], v[48:51], 0
    ds_read_b128 v[72:75], v244 offset:57344
    v_exp_f32 v120, v120
    v_exp_f32 v121, v121
    v_mfma_f32_16x16x32_bf16 v[132:135], v[64:67], v[48:51], 0
    ds_read_b128 v[80:83], v244 offset:58368
    v_exp_f32 v122, v122
    v_cvt_pk_bf16_f32 v136, v120, v121
    v_mfma_f32_16x16x32_bf16 v[152:155], v[100:103], v[140:143], v[152:155]
    v_exp_f32 v123, v123
    v_exp_f32 v124, v124
    v_cvt_pk_bf16_f32 v137, v122, v123
    v_mfma_f32_16x16x32_bf16 v[156:159], v[116:119], v[140:143], v[156:159]
    v_exp_f32 v125, v125
    v_exp_f32 v126, v126
    v_cvt_pk_bf16_f32 v138, v124, v125
    v_exp_f32 v127, v127
    v_mfma_f32_16x16x32_bf16 v[164:167], v[226:229], v[140:143], v[164:167]
    v_cvt_pk_bf16_f32 v139, v126, v127
    s_waitcnt lgkmcnt(0)
    v_mfma_f32_16x16x32_bf16 v[120:123], v[72:75], v[40:43], v[236:239]
    v_exp_f32 v128, v128
    v_exp_f32 v129, v129
    v_mfma_f32_16x16x32_bf16 v[124:127], v[80:83], v[40:43], 0
    v_exp_f32 v130, v130
    v_cvt_pk_bf16_f32 v140, v128, v129
    v_mfma_f32_16x16x32_bf16 v[144:147], v[96:99], v[136:139], v[144:147]
    v_exp_f32 v131, v131
    v_exp_f32 v132, v132
    v_cvt_pk_bf16_f32 v141, v130, v131
    v_mfma_f32_16x16x32_bf16 v[148:151], v[112:115], v[136:139], v[148:151]
    ds_read_b128 v[100:103], v244 offset:59392
    v_exp_f32 v133, v133
    v_exp_f32 v134, v134
    v_cvt_pk_bf16_f32 v142, v132, v133
    v_exp_f32 v135, v135
    v_mfma_f32_16x16x32_bf16 v[160:163], v[226:229], v[136:139], v[160:163]
    ds_read_b128 v[116:119], v244 offset:60416
    v_cvt_pk_bf16_f32 v143, v134, v135
    v_mfma_f32_16x16x32_bf16 v[132:135], v[80:83], v[48:51], v[236:239]
    v_exp_f32 v120, v120
    v_exp_f32 v121, v121
    v_mfma_f32_16x16x32_bf16 v[152:155], v[96:99], v[140:143], v[152:155]
    v_exp_f32 v122, v122
    v_cvt_pk_bf16_f32 v136, v120, v121
    v_mfma_f32_16x16x32_bf16 v[156:159], v[112:115], v[140:143], v[156:159]
    v_exp_f32 v123, v123
    v_exp_f32 v124, v124
    v_cvt_pk_bf16_f32 v137, v122, v123
    v_mfma_f32_16x16x32_bf16 v[164:167], v[226:229], v[140:143], v[164:167]
    v_exp_f32 v125, v125
    v_exp_f32 v126, v126
    v_cvt_pk_bf16_f32 v138, v124, v125
    v_exp_f32 v127, v127
    s_nop 0
    v_cvt_pk_bf16_f32 v139, v126, v127
    s_waitcnt lgkmcnt(0)
    s_nop 0
    v_mfma_f32_16x16x32_bf16 v[144:147], v[100:103], v[136:139], v[144:147]
    v_exp_f32 v132, v132
    v_mfma_f32_16x16x32_bf16 v[148:151], v[116:119], v[136:139], v[148:151]
    v_exp_f32 v133, v133
    v_mov_b32 v141, 0
    v_mfma_f32_16x16x32_bf16 v[160:163], v[226:229], v[136:139], v[160:163]
    v_exp_f32 v134, v134
    v_cvt_pk_bf16_f32 v142, v132, v133
    v_exp_f32 v135, v135
    v_mov_b32 v140, 0
    v_cvt_pk_bf16_f32 v143, v134, v135
    s_branch L_afin
L_cstart:
    s_lshl_b32 s27, s20, 2
    s_add_u32 s27, s27, s3
    s_lshl_b32 s27, s27, 16
    s_lshl_b32 s28, s21, 7
    s_add_u32 s27, s27, s28
    v_and_b32 v24, 15, v1
    v_lshlrev_b32 v24, 11, v24
    v_and_b32 v25, 48, v1
    v_add3_u32 v24, v24, v25, s27
    v_add_u32 v25, 32768, v24
    s_waitcnt lgkmcnt(0)
    s_mov_b32 s16, s48
    s_mov_b32 s17, s49
    s_mov_b32 s18, 4194304
    s_mov_b32 s19, 0x00020000
    buffer_load_dwordx4 v[8:11], v24, s[16:19], 0 offen offset:0
    buffer_load_dwordx4 v[12:15], v24, s[16:19], 0 offen offset:64
    buffer_load_dwordx4 v[16:19], v25, s[16:19], 0 offen offset:0
    buffer_load_dwordx4 v[20:23], v25, s[16:19], 0 offen offset:64
    s_or_b32 s84, s75, 1
    s_mov_b32 s12, s64
    s_mov_b32 s13, s65
    s_mov_b32 s14, 75497472
    s_mov_b32 s15, 0x00020000
    v_mov_b32 v28, 843776
    buffer_load_dwordx2 v[26:27], v28, s[12:15], 0 offen sc1
    s_mov_b32 s8, s52
    s_mov_b32 s9, s53
    s_mov_b32 s10, 2097152
    s_mov_b32 s11, 0x00020000
    s_mov_b32 s22, 0
    s_mov_b32 s23, 0
    v_mov_b32 v6, 0
    v_bfe_u32 v28, v1, 2, 3
    v_bfe_u32 v29, v1, 3, 2
    v_and_b32 v30, 3, v1
    v_lshlrev_b32 v28, 7, v28
    v_lshlrev_b32 v29, 5, v29
    v_lshlrev_b32 v30, 3, v30
    v_add3_u32 v2, v28, v29, v30
    v_and_b32 v28, 15, v1
    v_lshrrev_b32 v29, 4, v1
    v_lshlrev_b32 v29, 2, v29
    v_sub_u32 v4, v28, v29
    s_lshl_b32 s85, s75, 10
    s_lshl_b32 s86, s21, 17
    s_lshl_b32 s27, s75, 14
    s_lshl_b32 s28, s21, 7
    s_add_u32 s27, s27, s28
    v_lshrrev_b32 v3, 3, v1
    v_lshlrev_b32 v3, 11, v3
    v_add3_u32 v3, v3, v173, s27
    s_lshl_b32 s27, s20, 18
    s_lshl_b32 s28, s21, 12
    s_add_u32 s27, s27, s28
    s_lshl_b32 s28, s75, 16
    s_add_u32 s71, s27, s28
    s_lshl_b32 s28, s84, 16
    s_add_u32 s27, s27, s28
    s_and_b32 s28, s75, 1
    s_lshl_b32 s29, s28, 11
    s_add_u32 s27, s27, s29
    s_add_u32 s72, s27, 2097152
    s_lshl_b32 s27, s20, 4
    s_add_u32 s27, s27, s21
    s_lshl_b32 s27, s27, 2
    s_and_b32 s29, s75, 2
    s_add_u32 s27, s27, s29
    s_lshl_b32 s27, s27, 1
    s_add_u32 s27, s27, s28
    s_lshl_b32 s27, s27, 12
    s_add_u32 s73, s27, 14680064
    v_mov_b32 v176, -1
    v_mov_b32 v177, -1
    v_mov_b32 v178, -1
    v_mov_b32 v179, -1
    v_subrev_u32 v222, 0, v4
    v_ashrrev_i32 v222, 31, v222
    v_and_b32 v222, 4048155338, v222
    v_subrev_u32 v223, 1, v4
    v_ashrrev_i32 v223, 31, v223
    v_and_b32 v223, 4048155338, v223
    v_subrev_u32 v224, 2, v4
    v_ashrrev_i32 v224, 31, v224
    v_and_b32 v224, 4048155338, v224
    v_subrev_u32 v225, 3, v4
    v_ashrrev_i32 v225, 31, v225
    v_and_b32 v225, 4048155338, v225
    s_lshl_b32 s27, s21, 4
    s_add_u32 s27, s27, s20
    s_lshl_b32 s27, s27, 5
    s_add_u32 s27, s27, s75
    s_lshl_b32 s27, s27, 3
    s_add_u32 s87, s27, 851968
    s_mov_b32 s4, s50
    s_mov_b32 s5, s51
    s_mov_b32 s6, 6291456
    s_mov_b32 s7, 0x00020000
    s_mov_b32 s92, 2863311530
    s_mov_b32 s93, 2863311530
    s_mov_b32 s94, 3435973836
    s_mov_b32 s95, 3435973836
    s_mov_b32 s96, 983040
    s_mov_b32 s97, 268370175
    s_mov_b32 s98, 4128771
    s_mov_b32 s99, 1073677311
    s_lshr_b32 s27, s3, 1
    s_lshl_b32 s27, s27, 13
    s_add_u32 s27, s27, 49152
    v_and_b32 v200, 15, v1
    v_bfe_u32 v201, v1, 1, 3
    v_lshrrev_b32 v202, 4, v1
    v_xor_b32 v201, v201, v202
    v_lshlrev_b32 v200, 7, v200
    v_lshlrev_b32 v201, 4, v201
    v_add3_u32 v200, v200, v201, s27
    v_xor_b32 v201, 64, v200
    s_and_b32 s28, s3, 1
    s_lshl_b32 s29, s28, 6
    v_xor_b32 v202, s29, v2
    v_lshrrev_b32 v203, 5, v1
    v_mul_u32_u24 v203, 3072, v203
    v_add_u32 v202, v202, v203
    v_xor_b32 v203, 32, v202
    v_add_u32 v204, 139264, v202
    v_add_u32 v205, 139264, v203
    s_lshr_b32 s27, s3, 1
    s_lshl_b32 s27, s27, 8
    s_add_u32 s27, s27, 131072
    s_lshl_b32 s28, s28, 7
    s_add_u32 s28, s28, 132096
    v_and_b32 v251, 15, v1
    v_and_b32 v250, 48, v1
    v_lshl_add_u32 v248, v251, 2, s27
    v_add_u32 v249, s27, v250
    v_add_u32 v250, s28, v250
    v_lshl_add_u32 v251, v251, 2, s28
    v_mov_b32 v226, 0x3f803f80
    v_mov_b32 v227, 0x3f803f80
    v_mov_b32 v228, 0x3f803f80
    v_mov_b32 v229, 0x3f803f80
    v_mov_b32 v240, -1
    v_mov_b32 v241, -1
    v_mov_b32 v242, -1
    v_mov_b32 v243, -1
    s_waitcnt vmcnt(0)
    v_readfirstlane_b32 s24, v26
    v_readfirstlane_b32 s25, v27
    s_add_u32 s24, s24, 1
    s_add_u32 s25, s25, 16
    s_and_b32 s25, s25, 0xfffffff0
    s_getreg_b32 s27, hwreg(HW_REG_XCC_ID, 0, 4)
    s_or_b32 s25, s25, s27
    v_mfma_f32_16x16x32_bf16 v[206:209], v[226:229], v[8:11], 0
    v_mfma_f32_16x16x32_bf16 v[210:213], v[8:11], v[8:11], 0
    v_mfma_f32_16x16x32_bf16 v[214:217], v[226:229], v[16:19], 0
    v_mfma_f32_16x16x32_bf16 v[218:221], v[16:19], v[16:19], 0
    v_mfma_f32_16x16x32_bf16 v[206:209], v[226:229], v[12:15], v[206:209]
    v_mfma_f32_16x16x32_bf16 v[210:213], v[12:15], v[12:15], v[210:213]
    v_mfma_f32_16x16x32_bf16 v[214:217], v[226:229], v[20:23], v[214:217]
    v_mfma_f32_16x16x32_bf16 v[218:221], v[20:23], v[20:23], v[218:221]
    s_mov_b32 s16, s60
    s_mov_b32 s17, s61
    s_mov_b32 s18, 4194304
    s_mov_b32 s19, 0x00020000
    v_permlane16_swap_b32 v8, v10
    v_permlane16_swap_b32 v9, v11
    s_nop 0
    v_permlane32_swap_b32 v8, v10
    v_permlane32_swap_b32 v9, v11
    v_permlane16_swap_b32 v12, v14
    v_permlane16_swap_b32 v13, v15
    s_nop 0
    v_permlane32_swap_b32 v12, v14
    v_permlane32_swap_b32 v13, v15
    v_permlane16_swap_b32 v16, v18
    v_permlane16_swap_b32 v17, v19
    s_nop 0
    v_permlane32_swap_b32 v16, v18
    v_permlane32_swap_b32 v17, v19
    v_permlane16_swap_b32 v20, v22
    v_permlane16_swap_b32 v21, v23
    s_nop 0
    v_permlane32_swap_b32 v20, v22
    s_nop 0
    v_permlane32_swap_b32 v21, v23
L_cgo:
    s_barrier
    ds_read_b128 v[120:123], v200 offset:0
    ds_read_b64_tr_b16 v[136:137], v204 offset:0
    ds_read_b64_tr_b16 v[138:139], v204 offset:6144
    ds_read_b128 v[124:127], v200 offset:2048
    ds_read_b128 v[128:131], v200 offset:4096
    ds_read_b128 v[132:135], v200 offset:6144
    ds_read_b64_tr_b16 v[140:141], v205 offset:0
    ds_read_b64_tr_b16 v[142:143], v205 offset:6144
    ds_read_b64_tr_b16 v[144:145], v204 offset:1024
    ds_read_b64_tr_b16 v[146:147], v204 offset:7168
    ds_read_b64_tr_b16 v[148:149], v205 offset:1024
    ds_read_b64_tr_b16 v[150:151], v205 offset:7168
    ds_read_b64_tr_b16 v[152:153], v204 offset:2048
    ds_read_b64_tr_b16 v[154:155], v204 offset:8192
    ds_read_b64_tr_b16 v[156:157], v205 offset:2048
    ds_read_b64_tr_b16 v[158:159], v205 offset:8192
    s_waitcnt lgkmcnt(13)
    v_mfma_f32_16x16x32_bf16 v[24:27], v[136:139], v[120:123], 0
    ds_read_b128 v[160:163], v201 offset:0
    s_waitcnt lgkmcnt(13)
    v_mfma_f32_16x16x32_bf16 v[32:35], v[136:139], v[124:127], 0
    ds_read_b64_tr_b16 v[176:177], v204 offset:12288
    s_waitcnt lgkmcnt(13)
    v_mfma_f32_16x16x32_bf16 v[40:43], v[136:139], v[128:131], 0
    ds_read_b64_tr_b16 v[178:179], v204 offset:18432
    s_waitcnt lgkmcnt(13)
    v_mfma_f32_16x16x32_bf16 v[48:51], v[136:139], v[132:135], 0
    ds_read_b128 v[164:167], v201 offset:2048
    s_waitcnt lgkmcnt(12)
    v_mfma_f32_16x16x32_bf16 v[52:55], v[140:143], v[132:135], 0
    ds_read_b128 v[168:171], v201 offset:4096
    v_mfma_f32_16x16x32_bf16 v[44:47], v[140:143], v[128:131], 0
    ds_read_b128 v[172:175], v201 offset:6144
    v_mfma_f32_16x16x32_bf16 v[36:39], v[140:143], v[124:127], 0
    ds_read_b64_tr_b16 v[180:181], v205 offset:12288
    v_mfma_f32_16x16x32_bf16 v[28:31], v[140:143], v[120:123], 0
    ds_read_b64_tr_b16 v[182:183], v205 offset:18432
    s_waitcnt lgkmcnt(14)
    v_mfma_f32_16x16x32_bf16 v[56:59], v[144:147], v[120:123], 0
    ds_read_b64_tr_b16 v[184:185], v204 offset:13312
    v_mfma_f32_16x16x32_bf16 v[64:67], v[144:147], v[124:127], 0
    ds_read_b64_tr_b16 v[186:187], v204 offset:19456
    v_mfma_f32_16x16x32_bf16 v[72:75], v[144:147], v[128:131], 0
    ds_read_b64_tr_b16 v[188:189], v205 offset:13312
    v_mfma_f32_16x16x32_bf16 v[80:83], v[144:147], v[132:135], 0
    ds_read_b64_tr_b16 v[190:191], v205 offset:19456
    s_waitcnt lgkmcnt(15)
    v_mfma_f32_16x16x32_bf16 v[84:87], v[148:151], v[132:135], 0
    ds_read_b64_tr_b16 v[192:193], v204 offset:14336
    v_mfma_f32_16x16x32_bf16 v[76:79], v[148:151], v[128:131], 0
    ds_read_b64_tr_b16 v[194:195], v204 offset:20480
    v_mfma_f32_16x16x32_bf16 v[68:71], v[148:151], v[124:127], 0
    ds_read_b64_tr_b16 v[196:197], v205 offset:14336
    v_mfma_f32_16x16x32_bf16 v[60:63], v[148:151], v[120:123], 0
    ds_read_b64_tr_b16 v[198:199], v205 offset:20480
    s_waitcnt lgkmcnt(15)
    v_mfma_f32_16x16x32_bf16 v[88:91], v[120:123], v[152:155], 0
    v_cndmask_b32 v210, v210, v211, s[92:93]
    v_cndmask_b32 v212, v212, v213, s[92:93]
    v_mfma_f32_16x16x32_bf16 v[104:107], v[120:123], v[156:159], 0
    v_mov_b32 v230, v206
    v_cndmask_b32 v231, v210, v212, s[94:95]
    v_mfma_f32_16x16x32_bf16 v[108:111], v[124:127], v[156:159], 0
    v_cndmask_b32 v218, v218, v219, s[92:93]
    v_cndmask_b32 v220, v220, v221, s[92:93]
    v_mfma_f32_16x16x32_bf16 v[92:95], v[124:127], v[152:155], 0
    v_mov_b32 v232, v214
    v_cndmask_b32 v233, v218, v220, s[94:95]
    v_mfma_f32_16x16x32_bf16 v[96:99], v[128:131], v[152:155], 0
    v_and_b32 v237, 0xf0, v0
    s_lshr_b32 s27, s71, 4
    v_mfma_f32_16x16x32_bf16 v[112:115], v[128:131], v[156:159], 0
    v_mfma_f32_16x16x32_bf16 v[116:119], v[132:135], v[156:159], 0
    v_mfma_f32_16x16x32_bf16 v[100:103], v[132:135], v[152:155], 0
    s_waitcnt lgkmcnt(4)
    v_mfma_f32_16x16x32_bf16 v[24:27], v[176:179], v[160:163], v[24:27]
    v_mfma_f32_16x16x32_bf16 v[32:35], v[176:179], v[164:167], v[32:35]
    s_mov_b32 exec_lo, 0x00f0000f
    s_mov_b32 exec_hi, 0xf0000f00
    s_cmp_eq_u32 s23, 0
    s_cbranch_scc1 Lslow_86
    buffer_store_dwordx4 v[230:233], v237, s[12:15], s27 offen
Lback_87:
    s_mov_b64 exec, -1
    v_mfma_f32_16x16x32_bf16 v[40:43], v[176:179], v[168:171], v[40:43]
    v_mfma_f32_16x16x32_bf16 v[48:51], v[176:179], v[172:175], v[48:51]
    v_mfma_f32_16x16x32_bf16 v[52:55], v[180:183], v[172:175], v[52:55]
    s_cmp_eq_u32 s22, 0
    s_cbranch_scc0 Lw_88
    s_add_u32 s31, s71, 2097152
    buffer_store_dwordx4 v[240:243], v0, s[12:15], s31 offen offset:0 sc1
    buffer_store_dwordx4 v[240:243], v0, s[12:15], s31 offen offset:1024 sc1
    buffer_store_dwordx4 v[240:243], v0, s[12:15], s31 offen offset:2048 sc1
    buffer_store_dwordx4 v[240:243], v0, s[12:15], s31 offen offset:3072 sc1
Lw_88:
    v_mfma_f32_16x16x32_bf16 v[44:47], v[180:183], v[168:171], v[44:47]
    s_waitcnt lgkmcnt(0)
    v_mfma_f32_16x16x32_bf16 v[36:39], v[180:183], v[164:167], v[36:39]
    s_barrier
    v_mfma_f32_16x16x32_bf16 v[28:31], v[180:183], v[160:163], v[28:31]
    ds_read_b128 v[120:123], v200 offset:16384
    v_mfma_f32_16x16x32_bf16 v[56:59], v[184:187], v[160:163], v[56:59]
    ds_read_b64_tr_b16 v[136:137], v202 offset:0
    v_mfma_f32_16x16x32_bf16 v[64:67], v[184:187], v[164:167], v[64:67]
    ds_read_b64_tr_b16 v[138:139], v202 offset:6144
    v_mfma_f32_16x16x32_bf16 v[72:75], v[184:187], v[168:171], v[72:75]
    ds_read_b128 v[124:127], v200 offset:18432
    v_mfma_f32_16x16x32_bf16 v[80:83], v[184:187], v[172:175], v[80:83]
    ds_read_b128 v[128:131], v200 offset:20480
    v_mfma_f32_16x16x32_bf16 v[84:87], v[188:191], v[172:175], v[84:87]
    ds_read_b128 v[132:135], v200 offset:22528
    v_mfma_f32_16x16x32_bf16 v[76:79], v[188:191], v[168:171], v[76:79]
    ds_read_b64_tr_b16 v[140:141], v203 offset:0
    v_mfma_f32_16x16x32_bf16 v[68:71], v[188:191], v[164:167], v[68:71]
    ds_read_b64_tr_b16 v[142:143], v203 offset:6144
    v_mfma_f32_16x16x32_bf16 v[60:63], v[188:191], v[160:163], v[60:63]
    ds_read_b64_tr_b16 v[144:145], v202 offset:1024
    v_mfma_f32_16x16x32_bf16 v[88:91], v[160:163], v[192:195], v[88:91]
    ds_read_b64_tr_b16 v[146:147], v202 offset:7168
    v_mfma_f32_16x16x32_bf16 v[104:107], v[160:163], v[196:199], v[104:107]
    ds_read_b64_tr_b16 v[148:149], v203 offset:1024
    v_mfma_f32_16x16x32_bf16 v[108:111], v[164:167], v[196:199], v[108:111]
    ds_read_b64_tr_b16 v[150:151], v203 offset:7168
    v_mfma_f32_16x16x32_bf16 v[92:95], v[164:167], v[192:195], v[92:95]
    ds_read_b64_tr_b16 v[152:153], v202 offset:2048
    v_mfma_f32_16x16x32_bf16 v[96:99], v[168:171], v[192:195], v[96:99]
    ds_read_b64_tr_b16 v[154:155], v202 offset:8192
    v_mfma_f32_16x16x32_bf16 v[112:115], v[168:171], v[196:199], v[112:115]
    ds_read_b64_tr_b16 v[156:157], v203 offset:2048
    v_mfma_f32_16x16x32_bf16 v[116:119], v[172:175], v[196:199], v[116:119]
    ds_read_b64_tr_b16 v[158:159], v203 offset:8192
    v_mfma_f32_16x16x32_bf16 v[100:103], v[172:175], v[192:195], v[100:103]
    s_waitcnt lgkmcnt(4)
    v_mfma_f32_16x16x32_bf16 v[24:27], v[136:139], v[120:123], v[24:27]
    ds_read_b128 v[160:163], v201 offset:16384
    v_mfma_f32_16x16x32_bf16 v[32:35], v[136:139], v[124:127], v[32:35]
    ds_read_b64_tr_b16 v[176:177], v202 offset:12288
    v_mfma_f32_16x16x32_bf16 v[40:43], v[136:139], v[128:131], v[40:43]
    ds_read_b64_tr_b16 v[178:179], v202 offset:18432
    v_mfma_f32_16x16x32_bf16 v[48:51], v[136:139], v[132:135], v[48:51]
    ds_read_b128 v[164:167], v201 offset:18432
    v_mfma_f32_16x16x32_bf16 v[52:55], v[140:143], v[132:135], v[52:55]
    ds_read_b128 v[168:171], v201 offset:20480
    v_mfma_f32_16x16x32_bf16 v[44:47], v[140:143], v[128:131], v[44:47]
    ds_read_b128 v[172:175], v201 offset:22528
    v_mfma_f32_16x16x32_bf16 v[36:39], v[140:143], v[124:127], v[36:39]
    ds_read_b64_tr_b16 v[180:181], v203 offset:12288
    v_mfma_f32_16x16x32_bf16 v[28:31], v[140:143], v[120:123], v[28:31]
    ds_read_b64_tr_b16 v[182:183], v203 offset:18432
    s_waitcnt lgkmcnt(8)
    v_mfma_f32_16x16x32_bf16 v[56:59], v[144:147], v[120:123], v[56:59]
    ds_read_b64_tr_b16 v[184:185], v202 offset:13312
    v_mfma_f32_16x16x32_bf16 v[64:67], v[144:147], v[124:127], v[64:67]
    ds_read_b64_tr_b16 v[186:187], v202 offset:19456
    v_mfma_f32_16x16x32_bf16 v[72:75], v[144:147], v[128:131], v[72:75]
    ds_read_b64_tr_b16 v[188:189], v203 offset:13312
    v_mfma_f32_16x16x32_bf16 v[80:83], v[144:147], v[132:135], v[80:83]
    ds_read_b64_tr_b16 v[190:191], v203 offset:19456
    v_mfma_f32_16x16x32_bf16 v[84:87], v[148:151], v[132:135], v[84:87]
    ds_read_b64_tr_b16 v[192:193], v202 offset:14336
    v_mfma_f32_16x16x32_bf16 v[76:79], v[148:151], v[128:131], v[76:79]
    ds_read_b64_tr_b16 v[194:195], v202 offset:20480
    v_mfma_f32_16x16x32_bf16 v[68:71], v[148:151], v[124:127], v[68:71]
    ds_read_b64_tr_b16 v[196:197], v203 offset:14336
    v_mfma_f32_16x16x32_bf16 v[60:63], v[148:151], v[120:123], v[60:63]
    ds_read_b64_tr_b16 v[198:199], v203 offset:20480
    v_mfma_f32_16x16x32_bf16 v[88:91], v[120:123], v[152:155], v[88:91]
    s_lshr_b32 s27, s71, 9
    v_mfma_f32_16x16x32_bf16 v[104:107], v[120:123], v[156:159], v[104:107]
    s_lshl_b32 s28, s22, 13
    v_mfma_f32_16x16x32_bf16 v[108:111], v[124:127], v[156:159], v[108:111]
    s_add_u32 s27, s27, s28
    v_mfma_f32_16x16x32_bf16 v[92:95], v[124:127], v[152:155], v[92:95]
    s_add_u32 s27, s27, 786432
    v_mfma_f32_16x16x32_bf16 v[96:99], v[128:131], v[152:155], v[96:99]
    v_mov_b32 v236, s27
    v_mfma_f32_16x16x32_bf16 v[112:115], v[128:131], v[156:159], v[112:115]
    v_mov_b32 v234, s24
    v_mfma_f32_16x16x32_bf16 v[116:119], v[132:135], v[156:159], v[116:119]
    v_mov_b32 v235, s25
    v_mfma_f32_16x16x32_bf16 v[100:103], v[132:135], v[152:155], v[100:103]
    s_waitcnt lgkmcnt(4)
    v_mfma_f32_16x16x32_bf16 v[24:27], v[176:179], v[160:163], v[24:27]
    s_waitcnt lgkmcnt(0)
    v_mfma_f32_16x16x32_bf16 v[32:35], v[176:179], v[164:167], v[32:35]
    s_barrier
    v_mfma_f32_16x16x32_bf16 v[40:43], v[176:179], v[168:171], v[40:43]
    ds_read_b128 v[120:123], v200 offset:32768
    v_mfma_f32_16x16x32_bf16 v[48:51], v[176:179], v[172:175], v[48:51]
    ds_read_b64_tr_b16 v[136:137], v202 offset:24576
    v_mfma_f32_16x16x32_bf16 v[52:55], v[180:183], v[172:175], v[52:55]
    ds_read_b64_tr_b16 v[138:139], v202 offset:30720
    v_mfma_f32_16x16x32_bf16 v[44:47], v[180:183], v[168:171], v[44:47]
    ds_read_b128 v[124:127], v200 offset:34816
    v_mfma_f32_16x16x32_bf16 v[36:39], v[180:183], v[164:167], v[36:39]
    ds_read_b128 v[128:131], v200 offset:36864
    v_mfma_f32_16x16x32_bf16 v[28:31], v[180:183], v[160:163], v[28:31]
    ds_read_b128 v[132:135], v200 offset:38912
    v_mfma_f32_16x16x32_bf16 v[56:59], v[184:187], v[160:163], v[56:59]
    ds_read_b64_tr_b16 v[140:141], v203 offset:24576
    v_mfma_f32_16x16x32_bf16 v[64:67], v[184:187], v[164:167], v[64:67]
    ds_read_b64_tr_b16 v[142:143], v203 offset:30720
    v_mfma_f32_16x16x32_bf16 v[72:75], v[184:187], v[168:171], v[72:75]
    ds_read_b64_tr_b16 v[144:145], v202 offset:25600
    v_mfma_f32_16x16x32_bf16 v[80:83], v[184:187], v[172:175], v[80:83]
    ds_read_b64_tr_b16 v[146:147], v202 offset:31744
    v_mfma_f32_16x16x32_bf16 v[84:87], v[188:191], v[172:175], v[84:87]
    ds_read_b64_tr_b16 v[148:149], v203 offset:25600
    v_mfma_f32_16x16x32_bf16 v[76:79], v[188:191], v[168:171], v[76:79]
    ds_read_b64_tr_b16 v[150:151], v203 offset:31744
    v_mfma_f32_16x16x32_bf16 v[68:71], v[188:191], v[164:167], v[68:71]
    ds_read_b64_tr_b16 v[152:153], v202 offset:26624
    v_mfma_f32_16x16x32_bf16 v[60:63], v[188:191], v[160:163], v[60:63]
    ds_read_b64_tr_b16 v[154:155], v202 offset:32768
    v_mfma_f32_16x16x32_bf16 v[88:91], v[160:163], v[192:195], v[88:91]
    ds_read_b64_tr_b16 v[156:157], v203 offset:26624
    v_mfma_f32_16x16x32_bf16 v[104:107], v[160:163], v[196:199], v[104:107]
    ds_read_b64_tr_b16 v[158:159], v203 offset:32768
    v_mfma_f32_16x16x32_bf16 v[108:111], v[164:167], v[196:199], v[108:111]
    v_mfma_f32_16x16x32_bf16 v[92:95], v[164:167], v[192:195], v[92:95]
    s_waitcnt vmcnt(0)
    s_mov_b64 exec, 1
    s_cmp_eq_u32 s23, 0
    s_cbranch_scc1 Lslow_89
    buffer_store_dwordx2 v[234:235], v236, s[12:15], 0 offen offset:0
Lback_90:
    s_mov_b64 exec, -1
    v_mfma_f32_16x16x32_bf16 v[96:99], v[168:171], v[192:195], v[96:99]
    v_mfma_f32_16x16x32_bf16 v[112:115], v[168:171], v[196:199], v[112:115]
    s_mov_b32 s74, 0
    v_mfma_f32_16x16x32_bf16 v[116:119], v[172:175], v[196:199], v[116:119]
    s_waitcnt lgkmcnt(4)
    v_mfma_f32_16x16x32_bf16 v[100:103], v[172:175], v[192:195], v[100:103]
    .p2align 3
L_cloop:
    v_mfma_f32_16x16x32_bf16 v[24:27], v[136:139], v[120:123], v[24:27]
    ds_read_b128 v[160:163], v201 offset:32768
    v_mfma_f32_16x16x32_bf16 v[32:35], v[136:139], v[124:127], v[32:35]
    ds_read_b64_tr_b16 v[176:177], v202 offset:36864
    v_mfma_f32_16x16x32_bf16 v[40:43], v[136:139], v[128:131], v[40:43]
    ds_read_b64_tr_b16 v[178:179], v202 offset:43008
    v_mfma_f32_16x16x32_bf16 v[48:51], v[136:139], v[132:135], v[48:51]
    ds_read_b128 v[164:167], v201 offset:34816
    v_mfma_f32_16x16x32_bf16 v[52:55], v[140:143], v[132:135], v[52:55]
    ds_read_b128 v[168:171], v201 offset:36864
    v_mfma_f32_16x16x32_bf16 v[44:47], v[140:143], v[128:131], v[44:47]
    ds_read_b128 v[172:175], v201 offset:38912
    v_mfma_f32_16x16x32_bf16 v[36:39], v[140:143], v[124:127], v[36:39]
    ds_read_b64_tr_b16 v[180:181], v203 offset:36864
    v_mfma_f32_16x16x32_bf16 v[28:31], v[140:143], v[120:123], v[28:31]
    ds_read_b64_tr_b16 v[182:183], v203 offset:43008
    s_waitcnt lgkmcnt(8)
    v_mfma_f32_16x16x32_bf16 v[56:59], v[144:147], v[120:123], v[56:59]
    ds_read_b64_tr_b16 v[184:185], v202 offset:37888
    v_mfma_f32_16x16x32_bf16 v[64:67], v[144:147], v[124:127], v[64:67]
    ds_read_b64_tr_b16 v[186:187], v202 offset:44032
    v_mfma_f32_16x16x32_bf16 v[72:75], v[144:147], v[128:131], v[72:75]
    ds_read_b64_tr_b16 v[188:189], v203 offset:37888
    v_mfma_f32_16x16x32_bf16 v[80:83], v[144:147], v[132:135], v[80:83]
    ds_read_b64_tr_b16 v[190:191], v203 offset:44032
    v_mfma_f32_16x16x32_bf16 v[84:87], v[148:151], v[132:135], v[84:87]
    ds_read_b64_tr_b16 v[192:193], v202 offset:38912
    v_mfma_f32_16x16x32_bf16 v[76:79], v[148:151], v[128:131], v[76:79]
    ds_read_b64_tr_b16 v[194:195], v202 offset:45056
    v_mfma_f32_16x16x32_bf16 v[68:71], v[148:151], v[124:127], v[68:71]
    ds_read_b64_tr_b16 v[196:197], v203 offset:38912
    v_mfma_f32_16x16x32_bf16 v[60:63], v[148:151], v[120:123], v[60:63]
    ds_read_b64_tr_b16 v[198:199], v203 offset:45056
    v_mfma_f32_16x16x32_bf16 v[88:91], v[120:123], v[152:155], v[88:91]
    v_mfma_f32_16x16x32_bf16 v[104:107], v[120:123], v[156:159], v[104:107]
    v_mfma_f32_16x16x32_bf16 v[108:111], v[124:127], v[156:159], v[108:111]
    v_mfma_f32_16x16x32_bf16 v[92:95], v[124:127], v[152:155], v[92:95]
    v_mfma_f32_16x16x32_bf16 v[96:99], v[128:131], v[152:155], v[96:99]
    v_mfma_f32_16x16x32_bf16 v[112:115], v[128:131], v[156:159], v[112:115]
    v_mfma_f32_16x16x32_bf16 v[116:119], v[132:135], v[156:159], v[116:119]
    v_mfma_f32_16x16x32_bf16 v[100:103], v[132:135], v[152:155], v[100:103]
    s_waitcnt lgkmcnt(4)
    v_mfma_f32_16x16x32_bf16 v[24:27], v[176:179], v[160:163], v[24:27]
    s_waitcnt lgkmcnt(0)
    v_mfma_f32_16x16x32_bf16 v[32:35], v[176:179], v[164:167], v[32:35]
    s_barrier
    v_mfma_f32_16x16x32_bf16 v[40:43], v[176:179], v[168:171], v[40:43]
    ds_read_b128 v[120:123], v200 offset:0
    v_mfma_f32_16x16x32_bf16 v[48:51], v[176:179], v[172:175], v[48:51]
    ds_read_b64_tr_b16 v[136:137], v204 offset:0
    v_mfma_f32_16x16x32_bf16 v[52:55], v[180:183], v[172:175], v[52:55]
    ds_read_b64_tr_b16 v[138:139], v204 offset:6144
    v_mfma_f32_16x16x32_bf16 v[44:47], v[180:183], v[168:171], v[44:47]
    ds_read_b128 v[124:127], v200 offset:2048
    v_mfma_f32_16x16x32_bf16 v[36:39], v[180:183], v[164:167], v[36:39]
    ds_read_b128 v[128:131], v200 offset:4096
    v_mfma_f32_16x16x32_bf16 v[28:31], v[180:183], v[160:163], v[28:31]
    ds_read_b128 v[132:135], v200 offset:6144
    v_mfma_f32_16x16x32_bf16 v[56:59], v[184:187], v[160:163], v[56:59]
    ds_read_b64_tr_b16 v[140:141], v205 offset:0
    v_mfma_f32_16x16x32_bf16 v[64:67], v[184:187], v[164:167], v[64:67]
    ds_read_b64_tr_b16 v[142:143], v205 offset:6144
    v_mfma_f32_16x16x32_bf16 v[72:75], v[184:187], v[168:171], v[72:75]
    ds_read_b64_tr_b16 v[144:145], v204 offset:1024
    v_mfma_f32_16x16x32_bf16 v[80:83], v[184:187], v[172:175], v[80:83]
    ds_read_b64_tr_b16 v[146:147], v204 offset:7168
    v_mfma_f32_16x16x32_bf16 v[84:87], v[188:191], v[172:175], v[84:87]
    ds_read_b64_tr_b16 v[148:149], v205 offset:1024
    v_mfma_f32_16x16x32_bf16 v[76:79], v[188:191], v[168:171], v[76:79]
    ds_read_b64_tr_b16 v[150:151], v205 offset:7168
    v_mfma_f32_16x16x32_bf16 v[68:71], v[188:191], v[164:167], v[68:71]
    ds_read_b64_tr_b16 v[152:153], v204 offset:2048
    v_mfma_f32_16x16x32_bf16 v[60:63], v[188:191], v[160:163], v[60:63]
    ds_read_b64_tr_b16 v[154:155], v204 offset:8192
    v_mfma_f32_16x16x32_bf16 v[88:91], v[160:163], v[192:195], v[88:91]
    ds_read_b64_tr_b16 v[156:157], v205 offset:2048
    v_mfma_f32_16x16x32_bf16 v[104:107], v[160:163], v[196:199], v[104:107]
    ds_read_b64_tr_b16 v[158:159], v205 offset:8192
    v_mfma_f32_16x16x32_bf16 v[108:111], v[164:167], v[196:199], v[108:111]
    v_mfma_f32_16x16x32_bf16 v[92:95], v[164:167], v[192:195], v[92:95]
    v_mfma_f32_16x16x32_bf16 v[96:99], v[168:171], v[192:195], v[96:99]
    v_mfma_f32_16x16x32_bf16 v[112:115], v[168:171], v[196:199], v[112:115]
    v_mfma_f32_16x16x32_bf16 v[116:119], v[172:175], v[196:199], v[116:119]
    s_waitcnt lgkmcnt(4)
    v_mfma_f32_16x16x32_bf16 v[100:103], v[172:175], v[192:195], v[100:103]
    v_mfma_f32_16x16x32_bf16 v[24:27], v[136:139], v[120:123], v[24:27]
    ds_read_b128 v[160:163], v201 offset:0
    v_mfma_f32_16x16x32_bf16 v[32:35], v[136:139], v[124:127], v[32:35]
    ds_read_b64_tr_b16 v[176:177], v204 offset:12288
    v_mfma_f32_16x16x32_bf16 v[40:43], v[136:139], v[128:131], v[40:43]
    ds_read_b64_tr_b16 v[178:179], v204 offset:18432
    v_mfma_f32_16x16x32_bf16 v[48:51], v[136:139], v[132:135], v[48:51]
    ds_read_b128 v[164:167], v201 offset:2048
    v_mfma_f32_16x16x32_bf16 v[52:55], v[140:143], v[132:135], v[52:55]
    ds_read_b128 v[168:171], v201 offset:4096
    v_mfma_f32_16x16x32_bf16 v[44:47], v[140:143], v[128:131], v[44:47]
    ds_read_b128 v[172:175], v201 offset:6144
    v_mfma_f32_16x16x32_bf16 v[36:39], v[140:143], v[124:127], v[36:39]
    ds_read_b64_tr_b16 v[180:181], v205 offset:12288
    v_mfma_f32_16x16x32_bf16 v[28:31], v[140:143], v[120:123], v[28:31]
    ds_read_b64_tr_b16 v[182:183], v205 offset:18432
    s_waitcnt lgkmcnt(8)
    v_mfma_f32_16x16x32_bf16 v[56:59], v[144:147], v[120:123], v[56:59]
    ds_read_b64_tr_b16 v[184:185], v204 offset:13312
    v_mfma_f32_16x16x32_bf16 v[64:67], v[144:147], v[124:127], v[64:67]
    ds_read_b64_tr_b16 v[186:187], v204 offset:19456
    v_mfma_f32_16x16x32_bf16 v[72:75], v[144:147], v[128:131], v[72:75]
    ds_read_b64_tr_b16 v[188:189], v205 offset:13312
    v_mfma_f32_16x16x32_bf16 v[80:83], v[144:147], v[132:135], v[80:83]
    ds_read_b64_tr_b16 v[190:191], v205 offset:19456
    v_mfma_f32_16x16x32_bf16 v[84:87], v[148:151], v[132:135], v[84:87]
    ds_read_b64_tr_b16 v[192:193], v204 offset:14336
    v_mfma_f32_16x16x32_bf16 v[76:79], v[148:151], v[128:131], v[76:79]
    ds_read_b64_tr_b16 v[194:195], v204 offset:20480
    v_mfma_f32_16x16x32_bf16 v[68:71], v[148:151], v[124:127], v[68:71]
    ds_read_b64_tr_b16 v[196:197], v205 offset:14336
    v_mfma_f32_16x16x32_bf16 v[60:63], v[148:151], v[120:123], v[60:63]
    ds_read_b64_tr_b16 v[198:199], v205 offset:20480
    v_mfma_f32_16x16x32_bf16 v[88:91], v[120:123], v[152:155], v[88:91]
    v_mfma_f32_16x16x32_bf16 v[104:107], v[120:123], v[156:159], v[104:107]
    v_mfma_f32_16x16x32_bf16 v[108:111], v[124:127], v[156:159], v[108:111]
    v_mfma_f32_16x16x32_bf16 v[92:95], v[124:127], v[152:155], v[92:95]
    v_mfma_f32_16x16x32_bf16 v[96:99], v[128:131], v[152:155], v[96:99]
    v_mfma_f32_16x16x32_bf16 v[112:115], v[128:131], v[156:159], v[112:115]
    v_mfma_f32_16x16x32_bf16 v[116:119], v[132:135], v[156:159], v[116:119]
    v_mfma_f32_16x16x32_bf16 v[100:103], v[132:135], v[152:155], v[100:103]
    s_waitcnt lgkmcnt(4)
    v_mfma_f32_16x16x32_bf16 v[24:27], v[176:179], v[160:163], v[24:27]
    s_waitcnt lgkmcnt(0)
    v_mfma_f32_16x16x32_bf16 v[32:35], v[176:179], v[164:167], v[32:35]
    s_barrier
    v_mfma_f32_16x16x32_bf16 v[40:43], v[176:179], v[168:171], v[40:43]
    ds_read_b128 v[120:123], v200 offset:16384
    v_mfma_f32_16x16x32_bf16 v[48:51], v[176:179], v[172:175], v[48:51]
    ds_read_b64_tr_b16 v[136:137], v202 offset:0
    v_mfma_f32_16x16x32_bf16 v[52:55], v[180:183], v[172:175], v[52:55]
    ds_read_b64_tr_b16 v[138:139], v202 offset:6144
    v_mfma_f32_16x16x32_bf16 v[44:47], v[180:183], v[168:171], v[44:47]
    ds_read_b128 v[124:127], v200 offset:18432
    v_mfma_f32_16x16x32_bf16 v[36:39], v[180:183], v[164:167], v[36:39]
    ds_read_b128 v[128:131], v200 offset:20480
    v_mfma_f32_16x16x32_bf16 v[28:31], v[180:183], v[160:163], v[28:31]
    ds_read_b128 v[132:135], v200 offset:22528
    v_mfma_f32_16x16x32_bf16 v[56:59], v[184:187], v[160:163], v[56:59]
    ds_read_b64_tr_b16 v[140:141], v203 offset:0
    v_mfma_f32_16x16x32_bf16 v[64:67], v[184:187], v[164:167], v[64:67]
    ds_read_b64_tr_b16 v[142:143], v203 offset:6144
    v_mfma_f32_16x16x32_bf16 v[72:75], v[184:187], v[168:171], v[72:75]
    ds_read_b64_tr_b16 v[144:145], v202 offset:1024
    v_mfma_f32_16x16x32_bf16 v[80:83], v[184:187], v[172:175], v[80:83]
    ds_read_b64_tr_b16 v[146:147], v202 offset:7168
    v_mfma_f32_16x16x32_bf16 v[84:87], v[188:191], v[172:175], v[84:87]
    ds_read_b64_tr_b16 v[148:149], v203 offset:1024
    v_mfma_f32_16x16x32_bf16 v[76:79], v[188:191], v[168:171], v[76:79]
    ds_read_b64_tr_b16 v[150:151], v203 offset:7168
    v_mfma_f32_16x16x32_bf16 v[68:71], v[188:191], v[164:167], v[68:71]
    ds_read_b64_tr_b16 v[152:153], v202 offset:2048
    v_mfma_f32_16x16x32_bf16 v[60:63], v[188:191], v[160:163], v[60:63]
    ds_read_b64_tr_b16 v[154:155], v202 offset:8192
    v_mfma_f32_16x16x32_bf16 v[88:91], v[160:163], v[192:195], v[88:91]
    ds_read_b64_tr_b16 v[156:157], v203 offset:2048
    v_mfma_f32_16x16x32_bf16 v[104:107], v[160:163], v[196:199], v[104:107]
    ds_read_b64_tr_b16 v[158:159], v203 offset:8192
    v_mfma_f32_16x16x32_bf16 v[108:111], v[164:167], v[196:199], v[108:111]
    v_mfma_f32_16x16x32_bf16 v[92:95], v[164:167], v[192:195], v[92:95]
    v_mfma_f32_16x16x32_bf16 v[96:99], v[168:171], v[192:195], v[96:99]
    v_mfma_f32_16x16x32_bf16 v[112:115], v[168:171], v[196:199], v[112:115]
    v_mfma_f32_16x16x32_bf16 v[116:119], v[172:175], v[196:199], v[116:119]
    s_waitcnt lgkmcnt(4)
    v_mfma_f32_16x16x32_bf16 v[100:103], v[172:175], v[192:195], v[100:103]
    v_mfma_f32_16x16x32_bf16 v[24:27], v[136:139], v[120:123], v[24:27]
    ds_read_b128 v[160:163], v201 offset:16384
    v_mfma_f32_16x16x32_bf16 v[32:35], v[136:139], v[124:127], v[32:35]
    ds_read_b64_tr_b16 v[176:177], v202 offset:12288
    v_mfma_f32_16x16x32_bf16 v[40:43], v[136:139], v[128:131], v[40:43]
    ds_read_b64_tr_b16 v[178:179], v202 offset:18432
    v_mfma_f32_16x16x32_bf16 v[48:51], v[136:139], v[132:135], v[48:51]
    ds_read_b128 v[164:167], v201 offset:18432
    v_mfma_f32_16x16x32_bf16 v[52:55], v[140:143], v[132:135], v[52:55]
    ds_read_b128 v[168:171], v201 offset:20480
    v_mfma_f32_16x16x32_bf16 v[44:47], v[140:143], v[128:131], v[44:47]
    ds_read_b128 v[172:175], v201 offset:22528
    v_mfma_f32_16x16x32_bf16 v[36:39], v[140:143], v[124:127], v[36:39]
    ds_read_b64_tr_b16 v[180:181], v203 offset:12288
    v_mfma_f32_16x16x32_bf16 v[28:31], v[140:143], v[120:123], v[28:31]
    ds_read_b64_tr_b16 v[182:183], v203 offset:18432
    s_waitcnt lgkmcnt(8)
    v_mfma_f32_16x16x32_bf16 v[56:59], v[144:147], v[120:123], v[56:59]
    ds_read_b64_tr_b16 v[184:185], v202 offset:13312
    v_mfma_f32_16x16x32_bf16 v[64:67], v[144:147], v[124:127], v[64:67]
    ds_read_b64_tr_b16 v[186:187], v202 offset:19456
    v_mfma_f32_16x16x32_bf16 v[72:75], v[144:147], v[128:131], v[72:75]
    ds_read_b64_tr_b16 v[188:189], v203 offset:13312
    v_mfma_f32_16x16x32_bf16 v[80:83], v[144:147], v[132:135], v[80:83]
    ds_read_b64_tr_b16 v[190:191], v203 offset:19456
    v_mfma_f32_16x16x32_bf16 v[84:87], v[148:151], v[132:135], v[84:87]
    ds_read_b64_tr_b16 v[192:193], v202 offset:14336
    v_mfma_f32_16x16x32_bf16 v[76:79], v[148:151], v[128:131], v[76:79]
    ds_read_b64_tr_b16 v[194:195], v202 offset:20480
    v_mfma_f32_16x16x32_bf16 v[68:71], v[148:151], v[124:127], v[68:71]
    ds_read_b64_tr_b16 v[196:197], v203 offset:14336
    v_mfma_f32_16x16x32_bf16 v[60:63], v[148:151], v[120:123], v[60:63]
    ds_read_b64_tr_b16 v[198:199], v203 offset:20480
    v_mfma_f32_16x16x32_bf16 v[88:91], v[120:123], v[152:155], v[88:91]
    v_mfma_f32_16x16x32_bf16 v[104:107], v[120:123], v[156:159], v[104:107]
    v_mfma_f32_16x16x32_bf16 v[108:111], v[124:127], v[156:159], v[108:111]
    v_mfma_f32_16x16x32_bf16 v[92:95], v[124:127], v[152:155], v[92:95]
    v_mfma_f32_16x16x32_bf16 v[96:99], v[128:131], v[152:155], v[96:99]
    v_mfma_f32_16x16x32_bf16 v[112:115], v[128:131], v[156:159], v[112:115]
    v_mfma_f32_16x16x32_bf16 v[116:119], v[132:135], v[156:159], v[116:119]
    v_mfma_f32_16x16x32_bf16 v[100:103], v[132:135], v[152:155], v[100:103]
    s_waitcnt lgkmcnt(4)
    v_mfma_f32_16x16x32_bf16 v[24:27], v[176:179], v[160:163], v[24:27]
    s_waitcnt lgkmcnt(0)
    v_mfma_f32_16x16x32_bf16 v[32:35], v[176:179], v[164:167], v[32:35]
    s_barrier
    v_mfma_f32_16x16x32_bf16 v[40:43], v[176:179], v[168:171], v[40:43]
    ds_read_b128 v[120:123], v200 offset:32768
    v_mfma_f32_16x16x32_bf16 v[48:51], v[176:179], v[172:175], v[48:51]
    ds_read_b64_tr_b16 v[136:137], v202 offset:24576
    v_mfma_f32_16x16x32_bf16 v[52:55], v[180:183], v[172:175], v[52:55]
    ds_read_b64_tr_b16 v[138:139], v202 offset:30720
    v_mfma_f32_16x16x32_bf16 v[44:47], v[180:183], v[168:171], v[44:47]
    ds_read_b128 v[124:127], v200 offset:34816
    v_mfma_f32_16x16x32_bf16 v[36:39], v[180:183], v[164:167], v[36:39]
    ds_read_b128 v[128:131], v200 offset:36864
    v_mfma_f32_16x16x32_bf16 v[28:31], v[180:183], v[160:163], v[28:31]
    ds_read_b128 v[132:135], v200 offset:38912
    v_mfma_f32_16x16x32_bf16 v[56:59], v[184:187], v[160:163], v[56:59]
    ds_read_b64_tr_b16 v[140:141], v203 offset:24576
    v_mfma_f32_16x16x32_bf16 v[64:67], v[184:187], v[164:167], v[64:67]
    ds_read_b64_tr_b16 v[142:143], v203 offset:30720
    v_mfma_f32_16x16x32_bf16 v[72:75], v[184:187], v[168:171], v[72:75]
    ds_read_b64_tr_b16 v[144:145], v202 offset:25600
    v_mfma_f32_16x16x32_bf16 v[80:83], v[184:187], v[172:175], v[80:83]
    ds_read_b64_tr_b16 v[146:147], v202 offset:31744
    v_mfma_f32_16x16x32_bf16 v[84:87], v[188:191], v[172:175], v[84:87]
    ds_read_b64_tr_b16 v[148:149], v203 offset:25600
    v_mfma_f32_16x16x32_bf16 v[76:79], v[188:191], v[168:171], v[76:79]
    ds_read_b64_tr_b16 v[150:151], v203 offset:31744
    v_mfma_f32_16x16x32_bf16 v[68:71], v[188:191], v[164:167], v[68:71]
    ds_read_b64_tr_b16 v[152:153], v202 offset:26624
    v_mfma_f32_16x16x32_bf16 v[60:63], v[188:191], v[160:163], v[60:63]
    ds_read_b64_tr_b16 v[154:155], v202 offset:32768
    v_mfma_f32_16x16x32_bf16 v[88:91], v[160:163], v[192:195], v[88:91]
    ds_read_b64_tr_b16 v[156:157], v203 offset:26624
    v_mfma_f32_16x16x32_bf16 v[104:107], v[160:163], v[196:199], v[104:107]
    ds_read_b64_tr_b16 v[158:159], v203 offset:32768
    v_mfma_f32_16x16x32_bf16 v[108:111], v[164:167], v[196:199], v[108:111]
    v_mfma_f32_16x16x32_bf16 v[92:95], v[164:167], v[192:195], v[92:95]
    s_add_u32 s74, s74, 1
    v_mfma_f32_16x16x32_bf16 v[96:99], v[168:171], v[192:195], v[96:99]
    s_cmp_lt_u32 s74, 4
    v_mfma_f32_16x16x32_bf16 v[112:115], v[168:171], v[196:199], v[112:115]
    v_mfma_f32_16x16x32_bf16 v[116:119], v[172:175], v[196:199], v[116:119]
    s_waitcnt lgkmcnt(4)
    v_mfma_f32_16x16x32_bf16 v[100:103], v[172:175], v[192:195], v[100:103]
    s_cbranch_scc1 L_cloop
    v_mfma_f32_16x16x32_bf16 v[24:27], v[136:139], v[120:123], v[24:27]
    ds_read_b128 v[160:163], v201 offset:32768
    v_mfma_f32_16x16x32_bf16 v[32:35], v[136:139], v[124:127], v[32:35]
    ds_read_b64_tr_b16 v[176:177], v202 offset:36864
    v_mfma_f32_16x16x32_bf16 v[40:43], v[136:139], v[128:131], v[40:43]
    ds_read_b64_tr_b16 v[178:179], v202 offset:43008
    v_mfma_f32_16x16x32_bf16 v[48:51], v[136:139], v[132:135], v[48:51]
    ds_read_b128 v[164:167], v201 offset:34816
    v_mfma_f32_16x16x32_bf16 v[52:55], v[140:143], v[132:135], v[52:55]
    ds_read_b128 v[168:171], v201 offset:36864
    v_mfma_f32_16x16x32_bf16 v[44:47], v[140:143], v[128:131], v[44:47]
    ds_read_b128 v[172:175], v201 offset:38912
    v_mfma_f32_16x16x32_bf16 v[36:39], v[140:143], v[124:127], v[36:39]
    ds_read_b64_tr_b16 v[180:181], v203 offset:36864
    v_mfma_f32_16x16x32_bf16 v[28:31], v[140:143], v[120:123], v[28:31]
    ds_read_b64_tr_b16 v[182:183], v203 offset:43008
    s_waitcnt lgkmcnt(8)
    v_mfma_f32_16x16x32_bf16 v[56:59], v[144:147], v[120:123], v[56:59]
    ds_read_b64_tr_b16 v[184:185], v202 offset:37888
    v_mfma_f32_16x16x32_bf16 v[64:67], v[144:147], v[124:127], v[64:67]
    ds_read_b64_tr_b16 v[186:187], v202 offset:44032
    v_mfma_f32_16x16x32_bf16 v[72:75], v[144:147], v[128:131], v[72:75]
    ds_read_b64_tr_b16 v[188:189], v203 offset:37888
    v_mfma_f32_16x16x32_bf16 v[80:83], v[144:147], v[132:135], v[80:83]
    ds_read_b64_tr_b16 v[190:191], v203 offset:44032
    v_mfma_f32_16x16x32_bf16 v[84:87], v[148:151], v[132:135], v[84:87]
    ds_read_b64_tr_b16 v[192:193], v202 offset:38912
    v_mfma_f32_16x16x32_bf16 v[76:79], v[148:151], v[128:131], v[76:79]
    ds_read_b64_tr_b16 v[194:195], v202 offset:45056
    v_mfma_f32_16x16x32_bf16 v[68:71], v[148:151], v[124:127], v[68:71]
    ds_read_b64_tr_b16 v[196:197], v203 offset:38912
    v_mfma_f32_16x16x32_bf16 v[60:63], v[148:151], v[120:123], v[60:63]
    ds_read_b64_tr_b16 v[198:199], v203 offset:45056
    v_mfma_f32_16x16x32_bf16 v[88:91], v[120:123], v[152:155], v[88:91]
    v_mfma_f32_16x16x32_bf16 v[104:107], v[120:123], v[156:159], v[104:107]
    v_mov_b32 v252, 132864
    v_mfma_f32_16x16x32_bf16 v[108:111], v[124:127], v[156:159], v[108:111]
    v_mfma_f32_16x16x32_bf16 v[92:95], v[124:127], v[152:155], v[92:95]
    v_mfma_f32_16x16x32_bf16 v[96:99], v[128:131], v[152:155], v[96:99]
    v_mfma_f32_16x16x32_bf16 v[112:115], v[128:131], v[156:159], v[112:115]
    v_mfma_f32_16x16x32_bf16 v[116:119], v[132:135], v[156:159], v[116:119]
    v_mfma_f32_16x16x32_bf16 v[100:103], v[132:135], v[152:155], v[100:103]
    s_waitcnt lgkmcnt(4)
    v_mfma_f32_16x16x32_bf16 v[24:27], v[176:179], v[160:163], v[24:27]
    s_waitcnt lgkmcnt(0)
    v_mfma_f32_16x16x32_bf16 v[32:35], v[176:179], v[164:167], v[32:35]
    s_barrier
    v_mfma_f32_16x16x32_bf16 v[40:43], v[176:179], v[168:171], v[40:43]
    ds_read_b128 v[120:123], v200 offset:0
    v_mfma_f32_16x16x32_bf16 v[48:51], v[176:179], v[172:175], v[48:51]
    ds_read_b64_tr_b16 v[136:137], v204 offset:0
    v_mfma_f32_16x16x32_bf16 v[52:55], v[180:183], v[172:175], v[52:55]
    ds_read_b64_tr_b16 v[138:139], v204 offset:6144
    v_mfma_f32_16x16x32_bf16 v[44:47], v[180:183], v[168:171], v[44:47]
    ds_read_b128 v[124:127], v200 offset:2048
    v_mfma_f32_16x16x32_bf16 v[36:39], v[180:183], v[164:167], v[36:39]
    ds_read_b128 v[128:131], v200 offset:4096
    v_mfma_f32_16x16x32_bf16 v[28:31], v[180:183], v[160:163], v[28:31]
    ds_read_b128 v[132:135], v200 offset:6144
    v_mfma_f32_16x16x32_bf16 v[56:59], v[184:187], v[160:163], v[56:59]
    ds_read_b64_tr_b16 v[140:141], v205 offset:0
    v_mfma_f32_16x16x32_bf16 v[64:67], v[184:187], v[164:167], v[64:67]
    ds_read_b64_tr_b16 v[142:143], v205 offset:6144
    v_mfma_f32_16x16x32_bf16 v[72:75], v[184:187], v[168:171], v[72:75]
    ds_read_b64_tr_b16 v[144:145], v204 offset:1024
    v_mfma_f32_16x16x32_bf16 v[80:83], v[184:187], v[172:175], v[80:83]
    ds_read_b64_tr_b16 v[146:147], v204 offset:7168
    v_mfma_f32_16x16x32_bf16 v[84:87], v[188:191], v[172:175], v[84:87]
    ds_read_b64_tr_b16 v[148:149], v205 offset:1024
    v_mfma_f32_16x16x32_bf16 v[76:79], v[188:191], v[168:171], v[76:79]
    ds_read_b64_tr_b16 v[150:151], v205 offset:7168
    v_mfma_f32_16x16x32_bf16 v[68:71], v[188:191], v[164:167], v[68:71]
    ds_read_b64_tr_b16 v[152:153], v204 offset:2048
    v_mfma_f32_16x16x32_bf16 v[60:63], v[188:191], v[160:163], v[60:63]
    ds_read_b64_tr_b16 v[154:155], v204 offset:8192
    v_mfma_f32_16x16x32_bf16 v[88:91], v[160:163], v[192:195], v[88:91]
    ds_read_b64_tr_b16 v[156:157], v205 offset:2048
    v_mfma_f32_16x16x32_bf16 v[104:107], v[160:163], v[196:199], v[104:107]
    ds_read_b64_tr_b16 v[158:159], v205 offset:8192
    v_mfma_f32_16x16x32_bf16 v[108:111], v[164:167], v[196:199], v[108:111]
    v_mfma_f32_16x16x32_bf16 v[92:95], v[164:167], v[192:195], v[92:95]
    v_mfma_f32_16x16x32_bf16 v[96:99], v[168:171], v[192:195], v[96:99]
    v_mfma_f32_16x16x32_bf16 v[112:115], v[168:171], v[196:199], v[112:115]
    v_mfma_f32_16x16x32_bf16 v[116:119], v[172:175], v[196:199], v[116:119]
    s_waitcnt lgkmcnt(4)
    v_mfma_f32_16x16x32_bf16 v[100:103], v[172:175], v[192:195], v[100:103]
    v_mfma_f32_16x16x32_bf16 v[56:59], v[144:147], v[120:123], v[56:59]
    ds_read_b128 v[160:163], v201 offset:0
    v_mfma_f32_16x16x32_bf16 v[64:67], v[144:147], v[124:127], v[64:67]
    ds_read_b64_tr_b16 v[184:185], v204 offset:13312
    v_mfma_f32_16x16x32_bf16 v[72:75], v[144:147], v[128:131], v[72:75]
    ds_read_b64_tr_b16 v[186:187], v204 offset:19456
    v_mfma_f32_16x16x32_bf16 v[80:83], v[144:147], v[132:135], v[80:83]
    ds_read_b128 v[164:167], v201 offset:2048
    v_mfma_f32_16x16x32_bf16 v[84:87], v[148:151], v[132:135], v[84:87]
    ds_read_b128 v[168:171], v201 offset:4096
    v_mfma_f32_16x16x32_bf16 v[76:79], v[148:151], v[128:131], v[76:79]
    ds_read_b128 v[172:175], v201 offset:6144
    v_mfma_f32_16x16x32_bf16 v[68:71], v[148:151], v[124:127], v[68:71]
    ds_read_b64_tr_b16 v[188:189], v205 offset:13312
    v_mfma_f32_16x16x32_bf16 v[60:63], v[148:151], v[120:123], v[60:63]
    ds_read_b64_tr_b16 v[190:191], v205 offset:19456
    s_waitcnt lgkmcnt(8)
    v_mfma_f32_16x16x32_bf16 v[88:91], v[120:123], v[152:155], v[88:91]
    ds_read_b64_tr_b16 v[192:193], v204 offset:14336
    v_mfma_f32_16x16x32_bf16 v[104:107], v[120:123], v[156:159], v[104:107]
    ds_read_b64_tr_b16 v[194:195], v204 offset:20480
    v_mfma_f32_16x16x32_bf16 v[108:111], v[124:127], v[156:159], v[108:111]
    ds_read_b64_tr_b16 v[196:197], v205 offset:14336
    v_mfma_f32_16x16x32_bf16 v[92:95], v[124:127], v[152:155], v[92:95]
    ds_read_b64_tr_b16 v[198:199], v205 offset:20480
    v_mfma_f32_16x16x32_bf16 v[96:99], v[128:131], v[152:155], v[96:99]
    ds_read_b64_tr_b16 v[176:177], v204 offset:12288
    v_mfma_f32_16x16x32_bf16 v[112:115], v[128:131], v[156:159], v[112:115]
    ds_read_b64_tr_b16 v[178:179], v204 offset:18432
    v_mfma_f32_16x16x32_bf16 v[116:119], v[132:135], v[156:159], v[116:119]
    ds_read_b64_tr_b16 v[180:181], v205 offset:12288
    v_mfma_f32_16x16x32_bf16 v[100:103], v[132:135], v[152:155], v[100:103]
    ds_read_b64_tr_b16 v[182:183], v205 offset:18432
    s_waitcnt lgkmcnt(8)
    v_mfma_f32_16x16x32_bf16 v[56:59], v[184:187], v[160:163], v[56:59]
    ds_read2_b32 v[212:213], v248 offset0:48 offset1:176
    v_mfma_f32_16x16x32_bf16 v[64:67], v[184:187], v[164:167], v[64:67]
    ds_read_b128 v[214:217], v250 offset:256
    v_mfma_f32_16x16x32_bf16 v[72:75], v[184:187], v[168:171], v[72:75]
    ds_read_b128 v[218:221], v250 offset:320
    v_mfma_f32_16x16x32_bf16 v[80:83], v[184:187], v[172:175], v[80:83]
    ds_read2_b32 v[230:231], v251 offset0:128 offset1:144
    v_mfma_f32_16x16x32_bf16 v[84:87], v[188:191], v[172:175], v[84:87]
    ds_read_b128 v[232:235], v249 offset:192
    s_waitcnt lgkmcnt(5)
    v_mfma_f32_16x16x32_bf16 v[76:79], v[188:191], v[168:171], v[76:79]
    ds_read_b128 v[236:239], v249 offset:704
    s_barrier
    v_mfma_f32_16x16x32_bf16 v[68:71], v[188:191], v[164:167], v[68:71]
    ds_read2_b32 v[210:211], v248 offset0:32 offset1:160
    v_mfma_f32_16x16x32_bf16 v[60:63], v[188:191], v[160:163], v[60:63]
    ds_read_b128 v[240:243], v249 offset:128
    v_mfma_f32_16x16x32_bf16 v[88:91], v[160:163], v[192:195], v[88:91]
    ds_read_b128 v[244:247], v249 offset:640
    v_mfma_f32_16x16x32_bf16 v[104:107], v[160:163], v[196:199], v[104:107]
    ds_read2_b32 v[208:209], v248 offset0:16 offset1:144
    v_mfma_f32_16x16x32_bf16 v[108:111], v[164:167], v[196:199], v[108:111]
    ds_read_b128 v[144:147], v249 offset:64
    v_mfma_f32_16x16x32_bf16 v[92:95], v[164:167], v[192:195], v[92:95]
    ds_read_b128 v[148:151], v249 offset:576
    v_mfma_f32_16x16x32_bf16 v[96:99], v[168:171], v[192:195], v[96:99]
    ds_read2_b32 v[206:207], v248 offset0:0 offset1:128
    s_bitcmp1_b32 s22, 0
    v_mfma_f32_16x16x32_bf16 v[112:115], v[168:171], v[196:199], v[112:115]
    ds_read_b128 v[152:155], v249 offset:0
    v_mfma_f32_16x16x32_bf16 v[116:119], v[172:175], v[196:199], v[116:119]
    ds_read_b128 v[156:159], v249 offset:512
    v_mfma_f32_16x16x32_bf16 v[100:103], v[172:175], v[192:195], v[100:103]
    ds_read_b128 v[192:195], v250 offset:0
    ds_read_b128 v[196:199], v250 offset:64
    ds_read_b32 v252, v252
    s_cbranch_scc1 L_tailB
    s_add_u32 s27, s73, 8192
    s_waitcnt lgkmcnt(9)
    v_pk_mul_f32 v[184:185], v[214:215], v[212:213] op_sel:[0,1] op_sel_hi:[1,1]
    v_pk_fma_f32 v[184:185], v[80:81], v[212:213], v[184:185] op_sel_hi:[1,0,1]
    v_cvt_pk_bf16_f32 v80, v184, v185
    v_pk_mul_f32 v[186:187], v[216:217], v[212:213] op_sel:[0,1] op_sel_hi:[1,1]
    v_pk_fma_f32 v[186:187], v[82:83], v[212:213], v[186:187] op_sel_hi:[1,0,1]
    v_cvt_pk_bf16_f32 v81, v186, v187
    v_pk_mul_f32 v[188:189], v[218:219], v[212:213] op_sel:[0,1] op_sel_hi:[1,1]
    v_pk_fma_f32 v[188:189], v[84:85], v[212:213], v[188:189] op_sel_hi:[1,0,1]
    v_cvt_pk_bf16_f32 v82, v188, v189
    v_pk_mul_f32 v[190:191], v[220:221], v[212:213] op_sel:[0,1] op_sel_hi:[1,1]
    v_pk_fma_f32 v[190:191], v[86:87], v[212:213], v[190:191] op_sel_hi:[1,0,1]
    v_cvt_pk_bf16_f32 v83, v190, v191
    buffer_store_dwordx4 v[80:83], v0, s[12:15], s27 offen offset:1024 sc1
    v_pk_mul_f32 v[186:187], v[238:239], v[230:231] op_sel:[0,0] op_sel_hi:[1,0]
    v_pk_fma_f32 v[186:187], v[102:103], v[234:235], v[186:187]
    v_cvt_pk_bf16_f32 v103, v186, v187
    v_pk_mul_f32 v[184:185], v[236:237], v[230:231] op_sel:[0,0] op_sel_hi:[1,0]
    v_pk_fma_f32 v[184:185], v[100:101], v[232:233], v[184:185]
    v_cvt_pk_bf16_f32 v102, v184, v185
    v_pk_mul_f32 v[190:191], v[238:239], v[230:231] op_sel:[0,1] op_sel_hi:[1,1]
    v_pk_fma_f32 v[190:191], v[118:119], v[234:235], v[190:191]
    v_cvt_pk_bf16_f32 v119, v190, v191
    v_pk_mul_f32 v[188:189], v[236:237], v[230:231] op_sel:[0,1] op_sel_hi:[1,1]
    v_pk_fma_f32 v[188:189], v[116:117], v[232:233], v[188:189]
    v_cvt_pk_bf16_f32 v118, v188, v189
    v_pk_mul_f32 v[184:185], v[214:215], v[210:211] op_sel:[0,1] op_sel_hi:[1,1]
    v_pk_fma_f32 v[184:185], v[72:73], v[210:211], v[184:185] op_sel_hi:[1,0,1]
    v_cvt_pk_bf16_f32 v72, v184, v185
    v_pk_mul_f32 v[186:187], v[216:217], v[210:211] op_sel:[0,1] op_sel_hi:[1,1]
    v_pk_fma_f32 v[186:187], v[74:75], v[210:211], v[186:187] op_sel_hi:[1,0,1]
    v_cvt_pk_bf16_f32 v73, v186, v187
    v_pk_mul_f32 v[188:189], v[218:219], v[210:211] op_sel:[0,1] op_sel_hi:[1,1]
    v_pk_fma_f32 v[188:189], v[76:77], v[210:211], v[188:189] op_sel_hi:[1,0,1]
    v_cvt_pk_bf16_f32 v74, v188, v189
    v_pk_mul_f32 v[190:191], v[220:221], v[210:211] op_sel:[0,1] op_sel_hi:[1,1]
    v_pk_fma_f32 v[190:191], v[78:79], v[210:211], v[190:191] op_sel_hi:[1,0,1]
    v_cvt_pk_bf16_f32 v75, v190, v191
    buffer_store_dwordx4 v[72:75], v0, s[12:15], s27 offen offset:0 sc1
    v_pk_mul_f32 v[186:187], v[246:247], v[230:231] op_sel:[0,0] op_sel_hi:[1,0]
    v_pk_fma_f32 v[186:187], v[98:99], v[242:243], v[186:187]
    v_cvt_pk_bf16_f32 v101, v186, v187
    v_pk_mul_f32 v[184:185], v[244:245], v[230:231] op_sel:[0,0] op_sel_hi:[1,0]
    v_pk_fma_f32 v[184:185], v[96:97], v[240:241], v[184:185]
    v_cvt_pk_bf16_f32 v100, v184, v185
    buffer_store_dwordx4 v[100:103], v0, s[12:15], s27 offen offset:2048 sc1
    v_pk_mul_f32 v[190:191], v[246:247], v[230:231] op_sel:[0,1] op_sel_hi:[1,1]
    v_pk_fma_f32 v[190:191], v[114:115], v[242:243], v[190:191]
    v_cvt_pk_bf16_f32 v117, v190, v191
    v_pk_mul_f32 v[188:189], v[244:245], v[230:231] op_sel:[0,1] op_sel_hi:[1,1]
    v_pk_fma_f32 v[188:189], v[112:113], v[240:241], v[188:189]
    v_cvt_pk_bf16_f32 v116, v188, v189
    buffer_store_dwordx4 v[116:119], v0, s[12:15], s27 offen offset:3072 sc1
    s_waitcnt lgkmcnt(0)
    v_pk_mul_f32 v[184:185], v[214:215], v[208:209] op_sel:[0,1] op_sel_hi:[1,1]
    v_pk_fma_f32 v[184:185], v[64:65], v[208:209], v[184:185] op_sel_hi:[1,0,1]
    v_cvt_pk_bf16_f32 v64, v184, v185
    v_pk_mul_f32 v[186:187], v[216:217], v[208:209] op_sel:[0,1] op_sel_hi:[1,1]
    v_pk_fma_f32 v[186:187], v[66:67], v[208:209], v[186:187] op_sel_hi:[1,0,1]
    v_cvt_pk_bf16_f32 v65, v186, v187
    v_pk_mul_f32 v[188:189], v[218:219], v[208:209] op_sel:[0,1] op_sel_hi:[1,1]
    v_pk_fma_f32 v[188:189], v[68:69], v[208:209], v[188:189] op_sel_hi:[1,0,1]
    v_cvt_pk_bf16_f32 v66, v188, v189
    v_pk_mul_f32 v[190:191], v[220:221], v[208:209] op_sel:[0,1] op_sel_hi:[1,1]
    v_pk_fma_f32 v[190:191], v[70:71], v[208:209], v[190:191] op_sel_hi:[1,0,1]
    v_cvt_pk_bf16_f32 v67, v190, v191
    buffer_store_dwordx4 v[64:67], v0, s[12:15], s73 offen offset:1024 sc1
    v_pk_mul_f32 v[186:187], v[150:151], v[230:231] op_sel:[0,0] op_sel_hi:[1,0]
    v_pk_fma_f32 v[186:187], v[94:95], v[146:147], v[186:187]
    v_cvt_pk_bf16_f32 v99, v186, v187
    v_pk_mul_f32 v[184:185], v[148:149], v[230:231] op_sel:[0,0] op_sel_hi:[1,0]
    v_pk_fma_f32 v[184:185], v[92:93], v[144:145], v[184:185]
    v_cvt_pk_bf16_f32 v98, v184, v185
    v_pk_mul_f32 v[190:191], v[150:151], v[230:231] op_sel:[0,1] op_sel_hi:[1,1]
    v_pk_fma_f32 v[190:191], v[110:111], v[146:147], v[190:191]
    v_cvt_pk_bf16_f32 v115, v190, v191
    v_pk_mul_f32 v[188:189], v[148:149], v[230:231] op_sel:[0,1] op_sel_hi:[1,1]
    v_pk_fma_f32 v[188:189], v[108:109], v[144:145], v[188:189]
    v_cvt_pk_bf16_f32 v114, v188, v189
    v_pk_mul_f32 v[184:185], v[214:215], v[206:207] op_sel:[0,1] op_sel_hi:[1,1]
    v_pk_fma_f32 v[184:185], v[56:57], v[206:207], v[184:185] op_sel_hi:[1,0,1]
    v_cvt_pk_bf16_f32 v56, v184, v185
    v_pk_mul_f32 v[186:187], v[216:217], v[206:207] op_sel:[0,1] op_sel_hi:[1,1]
    v_pk_fma_f32 v[186:187], v[58:59], v[206:207], v[186:187] op_sel_hi:[1,0,1]
    v_cvt_pk_bf16_f32 v57, v186, v187
    v_pk_mul_f32 v[188:189], v[218:219], v[206:207] op_sel:[0,1] op_sel_hi:[1,1]
    v_pk_fma_f32 v[188:189], v[60:61], v[206:207], v[188:189] op_sel_hi:[1,0,1]
    v_cvt_pk_bf16_f32 v58, v188, v189
    v_pk_mul_f32 v[190:191], v[220:221], v[206:207] op_sel:[0,1] op_sel_hi:[1,1]
    v_pk_fma_f32 v[190:191], v[62:63], v[206:207], v[190:191] op_sel_hi:[1,0,1]
    v_cvt_pk_bf16_f32 v59, v190, v191
    buffer_store_dwordx4 v[56:59], v0, s[12:15], s73 offen offset:0 sc1
    v_pk_mul_f32 v[186:187], v[158:159], v[230:231] op_sel:[0,0] op_sel_hi:[1,0]
    v_pk_fma_f32 v[186:187], v[90:91], v[154:155], v[186:187]
    v_cvt_pk_bf16_f32 v97, v186, v187
    v_pk_mul_f32 v[184:185], v[156:157], v[230:231] op_sel:[0,0] op_sel_hi:[1,0]
    v_pk_fma_f32 v[184:185], v[88:89], v[152:153], v[184:185]
    v_cvt_pk_bf16_f32 v96, v184, v185
    buffer_store_dwordx4 v[96:99], v0, s[12:15], s73 offen offset:2048 sc1
    v_pk_mul_f32 v[190:191], v[158:159], v[230:231] op_sel:[0,1] op_sel_hi:[1,1]
    v_pk_fma_f32 v[190:191], v[106:107], v[154:155], v[190:191]
    v_cvt_pk_bf16_f32 v113, v190, v191
    v_pk_mul_f32 v[188:189], v[156:157], v[230:231] op_sel:[0,1] op_sel_hi:[1,1]
    v_pk_fma_f32 v[188:189], v[104:105], v[152:153], v[188:189]
    v_cvt_pk_bf16_f32 v112, v188, v189
    buffer_store_dwordx4 v[112:115], v0, s[12:15], s73 offen offset:3072 sc1
    s_cmp_eq_u32 s22, 0
    s_cbranch_scc0 Lw_91
    v_readfirstlane_b32 s23, v252
Lw_91:
    s_and_b32 s27, s73, 0x7fff
    s_add_u32 s27, s27, 65536
    v_add_u32 v253, s27, v0
    s_cmp_ge_u32 s3, 2
    s_cbranch_scc1 L_tailA3
    v_mfma_f32_16x16x32_bf16 v[24:27], v[136:139], v[120:123], v[24:27]
    ds_write_b128 v253, v[56:59] offset:0
    v_mfma_f32_16x16x32_bf16 v[32:35], v[136:139], v[124:127], v[32:35]
    s_mov_b32 s35, 1048744942
    v_mul_f32 v206, s35, v206
    v_mfma_f32_16x16x32_bf16 v[40:43], v[136:139], v[128:131], v[40:43]
    ds_write_b128 v253, v[64:67] offset:1024
    v_mfma_f32_16x16x32_bf16 v[48:51], v[136:139], v[132:135], v[48:51]
    v_mul_f32 v207, s35, v207
    v_mul_f32 v208, s35, v208
    v_mfma_f32_16x16x32_bf16 v[52:55], v[140:143], v[132:135], v[52:55]
    ds_write_b128 v253, v[96:99] offset:2048
    v_mfma_f32_16x16x32_bf16 v[44:47], v[140:143], v[128:131], v[44:47]
    v_mul_f32 v209, s35, v209
    v_mul_f32 v210, s35, v210
    v_mfma_f32_16x16x32_bf16 v[36:39], v[140:143], v[124:127], v[36:39]
    ds_write_b128 v253, v[112:115] offset:3072
    v_mfma_f32_16x16x32_bf16 v[28:31], v[140:143], v[120:123], v[28:31]
    v_mul_f32 v211, s35, v211
    v_mul_f32 v212, s35, v212
    v_mfma_f32_16x16x32_bf16 v[24:27], v[176:179], v[160:163], v[24:27]
    ds_write_b128 v253, v[72:75] offset:8192
    v_mfma_f32_16x16x32_bf16 v[32:35], v[176:179], v[164:167], v[32:35]
    v_mul_f32 v213, s35, v213
    s_xor_b32 s28, s3, 2
    v_mfma_f32_16x16x32_bf16 v[40:43], v[176:179], v[168:171], v[40:43]
    ds_write_b128 v253, v[80:83] offset:9216
    v_mfma_f32_16x16x32_bf16 v[48:51], v[176:179], v[172:175], v[48:51]
    s_lshl_b32 s28, s28, 11
    s_add_u32 s28, s28, 49152
    v_mfma_f32_16x16x32_bf16 v[52:55], v[180:183], v[172:175], v[52:55]
    ds_write_b128 v253, v[100:103] offset:10240
    v_mfma_f32_16x16x32_bf16 v[44:47], v[180:183], v[168:171], v[44:47]
    v_add_u32 v254, s28, v0
    v_mov_b32 v245, s87
    v_mfma_f32_16x16x32_bf16 v[36:39], v[180:183], v[164:167], v[36:39]
    ds_write_b128 v253, v[116:119] offset:11264
    v_mfma_f32_16x16x32_bf16 v[28:31], v[180:183], v[160:163], v[28:31]
    v_mov_b32 v246, s24
    v_mov_b32 v247, s25
    v_pk_mul_f32 v[184:185], v[192:193], v[206:207] op_sel:[0,1] op_sel_hi:[1,1]
    v_pk_fma_f32 v[184:185], v[24:25], v[206:207], v[184:185] op_sel_hi:[1,0,1]
    v_cvt_pk_bf16_f32 v24, v184, v185
    v_pk_mul_f32 v[186:187], v[194:195], v[206:207] op_sel:[0,1] op_sel_hi:[1,1]
    v_pk_fma_f32 v[186:187], v[26:27], v[206:207], v[186:187] op_sel_hi:[1,0,1]
    v_cvt_pk_bf16_f32 v25, v186, v187
    v_pk_mul_f32 v[188:189], v[196:197], v[206:207] op_sel:[0,1] op_sel_hi:[1,1]
    v_pk_fma_f32 v[188:189], v[28:29], v[206:207], v[188:189] op_sel_hi:[1,0,1]
    v_cvt_pk_bf16_f32 v26, v188, v189
    v_pk_mul_f32 v[190:191], v[198:199], v[206:207] op_sel:[0,1] op_sel_hi:[1,1]
    v_pk_fma_f32 v[190:191], v[30:31], v[206:207], v[190:191] op_sel_hi:[1,0,1]
    v_cvt_pk_bf16_f32 v27, v190, v191
    ds_write_b128 v254, v[24:27] offset:0
    v_pk_mul_f32 v[184:185], v[192:193], v[208:209] op_sel:[0,1] op_sel_hi:[1,1]
    v_pk_fma_f32 v[184:185], v[32:33], v[208:209], v[184:185] op_sel_hi:[1,0,1]
    v_cvt_pk_bf16_f32 v32, v184, v185
    v_pk_mul_f32 v[186:187], v[194:195], v[208:209] op_sel:[0,1] op_sel_hi:[1,1]
    v_pk_fma_f32 v[186:187], v[34:35], v[208:209], v[186:187] op_sel_hi:[1,0,1]
    v_cvt_pk_bf16_f32 v33, v186, v187
    v_pk_mul_f32 v[188:189], v[196:197], v[208:209] op_sel:[0,1] op_sel_hi:[1,1]
    v_pk_fma_f32 v[188:189], v[36:37], v[208:209], v[188:189] op_sel_hi:[1,0,1]
    v_cvt_pk_bf16_f32 v34, v188, v189
    v_pk_mul_f32 v[190:191], v[198:199], v[208:209] op_sel:[0,1] op_sel_hi:[1,1]
    v_pk_fma_f32 v[190:191], v[38:39], v[208:209], v[190:191] op_sel_hi:[1,0,1]
    v_cvt_pk_bf16_f32 v35, v190, v191
    ds_write_b128 v254, v[32:35] offset:1024
    v_pk_mul_f32 v[184:185], v[192:193], v[210:211] op_sel:[0,1] op_sel_hi:[1,1]
    v_pk_fma_f32 v[184:185], v[40:41], v[210:211], v[184:185] op_sel_hi:[1,0,1]
    v_cvt_pk_bf16_f32 v40, v184, v185
    v_pk_mul_f32 v[186:187], v[194:195], v[210:211] op_sel:[0,1] op_sel_hi:[1,1]
    v_pk_fma_f32 v[186:187], v[42:43], v[210:211], v[186:187] op_sel_hi:[1,0,1]
    v_cvt_pk_bf16_f32 v41, v186, v187
    v_pk_mul_f32 v[188:189], v[196:197], v[210:211] op_sel:[0,1] op_sel_hi:[1,1]
    v_pk_fma_f32 v[188:189], v[44:45], v[210:211], v[188:189] op_sel_hi:[1,0,1]
    v_cvt_pk_bf16_f32 v42, v188, v189
    v_pk_mul_f32 v[190:191], v[198:199], v[210:211] op_sel:[0,1] op_sel_hi:[1,1]
    v_pk_fma_f32 v[190:191], v[46:47], v[210:211], v[190:191] op_sel_hi:[1,0,1]
    v_cvt_pk_bf16_f32 v43, v190, v191
    v_pk_mul_f32 v[184:185], v[192:193], v[212:213] op_sel:[0,1] op_sel_hi:[1,1]
    v_pk_fma_f32 v[184:185], v[48:49], v[212:213], v[184:185] op_sel_hi:[1,0,1]
    v_cvt_pk_bf16_f32 v48, v184, v185
    v_pk_mul_f32 v[186:187], v[194:195], v[212:213] op_sel:[0,1] op_sel_hi:[1,1]
    v_pk_fma_f32 v[186:187], v[50:51], v[212:213], v[186:187] op_sel_hi:[1,0,1]
    v_cvt_pk_bf16_f32 v49, v186, v187
    v_pk_mul_f32 v[188:189], v[196:197], v[212:213] op_sel:[0,1] op_sel_hi:[1,1]
    v_pk_fma_f32 v[188:189], v[52:53], v[212:213], v[188:189] op_sel_hi:[1,0,1]
    v_cvt_pk_bf16_f32 v50, v188, v189
    v_pk_mul_f32 v[190:191], v[198:199], v[212:213] op_sel:[0,1] op_sel_hi:[1,1]
    v_pk_fma_f32 v[190:191], v[54:55], v[212:213], v[190:191] op_sel_hi:[1,0,1]
    v_cvt_pk_bf16_f32 v51, v190, v191
    s_waitcnt lgkmcnt(0)
    s_barrier
    v_mfma_f32_16x16x32_bf16 v[120:123], v[72:75], v[40:43], v[222:225]
    v_mfma_f32_16x16x32_bf16 v[128:131], v[72:75], v[48:51], 0
    s_nop 6
    v_exp_f32 v120, v120
    v_mfma_f32_16x16x32_bf16 v[132:135], v[80:83], v[48:51], v[222:225]
    v_exp_f32 v121, v121
    v_mov_b32 v139, 0
    v_exp_f32 v122, v122
    v_cvt_pk_bf16_f32 v136, v120, v121
    v_exp_f32 v123, v123
    v_mov_b32 v138, 0
    v_cvt_pk_bf16_f32 v137, v122, v123
    v_mfma_f32_16x16x32_bf16 v[120:123], v[56:59], v[40:43], 0
    v_exp_f32 v128, v128
    v_exp_f32 v129, v129
    v_mfma_f32_16x16x32_bf16 v[124:127], v[64:67], v[40:43], 0
    v_exp_f32 v130, v130
    v_cvt_pk_bf16_f32 v140, v128, v129
    v_mfma_f32_16x16x32_bf16 v[144:147], v[100:103], v[136:139], 0
    v_exp_f32 v131, v131
    v_exp_f32 v132, v132
    v_cvt_pk_bf16_f32 v141, v130, v131
    v_mfma_f32_16x16x32_bf16 v[148:151], v[116:119], v[136:139], 0
    v_exp_f32 v133, v133
    v_exp_f32 v134, v134
    v_cvt_pk_bf16_f32 v142, v132, v133
    v_exp_f32 v135, v135
    v_mfma_f32_16x16x32_bf16 v[160:163], v[226:229], v[136:139], 0
    v_cvt_pk_bf16_f32 v143, v134, v135
    v_mfma_f32_16x16x32_bf16 v[128:131], v[56:59], v[48:51], 0
    v_exp_f32 v120, v120
    v_exp_f32 v121, v121
    v_mfma_f32_16x16x32_bf16 v[132:135], v[64:67], v[48:51], 0
    v_exp_f32 v122, v122
    v_cvt_pk_bf16_f32 v136, v120, v121
    v_mfma_f32_16x16x32_bf16 v[152:155], v[100:103], v[140:143], 0
    v_exp_f32 v123, v123
    v_exp_f32 v124, v124
    v_cvt_pk_bf16_f32 v137, v122, v123
    v_mfma_f32_16x16x32_bf16 v[156:159], v[116:119], v[140:143], 0
    v_exp_f32 v125, v125
    v_exp_f32 v126, v126
    v_cvt_pk_bf16_f32 v138, v124, v125
    v_exp_f32 v127, v127
    v_mfma_f32_16x16x32_bf16 v[164:167], v[226:229], v[140:143], 0
    v_cvt_pk_bf16_f32 v139, v126, v127
    s_waitcnt lgkmcnt(0)
    s_nop 0
    v_mfma_f32_16x16x32_bf16 v[144:147], v[96:99], v[136:139], v[144:147]
    v_exp_f32 v128, v128
    v_exp_f32 v129, v129
    v_mfma_f32_16x16x32_bf16 v[148:151], v[112:115], v[136:139], v[148:151]
    v_exp_f32 v130, v130
    v_cvt_pk_bf16_f32 v140, v128, v129
    v_mfma_f32_16x16x32_bf16 v[160:163], v[226:229], v[136:139], v[160:163]
    v_exp_f32 v131, v131
    v_exp_f32 v132, v132
    v_cvt_pk_bf16_f32 v141, v130, v131
    v_exp_f32 v133, v133
    v_exp_f32 v134, v134
    v_cvt_pk_bf16_f32 v142, v132, v133
    v_exp_f32 v135, v135
    s_nop 0
    v_cvt_pk_bf16_f32 v143, v134, v135
    s_waitcnt vmcnt(0)
    s_mov_b64 exec, 1
    buffer_store_dwordx2 v[246:247], v245, s[12:15], 0 offen offset:0 sc1
    s_mov_b64 exec, -1
    s_and_b32 s27, s73, 4096
    s_add_u32 s27, s27, 98304
    v_add_u32 v244, s27, v0
    v_xor_b32 v236, 4048155338, v222
    v_xor_b32 v237, 4048155338, v223
    v_xor_b32 v238, 4048155338, v224
    v_xor_b32 v239, 4048155338, v225
    s_barrier
    ds_read_b128 v[72:75], v244 offset:0
    ds_read_b128 v[80:83], v244 offset:1024
    ds_read_b128 v[100:103], v244 offset:2048
    ds_read_b128 v[116:119], v244 offset:3072
    s_waitcnt lgkmcnt(2)
    v_mfma_f32_16x16x32_bf16 v[120:123], v[72:75], v[40:43], 0
    v_mfma_f32_16x16x32_bf16 v[124:127], v[80:83], v[40:43], 0
    v_mfma_f32_16x16x32_bf16 v[128:131], v[72:75], v[48:51], 0
    ds_read_b128 v[56:59], v244 offset:8192
    s_nop 4
    v_exp_f32 v120, v120
    v_exp_f32 v121, v121
    v_mfma_f32_16x16x32_bf16 v[132:135], v[80:83], v[48:51], 0
    ds_read_b128 v[64:67], v244 offset:9216
    v_exp_f32 v122, v122
    v_cvt_pk_bf16_f32 v136, v120, v121
    v_mfma_f32_16x16x32_bf16 v[152:155], v[96:99], v[140:143], v[152:155]
    v_exp_f32 v123, v123
    v_exp_f32 v124, v124
    v_cvt_pk_bf16_f32 v137, v122, v123
    v_mfma_f32_16x16x32_bf16 v[156:159], v[112:115], v[140:143], v[156:159]
    v_exp_f32 v125, v125
    v_exp_f32 v126, v126
    v_cvt_pk_bf16_f32 v138, v124, v125
    v_exp_f32 v127, v127
    v_mfma_f32_16x16x32_bf16 v[164:167], v[226:229], v[140:143], v[164:167]
    v_cvt_pk_bf16_f32 v139, v126, v127
    s_cmp_eq_u32 s20, 0
    s_cbranch_scc0 Lw_92
    v_mov_b32 v226, 0
    v_mov_b32 v227, 0
    v_mov_b32 v228, 0
    v_mov_b32 v229, 0
Lw_92:
    s_waitcnt lgkmcnt(0)
    v_mfma_f32_16x16x32_bf16 v[120:123], v[56:59], v[40:43], 0
    v_exp_f32 v128, v128
    v_exp_f32 v129, v129
    v_mfma_f32_16x16x32_bf16 v[124:127], v[64:67], v[40:43], 0
    v_exp_f32 v130, v130
    v_cvt_pk_bf16_f32 v140, v128, v129
    v_mfma_f32_16x16x32_bf16 v[144:147], v[100:103], v[136:139], v[144:147]
    v_exp_f32 v131, v131
    v_exp_f32 v132, v132
    v_cvt_pk_bf16_f32 v141, v130, v131
    v_mfma_f32_16x16x32_bf16 v[148:151], v[116:119], v[136:139], v[148:151]
    ds_read_b128 v[96:99], v244 offset:10240
    v_exp_f32 v133, v133
    v_exp_f32 v134, v134
    v_cvt_pk_bf16_f32 v142, v132, v133
    v_exp_f32 v135, v135
    v_mfma_f32_16x16x32_bf16 v[160:163], v[226:229], v[136:139], v[160:163]
    ds_read_b128 v[112:115], v244 offset:11264
    v_cvt_pk_bf16_f32 v143, v134, v135
    s_barrier
    v_mfma_f32_16x16x32_bf16 v[128:131], v[56:59], v[48:51], 0
    ds_read_b128 v[72:75], v244 offset:16384
    v_exp_f32 v120, v120
    v_exp_f32 v121, v121
    v_mfma_f32_16x16x32_bf16 v[132:135], v[64:67], v[48:51], 0
    ds_read_b128 v[80:83], v244 offset:17408
    v_exp_f32 v122, v122
    v_cvt_pk_bf16_f32 v136, v120, v121
    v_mfma_f32_16x16x32_bf16 v[152:155], v[100:103], v[140:143], v[152:155]
    v_exp_f32 v123, v123
    v_exp_f32 v124, v124
    v_cvt_pk_bf16_f32 v137, v122, v123
    v_mfma_f32_16x16x32_bf16 v[156:159], v[116:119], v[140:143], v[156:159]
    v_exp_f32 v125, v125
    v_exp_f32 v126, v126
    v_cvt_pk_bf16_f32 v138, v124, v125
    v_exp_f32 v127, v127
    v_mfma_f32_16x16x32_bf16 v[164:167], v[226:229], v[140:143], v[164:167]
    v_cvt_pk_bf16_f32 v139, v126, v127
    s_waitcnt lgkmcnt(0)
    v_mfma_f32_16x16x32_bf16 v[120:123], v[72:75], v[40:43], 0
    v_exp_f32 v128, v128
    v_exp_f32 v129, v129
    v_mfma_f32_16x16x32_bf16 v[124:127], v[80:83], v[40:43], 0
    v_exp_f32 v130, v130
    v_cvt_pk_bf16_f32 v140, v128, v129
    v_mfma_f32_16x16x32_bf16 v[144:147], v[96:99], v[136:139], v[144:147]
    v_exp_f32 v131, v131
    v_exp_f32 v132, v132
    v_cvt_pk_bf16_f32 v141, v130, v131
    v_mfma_f32_16x16x32_bf16 v[148:151], v[112:115], v[136:139], v[148:151]
    ds_read_b128 v[100:103], v244 offset:18432
    v_exp_f32 v133, v133
    v_exp_f32 v134, v134
    v_cvt_pk_bf16_f32 v142, v132, v133
    v_exp_f32 v135, v135
    v_mfma_f32_16x16x32_bf16 v[160:163], v[226:229], v[136:139], v[160:163]
    ds_read_b128 v[116:119], v244 offset:19456
    v_cvt_pk_bf16_f32 v143, v134, v135
    v_mfma_f32_16x16x32_bf16 v[128:131], v[72:75], v[48:51], 0
    ds_read_b128 v[56:59], v244 offset:24576
    v_exp_f32 v120, v120
    v_exp_f32 v121, v121
    v_mfma_f32_16x16x32_bf16 v[132:135], v[80:83], v[48:51], 0
    ds_read_b128 v[64:67], v244 offset:25600
    v_exp_f32 v122, v122
    v_cvt_pk_bf16_f32 v136, v120, v121
    v_mfma_f32_16x16x32_bf16 v[152:155], v[96:99], v[140:143], v[152:155]
    v_exp_f32 v123, v123
    v_exp_f32 v124, v124
    v_cvt_pk_bf16_f32 v137, v122, v123
    v_mfma_f32_16x16x32_bf16 v[156:159], v[112:115], v[140:143], v[156:159]
    v_exp_f32 v125, v125
    v_exp_f32 v126, v126
    v_cvt_pk_bf16_f32 v138, v124, v125
    v_exp_f32 v127, v127
    v_mfma_f32_16x16x32_bf16 v[164:167], v[226:229], v[140:143], v[164:167]
    v_cvt_pk_bf16_f32 v139, v126, v127
    s_waitcnt lgkmcnt(0)
    v_mfma_f32_16x16x32_bf16 v[120:123], v[56:59], v[40:43], 0
    v_exp_f32 v128, v128
    v_exp_f32 v129, v129
    v_mfma_f32_16x16x32_bf16 v[124:127], v[64:67], v[40:43], 0
    v_exp_f32 v130, v130
    v_cvt_pk_bf16_f32 v140, v128, v129
    v_mfma_f32_16x16x32_bf16 v[144:147], v[100:103], v[136:139], v[144:147]
    v_exp_f32 v131, v131
    v_exp_f32 v132, v132
    v_cvt_pk_bf16_f32 v141, v130, v131
    v_mfma_f32_16x16x32_bf16 v[148:151], v[116:119], v[136:139], v[148:151]
    ds_read_b128 v[96:99], v244 offset:26624
    v_exp_f32 v133, v133
    v_exp_f32 v134, v134
    v_cvt_pk_bf16_f32 v142, v132, v133
    v_exp_f32 v135, v135
    v_mfma_f32_16x16x32_bf16 v[160:163], v[226:229], v[136:139], v[160:163]
    ds_read_b128 v[112:115], v244 offset:27648
    v_cvt_pk_bf16_f32 v143, v134, v135
    s_barrier
    v_mfma_f32_16x16x32_bf16 v[128:131], v[56:59], v[48:51], 0
    ds_read_b128 v[72:75], v244 offset:32768
    v_exp_f32 v120, v120
    v_exp_f32 v121, v121
    v_mfma_f32_16x16x32_bf16 v[132:135], v[64:67], v[48:51], 0
    ds_read_b128 v[80:83], v244 offset:33792
    v_exp_f32 v122, v122
    v_cvt_pk_bf16_f32 v136, v120, v121
    v_mfma_f32_16x16x32_bf16 v[152:155], v[100:103], v[140:143], v[152:155]
    v_exp_f32 v123, v123
    v_exp_f32 v124, v124
    v_cvt_pk_bf16_f32 v137, v122, v123
    v_mfma_f32_16x16x32_bf16 v[156:159], v[116:119], v[140:143], v[156:159]
    v_exp_f32 v125, v125
    v_exp_f32 v126, v126
    v_cvt_pk_bf16_f32 v138, v124, v125
    v_exp_f32 v127, v127
    v_mfma_f32_16x16x32_bf16 v[164:167], v[226:229], v[140:143], v[164:167]
    v_cvt_pk_bf16_f32 v139, v126, v127
    s_waitcnt lgkmcnt(0)
    v_mfma_f32_16x16x32_bf16 v[120:123], v[72:75], v[40:43], 0
    v_exp_f32 v128, v128
    v_exp_f32 v129, v129
    v_mfma_f32_16x16x32_bf16 v[124:127], v[80:83], v[40:43], 0
    v_exp_f32 v130, v130
    v_cvt_pk_bf16_f32 v140, v128, v129
    v_mfma_f32_16x16x32_bf16 v[144:147], v[96:99], v[136:139], v[144:147]
    v_exp_f32 v131, v131
    v_exp_f32 v132, v132
    v_cvt_pk_bf16_f32 v141, v130, v131
    v_mfma_f32_16x16x32_bf16 v[148:151], v[112:115], v[136:139], v[148:151]
    ds_read_b128 v[100:103], v244 offset:34816
    v_exp_f32 v133, v133
    v_exp_f32 v134, v134
    v_cvt_pk_bf16_f32 v142, v132, v133
    v_exp_f32 v135, v135
    v_mfma_f32_16x16x32_bf16 v[160:163], v[226:229], v[136:139], v[160:163]
    ds_read_b128 v[116:119], v244 offset:35840
    v_cvt_pk_bf16_f32 v143, v134, v135
    v_mfma_f32_16x16x32_bf16 v[128:131], v[72:75], v[48:51], 0
    ds_read_b128 v[56:59], v244 offset:40960
    v_exp_f32 v120, v120
    v_exp_f32 v121, v121
    v_mfma_f32_16x16x32_bf16 v[132:135], v[80:83], v[48:51], 0
    ds_read_b128 v[64:67], v244 offset:41984
    v_exp_f32 v122, v122
    v_cvt_pk_bf16_f32 v136, v120, v121
    v_mfma_f32_16x16x32_bf16 v[152:155], v[96:99], v[140:143], v[152:155]
    v_exp_f32 v123, v123
    v_exp_f32 v124, v124
    v_cvt_pk_bf16_f32 v137, v122, v123
    v_mfma_f32_16x16x32_bf16 v[156:159], v[112:115], v[140:143], v[156:159]
    v_exp_f32 v125, v125
    v_exp_f32 v126, v126
    v_cvt_pk_bf16_f32 v138, v124, v125
    v_exp_f32 v127, v127
    v_mfma_f32_16x16x32_bf16 v[164:167], v[226:229], v[140:143], v[164:167]
    v_cvt_pk_bf16_f32 v139, v126, v127
    s_cmp_eq_u32 s20, 1
    s_cbranch_scc0 Lw_93
    v_mov_b32 v226, 0
    v_mov_b32 v227, 0
    v_mov_b32 v228, 0
    v_mov_b32 v229, 0
Lw_93:
    s_waitcnt lgkmcnt(0)
    v_mfma_f32_16x16x32_bf16 v[120:123], v[56:59], v[40:43], 0
    v_exp_f32 v128, v128
    v_exp_f32 v129, v129
    v_mfma_f32_16x16x32_bf16 v[124:127], v[64:67], v[40:43], 0
    v_exp_f32 v130, v130
    v_cvt_pk_bf16_f32 v140, v128, v129
    v_mfma_f32_16x16x32_bf16 v[144:147], v[100:103], v[136:139], v[144:147]
    v_exp_f32 v131, v131
    v_exp_f32 v132, v132
    v_cvt_pk_bf16_f32 v141, v130, v131
    v_mfma_f32_16x16x32_bf16 v[148:151], v[116:119], v[136:139], v[148:151]
    ds_read_b128 v[96:99], v244 offset:43008
    v_exp_f32 v133, v133
    v_exp_f32 v134, v134
    v_cvt_pk_bf16_f32 v142, v132, v133
    v_exp_f32 v135, v135
    v_mfma_f32_16x16x32_bf16 v[160:163], v[226:229], v[136:139], v[160:163]
    ds_read_b128 v[112:115], v244 offset:44032
    v_cvt_pk_bf16_f32 v143, v134, v135
    v_mfma_f32_16x16x32_bf16 v[128:131], v[56:59], v[48:51], 0
    ds_read_b128 v[72:75], v244 offset:49152
    v_exp_f32 v120, v120
    v_exp_f32 v121, v121
    v_mfma_f32_16x16x32_bf16 v[132:135], v[64:67], v[48:51], 0
    ds_read_b128 v[80:83], v244 offset:50176
    v_exp_f32 v122, v122
    v_cvt_pk_bf16_f32 v136, v120, v121
    v_mfma_f32_16x16x32_bf16 v[152:155], v[100:103], v[140:143], v[152:155]
    v_exp_f32 v123, v123
    v_exp_f32 v124, v124
    v_cvt_pk_bf16_f32 v137, v122, v123
    v_mfma_f32_16x16x32_bf16 v[156:159], v[116:119], v[140:143], v[156:159]
    v_exp_f32 v125, v125
    v_exp_f32 v126, v126
    v_cvt_pk_bf16_f32 v138, v124, v125
    v_exp_f32 v127, v127
    v_mfma_f32_16x16x32_bf16 v[164:167], v[226:229], v[140:143], v[164:167]
    v_cvt_pk_bf16_f32 v139, v126, v127
    s_waitcnt lgkmcnt(0)
    v_mfma_f32_16x16x32_bf16 v[120:123], v[72:75], v[40:43], v[236:239]
    v_exp_f32 v128, v128
    v_exp_f32 v129, v129
    v_mfma_f32_16x16x32_bf16 v[124:127], v[80:83], v[40:43], 0
    v_exp_f32 v130, v130
    v_cvt_pk_bf16_f32 v140, v128, v129
    v_mfma_f32_16x16x32_bf16 v[144:147], v[96:99], v[136:139], v[144:147]
    v_exp_f32 v131, v131
    v_exp_f32 v132, v132
    v_cvt_pk_bf16_f32 v141, v130, v131
    v_mfma_f32_16x16x32_bf16 v[148:151], v[112:115], v[136:139], v[148:151]
    ds_read_b128 v[100:103], v244 offset:51200
    v_exp_f32 v133, v133
    v_exp_f32 v134, v134
    v_cvt_pk_bf16_f32 v142, v132, v133
    v_exp_f32 v135, v135
    v_mfma_f32_16x16x32_bf16 v[160:163], v[226:229], v[136:139], v[160:163]
    ds_read_b128 v[116:119], v244 offset:52224
    v_cvt_pk_bf16_f32 v143, v134, v135
    v_mfma_f32_16x16x32_bf16 v[132:135], v[80:83], v[48:51], v[236:239]
    v_exp_f32 v120, v120
    v_exp_f32 v121, v121
    v_mfma_f32_16x16x32_bf16 v[152:155], v[96:99], v[140:143], v[152:155]
    v_exp_f32 v122, v122
    v_cvt_pk_bf16_f32 v136, v120, v121
    v_mfma_f32_16x16x32_bf16 v[156:159], v[112:115], v[140:143], v[156:159]
    v_exp_f32 v123, v123
    v_exp_f32 v124, v124
    v_cvt_pk_bf16_f32 v137, v122, v123
    v_mfma_f32_16x16x32_bf16 v[164:167], v[226:229], v[140:143], v[164:167]
    v_exp_f32 v125, v125
    v_exp_f32 v126, v126
    v_cvt_pk_bf16_f32 v138, v124, v125
    v_exp_f32 v127, v127
    s_nop 0
    v_cvt_pk_bf16_f32 v139, v126, v127
    s_waitcnt lgkmcnt(0)
    s_nop 0
    v_mfma_f32_16x16x32_bf16 v[144:147], v[100:103], v[136:139], v[144:147]
    v_exp_f32 v132, v132
    v_mfma_f32_16x16x32_bf16 v[148:151], v[116:119], v[136:139], v[148:151]
    v_exp_f32 v133, v133
    v_mov_b32 v141, 0
    v_mfma_f32_16x16x32_bf16 v[160:163], v[226:229], v[136:139], v[160:163]
    v_exp_f32 v134, v134
    v_cvt_pk_bf16_f32 v142, v132, v133
    v_exp_f32 v135, v135
    v_mov_b32 v140, 0
    v_cvt_pk_bf16_f32 v143, v134, v135
    s_branch L_afin
L_tailA3:
    v_mfma_f32_16x16x32_bf16 v[24:27], v[136:139], v[120:123], v[24:27]
    ds_write_b128 v253, v[56:59] offset:0
    v_mfma_f32_16x16x32_bf16 v[32:35], v[136:139], v[124:127], v[32:35]
    s_mov_b32 s35, 1048744942
    v_mul_f32 v206, s35, v206
    v_mfma_f32_16x16x32_bf16 v[40:43], v[136:139], v[128:131], v[40:43]
    ds_write_b128 v253, v[64:67] offset:1024
    v_mfma_f32_16x16x32_bf16 v[48:51], v[136:139], v[132:135], v[48:51]
    v_mul_f32 v207, s35, v207
    v_mul_f32 v208, s35, v208
    v_mfma_f32_16x16x32_bf16 v[52:55], v[140:143], v[132:135], v[52:55]
    ds_write_b128 v253, v[96:99] offset:2048
    v_mfma_f32_16x16x32_bf16 v[44:47], v[140:143], v[128:131], v[44:47]
    v_mul_f32 v209, s35, v209
    v_mul_f32 v210, s35, v210
    v_mfma_f32_16x16x32_bf16 v[36:39], v[140:143], v[124:127], v[36:39]
    ds_write_b128 v253, v[112:115] offset:3072
    v_mfma_f32_16x16x32_bf16 v[28:31], v[140:143], v[120:123], v[28:31]
    v_mul_f32 v211, s35, v211
    v_mul_f32 v212, s35, v212
    v_mfma_f32_16x16x32_bf16 v[24:27], v[176:179], v[160:163], v[24:27]
    v_mul_f32 v213, s35, v213
    s_xor_b32 s28, s3, 2
    v_mfma_f32_16x16x32_bf16 v[32:35], v[176:179], v[164:167], v[32:35]
    s_lshl_b32 s28, s28, 11
    s_add_u32 s28, s28, 49152
    v_mfma_f32_16x16x32_bf16 v[40:43], v[176:179], v[168:171], v[40:43]
    v_add_u32 v254, s28, v0
    v_mov_b32 v245, s87
    v_mfma_f32_16x16x32_bf16 v[48:51], v[176:179], v[172:175], v[48:51]
    v_mov_b32 v246, s24
    v_mov_b32 v247, s25
    v_mfma_f32_16x16x32_bf16 v[52:55], v[180:183], v[172:175], v[52:55]
    v_mfma_f32_16x16x32_bf16 v[44:47], v[180:183], v[168:171], v[44:47]
    v_mfma_f32_16x16x32_bf16 v[36:39], v[180:183], v[164:167], v[36:39]
    v_mfma_f32_16x16x32_bf16 v[28:31], v[180:183], v[160:163], v[28:31]
    v_pk_mul_f32 v[184:185], v[192:193], v[206:207] op_sel:[0,1] op_sel_hi:[1,1]
    v_pk_fma_f32 v[184:185], v[24:25], v[206:207], v[184:185] op_sel_hi:[1,0,1]
    v_cvt_pk_bf16_f32 v24, v184, v185
    v_pk_mul_f32 v[186:187], v[194:195], v[206:207] op_sel:[0,1] op_sel_hi:[1,1]
    v_pk_fma_f32 v[186:187], v[26:27], v[206:207], v[186:187] op_sel_hi:[1,0,1]
    v_cvt_pk_bf16_f32 v25, v186, v187
    v_pk_mul_f32 v[188:189], v[196:197], v[206:207] op_sel:[0,1] op_sel_hi:[1,1]
    s_nop 0
    v_pk_fma_f32 v[188:189], v[28:29], v[206:207], v[188:189] op_sel_hi:[1,0,1]
    v_cvt_pk_bf16_f32 v26, v188, v189
    v_pk_mul_f32 v[190:191], v[198:199], v[206:207] op_sel:[0,1] op_sel_hi:[1,1]
    v_pk_fma_f32 v[190:191], v[30:31], v[206:207], v[190:191] op_sel_hi:[1,0,1]
    v_cvt_pk_bf16_f32 v27, v190, v191
    ds_write_b128 v254, v[24:27] offset:0
    v_pk_mul_f32 v[184:185], v[192:193], v[208:209] op_sel:[0,1] op_sel_hi:[1,1]
    v_pk_fma_f32 v[184:185], v[32:33], v[208:209], v[184:185] op_sel_hi:[1,0,1]
    v_cvt_pk_bf16_f32 v32, v184, v185
    v_pk_mul_f32 v[186:187], v[194:195], v[208:209] op_sel:[0,1] op_sel_hi:[1,1]
    v_pk_fma_f32 v[186:187], v[34:35], v[208:209], v[186:187] op_sel_hi:[1,0,1]
    v_cvt_pk_bf16_f32 v33, v186, v187
    v_pk_mul_f32 v[188:189], v[196:197], v[208:209] op_sel:[0,1] op_sel_hi:[1,1]
    v_pk_fma_f32 v[188:189], v[36:37], v[208:209], v[188:189] op_sel_hi:[1,0,1]
    v_cvt_pk_bf16_f32 v34, v188, v189
    v_pk_mul_f32 v[190:191], v[198:199], v[208:209] op_sel:[0,1] op_sel_hi:[1,1]
    v_pk_fma_f32 v[190:191], v[38:39], v[208:209], v[190:191] op_sel_hi:[1,0,1]
    v_cvt_pk_bf16_f32 v35, v190, v191
    ds_write_b128 v254, v[32:35] offset:1024
    v_pk_mul_f32 v[184:185], v[192:193], v[210:211] op_sel:[0,1] op_sel_hi:[1,1]
    v_pk_fma_f32 v[184:185], v[40:41], v[210:211], v[184:185] op_sel_hi:[1,0,1]
    v_cvt_pk_bf16_f32 v40, v184, v185
    v_pk_mul_f32 v[186:187], v[194:195], v[210:211] op_sel:[0,1] op_sel_hi:[1,1]
    v_pk_fma_f32 v[186:187], v[42:43], v[210:211], v[186:187] op_sel_hi:[1,0,1]
    v_cvt_pk_bf16_f32 v41, v186, v187
    v_pk_mul_f32 v[188:189], v[196:197], v[210:211] op_sel:[0,1] op_sel_hi:[1,1]
    v_pk_fma_f32 v[188:189], v[44:45], v[210:211], v[188:189] op_sel_hi:[1,0,1]
    v_cvt_pk_bf16_f32 v42, v188, v189
    v_pk_mul_f32 v[190:191], v[198:199], v[210:211] op_sel:[0,1] op_sel_hi:[1,1]
    v_pk_fma_f32 v[190:191], v[46:47], v[210:211], v[190:191] op_sel_hi:[1,0,1]
    v_cvt_pk_bf16_f32 v43, v190, v191
    v_subrev_u32 v244, 16384, v253
    v_pk_mul_f32 v[184:185], v[192:193], v[212:213] op_sel:[0,1] op_sel_hi:[1,1]
    v_pk_fma_f32 v[184:185], v[48:49], v[212:213], v[184:185] op_sel_hi:[1,0,1]
    v_cvt_pk_bf16_f32 v48, v184, v185
    v_pk_mul_f32 v[186:187], v[194:195], v[212:213] op_sel:[0,1] op_sel_hi:[1,1]
    v_pk_fma_f32 v[186:187], v[50:51], v[212:213], v[186:187] op_sel_hi:[1,0,1]
    v_cvt_pk_bf16_f32 v49, v186, v187
    v_pk_mul_f32 v[188:189], v[196:197], v[212:213] op_sel:[0,1] op_sel_hi:[1,1]
    v_pk_fma_f32 v[188:189], v[52:53], v[212:213], v[188:189] op_sel_hi:[1,0,1]
    v_cvt_pk_bf16_f32 v50, v188, v189
    v_pk_mul_f32 v[190:191], v[198:199], v[212:213] op_sel:[0,1] op_sel_hi:[1,1]
    v_pk_fma_f32 v[190:191], v[54:55], v[212:213], v[190:191] op_sel_hi:[1,0,1]
    v_cvt_pk_bf16_f32 v51, v190, v191
    s_waitcnt lgkmcnt(0)
    s_barrier
    v_mfma_f32_16x16x32_bf16 v[120:123], v[72:75], v[40:43], v[222:225]
    v_mfma_f32_16x16x32_bf16 v[128:131], v[72:75], v[48:51], 0
    s_nop 6
    v_exp_f32 v120, v120
    v_mfma_f32_16x16x32_bf16 v[132:135], v[80:83], v[48:51], v[222:225]
    v_exp_f32 v121, v121
    v_mov_b32 v139, 0
    v_exp_f32 v122, v122
    v_cvt_pk_bf16_f32 v136, v120, v121
    v_exp_f32 v123, v123
    v_mov_b32 v138, 0
    v_cvt_pk_bf16_f32 v137, v122, v123
    v_mfma_f32_16x16x32_bf16 v[120:123], v[56:59], v[40:43], 0
    v_exp_f32 v128, v128
    v_exp_f32 v129, v129
    v_mfma_f32_16x16x32_bf16 v[124:127], v[64:67], v[40:43], 0
    v_exp_f32 v130, v130
    v_cvt_pk_bf16_f32 v140, v128, v129
    v_mfma_f32_16x16x32_bf16 v[144:147], v[100:103], v[136:139], 0
    v_exp_f32 v131, v131
    v_exp_f32 v132, v132
    v_cvt_pk_bf16_f32 v141, v130, v131
    v_mfma_f32_16x16x32_bf16 v[148:151], v[116:119], v[136:139], 0
    v_exp_f32 v133, v133
    v_exp_f32 v134, v134
    v_cvt_pk_bf16_f32 v142, v132, v133
    v_exp_f32 v135, v135
    v_mfma_f32_16x16x32_bf16 v[160:163], v[226:229], v[136:139], 0
    v_cvt_pk_bf16_f32 v143, v134, v135
    v_mfma_f32_16x16x32_bf16 v[128:131], v[56:59], v[48:51], 0
    ds_read_b128 v[72:75], v244 offset:8192
    v_exp_f32 v120, v120
    v_exp_f32 v121, v121
    v_mfma_f32_16x16x32_bf16 v[132:135], v[64:67], v[48:51], 0
    ds_read_b128 v[80:83], v244 offset:9216
    v_exp_f32 v122, v122
    v_cvt_pk_bf16_f32 v136, v120, v121
    v_mfma_f32_16x16x32_bf16 v[152:155], v[100:103], v[140:143], 0
    v_exp_f32 v123, v123
    v_exp_f32 v124, v124
    v_cvt_pk_bf16_f32 v137, v122, v123
    v_mfma_f32_16x16x32_bf16 v[156:159], v[116:119], v[140:143], 0
    v_exp_f32 v125, v125
    v_exp_f32 v126, v126
    v_cvt_pk_bf16_f32 v138, v124, v125
    v_exp_f32 v127, v127
    v_mfma_f32_16x16x32_bf16 v[164:167], v[226:229], v[140:143], 0
    v_cvt_pk_bf16_f32 v139, v126, v127
    s_waitcnt lgkmcnt(0)
    v_mfma_f32_16x16x32_bf16 v[120:123], v[72:75], v[40:43], 0
    v_exp_f32 v128, v128
    v_exp_f32 v129, v129
    v_mfma_f32_16x16x32_bf16 v[124:127], v[80:83], v[40:43], 0
    v_exp_f32 v130, v130
    v_cvt_pk_bf16_f32 v140, v128, v129
    v_mfma_f32_16x16x32_bf16 v[144:147], v[96:99], v[136:139], v[144:147]
    v_exp_f32 v131, v131
    v_exp_f32 v132, v132
    v_cvt_pk_bf16_f32 v141, v130, v131
    v_mfma_f32_16x16x32_bf16 v[148:151], v[112:115], v[136:139], v[148:151]
    ds_read_b128 v[100:103], v244 offset:10240
    v_exp_f32 v133, v133
    v_exp_f32 v134, v134
    v_cvt_pk_bf16_f32 v142, v132, v133
    v_exp_f32 v135, v135
    v_mfma_f32_16x16x32_bf16 v[160:163], v[226:229], v[136:139], v[160:163]
    ds_read_b128 v[116:119], v244 offset:11264
    v_cvt_pk_bf16_f32 v143, v134, v135
    v_mfma_f32_16x16x32_bf16 v[128:131], v[72:75], v[48:51], 0
    ds_read_b128 v[56:59], v244 offset:0
    v_exp_f32 v120, v120
    v_exp_f32 v121, v121
    v_mfma_f32_16x16x32_bf16 v[132:135], v[80:83], v[48:51], 0
    ds_read_b128 v[64:67], v244 offset:1024
    v_exp_f32 v122, v122
    v_cvt_pk_bf16_f32 v136, v120, v121
    v_mfma_f32_16x16x32_bf16 v[152:155], v[96:99], v[140:143], v[152:155]
    v_exp_f32 v123, v123
    v_exp_f32 v124, v124
    v_cvt_pk_bf16_f32 v137, v122, v123
    v_mfma_f32_16x16x32_bf16 v[156:159], v[112:115], v[140:143], v[156:159]
    v_exp_f32 v125, v125
    v_exp_f32 v126, v126
    v_cvt_pk_bf16_f32 v138, v124, v125
    v_exp_f32 v127, v127
    v_mfma_f32_16x16x32_bf16 v[164:167], v[226:229], v[140:143], v[164:167]
    v_cvt_pk_bf16_f32 v139, v126, v127
    s_waitcnt lgkmcnt(0)
    v_mfma_f32_16x16x32_bf16 v[120:123], v[56:59], v[40:43], 0
    v_exp_f32 v128, v128
    v_exp_f32 v129, v129
    v_mfma_f32_16x16x32_bf16 v[124:127], v[64:67], v[40:43], 0
    v_exp_f32 v130, v130
    v_cvt_pk_bf16_f32 v140, v128, v129
    v_mfma_f32_16x16x32_bf16 v[144:147], v[100:103], v[136:139], v[144:147]
    v_exp_f32 v131, v131
    v_exp_f32 v132, v132
    v_cvt_pk_bf16_f32 v141, v130, v131
    v_mfma_f32_16x16x32_bf16 v[148:151], v[116:119], v[136:139], v[148:151]
    ds_read_b128 v[96:99], v244 offset:2048
    v_exp_f32 v133, v133
    v_exp_f32 v134, v134
    v_cvt_pk_bf16_f32 v142, v132, v133
    v_exp_f32 v135, v135
    v_mfma_f32_16x16x32_bf16 v[160:163], v[226:229], v[136:139], v[160:163]
    ds_read_b128 v[112:115], v244 offset:3072
    v_cvt_pk_bf16_f32 v143, v134, v135
    s_waitcnt vmcnt(0)
    s_mov_b64 exec, 1
    buffer_store_dwordx2 v[246:247], v245, s[12:15], 0 offen offset:0 sc1
    s_mov_b64 exec, -1
    v_mfma_f32_16x16x32_bf16 v[128:131], v[56:59], v[48:51], 0
    v_exp_f32 v120, v120
    v_exp_f32 v121, v121
    v_mfma_f32_16x16x32_bf16 v[132:135], v[64:67], v[48:51], 0
    v_exp_f32 v122, v122
    v_cvt_pk_bf16_f32 v136, v120, v121
    v_mfma_f32_16x16x32_bf16 v[152:155], v[100:103], v[140:143], v[152:155]
    v_exp_f32 v123, v123
    v_exp_f32 v124, v124
    v_cvt_pk_bf16_f32 v137, v122, v123
    v_mfma_f32_16x16x32_bf16 v[156:159], v[116:119], v[140:143], v[156:159]
    v_exp_f32 v125, v125
    v_exp_f32 v126, v126
    v_cvt_pk_bf16_f32 v138, v124, v125
    v_exp_f32 v127, v127
    v_mfma_f32_16x16x32_bf16 v[164:167], v[226:229], v[140:143], v[164:167]
    v_cvt_pk_bf16_f32 v139, v126, v127
    s_waitcnt lgkmcnt(0)
    s_nop 0
    v_mfma_f32_16x16x32_bf16 v[144:147], v[96:99], v[136:139], v[144:147]
    v_exp_f32 v128, v128
    v_exp_f32 v129, v129
    v_mfma_f32_16x16x32_bf16 v[148:151], v[112:115], v[136:139], v[148:151]
    v_exp_f32 v130, v130
    v_cvt_pk_bf16_f32 v140, v128, v129
    v_mfma_f32_16x16x32_bf16 v[160:163], v[226:229], v[136:139], v[160:163]
    v_exp_f32 v131, v131
    v_exp_f32 v132, v132
    v_cvt_pk_bf16_f32 v141, v130, v131
    v_exp_f32 v133, v133
    v_exp_f32 v134, v134
    v_cvt_pk_bf16_f32 v142, v132, v133
    v_exp_f32 v135, v135
    s_nop 0
    v_cvt_pk_bf16_f32 v143, v134, v135
    s_and_b32 s27, s73, 4096
    s_add_u32 s27, s27, 98304
    v_add_u32 v244, s27, v0
    v_xor_b32 v236, 4048155338, v222
    v_xor_b32 v237, 4048155338, v223
    v_xor_b32 v238, 4048155338, v224
    v_xor_b32 v239, 4048155338, v225
    s_barrier
    ds_read_b128 v[72:75], v244 offset:0
    ds_read_b128 v[80:83], v244 offset:1024
    ds_read_b128 v[100:103], v244 offset:2048
    ds_read_b128 v[116:119], v244 offset:3072
    s_and_b32 s27, s73, 4294942719
    s_sub_u32 s27, s27, 1048576
    s_cmp_lt_u32 s20, 2
    s_cselect_b32 s27, 1073741824, s27
    v_add_u32 v245, s27, v0
    s_and_b32 s28, s73, 4096
    s_add_u32 m0, s28, 139264
    s_mov_b32 s27, 16384
    buffer_load_dwordx4 v245, s[12:15], s27 offen offset:0 sc1 lds
    buffer_load_dwordx4 v245, s[12:15], s27 offen offset:1024 sc1 lds
    buffer_load_dwordx4 v245, s[12:15], s27 offen offset:2048 sc1 lds
    buffer_load_dwordx4 v245, s[12:15], s27 offen offset:3072 sc1 lds
    s_waitcnt lgkmcnt(2)
    v_mfma_f32_16x16x32_bf16 v[120:123], v[72:75], v[40:43], 0
    v_mfma_f32_16x16x32_bf16 v[124:127], v[80:83], v[40:43], 0
    v_mfma_f32_16x16x32_bf16 v[128:131], v[72:75], v[48:51], 0
    ds_read_b128 v[56:59], v244 offset:8192
    s_nop 4
    v_exp_f32 v120, v120
    v_exp_f32 v121, v121
    v_mfma_f32_16x16x32_bf16 v[132:135], v[80:83], v[48:51], 0
    ds_read_b128 v[64:67], v244 offset:9216
    v_exp_f32 v122, v122
    v_cvt_pk_bf16_f32 v136, v120, v121
    v_mfma_f32_16x16x32_bf16 v[152:155], v[96:99], v[140:143], v[152:155]
    s_add_u32 m0, s28, 155648
    s_mov_b32 s27, 0
    buffer_load_dwordx4 v245, s[12:15], s27 offen offset:0 sc1 lds
    v_exp_f32 v123, v123
    v_exp_f32 v124, v124
    v_cvt_pk_bf16_f32 v137, v122, v123
    v_mfma_f32_16x16x32_bf16 v[156:159], v[112:115], v[140:143], v[156:159]
    buffer_load_dwordx4 v245, s[12:15], s27 offen offset:1024 sc1 lds
    v_exp_f32 v125, v125
    v_exp_f32 v126, v126
    v_cvt_pk_bf16_f32 v138, v124, v125
    v_exp_f32 v127, v127
    v_mfma_f32_16x16x32_bf16 v[164:167], v[226:229], v[140:143], v[164:167]
    v_cvt_pk_bf16_f32 v139, v126, v127
    s_cmp_eq_u32 s20, 0
    s_cbranch_scc0 Lw_94
    v_mov_b32 v226, 0
    v_mov_b32 v227, 0
    v_mov_b32 v228, 0
    v_mov_b32 v229, 0
Lw_94:
    s_waitcnt lgkmcnt(0)
    v_mfma_f32_16x16x32_bf16 v[120:123], v[56:59], v[40:43], 0
    buffer_load_dwordx4 v245, s[12:15], s27 offen offset:2048 sc1 lds
    v_exp_f32 v128, v128
    v_exp_f32 v129, v129
    v_mfma_f32_16x16x32_bf16 v[124:127], v[64:67], v[40:43], 0
    buffer_load_dwordx4 v245, s[12:15], s27 offen offset:3072 sc1 lds
    v_exp_f32 v130, v130
    v_cvt_pk_bf16_f32 v140, v128, v129
    v_mfma_f32_16x16x32_bf16 v[144:147], v[100:103], v[136:139], v[144:147]
    v_exp_f32 v131, v131
    v_exp_f32 v132, v132
    v_cvt_pk_bf16_f32 v141, v130, v131
    v_mfma_f32_16x16x32_bf16 v[148:151], v[116:119], v[136:139], v[148:151]
    ds_read_b128 v[96:99], v244 offset:10240
    v_exp_f32 v133, v133
    v_exp_f32 v134, v134
    v_cvt_pk_bf16_f32 v142, v132, v133
    v_exp_f32 v135, v135
    v_mfma_f32_16x16x32_bf16 v[160:163], v[226:229], v[136:139], v[160:163]
    ds_read_b128 v[112:115], v244 offset:11264
    v_cvt_pk_bf16_f32 v143, v134, v135
    s_barrier
    v_mfma_f32_16x16x32_bf16 v[128:131], v[56:59], v[48:51], 0
    ds_read_b128 v[72:75], v244 offset:16384
    v_exp_f32 v120, v120
    v_exp_f32 v121, v121
    v_mfma_f32_16x16x32_bf16 v[132:135], v[64:67], v[48:51], 0
    ds_read_b128 v[80:83], v244 offset:17408
    v_exp_f32 v122, v122
    v_cvt_pk_bf16_f32 v136, v120, v121
    v_mfma_f32_16x16x32_bf16 v[152:155], v[100:103], v[140:143], v[152:155]
    s_add_u32 m0, s85, 49152
    s_add_u32 s36, s86, 786432
    s_and_b32 s36, s36, 0x1fffff
    buffer_load_dwordx4 v3, s[8:11], s36 offen lds
    v_exp_f32 v123, v123
    v_exp_f32 v124, v124
    v_cvt_pk_bf16_f32 v137, v122, v123
    v_mfma_f32_16x16x32_bf16 v[156:159], v[116:119], v[140:143], v[156:159]
    s_add_u32 m0, s85, 53248
    s_add_u32 s36, s86, 851968
    s_and_b32 s36, s36, 0x1fffff
    buffer_load_dwordx4 v3, s[8:11], s36 offen lds
    v_exp_f32 v125, v125
    v_exp_f32 v126, v126
    v_cvt_pk_bf16_f32 v138, v124, v125
    v_exp_f32 v127, v127
    v_mfma_f32_16x16x32_bf16 v[164:167], v[226:229], v[140:143], v[164:167]
    s_add_u32 m0, s85, 65536
    s_add_u32 s36, s86, 1048576
    s_and_b32 s36, s36, 0x1fffff
    buffer_load_dwordx4 v3, s[8:11], s36 offen lds
    v_cvt_pk_bf16_f32 v139, v126, v127
    s_waitcnt lgkmcnt(0)
    v_mfma_f32_16x16x32_bf16 v[120:123], v[72:75], v[40:43], 0
    s_add_u32 m0, s85, 69632
    s_add_u32 s36, s86, 1114112
    s_and_b32 s36, s36, 0x1fffff
    buffer_load_dwordx4 v3, s[8:11], s36 offen lds
    v_exp_f32 v128, v128
    v_exp_f32 v129, v129
    v_mfma_f32_16x16x32_bf16 v[124:127], v[80:83], v[40:43], 0
    s_add_u32 m0, s85, 73728
    s_add_u32 s36, s86, 1179648
    s_and_b32 s36, s36, 0x1fffff
    buffer_load_dwordx4 v3, s[8:11], s36 offen lds
    v_exp_f32 v130, v130
    v_cvt_pk_bf16_f32 v140, v128, v129
    v_mfma_f32_16x16x32_bf16 v[144:147], v[96:99], v[136:139], v[144:147]
    v_exp_f32 v131, v131
    v_exp_f32 v132, v132
    v_cvt_pk_bf16_f32 v141, v130, v131
    v_mfma_f32_16x16x32_bf16 v[148:151], v[112:115], v[136:139], v[148:151]
    ds_read_b128 v[100:103], v244 offset:18432
    v_exp_f32 v133, v133
    v_exp_f32 v134, v134
    v_cvt_pk_bf16_f32 v142, v132, v133
    v_exp_f32 v135, v135
    v_mfma_f32_16x16x32_bf16 v[160:163], v[226:229], v[136:139], v[160:163]
    ds_read_b128 v[116:119], v244 offset:19456
    v_cvt_pk_bf16_f32 v143, v134, v135
    v_mfma_f32_16x16x32_bf16 v[128:131], v[72:75], v[48:51], 0
    ds_read_b128 v[56:59], v244 offset:24576
    v_exp_f32 v120, v120
    v_exp_f32 v121, v121
    v_mfma_f32_16x16x32_bf16 v[132:135], v[80:83], v[48:51], 0
    ds_read_b128 v[64:67], v244 offset:25600
    v_exp_f32 v122, v122
    v_cvt_pk_bf16_f32 v136, v120, v121
    v_mfma_f32_16x16x32_bf16 v[152:155], v[96:99], v[140:143], v[152:155]
    s_add_u32 m0, s85, 77824
    s_add_u32 s36, s86, 1245184
    s_and_b32 s36, s36, 0x1fffff
    buffer_load_dwordx4 v3, s[8:11], s36 offen lds
    v_exp_f32 v123, v123
    v_exp_f32 v124, v124
    v_cvt_pk_bf16_f32 v137, v122, v123
    v_mfma_f32_16x16x32_bf16 v[156:159], v[112:115], v[140:143], v[156:159]
    s_add_u32 m0, s85, 81920
    s_add_u32 s36, s86, 1310720
    s_and_b32 s36, s36, 0x1fffff
    buffer_load_dwordx4 v3, s[8:11], s36 offen lds
    v_exp_f32 v125, v125
    v_exp_f32 v126, v126
    v_cvt_pk_bf16_f32 v138, v124, v125
    v_exp_f32 v127, v127
    v_mfma_f32_16x16x32_bf16 v[164:167], v[226:229], v[140:143], v[164:167]
    s_add_u32 m0, s85, 86016
    s_add_u32 s36, s86, 1376256
    s_and_b32 s36, s36, 0x1fffff
    buffer_load_dwordx4 v3, s[8:11], s36 offen lds
    v_cvt_pk_bf16_f32 v139, v126, v127
    s_waitcnt lgkmcnt(0)
    v_mfma_f32_16x16x32_bf16 v[120:123], v[56:59], v[40:43], 0
    s_add_u32 m0, s85, 98304
    s_add_u32 s36, s86, 1572864
    s_and_b32 s36, s36, 0x1fffff
    buffer_load_dwordx4 v3, s[8:11], s36 offen lds
    v_exp_f32 v128, v128
    v_exp_f32 v129, v129
    v_mfma_f32_16x16x32_bf16 v[124:127], v[64:67], v[40:43], 0
    s_add_u32 m0, s85, 102400
    s_add_u32 s36, s86, 1638400
    s_and_b32 s36, s36, 0x1fffff
    buffer_load_dwordx4 v3, s[8:11], s36 offen lds
    v_exp_f32 v130, v130
    v_cvt_pk_bf16_f32 v140, v128, v129
    v_mfma_f32_16x16x32_bf16 v[144:147], v[100:103], v[136:139], v[144:147]
    v_exp_f32 v131, v131
    v_exp_f32 v132, v132
    v_cvt_pk_bf16_f32 v141, v130, v131
    v_mfma_f32_16x16x32_bf16 v[148:151], v[116:119], v[136:139], v[148:151]
    ds_read_b128 v[96:99], v244 offset:26624
    v_exp_f32 v133, v133
    v_exp_f32 v134, v134
    v_cvt_pk_bf16_f32 v142, v132, v133
    v_exp_f32 v135, v135
    v_mfma_f32_16x16x32_bf16 v[160:163], v[226:229], v[136:139], v[160:163]
    ds_read_b128 v[112:115], v244 offset:27648
    v_cvt_pk_bf16_f32 v143, v134, v135
    s_waitcnt vmcnt(10)
    s_barrier
    v_mfma_f32_16x16x32_bf16 v[128:131], v[56:59], v[48:51], 0
    ds_read_b128 v[72:75], v244 offset:32768
    v_exp_f32 v120, v120
    v_exp_f32 v121, v121
    v_mfma_f32_16x16x32_bf16 v[132:135], v[64:67], v[48:51], 0
    ds_read_b128 v[80:83], v244 offset:33792
    v_exp_f32 v122, v122
    v_cvt_pk_bf16_f32 v136, v120, v121
    v_mfma_f32_16x16x32_bf16 v[152:155], v[100:103], v[140:143], v[152:155]
    s_add_u32 m0, s85, 106496
    s_add_u32 s36, s86, 1703936
    s_and_b32 s36, s36, 0x1fffff
    buffer_load_dwordx4 v3, s[8:11], s36 offen lds
    v_exp_f32 v123, v123
    v_exp_f32 v124, v124
    v_cvt_pk_bf16_f32 v137, v122, v123
    v_mfma_f32_16x16x32_bf16 v[156:159], v[116:119], v[140:143], v[156:159]
    s_add_u32 m0, s85, 110592
    s_add_u32 s36, s86, 1769472
    s_and_b32 s36, s36, 0x1fffff
    buffer_load_dwordx4 v3, s[8:11], s36 offen lds
    v_exp_f32 v125, v125
    v_exp_f32 v126, v126
    v_cvt_pk_bf16_f32 v138, v124, v125
    v_exp_f32 v127, v127
    v_mfma_f32_16x16x32_bf16 v[164:167], v[226:229], v[140:143], v[164:167]
    v_cvt_pk_bf16_f32 v139, v126, v127
    s_waitcnt lgkmcnt(0)
    v_mfma_f32_16x16x32_bf16 v[120:123], v[72:75], v[40:43], v[236:239]
    s_add_u32 m0, s85, 114688
    s_add_u32 s36, s86, 1835008
    s_and_b32 s36, s36, 0x1fffff
    buffer_load_dwordx4 v3, s[8:11], s36 offen lds
    v_exp_f32 v128, v128
    v_exp_f32 v129, v129
    v_mfma_f32_16x16x32_bf16 v[124:127], v[80:83], v[40:43], 0
    v_exp_f32 v130, v130
    v_cvt_pk_bf16_f32 v140, v128, v129
    v_mfma_f32_16x16x32_bf16 v[144:147], v[96:99], v[136:139], v[144:147]
    v_exp_f32 v131, v131
    v_exp_f32 v132, v132
    v_cvt_pk_bf16_f32 v141, v130, v131
    v_mfma_f32_16x16x32_bf16 v[148:151], v[112:115], v[136:139], v[148:151]
    ds_read_b128 v[100:103], v244 offset:34816
    v_exp_f32 v133, v133
    v_exp_f32 v134, v134
    v_cvt_pk_bf16_f32 v142, v132, v133
    v_exp_f32 v135, v135
    v_mfma_f32_16x16x32_bf16 v[160:163], v[226:229], v[136:139], v[160:163]
    ds_read_b128 v[116:119], v244 offset:35840
    v_cvt_pk_bf16_f32 v143, v134, v135
    v_mfma_f32_16x16x32_bf16 v[132:135], v[80:83], v[48:51], v[236:239]
    v_exp_f32 v120, v120
    v_exp_f32 v121, v121
    v_mfma_f32_16x16x32_bf16 v[152:155], v[96:99], v[140:143], v[152:155]
    v_exp_f32 v122, v122
    v_cvt_pk_bf16_f32 v136, v120, v121
    v_mfma_f32_16x16x32_bf16 v[156:159], v[112:115], v[140:143], v[156:159]
    s_add_u32 m0, s85, 118784
    s_add_u32 s36, s86, 1900544
    s_and_b32 s36, s36, 0x1fffff
    buffer_load_dwordx4 v3, s[8:11], s36 offen lds
    v_exp_f32 v123, v123
    v_exp_f32 v124, v124
    v_cvt_pk_bf16_f32 v137, v122, v123
    v_mfma_f32_16x16x32_bf16 v[164:167], v[226:229], v[140:143], v[164:167]
    v_exp_f32 v125, v125
    v_exp_f32 v126, v126
    v_cvt_pk_bf16_f32 v138, v124, v125
    v_exp_f32 v127, v127
    s_nop 0
    v_cvt_pk_bf16_f32 v139, v126, v127
    s_cmp_eq_u32 s20, 1
    s_cbranch_scc0 Lw_95
    v_mov_b32 v226, 0
    v_mov_b32 v227, 0
    v_mov_b32 v228, 0
    v_mov_b32 v229, 0
Lw_95:
    s_waitcnt lgkmcnt(0)
    v_mfma_f32_16x16x32_bf16 v[144:147], v[100:103], v[136:139], v[144:147]
    v_exp_f32 v132, v132
    v_mfma_f32_16x16x32_bf16 v[148:151], v[116:119], v[136:139], v[148:151]
    v_exp_f32 v133, v133
    v_mov_b32 v141, 0
    v_mfma_f32_16x16x32_bf16 v[160:163], v[226:229], v[136:139], v[160:163]
    v_exp_f32 v134, v134
    v_cvt_pk_bf16_f32 v142, v132, v133
    v_exp_f32 v135, v135
    v_mov_b32 v140, 0
    v_cvt_pk_bf16_f32 v143, v134, v135
    s_branch L_afin
L_afin:
    s_nop 0
    v_mfma_f32_16x16x32_bf16 v[152:155], v[100:103], v[140:143], v[152:155]
    v_mfma_f32_16x16x32_bf16 v[156:159], v[116:119], v[140:143], v[156:159]
    v_mfma_f32_16x16x32_bf16 v[164:167], v[226:229], v[140:143], v[164:167]
    v_rcp_f32 v245, v160
    s_nop 0
    v_mul_f32 v144, v144, v245
    v_mul_f32 v145, v145, v245
    v_mul_f32 v146, v146, v245
    v_mul_f32 v147, v147, v245
    v_mul_f32 v148, v148, v245
    v_mul_f32 v149, v149, v245
    v_mul_f32 v150, v150, v245
    v_mul_f32 v151, v151, v245
    v_add_u32 v247, 0x10000, v144
    v_cvt_pk_bf16_f32 v144, v144, v145
    v_cvt_pk_bf16_f32 v145, v146, v147
    v_and_b32_sdwa v144, v247, -2 dst_sel:WORD_0 dst_unused:UNUSED_PRESERVE src0_sel:WORD_1 src1_sel:DWORD
    v_cvt_pk_bf16_f32 v146, v148, v149
    v_cvt_pk_bf16_f32 v147, v150, v151
    s_nop 1
    v_mfma_f32_16x16x32_bf16 v[120:123], v[226:229], v[144:147], 0
    v_rcp_f32 v246, v164
    s_nop 0
    v_mul_f32 v152, v152, v246
    v_mul_f32 v153, v153, v246
    v_mul_f32 v154, v154, v246
    v_mul_f32 v155, v155, v246
    v_mul_f32 v156, v156, v246
    v_mul_f32 v157, v157, v246
    v_mul_f32 v158, v158, v246
    v_mul_f32 v159, v159, v246
    v_add_u32 v247, 0x10000, v152
    v_cvt_pk_bf16_f32 v152, v152, v153
    v_cvt_pk_bf16_f32 v153, v154, v155
    v_and_b32_sdwa v152, v247, -2 dst_sel:WORD_0 dst_unused:UNUSED_PRESERVE src0_sel:WORD_1 src1_sel:DWORD
    v_cvt_pk_bf16_f32 v154, v156, v157
    v_cvt_pk_bf16_f32 v155, v158, v159
    s_nop 1
    v_mfma_f32_16x16x32_bf16 v[120:123], v[226:229], v[152:155], v[120:123]
    v_max_f32 v245, v160, v164
    v_min_f32 v246, v160, v164
    v_cmp_nge_f32 vcc, 0x5d800000, v245
    s_nop 0
    s_mov_b64 s[28:29], vcc
    v_cmp_nle_f32 vcc, 0x21800000, v246
    s_nop 0
    s_or_b64 s[28:29], vcc, s[28:29]
    v_mov_b32 v245, 0x207
    v_cmp_class_f32 vcc, v120, v245
    s_nop 0
    s_or_b64 vcc, vcc, s[28:29]
    s_cbranch_vccnz L_exact
L_ostore:
    s_cmp_eq_u32 s23, 0
    s_cbranch_scc1 Lslow_96
    buffer_store_dwordx4 v[144:147], v0, s[12:15], s72 offen offset:0
    buffer_store_dwordx4 v[152:155], v0, s[12:15], s72 offen offset:1024
Lback_97:
    s_setprio 0
    s_add_u32 s73, s73, 8388608
    s_add_u32 s87, s87, 65536
    s_waitcnt vmcnt(2)
    s_barrier
    s_cmp_lt_u32 s3, 4
    s_cbranch_scc1 L_g2
    s_cmp_eq_u32 s22, 0
    s_cbranch_scc1 L_between0
    s_branch L_between2
L_tailB:
    s_lshl_b32 s27, s22, 3
    s_andn2_b32 s27, s27, 15
    s_add_u32 s27, s27, s20
    s_lshl_b32 s27, s27, 4
    s_add_u32 s27, s27, s21
    s_lshl_b32 s27, s27, 1
    s_waitcnt lgkmcnt(9)
    v_pk_mul_f32 v[184:185], v[214:215], v[212:213] op_sel:[0,1] op_sel_hi:[1,1]
    v_pk_fma_f32 v[184:185], v[80:81], v[212:213], v[184:185] op_sel_hi:[1,0,1]
    v_cvt_pk_bf16_f32 v80, v184, v185
    v_pk_mul_f32 v[186:187], v[216:217], v[212:213] op_sel:[0,1] op_sel_hi:[1,1]
    v_pk_fma_f32 v[186:187], v[82:83], v[212:213], v[186:187] op_sel_hi:[1,0,1]
    v_cvt_pk_bf16_f32 v81, v186, v187
    v_pk_mul_f32 v[188:189], v[218:219], v[212:213] op_sel:[0,1] op_sel_hi:[1,1]
    v_pk_fma_f32 v[188:189], v[84:85], v[212:213], v[188:189] op_sel_hi:[1,0,1]
    v_cvt_pk_bf16_f32 v82, v188, v189
    v_pk_mul_f32 v[190:191], v[220:221], v[212:213] op_sel:[0,1] op_sel_hi:[1,1]
    v_pk_fma_f32 v[190:191], v[86:87], v[212:213], v[190:191] op_sel_hi:[1,0,1]
    v_cvt_pk_bf16_f32 v83, v190, v191
    s_and_b32 s28, s3, 1
    s_add_u32 s27, s27, s28
    s_lshl_b32 s27, s27, 11
    s_add_u32 s27, s27, 31457280
    v_pk_mul_f32 v[186:187], v[238:239], v[230:231] op_sel:[0,0] op_sel_hi:[1,0]
    v_pk_fma_f32 v[186:187], v[102:103], v[234:235], v[186:187]
    v_cvt_pk_bf16_f32 v103, v186, v187
    v_pk_mul_f32 v[184:185], v[236:237], v[230:231] op_sel:[0,0] op_sel_hi:[1,0]
    v_pk_fma_f32 v[184:185], v[100:101], v[232:233], v[184:185]
    v_cvt_pk_bf16_f32 v102, v184, v185
    v_pk_mul_f32 v[190:191], v[238:239], v[230:231] op_sel:[0,1] op_sel_hi:[1,1]
    v_pk_fma_f32 v[190:191], v[118:119], v[234:235], v[190:191]
    v_cvt_pk_bf16_f32 v119, v190, v191
    v_pk_mul_f32 v[188:189], v[236:237], v[230:231] op_sel:[0,1] op_sel_hi:[1,1]
    v_pk_fma_f32 v[188:189], v[116:117], v[232:233], v[188:189]
    v_cvt_pk_bf16_f32 v118, v188, v189
    v_min_u32 v80, -2, v80
    v_min_u32 v232, -2, v102
    v_mov_b32 v233, v103
    v_mov_b32 v234, v118
    v_mov_b32 v235, v119
    s_lshl_b32 s28, s28, 11
    s_add_u32 s28, s28, 133120
    v_add_u32 v253, s28, v0
    s_cmp_ge_u32 s3, 2
    s_cbranch_scc1 Lup_98
    ds_write_b128 v253, v[80:83]
    ds_write_b128 v253, v[232:235] offset:1024
    s_sub_u32 s27, s27, 65536
    s_cmp_eq_u32 s20, 0
    s_cselect_b32 s74, 1073741824, s27
    s_cselect_b32 s29, 4048155338, 0
    s_branch Lon_99
Lup_98:
    buffer_store_dwordx4 v[80:83], v0, s[12:15], s27 offen sc1
    buffer_store_dwordx4 v[232:235], v0, s[12:15], s27 offen offset:1024 sc1
    s_mov_b32 s29, 0
Lon_99:
    v_pk_mul_f32 v[186:187], v[246:247], v[230:231] op_sel:[0,0] op_sel_hi:[1,0]
    v_pk_fma_f32 v[186:187], v[98:99], v[242:243], v[186:187]
    v_cvt_pk_bf16_f32 v101, v186, v187
    v_pk_mul_f32 v[184:185], v[244:245], v[230:231] op_sel:[0,0] op_sel_hi:[1,0]
    v_pk_fma_f32 v[184:185], v[96:97], v[240:241], v[184:185]
    v_cvt_pk_bf16_f32 v100, v184, v185
    v_pk_mul_f32 v[190:191], v[246:247], v[230:231] op_sel:[0,1] op_sel_hi:[1,1]
    v_pk_fma_f32 v[190:191], v[114:115], v[242:243], v[190:191]
    v_cvt_pk_bf16_f32 v117, v190, v191
    v_pk_mul_f32 v[188:189], v[244:245], v[230:231] op_sel:[0,1] op_sel_hi:[1,1]
    v_pk_fma_f32 v[188:189], v[112:113], v[240:241], v[188:189]
    v_cvt_pk_bf16_f32 v116, v188, v189
    v_pk_mul_f32 v[184:185], v[214:215], v[210:211] op_sel:[0,1] op_sel_hi:[1,1]
    v_pk_fma_f32 v[184:185], v[72:73], v[210:211], v[184:185] op_sel_hi:[1,0,1]
    v_cvt_pk_bf16_f32 v72, v184, v185
    v_pk_mul_f32 v[186:187], v[216:217], v[210:211] op_sel:[0,1] op_sel_hi:[1,1]
    v_pk_fma_f32 v[186:187], v[74:75], v[210:211], v[186:187] op_sel_hi:[1,0,1]
    v_cvt_pk_bf16_f32 v73, v186, v187
    v_pk_mul_f32 v[188:189], v[218:219], v[210:211] op_sel:[0,1] op_sel_hi:[1,1]
    v_pk_fma_f32 v[188:189], v[76:77], v[210:211], v[188:189] op_sel_hi:[1,0,1]
    v_cvt_pk_bf16_f32 v74, v188, v189
    v_pk_mul_f32 v[190:191], v[220:221], v[210:211] op_sel:[0,1] op_sel_hi:[1,1]
    v_pk_fma_f32 v[190:191], v[78:79], v[210:211], v[190:191] op_sel_hi:[1,0,1]
    v_cvt_pk_bf16_f32 v75, v190, v191
    s_waitcnt lgkmcnt(0)
    v_pk_mul_f32 v[184:185], v[214:215], v[208:209] op_sel:[0,1] op_sel_hi:[1,1]
    v_pk_fma_f32 v[184:185], v[64:65], v[208:209], v[184:185] op_sel_hi:[1,0,1]
    v_cvt_pk_bf16_f32 v64, v184, v185
    v_pk_mul_f32 v[186:187], v[216:217], v[208:209] op_sel:[0,1] op_sel_hi:[1,1]
    v_pk_fma_f32 v[186:187], v[66:67], v[208:209], v[186:187] op_sel_hi:[1,0,1]
    v_cvt_pk_bf16_f32 v65, v186, v187
    v_pk_mul_f32 v[188:189], v[218:219], v[208:209] op_sel:[0,1] op_sel_hi:[1,1]
    v_pk_fma_f32 v[188:189], v[68:69], v[208:209], v[188:189] op_sel_hi:[1,0,1]
    v_cvt_pk_bf16_f32 v66, v188, v189
    v_pk_mul_f32 v[190:191], v[220:221], v[208:209] op_sel:[0,1] op_sel_hi:[1,1]
    v_pk_fma_f32 v[190:191], v[70:71], v[208:209], v[190:191] op_sel_hi:[1,0,1]
    v_cvt_pk_bf16_f32 v67, v190, v191
    v_pk_mul_f32 v[186:187], v[150:151], v[230:231] op_sel:[0,0] op_sel_hi:[1,0]
    v_pk_fma_f32 v[186:187], v[94:95], v[146:147], v[186:187]
    v_cvt_pk_bf16_f32 v99, v186, v187
    v_pk_mul_f32 v[184:185], v[148:149], v[230:231] op_sel:[0,0] op_sel_hi:[1,0]
    v_pk_fma_f32 v[184:185], v[92:93], v[144:145], v[184:185]
    v_cvt_pk_bf16_f32 v98, v184, v185
    v_pk_mul_f32 v[190:191], v[150:151], v[230:231] op_sel:[0,1] op_sel_hi:[1,1]
    v_pk_fma_f32 v[190:191], v[110:111], v[146:147], v[190:191]
    v_cvt_pk_bf16_f32 v115, v190, v191
    v_pk_mul_f32 v[188:189], v[148:149], v[230:231] op_sel:[0,1] op_sel_hi:[1,1]
    v_pk_fma_f32 v[188:189], v[108:109], v[144:145], v[188:189]
    v_cvt_pk_bf16_f32 v114, v188, v189
    v_pk_mul_f32 v[184:185], v[214:215], v[206:207] op_sel:[0,1] op_sel_hi:[1,1]
    v_pk_fma_f32 v[184:185], v[56:57], v[206:207], v[184:185] op_sel_hi:[1,0,1]
    v_cvt_pk_bf16_f32 v56, v184, v185
    v_pk_mul_f32 v[186:187], v[216:217], v[206:207] op_sel:[0,1] op_sel_hi:[1,1]
    v_pk_fma_f32 v[186:187], v[58:59], v[206:207], v[186:187] op_sel_hi:[1,0,1]
    v_cvt_pk_bf16_f32 v57, v186, v187
    v_pk_mul_f32 v[188:189], v[218:219], v[206:207] op_sel:[0,1] op_sel_hi:[1,1]
    v_pk_fma_f32 v[188:189], v[60:61], v[206:207], v[188:189] op_sel_hi:[1,0,1]
    v_cvt_pk_bf16_f32 v58, v188, v189
    v_pk_mul_f32 v[190:191], v[220:221], v[206:207] op_sel:[0,1] op_sel_hi:[1,1]
    v_pk_fma_f32 v[190:191], v[62:63], v[206:207], v[190:191] op_sel_hi:[1,0,1]
    v_cvt_pk_bf16_f32 v59, v190, v191
    v_pk_mul_f32 v[186:187], v[158:159], v[230:231] op_sel:[0,0] op_sel_hi:[1,0]
    v_pk_fma_f32 v[186:187], v[90:91], v[154:155], v[186:187]
    v_cvt_pk_bf16_f32 v97, v186, v187
    v_pk_mul_f32 v[184:185], v[156:157], v[230:231] op_sel:[0,0] op_sel_hi:[1,0]
    v_pk_fma_f32 v[184:185], v[88:89], v[152:153], v[184:185]
    v_cvt_pk_bf16_f32 v96, v184, v185
    v_pk_mul_f32 v[190:191], v[158:159], v[230:231] op_sel:[0,1] op_sel_hi:[1,1]
    v_pk_fma_f32 v[190:191], v[106:107], v[154:155], v[190:191]
    v_cvt_pk_bf16_f32 v113, v190, v191
    v_pk_mul_f32 v[188:189], v[156:157], v[230:231] op_sel:[0,1] op_sel_hi:[1,1]
    v_pk_fma_f32 v[188:189], v[104:105], v[152:153], v[188:189]
    v_cvt_pk_bf16_f32 v112, v188, v189
    v_mfma_f32_16x16x32_bf16 v[24:27], v[136:139], v[120:123], v[24:27]
    s_mov_b32 s35, 1048744942
    v_mul_f32 v206, s35, v206
    v_mfma_f32_16x16x32_bf16 v[32:35], v[136:139], v[124:127], v[32:35]
    v_mul_f32 v207, s35, v207
    v_mul_f32 v208, s35, v208
    v_mfma_f32_16x16x32_bf16 v[40:43], v[136:139], v[128:131], v[40:43]
    v_mul_f32 v209, s35, v209
    v_mul_f32 v210, s35, v210
    v_mfma_f32_16x16x32_bf16 v[48:51], v[136:139], v[132:135], v[48:51]
    v_mul_f32 v211, s35, v211
    v_mul_f32 v212, s35, v212
    v_mfma_f32_16x16x32_bf16 v[52:55], v[140:143], v[132:135], v[52:55]
    v_mul_f32 v213, s35, v213
    v_mov_b32 v236, s29
    v_mfma_f32_16x16x32_bf16 v[44:47], v[140:143], v[128:131], v[44:47]
    v_mov_b32 v237, s29
    v_mov_b32 v238, s29
    v_mfma_f32_16x16x32_bf16 v[36:39], v[140:143], v[124:127], v[36:39]
    v_mov_b32 v239, s29
    v_mov_b32 v234, 0xffff
    v_mfma_f32_16x16x32_bf16 v[28:31], v[140:143], v[120:123], v[28:31]
    v_mov_b32 v235, 0xffff0000
    v_cndmask_b32 v235, v234, v235, s[92:93]
    v_mfma_f32_16x16x32_bf16 v[24:27], v[176:179], v[160:163], v[24:27]
    v_cndmask_b32 v232, 0, v235, s[96:97]
    v_cndmask_b32 v233, 0, v235, s[98:99]
    v_mfma_f32_16x16x32_bf16 v[32:35], v[176:179], v[164:167], v[32:35]
    v_xor_b32 v234, v232, v235
    v_xor_b32 v235, v233, v235
    v_mfma_f32_16x16x32_bf16 v[40:43], v[176:179], v[168:171], v[40:43]
    s_sub_u32 s28, s72, 65536
    v_mfma_f32_16x16x32_bf16 v[48:51], v[176:179], v[172:175], v[48:51]
    v_mfma_f32_16x16x32_bf16 v[52:55], v[180:183], v[172:175], v[52:55]
    v_mfma_f32_16x16x32_bf16 v[44:47], v[180:183], v[168:171], v[44:47]
    v_mfma_f32_16x16x32_bf16 v[36:39], v[180:183], v[164:167], v[36:39]
    s_barrier
    v_mfma_f32_16x16x32_bf16 v[28:31], v[180:183], v[160:163], v[28:31]
    s_cmp_ge_u32 s3, 2
    s_cbranch_scc1 Lup_100
    buffer_load_dwordx4 v[244:247], v0, s[12:15], s74 offen sc1
    buffer_load_dwordx4 v[240:243], v0, s[12:15], s74 offen offset:1024 sc1
    s_branch Lon_101
Lup_100:
    ds_read_b128 v[244:247], v253
    ds_read_b128 v[240:243], v253 offset:1024
Lon_101:
    v_pk_mul_f32 v[184:185], v[192:193], v[212:213] op_sel:[0,1] op_sel_hi:[1,1]
    v_pk_fma_f32 v[184:185], v[48:49], v[212:213], v[184:185] op_sel_hi:[1,0,1]
    v_cvt_pk_bf16_f32 v48, v184, v185
    v_pk_mul_f32 v[186:187], v[194:195], v[212:213] op_sel:[0,1] op_sel_hi:[1,1]
    v_pk_fma_f32 v[186:187], v[50:51], v[212:213], v[186:187] op_sel_hi:[1,0,1]
    v_cvt_pk_bf16_f32 v49, v186, v187
    v_pk_mul_f32 v[188:189], v[196:197], v[212:213] op_sel:[0,1] op_sel_hi:[1,1]
    v_pk_fma_f32 v[188:189], v[52:53], v[212:213], v[188:189] op_sel_hi:[1,0,1]
    v_cvt_pk_bf16_f32 v50, v188, v189
    v_pk_mul_f32 v[190:191], v[198:199], v[212:213] op_sel:[0,1] op_sel_hi:[1,1]
    v_pk_fma_f32 v[190:191], v[54:55], v[212:213], v[190:191] op_sel_hi:[1,0,1]
    v_cvt_pk_bf16_f32 v51, v190, v191
    v_pk_mul_f32 v[184:185], v[192:193], v[210:211] op_sel:[0,1] op_sel_hi:[1,1]
    v_pk_fma_f32 v[184:185], v[40:41], v[210:211], v[184:185] op_sel_hi:[1,0,1]
    v_cvt_pk_bf16_f32 v40, v184, v185
    v_pk_mul_f32 v[186:187], v[194:195], v[210:211] op_sel:[0,1] op_sel_hi:[1,1]
    v_pk_fma_f32 v[186:187], v[42:43], v[210:211], v[186:187] op_sel_hi:[1,0,1]
    v_cvt_pk_bf16_f32 v41, v186, v187
    v_pk_mul_f32 v[188:189], v[196:197], v[210:211] op_sel:[0,1] op_sel_hi:[1,1]
    v_pk_fma_f32 v[188:189], v[44:45], v[210:211], v[188:189] op_sel_hi:[1,0,1]
    v_cvt_pk_bf16_f32 v42, v188, v189
    v_pk_mul_f32 v[190:191], v[198:199], v[210:211] op_sel:[0,1] op_sel_hi:[1,1]
    v_pk_fma_f32 v[190:191], v[46:47], v[210:211], v[190:191] op_sel_hi:[1,0,1]
    v_cvt_pk_bf16_f32 v43, v190, v191
    v_pk_mul_f32 v[184:185], v[192:193], v[208:209] op_sel:[0,1] op_sel_hi:[1,1]
    v_pk_fma_f32 v[184:185], v[32:33], v[208:209], v[184:185] op_sel_hi:[1,0,1]
    v_cvt_pk_bf16_f32 v32, v184, v185
    v_pk_mul_f32 v[186:187], v[194:195], v[208:209] op_sel:[0,1] op_sel_hi:[1,1]
    v_pk_fma_f32 v[186:187], v[34:35], v[208:209], v[186:187] op_sel_hi:[1,0,1]
    v_cvt_pk_bf16_f32 v33, v186, v187
    v_pk_mul_f32 v[188:189], v[196:197], v[208:209] op_sel:[0,1] op_sel_hi:[1,1]
    v_pk_fma_f32 v[188:189], v[36:37], v[208:209], v[188:189] op_sel_hi:[1,0,1]
    v_cvt_pk_bf16_f32 v34, v188, v189
    v_pk_mul_f32 v[190:191], v[198:199], v[208:209] op_sel:[0,1] op_sel_hi:[1,1]
    v_pk_fma_f32 v[190:191], v[38:39], v[208:209], v[190:191] op_sel_hi:[1,0,1]
    v_cvt_pk_bf16_f32 v35, v190, v191
    v_pk_mul_f32 v[184:185], v[192:193], v[206:207] op_sel:[0,1] op_sel_hi:[1,1]
    v_pk_fma_f32 v[184:185], v[24:25], v[206:207], v[184:185] op_sel_hi:[1,0,1]
    v_cvt_pk_bf16_f32 v24, v184, v185
    v_pk_mul_f32 v[186:187], v[194:195], v[206:207] op_sel:[0,1] op_sel_hi:[1,1]
    v_pk_fma_f32 v[186:187], v[26:27], v[206:207], v[186:187] op_sel_hi:[1,0,1]
    v_cvt_pk_bf16_f32 v25, v186, v187
    v_pk_mul_f32 v[188:189], v[196:197], v[206:207] op_sel:[0,1] op_sel_hi:[1,1]
    v_pk_fma_f32 v[188:189], v[28:29], v[206:207], v[188:189] op_sel_hi:[1,0,1]
    v_cvt_pk_bf16_f32 v26, v188, v189
    v_pk_mul_f32 v[190:191], v[198:199], v[206:207] op_sel:[0,1] op_sel_hi:[1,1]
    v_pk_fma_f32 v[190:191], v[30:31], v[206:207], v[190:191] op_sel_hi:[1,0,1]
    v_cvt_pk_bf16_f32 v27, v190, v191
    v_mfma_f32_16x16x32_bf16 v[168:171], v[80:83], v[48:51], 0
    v_mfma_f32_16x16x32_bf16 v[172:175], v[72:75], v[48:51], 0
    v_mfma_f32_16x16x32_bf16 v[152:155], v[72:75], v[40:43], 0
    v_mfma_f32_16x16x32_bf16 v[156:159], v[64:67], v[40:43], 0
    v_mfma_f32_16x16x32_bf16 v[136:139], v[64:67], v[32:35], 0
    v_mfma_f32_16x16x32_bf16 v[140:143], v[56:59], v[32:35], 0
    s_nop 2
    v_cndmask_b32 v168, v168, v169, s[92:93]
    s_nop 0
    v_cndmask_b32 v152, v152, v153, s[92:93]
    s_nop 0
    v_cndmask_b32 v136, v136, v137, s[92:93]
    v_cndmask_b32 v170, v170, v171, s[92:93]
    v_cndmask_b32 v154, v154, v155, s[92:93]
    v_cndmask_b32 v138, v138, v139, s[92:93]
    v_cndmask_b32 v172, v172, v173, s[92:93]
    v_cndmask_b32 v156, v156, v157, s[92:93]
    v_cndmask_b32 v140, v140, v141, s[92:93]
    v_cndmask_b32 v174, v174, v175, s[92:93]
    v_cndmask_b32 v158, v158, v159, s[92:93]
    v_cndmask_b32 v142, v142, v143, s[92:93]
    v_cndmask_b32 v176, v168, v172, s[96:97]
    v_cndmask_b32 v160, v152, v156, s[96:97]
    v_cndmask_b32 v144, v136, v140, s[96:97]
    v_cndmask_b32 v177, v170, v174, s[98:99]
    v_cndmask_b32 v161, v154, v158, s[98:99]
    v_cndmask_b32 v145, v138, v142, s[98:99]
    v_max_f32 v178, v176, v177
    v_max_f32 v162, v160, v161
    v_max_f32 v146, v144, v145
    v_mov_b32 v179, v178
    v_mov_b32 v163, v162
    v_mov_b32 v147, v146
    v_permlane32_swap_b32 v178, v179
    v_permlane32_swap_b32 v162, v163
    v_permlane32_swap_b32 v146, v147
    v_max_f32 v178, v178, v179
    v_max_f32 v162, v162, v163
    v_max_f32 v146, v146, v147
    v_mov_b32 v179, v178
    v_mov_b32 v163, v162
    v_mov_b32 v147, v146
    v_permlane16_swap_b32 v178, v179
    v_permlane16_swap_b32 v162, v163
    v_permlane16_swap_b32 v146, v147
    v_max_f32 v178, v178, v179
    v_max_f32 v162, v162, v163
    v_max_f32 v146, v146, v147
    v_sub_f32 v176, v176, v178
    v_sub_f32 v160, v160, v162
    v_sub_f32 v144, v144, v146
    v_sub_f32 v177, v177, v178
    v_sub_f32 v161, v161, v162
    v_sub_f32 v145, v145, v146
    v_exp_f32 v176, v176
    v_exp_f32 v160, v160
    v_exp_f32 v144, v144
    v_exp_f32 v177, v177
    v_exp_f32 v161, v161
    v_exp_f32 v145, v145
    v_cvt_pk_bf16_f32 v176, v176, v176
    v_cvt_pk_bf16_f32 v160, v160, v160
    v_cvt_pk_bf16_f32 v144, v144, v144
    v_cvt_pk_bf16_f32 v177, v177, v177
    v_cvt_pk_bf16_f32 v161, v161, v161
    v_cvt_pk_bf16_f32 v145, v145, v145
    v_and_b32 v168, v232, v176
    v_and_b32 v152, v232, v160
    v_and_b32 v136, v232, v144
    v_and_b32 v169, v233, v177
    v_and_b32 v153, v233, v161
    v_and_b32 v137, v233, v145
    v_and_b32 v170, v234, v176
    v_and_b32 v154, v234, v160
    v_and_b32 v138, v234, v144
    v_and_b32 v171, v235, v177
    v_and_b32 v155, v235, v161
    v_and_b32 v139, v235, v145
    v_mfma_f32_16x16x32_bf16 v[172:175], v[226:229], v[168:171], 0
    v_mfma_f32_16x16x32_bf16 v[176:179], v[100:103], v[168:171], 0
    v_mfma_f32_16x16x32_bf16 v[180:183], v[116:119], v[168:171], 0
    v_mfma_f32_16x16x32_bf16 v[156:159], v[226:229], v[152:155], 0
    v_mfma_f32_16x16x32_bf16 v[160:163], v[98:101], v[152:155], 0
    v_mfma_f32_16x16x32_bf16 v[164:167], v[114:117], v[152:155], 0
    v_mfma_f32_16x16x32_bf16 v[140:143], v[226:229], v[136:139], 0
    v_mfma_f32_16x16x32_bf16 v[144:147], v[96:99], v[136:139], 0
    v_mfma_f32_16x16x32_bf16 v[148:151], v[112:115], v[136:139], 0
    v_rcp_f32 v172, v172
    s_nop 1
    v_rcp_f32 v156, v156
    s_nop 1
    v_rcp_f32 v140, v140
    v_mul_f32 v176, v176, v172
    v_mul_f32 v160, v160, v156
    v_mul_f32 v144, v144, v140
    v_mul_f32 v177, v177, v172
    v_mul_f32 v161, v161, v156
    v_mul_f32 v145, v145, v140
    v_mul_f32 v178, v178, v172
    v_mul_f32 v162, v162, v156
    v_mul_f32 v146, v146, v140
    v_mul_f32 v179, v179, v172
    v_mul_f32 v163, v163, v156
    v_mul_f32 v147, v147, v140
    v_mul_f32 v180, v180, v172
    v_mul_f32 v164, v164, v156
    v_mul_f32 v148, v148, v140
    v_mul_f32 v181, v181, v172
    v_mul_f32 v165, v165, v156
    v_mul_f32 v149, v149, v140
    v_mul_f32 v182, v182, v172
    v_mul_f32 v166, v166, v156
    v_mul_f32 v150, v150, v140
    v_mul_f32 v183, v183, v172
    v_mul_f32 v167, v167, v156
    v_mul_f32 v151, v151, v140
    v_cvt_pk_bf16_f32 v168, v176, v177
    v_cvt_pk_bf16_f32 v152, v160, v161
    v_cvt_pk_bf16_f32 v136, v144, v145
    v_cvt_pk_bf16_f32 v169, v178, v179
    v_cvt_pk_bf16_f32 v153, v162, v163
    v_cvt_pk_bf16_f32 v137, v146, v147
    v_or_b32_sdwa v168, v176, 1 dst_sel:WORD_0 dst_unused:UNUSED_PRESERVE src0_sel:WORD_1 src1_sel:DWORD
    v_or_b32_sdwa v152, v160, 1 dst_sel:WORD_0 dst_unused:UNUSED_PRESERVE src0_sel:WORD_1 src1_sel:DWORD
    v_or_b32_sdwa v136, v144, 1 dst_sel:WORD_0 dst_unused:UNUSED_PRESERVE src0_sel:WORD_1 src1_sel:DWORD
    v_cvt_pk_bf16_f32 v170, v180, v181
    v_cvt_pk_bf16_f32 v154, v164, v165
    v_cvt_pk_bf16_f32 v138, v148, v149
    v_cvt_pk_bf16_f32 v171, v182, v183
    v_cvt_pk_bf16_f32 v155, v166, v167
    v_cvt_pk_bf16_f32 v139, v150, v151
    s_cmp_eq_u32 s23, 0
    s_cbranch_scc1 Lslow_102
    buffer_store_dwordx4 v[168:171], v0, s[12:15], s72 offen offset:1024
    buffer_store_dwordx4 v[152:155], v0, s[12:15], s72 offen offset:0
    buffer_store_dwordx4 v[136:139], v0, s[12:15], s28 offen offset:1024
Lback_103:
    s_mov_b32 s26, 0
    s_waitcnt vmcnt(3) lgkmcnt(0)
Lhck_104:
    v_max_u32 v120, v244, v240
    v_cmp_eq_u32 vcc, -1, v120
    s_nop 0
    s_cbranch_vccnz Lhrt_106
Lhok_105:
    v_mfma_f32_16x16x32_bf16 v[120:123], v[56:59], v[24:27], 0
    v_mfma_f32_16x16x32_bf16 v[124:127], v[244:247], v[24:27], v[236:239]
    v_mov_b32 v94, v240
    v_mov_b32 v95, v241
    v_mov_b32 v110, v242
    v_mov_b32 v111, v243
    s_nop 2
    v_cndmask_b32 v120, v120, v121, s[92:93]
    v_cndmask_b32 v122, v122, v123, s[92:93]
    v_cndmask_b32 v124, v124, v125, s[92:93]
    v_cndmask_b32 v126, v126, v127, s[92:93]
    v_cndmask_b32 v128, v120, v124, s[96:97]
    v_cndmask_b32 v129, v122, v126, s[98:99]
    v_max_f32 v130, v128, v129
    v_mov_b32 v131, v130
    s_nop 1
    v_permlane32_swap_b32 v130, v131
    v_max_f32 v130, v130, v131
    v_mov_b32 v131, v130
    s_nop 1
    v_permlane16_swap_b32 v130, v131
    v_max_f32 v130, v130, v131
    v_sub_f32 v128, v128, v130
    v_sub_f32 v129, v129, v130
    v_exp_f32 v128, v128
    v_exp_f32 v129, v129
    v_cvt_pk_bf16_f32 v128, v128, v128
    v_cvt_pk_bf16_f32 v129, v129, v129
    v_and_b32 v120, v232, v128
    v_and_b32 v121, v233, v129
    v_and_b32 v122, v234, v128
    v_and_b32 v123, v235, v129
    s_nop 1
    v_mfma_f32_16x16x32_bf16 v[124:127], v[226:229], v[120:123], 0
    v_mfma_f32_16x16x32_bf16 v[128:131], v[94:97], v[120:123], 0
    v_mfma_f32_16x16x32_bf16 v[132:135], v[110:113], v[120:123], 0
    s_nop 5
    v_rcp_f32 v124, v124
    s_nop 0
    v_mul_f32 v128, v128, v124
    v_mul_f32 v129, v129, v124
    v_mul_f32 v130, v130, v124
    v_mul_f32 v131, v131, v124
    v_mul_f32 v132, v132, v124
    v_mul_f32 v133, v133, v124
    v_mul_f32 v134, v134, v124
    v_mul_f32 v135, v135, v124
    v_cvt_pk_bf16_f32 v120, v128, v129
    v_cvt_pk_bf16_f32 v121, v130, v131
    v_or_b32_sdwa v120, v128, 1 dst_sel:WORD_0 dst_unused:UNUSED_PRESERVE src0_sel:WORD_1 src1_sel:DWORD
    v_cvt_pk_bf16_f32 v122, v132, v133
    v_cvt_pk_bf16_f32 v123, v134, v135
    s_cmp_eq_u32 s23, 0
    s_cbranch_scc1 Lslow_107
    buffer_store_dwordx4 v[120:123], v0, s[12:15], s28 offen offset:0
Lback_108:
L_g2:
    s_and_b32 s27, s71, 0xffff0000
    s_add_u32 s27, s27, 2097152
    v_add_u32 v214, s27, v0
    s_and_b32 s55, s71, 0xffff
    buffer_load_dwordx4 v[104:107], v214, s[12:15], s55 offen offset:0 sc1
    buffer_load_dwordx4 v[108:111], v214, s[12:15], s55 offen offset:1024 sc1
    buffer_load_dwordx4 v[112:115], v214, s[12:15], s55 offen offset:2048 sc1
    buffer_load_dwordx4 v[116:119], v214, s[12:15], s55 offen offset:3072 sc1
    v_lshrrev_b32 v207, 5, v1
    v_lshl_add_u32 v206, v207, 10, v2
    v_xor_b32 v207, 32, v206
    v_xor_b32 v208, 64, v206
    v_xor_b32 v209, 96, v206
    ds_read_b64_tr_b16 v[56:57], v206 offset:0
    ds_read_b64_tr_b16 v[58:59], v206 offset:2048
    ds_read_b64_tr_b16 v[60:61], v207 offset:0
    ds_read_b64_tr_b16 v[62:63], v207 offset:2048
    ds_read_b64_tr_b16 v[64:65], v208 offset:0
    ds_read_b64_tr_b16 v[66:67], v208 offset:2048
    ds_read_b64_tr_b16 v[68:69], v209 offset:0
    ds_read_b64_tr_b16 v[70:71], v209 offset:2048
    s_add_u32 s55, s55, 4096
    s_and_b32 s55, s55, 0xffff
    buffer_load_dwordx4 v[120:123], v214, s[12:15], s55 offen offset:0 sc1
    buffer_load_dwordx4 v[124:127], v214, s[12:15], s55 offen offset:1024 sc1
    buffer_load_dwordx4 v[128:131], v214, s[12:15], s55 offen offset:2048 sc1
    buffer_load_dwordx4 v[132:135], v214, s[12:15], s55 offen offset:3072 sc1
    ds_read_b64_tr_b16 v[72:73], v206 offset:4096
    ds_read_b64_tr_b16 v[74:75], v206 offset:6144
    ds_read_b64_tr_b16 v[76:77], v207 offset:4096
    ds_read_b64_tr_b16 v[78:79], v207 offset:6144
    ds_read_b64_tr_b16 v[80:81], v208 offset:4096
    ds_read_b64_tr_b16 v[82:83], v208 offset:6144
    ds_read_b64_tr_b16 v[84:85], v209 offset:4096
    ds_read_b64_tr_b16 v[86:87], v209 offset:6144
    v_lshlrev_b32 v24, 16, v8
    v_and_b32 v25, 0xffff0000, v8
    v_lshlrev_b32 v26, 16, v9
    v_and_b32 v27, 0xffff0000, v9
    v_lshlrev_b32 v28, 16, v10
    v_and_b32 v29, 0xffff0000, v10
    v_lshlrev_b32 v30, 16, v11
    v_and_b32 v31, 0xffff0000, v11
    v_lshlrev_b32 v32, 16, v12
    v_and_b32 v33, 0xffff0000, v12
    v_lshlrev_b32 v34, 16, v13
    v_and_b32 v35, 0xffff0000, v13
    v_lshlrev_b32 v36, 16, v14
    v_and_b32 v37, 0xffff0000, v14
    v_lshlrev_b32 v38, 16, v15
    v_and_b32 v39, 0xffff0000, v15
    v_lshlrev_b32 v40, 16, v16
    v_and_b32 v41, 0xffff0000, v16
    v_lshlrev_b32 v42, 16, v17
    v_and_b32 v43, 0xffff0000, v17
    v_lshlrev_b32 v44, 16, v18
    v_and_b32 v45, 0xffff0000, v18
    v_lshlrev_b32 v46, 16, v19
    v_and_b32 v47, 0xffff0000, v19
    v_lshlrev_b32 v48, 16, v20
    v_and_b32 v49, 0xffff0000, v20
    v_lshlrev_b32 v50, 16, v21
    v_and_b32 v51, 0xffff0000, v21
    v_lshlrev_b32 v52, 16, v22
    v_and_b32 v53, 0xffff0000, v22
    v_lshlrev_b32 v54, 16, v23
    v_and_b32 v55, 0xffff0000, v23
    v_add_u32 v210, 65536, v206
    v_add_u32 v211, 65536, v207
    v_add_u32 v212, 65536, v208
    v_add_u32 v213, 65536, v209
    v_mov_b32 v226, 0x3f803f80
    v_mov_b32 v227, 0x3f803f80
    v_mov_b32 v228, 0x3f803f80
    v_mov_b32 v229, 0x3f803f80
    s_lshr_b32 s27, s3, 1
    s_lshl_b32 s27, s27, 13
    s_add_u32 s27, s27, 49152
    v_add_u32 v200, s27, v0
    v_add_u32 v201, 1024, v200
    s_lshl_b32 s27, s3, 12
    s_add_u32 s27, s27, 49152
    v_add_u32 v240, s27, v0
    s_waitcnt vmcnt(4)
    v_bitop3_b32 v216, v104, v108, s22 bitop3:0x7e
    v_bitop3_b32 v217, v112, v116, s22 bitop3:0x7e
    v_bitop3_b32 v216, v216, v217, 1 bitop3:0xa8
    v_cmp_ne_u32 vcc, 0, v216
    s_waitcnt lgkmcnt(8)
    s_cbranch_vccnz Lock_109
Look_110:
    v_mfma_f32_16x16x32_bf16 v[24:27], v[56:59], v[104:107], v[24:27]
    ds_read_b64_tr_b16 v[88:89], v206 offset:8192
    s_add_u32 s55, s55, 4096
    s_and_b32 s55, s55, 0xffff
    buffer_load_dwordx4 v[136:139], v214, s[12:15], s55 offen offset:0 sc1
    v_mfma_f32_16x16x32_bf16 v[40:43], v[56:59], v[108:111], v[40:43]
    ds_read_b64_tr_b16 v[90:91], v206 offset:10240
    buffer_load_dwordx4 v[140:143], v214, s[12:15], s55 offen offset:1024 sc1
    v_mfma_f32_16x16x32_bf16 v[44:47], v[60:63], v[108:111], v[44:47]
    ds_read_b64_tr_b16 v[92:93], v207 offset:8192
    buffer_load_dwordx4 v[144:147], v214, s[12:15], s55 offen offset:2048 sc1
    v_mfma_f32_16x16x32_bf16 v[28:31], v[60:63], v[104:107], v[28:31]
    ds_read_b64_tr_b16 v[94:95], v207 offset:10240
    buffer_load_dwordx4 v[148:151], v214, s[12:15], s55 offen offset:3072 sc1
    v_mfma_f32_16x16x32_bf16 v[32:35], v[64:67], v[104:107], v[32:35]
    ds_read_b64_tr_b16 v[96:97], v208 offset:8192
    s_add_u32 s55, s55, 4096
    s_and_b32 s55, s55, 0xffff
    v_mfma_f32_16x16x32_bf16 v[48:51], v[64:67], v[108:111], v[48:51]
    ds_read_b64_tr_b16 v[98:99], v208 offset:10240
    buffer_load_dwordx4 v[152:155], v214, s[12:15], s55 offen offset:0 sc1
    v_mfma_f32_16x16x32_bf16 v[52:55], v[68:71], v[108:111], v[52:55]
    ds_read_b64_tr_b16 v[100:101], v209 offset:8192
    buffer_load_dwordx4 v[156:159], v214, s[12:15], s55 offen offset:1024 sc1
    v_mfma_f32_16x16x32_bf16 v[36:39], v[68:71], v[104:107], v[36:39]
    ds_read_b64_tr_b16 v[102:103], v209 offset:10240
    s_waitcnt lgkmcnt(8)
    buffer_load_dwordx4 v[160:163], v214, s[12:15], s55 offen offset:2048 sc1
    v_mfma_f32_16x16x32_bf16 v[24:27], v[72:75], v[112:115], v[24:27]
    ds_read_b64_tr_b16 v[56:57], v206 offset:12288
    buffer_load_dwordx4 v[164:167], v214, s[12:15], s55 offen offset:3072 sc1
    v_mfma_f32_16x16x32_bf16 v[40:43], v[72:75], v[116:119], v[40:43]
    ds_read_b64_tr_b16 v[58:59], v206 offset:14336
    s_waitcnt vmcnt(8)
    v_mfma_f32_16x16x32_bf16 v[44:47], v[76:79], v[116:119], v[44:47]
    ds_read_b64_tr_b16 v[60:61], v207 offset:12288
    v_bitop3_b32 v216, v120, v124, s22 bitop3:0x7e
    v_mfma_f32_16x16x32_bf16 v[28:31], v[76:79], v[112:115], v[28:31]
    ds_read_b64_tr_b16 v[62:63], v207 offset:14336
    v_bitop3_b32 v217, v128, v132, s22 bitop3:0x7e
    v_mfma_f32_16x16x32_bf16 v[32:35], v[80:83], v[112:115], v[32:35]
    ds_read_b64_tr_b16 v[64:65], v208 offset:12288
    v_bitop3_b32 v216, v216, v217, 1 bitop3:0xa8
    v_mfma_f32_16x16x32_bf16 v[48:51], v[80:83], v[116:119], v[48:51]
    ds_read_b64_tr_b16 v[66:67], v208 offset:14336
    v_cmp_ne_u32 vcc, 0, v216
    v_mfma_f32_16x16x32_bf16 v[52:55], v[84:87], v[116:119], v[52:55]
    ds_read_b64_tr_b16 v[68:69], v209 offset:12288
    v_mfma_f32_16x16x32_bf16 v[36:39], v[84:87], v[112:115], v[36:39]
    ds_read_b64_tr_b16 v[70:71], v209 offset:14336
    s_waitcnt lgkmcnt(8)
    s_cbranch_vccnz Lock_111
Look_112:
    v_mfma_f32_16x16x32_bf16 v[24:27], v[88:91], v[120:123], v[24:27]
    ds_read_b64_tr_b16 v[72:73], v206 offset:16384
    s_add_u32 s55, s55, 4096
    v_mfma_f32_16x16x32_bf16 v[40:43], v[88:91], v[124:127], v[40:43]
    ds_read_b64_tr_b16 v[74:75], v206 offset:18432
    s_and_b32 s55, s55, 0xffff
    v_mfma_f32_16x16x32_bf16 v[44:47], v[92:95], v[124:127], v[44:47]
    ds_read_b64_tr_b16 v[76:77], v207 offset:16384
    buffer_load_dwordx4 v[168:171], v214, s[12:15], s55 offen offset:0 sc1
    v_mfma_f32_16x16x32_bf16 v[28:31], v[92:95], v[120:123], v[28:31]
    ds_read_b64_tr_b16 v[78:79], v207 offset:18432
    v_mfma_f32_16x16x32_bf16 v[32:35], v[96:99], v[120:123], v[32:35]
    ds_read_b64_tr_b16 v[80:81], v208 offset:16384
    buffer_load_dwordx4 v[172:175], v214, s[12:15], s55 offen offset:1024 sc1
    v_mfma_f32_16x16x32_bf16 v[48:51], v[96:99], v[124:127], v[48:51]
    ds_read_b64_tr_b16 v[82:83], v208 offset:18432
    v_mfma_f32_16x16x32_bf16 v[52:55], v[100:103], v[124:127], v[52:55]
    ds_read_b64_tr_b16 v[84:85], v209 offset:16384
    buffer_load_dwordx4 v[176:179], v214, s[12:15], s55 offen offset:2048 sc1
    v_mfma_f32_16x16x32_bf16 v[36:39], v[100:103], v[120:123], v[36:39]
    ds_read_b64_tr_b16 v[86:87], v209 offset:18432
    s_waitcnt lgkmcnt(8)
    v_mfma_f32_16x16x32_bf16 v[24:27], v[56:59], v[128:131], v[24:27]
    ds_read_b64_tr_b16 v[88:89], v206 offset:20480
    buffer_load_dwordx4 v[180:183], v214, s[12:15], s55 offen offset:3072 sc1
    v_mfma_f32_16x16x32_bf16 v[40:43], v[56:59], v[132:135], v[40:43]
    ds_read_b64_tr_b16 v[90:91], v206 offset:22528
    s_waitcnt vmcnt(8)
    v_mfma_f32_16x16x32_bf16 v[44:47], v[60:63], v[132:135], v[44:47]
    ds_read_b64_tr_b16 v[92:93], v207 offset:20480
    v_bitop3_b32 v216, v136, v140, s22 bitop3:0x7e
    v_mfma_f32_16x16x32_bf16 v[28:31], v[60:63], v[128:131], v[28:31]
    ds_read_b64_tr_b16 v[94:95], v207 offset:22528
    v_bitop3_b32 v217, v144, v148, s22 bitop3:0x7e
    v_mfma_f32_16x16x32_bf16 v[32:35], v[64:67], v[128:131], v[32:35]
    ds_read_b64_tr_b16 v[96:97], v208 offset:20480
    v_bitop3_b32 v216, v216, v217, 1 bitop3:0xa8
    v_mfma_f32_16x16x32_bf16 v[48:51], v[64:67], v[132:135], v[48:51]
    ds_read_b64_tr_b16 v[98:99], v208 offset:22528
    v_cmp_ne_u32 vcc, 0, v216
    v_mfma_f32_16x16x32_bf16 v[52:55], v[68:71], v[132:135], v[52:55]
    ds_read_b64_tr_b16 v[100:101], v209 offset:20480
    v_mfma_f32_16x16x32_bf16 v[36:39], v[68:71], v[128:131], v[36:39]
    ds_read_b64_tr_b16 v[102:103], v209 offset:22528
    s_waitcnt lgkmcnt(8)
    s_cbranch_vccnz Lock_113
Look_114:
    v_mfma_f32_16x16x32_bf16 v[24:27], v[72:75], v[136:139], v[24:27]
    ds_read_b64_tr_b16 v[56:57], v206 offset:24576
    s_add_u32 s55, s55, 4096
    s_and_b32 s55, s55, 0xffff
    buffer_load_dwordx4 v[104:107], v214, s[12:15], s55 offen offset:0 sc1
    v_mfma_f32_16x16x32_bf16 v[40:43], v[72:75], v[140:143], v[40:43]
    ds_read_b64_tr_b16 v[58:59], v206 offset:26624
    buffer_load_dwordx4 v[108:111], v214, s[12:15], s55 offen offset:1024 sc1
    v_mfma_f32_16x16x32_bf16 v[44:47], v[76:79], v[140:143], v[44:47]
    ds_read_b64_tr_b16 v[60:61], v207 offset:24576
    buffer_load_dwordx4 v[112:115], v214, s[12:15], s55 offen offset:2048 sc1
    v_mfma_f32_16x16x32_bf16 v[28:31], v[76:79], v[136:139], v[28:31]
    ds_read_b64_tr_b16 v[62:63], v207 offset:26624
    buffer_load_dwordx4 v[116:119], v214, s[12:15], s55 offen offset:3072 sc1
    v_mfma_f32_16x16x32_bf16 v[32:35], v[80:83], v[136:139], v[32:35]
    ds_read_b64_tr_b16 v[64:65], v208 offset:24576
    s_add_u32 s55, s55, 4096
    s_and_b32 s55, s55, 0xffff
    v_mfma_f32_16x16x32_bf16 v[48:51], v[80:83], v[140:143], v[48:51]
    ds_read_b64_tr_b16 v[66:67], v208 offset:26624
    buffer_load_dwordx4 v[120:123], v214, s[12:15], s55 offen offset:0 sc1
    v_mfma_f32_16x16x32_bf16 v[52:55], v[84:87], v[140:143], v[52:55]
    ds_read_b64_tr_b16 v[68:69], v209 offset:24576
    buffer_load_dwordx4 v[124:127], v214, s[12:15], s55 offen offset:1024 sc1
    v_mfma_f32_16x16x32_bf16 v[36:39], v[84:87], v[136:139], v[36:39]
    ds_read_b64_tr_b16 v[70:71], v209 offset:26624
    s_waitcnt lgkmcnt(8)
    buffer_load_dwordx4 v[128:131], v214, s[12:15], s55 offen offset:2048 sc1
    v_mfma_f32_16x16x32_bf16 v[24:27], v[88:91], v[144:147], v[24:27]
    ds_read_b64_tr_b16 v[72:73], v206 offset:28672
    buffer_load_dwordx4 v[132:135], v214, s[12:15], s55 offen offset:3072 sc1
    v_mfma_f32_16x16x32_bf16 v[40:43], v[88:91], v[148:151], v[40:43]
    ds_read_b64_tr_b16 v[74:75], v206 offset:30720
    s_waitcnt vmcnt(12)
    v_mfma_f32_16x16x32_bf16 v[44:47], v[92:95], v[148:151], v[44:47]
    ds_read_b64_tr_b16 v[76:77], v207 offset:28672
    v_bitop3_b32 v216, v152, v156, s22 bitop3:0x7e
    v_mfma_f32_16x16x32_bf16 v[28:31], v[92:95], v[144:147], v[28:31]
    ds_read_b64_tr_b16 v[78:79], v207 offset:30720
    v_bitop3_b32 v217, v160, v164, s22 bitop3:0x7e
    v_mfma_f32_16x16x32_bf16 v[32:35], v[96:99], v[144:147], v[32:35]
    ds_read_b64_tr_b16 v[80:81], v208 offset:28672
    v_bitop3_b32 v216, v216, v217, 1 bitop3:0xa8
    v_mfma_f32_16x16x32_bf16 v[48:51], v[96:99], v[148:151], v[48:51]
    ds_read_b64_tr_b16 v[82:83], v208 offset:30720
    v_cmp_ne_u32 vcc, 0, v216
    v_mfma_f32_16x16x32_bf16 v[52:55], v[100:103], v[148:151], v[52:55]
    ds_read_b64_tr_b16 v[84:85], v209 offset:28672
    v_mfma_f32_16x16x32_bf16 v[36:39], v[100:103], v[144:147], v[36:39]
    ds_read_b64_tr_b16 v[86:87], v209 offset:30720
    s_waitcnt lgkmcnt(8)
    s_cbranch_vccnz Lock_115
Look_116:
    v_mfma_f32_16x16x32_bf16 v[24:27], v[56:59], v[152:155], v[24:27]
    ds_read_b64_tr_b16 v[88:89], v206 offset:32768
    s_add_u32 s55, s55, 4096
    v_mfma_f32_16x16x32_bf16 v[40:43], v[56:59], v[156:159], v[40:43]
    ds_read_b64_tr_b16 v[90:91], v206 offset:34816
    s_and_b32 s55, s55, 0xffff
    v_mfma_f32_16x16x32_bf16 v[44:47], v[60:63], v[156:159], v[44:47]
    ds_read_b64_tr_b16 v[92:93], v207 offset:32768
    buffer_load_dwordx4 v[136:139], v214, s[12:15], s55 offen offset:0 sc1
    v_mfma_f32_16x16x32_bf16 v[28:31], v[60:63], v[152:155], v[28:31]
    ds_read_b64_tr_b16 v[94:95], v207 offset:34816
    v_mfma_f32_16x16x32_bf16 v[32:35], v[64:67], v[152:155], v[32:35]
    ds_read_b64_tr_b16 v[96:97], v208 offset:32768
    buffer_load_dwordx4 v[140:143], v214, s[12:15], s55 offen offset:1024 sc1
    v_mfma_f32_16x16x32_bf16 v[48:51], v[64:67], v[156:159], v[48:51]
    ds_read_b64_tr_b16 v[98:99], v208 offset:34816
    v_mfma_f32_16x16x32_bf16 v[52:55], v[68:71], v[156:159], v[52:55]
    ds_read_b64_tr_b16 v[100:101], v209 offset:32768
    buffer_load_dwordx4 v[144:147], v214, s[12:15], s55 offen offset:2048 sc1
    v_mfma_f32_16x16x32_bf16 v[36:39], v[68:71], v[152:155], v[36:39]
    ds_read_b64_tr_b16 v[102:103], v209 offset:34816
    s_waitcnt lgkmcnt(8)
    v_mfma_f32_16x16x32_bf16 v[24:27], v[72:75], v[160:163], v[24:27]
    ds_read_b64_tr_b16 v[56:57], v206 offset:36864
    buffer_load_dwordx4 v[148:151], v214, s[12:15], s55 offen offset:3072 sc1
    v_mfma_f32_16x16x32_bf16 v[40:43], v[72:75], v[164:167], v[40:43]
    ds_read_b64_tr_b16 v[58:59], v206 offset:38912
    s_waitcnt vmcnt(12)
    v_mfma_f32_16x16x32_bf16 v[44:47], v[76:79], v[164:167], v[44:47]
    ds_read_b64_tr_b16 v[60:61], v207 offset:36864
    v_bitop3_b32 v216, v168, v172, s22 bitop3:0x7e
    v_mfma_f32_16x16x32_bf16 v[28:31], v[76:79], v[160:163], v[28:31]
    ds_read_b64_tr_b16 v[62:63], v207 offset:38912
    v_bitop3_b32 v217, v176, v180, s22 bitop3:0x7e
    v_mfma_f32_16x16x32_bf16 v[32:35], v[80:83], v[160:163], v[32:35]
    ds_read_b64_tr_b16 v[64:65], v208 offset:36864
    v_bitop3_b32 v216, v216, v217, 1 bitop3:0xa8
    v_mfma_f32_16x16x32_bf16 v[48:51], v[80:83], v[164:167], v[48:51]
    ds_read_b64_tr_b16 v[66:67], v208 offset:38912
    v_cmp_ne_u32 vcc, 0, v216
    v_mfma_f32_16x16x32_bf16 v[52:55], v[84:87], v[164:167], v[52:55]
    ds_read_b64_tr_b16 v[68:69], v209 offset:36864
    v_mfma_f32_16x16x32_bf16 v[36:39], v[84:87], v[160:163], v[36:39]
    ds_read_b64_tr_b16 v[70:71], v209 offset:38912
    s_waitcnt lgkmcnt(8)
    s_cbranch_vccnz Lock_117
Look_118:
    v_mfma_f32_16x16x32_bf16 v[24:27], v[88:91], v[168:171], v[24:27]
    ds_read_b64_tr_b16 v[72:73], v206 offset:40960
    s_add_u32 s55, s55, 4096
    v_mfma_f32_16x16x32_bf16 v[40:43], v[88:91], v[172:175], v[40:43]
    ds_read_b64_tr_b16 v[74:75], v206 offset:43008
    s_and_b32 s55, s55, 0xffff
    v_mfma_f32_16x16x32_bf16 v[44:47], v[92:95], v[172:175], v[44:47]
    ds_read_b64_tr_b16 v[76:77], v207 offset:40960
    buffer_load_dwordx4 v[152:155], v214, s[12:15], s55 offen offset:0 sc1
    v_mfma_f32_16x16x32_bf16 v[28:31], v[92:95], v[168:171], v[28:31]
    ds_read_b64_tr_b16 v[78:79], v207 offset:43008
    v_mfma_f32_16x16x32_bf16 v[32:35], v[96:99], v[168:171], v[32:35]
    ds_read_b64_tr_b16 v[80:81], v208 offset:40960
    buffer_load_dwordx4 v[156:159], v214, s[12:15], s55 offen offset:1024 sc1
    v_mfma_f32_16x16x32_bf16 v[48:51], v[96:99], v[172:175], v[48:51]
    ds_read_b64_tr_b16 v[82:83], v208 offset:43008
    v_mfma_f32_16x16x32_bf16 v[52:55], v[100:103], v[172:175], v[52:55]
    ds_read_b64_tr_b16 v[84:85], v209 offset:40960
    buffer_load_dwordx4 v[160:163], v214, s[12:15], s55 offen offset:2048 sc1
    v_mfma_f32_16x16x32_bf16 v[36:39], v[100:103], v[168:171], v[36:39]
    ds_read_b64_tr_b16 v[86:87], v209 offset:43008
    s_waitcnt lgkmcnt(8)
    v_mfma_f32_16x16x32_bf16 v[24:27], v[56:59], v[176:179], v[24:27]
    ds_read_b64_tr_b16 v[88:89], v206 offset:45056
    buffer_load_dwordx4 v[164:167], v214, s[12:15], s55 offen offset:3072 sc1
    v_mfma_f32_16x16x32_bf16 v[40:43], v[56:59], v[180:183], v[40:43]
    ds_read_b64_tr_b16 v[90:91], v206 offset:47104
    s_waitcnt vmcnt(12)
    v_mfma_f32_16x16x32_bf16 v[44:47], v[60:63], v[180:183], v[44:47]
    ds_read_b64_tr_b16 v[92:93], v207 offset:45056
    v_bitop3_b32 v216, v104, v108, s22 bitop3:0x7e
    v_mfma_f32_16x16x32_bf16 v[28:31], v[60:63], v[176:179], v[28:31]
    ds_read_b64_tr_b16 v[94:95], v207 offset:47104
    v_bitop3_b32 v217, v112, v116, s22 bitop3:0x7e
    v_mfma_f32_16x16x32_bf16 v[32:35], v[64:67], v[176:179], v[32:35]
    ds_read_b64_tr_b16 v[96:97], v208 offset:45056
    v_bitop3_b32 v216, v216, v217, 1 bitop3:0xa8
    v_mfma_f32_16x16x32_bf16 v[48:51], v[64:67], v[180:183], v[48:51]
    ds_read_b64_tr_b16 v[98:99], v208 offset:47104
    v_cmp_ne_u32 vcc, 0, v216
    v_mfma_f32_16x16x32_bf16 v[52:55], v[68:71], v[180:183], v[52:55]
    ds_read_b64_tr_b16 v[100:101], v209 offset:45056
    s_barrier
    v_mfma_f32_16x16x32_bf16 v[36:39], v[68:71], v[176:179], v[36:39]
    ds_read_b64_tr_b16 v[102:103], v209 offset:47104
    s_waitcnt lgkmcnt(8)
    s_cbranch_vccnz Lock_119
Look_120:
    v_mfma_f32_16x16x32_bf16 v[24:27], v[72:75], v[104:107], v[24:27]
    ds_read_b64_tr_b16 v[56:57], v206 offset:49152
    s_add_u32 s55, s55, 4096
    v_mfma_f32_16x16x32_bf16 v[40:43], v[72:75], v[108:111], v[40:43]
    ds_read_b64_tr_b16 v[58:59], v206 offset:51200
    s_and_b32 s55, s55, 0xffff
    v_mfma_f32_16x16x32_bf16 v[44:47], v[76:79], v[108:111], v[44:47]
    ds_read_b64_tr_b16 v[60:61], v207 offset:49152
    buffer_load_dwordx4 v[168:171], v214, s[12:15], s55 offen offset:0 sc1
    v_mfma_f32_16x16x32_bf16 v[28:31], v[76:79], v[104:107], v[28:31]
    ds_read_b64_tr_b16 v[62:63], v207 offset:51200
    v_mfma_f32_16x16x32_bf16 v[32:35], v[80:83], v[104:107], v[32:35]
    ds_read_b64_tr_b16 v[64:65], v208 offset:49152
    buffer_load_dwordx4 v[172:175], v214, s[12:15], s55 offen offset:1024 sc1
    v_mfma_f32_16x16x32_bf16 v[48:51], v[80:83], v[108:111], v[48:51]
    ds_read_b64_tr_b16 v[66:67], v208 offset:51200
    v_mfma_f32_16x16x32_bf16 v[52:55], v[84:87], v[108:111], v[52:55]
    ds_read_b64_tr_b16 v[68:69], v209 offset:49152
    buffer_load_dwordx4 v[176:179], v214, s[12:15], s55 offen offset:2048 sc1
    v_mfma_f32_16x16x32_bf16 v[36:39], v[84:87], v[104:107], v[36:39]
    ds_read_b64_tr_b16 v[70:71], v209 offset:51200
    s_waitcnt lgkmcnt(8)
    v_mfma_f32_16x16x32_bf16 v[24:27], v[88:91], v[112:115], v[24:27]
    ds_read_b64_tr_b16 v[72:73], v206 offset:53248
    buffer_load_dwordx4 v[180:183], v214, s[12:15], s55 offen offset:3072 sc1
    v_mfma_f32_16x16x32_bf16 v[40:43], v[88:91], v[116:119], v[40:43]
    ds_read_b64_tr_b16 v[74:75], v206 offset:55296
    s_waitcnt vmcnt(12)
    v_mfma_f32_16x16x32_bf16 v[44:47], v[92:95], v[116:119], v[44:47]
    ds_read_b64_tr_b16 v[76:77], v207 offset:53248
    v_bitop3_b32 v216, v120, v124, s22 bitop3:0x7e
    v_mfma_f32_16x16x32_bf16 v[28:31], v[92:95], v[112:115], v[28:31]
    ds_read_b64_tr_b16 v[78:79], v207 offset:55296
    v_bitop3_b32 v217, v128, v132, s22 bitop3:0x7e
    v_mfma_f32_16x16x32_bf16 v[32:35], v[96:99], v[112:115], v[32:35]
    ds_read_b64_tr_b16 v[80:81], v208 offset:53248
    v_bitop3_b32 v216, v216, v217, 1 bitop3:0xa8
    v_mfma_f32_16x16x32_bf16 v[48:51], v[96:99], v[116:119], v[48:51]
    ds_read_b64_tr_b16 v[82:83], v208 offset:55296
    v_cmp_ne_u32 vcc, 0, v216
    v_mfma_f32_16x16x32_bf16 v[52:55], v[100:103], v[116:119], v[52:55]
    ds_read_b64_tr_b16 v[84:85], v209 offset:53248
    v_mfma_f32_16x16x32_bf16 v[36:39], v[100:103], v[112:115], v[36:39]
    ds_read_b64_tr_b16 v[86:87], v209 offset:55296
    s_waitcnt lgkmcnt(8)
    s_cbranch_vccnz Lock_121
Look_122:
    v_mfma_f32_16x16x32_bf16 v[24:27], v[56:59], v[120:123], v[24:27]
    ds_read_b64_tr_b16 v[88:89], v206 offset:57344
    s_add_u32 s55, s55, 4096
    v_mfma_f32_16x16x32_bf16 v[40:43], v[56:59], v[124:127], v[40:43]
    ds_read_b64_tr_b16 v[90:91], v206 offset:59392
    s_and_b32 s55, s55, 0xffff
    v_mfma_f32_16x16x32_bf16 v[44:47], v[60:63], v[124:127], v[44:47]
    ds_read_b64_tr_b16 v[92:93], v207 offset:57344
    buffer_load_dwordx4 v[104:107], v214, s[12:15], s55 offen offset:0 sc1
    v_mfma_f32_16x16x32_bf16 v[28:31], v[60:63], v[120:123], v[28:31]
    ds_read_b64_tr_b16 v[94:95], v207 offset:59392
    v_mfma_f32_16x16x32_bf16 v[32:35], v[64:67], v[120:123], v[32:35]
    ds_read_b64_tr_b16 v[96:97], v208 offset:57344
    buffer_load_dwordx4 v[108:111], v214, s[12:15], s55 offen offset:1024 sc1
    v_mfma_f32_16x16x32_bf16 v[48:51], v[64:67], v[124:127], v[48:51]
    ds_read_b64_tr_b16 v[98:99], v208 offset:59392
    v_mfma_f32_16x16x32_bf16 v[52:55], v[68:71], v[124:127], v[52:55]
    ds_read_b64_tr_b16 v[100:101], v209 offset:57344
    buffer_load_dwordx4 v[112:115], v214, s[12:15], s55 offen offset:2048 sc1
    v_mfma_f32_16x16x32_bf16 v[36:39], v[68:71], v[120:123], v[36:39]
    ds_read_b64_tr_b16 v[102:103], v209 offset:59392
    s_waitcnt lgkmcnt(8)
    v_mfma_f32_16x16x32_bf16 v[24:27], v[72:75], v[128:131], v[24:27]
    ds_read_b64_tr_b16 v[56:57], v206 offset:61440
    buffer_load_dwordx4 v[116:119], v214, s[12:15], s55 offen offset:3072 sc1
    v_mfma_f32_16x16x32_bf16 v[40:43], v[72:75], v[132:135], v[40:43]
    ds_read_b64_tr_b16 v[58:59], v206 offset:63488
    s_waitcnt vmcnt(12)
    v_mfma_f32_16x16x32_bf16 v[44:47], v[76:79], v[132:135], v[44:47]
    ds_read_b64_tr_b16 v[60:61], v207 offset:61440
    v_bitop3_b32 v216, v136, v140, s22 bitop3:0x7e
    v_mfma_f32_16x16x32_bf16 v[28:31], v[76:79], v[128:131], v[28:31]
    ds_read_b64_tr_b16 v[62:63], v207 offset:63488
    v_bitop3_b32 v217, v144, v148, s22 bitop3:0x7e
    v_mfma_f32_16x16x32_bf16 v[32:35], v[80:83], v[128:131], v[32:35]
    ds_read_b64_tr_b16 v[64:65], v208 offset:61440
    v_bitop3_b32 v216, v216, v217, 1 bitop3:0xa8
    v_mfma_f32_16x16x32_bf16 v[48:51], v[80:83], v[132:135], v[48:51]
    ds_read_b64_tr_b16 v[66:67], v208 offset:63488
    v_cmp_ne_u32 vcc, 0, v216
    v_mfma_f32_16x16x32_bf16 v[52:55], v[84:87], v[132:135], v[52:55]
    ds_read_b64_tr_b16 v[68:69], v209 offset:61440
    v_mfma_f32_16x16x32_bf16 v[36:39], v[84:87], v[128:131], v[36:39]
    ds_read_b64_tr_b16 v[70:71], v209 offset:63488
    s_waitcnt lgkmcnt(8)
    s_cbranch_vccnz Lock_123
Look_124:
    v_mfma_f32_16x16x32_bf16 v[24:27], v[88:91], v[136:139], v[24:27]
    ds_read_b64_tr_b16 v[72:73], v210 offset:0
    s_add_u32 s55, s55, 4096
    v_mfma_f32_16x16x32_bf16 v[40:43], v[88:91], v[140:143], v[40:43]
    ds_read_b64_tr_b16 v[74:75], v210 offset:2048
    s_and_b32 s55, s55, 0xffff
    v_mfma_f32_16x16x32_bf16 v[44:47], v[92:95], v[140:143], v[44:47]
    ds_read_b64_tr_b16 v[76:77], v211 offset:0
    buffer_load_dwordx4 v[120:123], v214, s[12:15], s55 offen offset:0 sc1
    v_mfma_f32_16x16x32_bf16 v[28:31], v[92:95], v[136:139], v[28:31]
    ds_read_b64_tr_b16 v[78:79], v211 offset:2048
    v_mfma_f32_16x16x32_bf16 v[32:35], v[96:99], v[136:139], v[32:35]
    ds_read_b64_tr_b16 v[80:81], v212 offset:0
    buffer_load_dwordx4 v[124:127], v214, s[12:15], s55 offen offset:1024 sc1
    v_mfma_f32_16x16x32_bf16 v[48:51], v[96:99], v[140:143], v[48:51]
    ds_read_b64_tr_b16 v[82:83], v212 offset:2048
    v_mfma_f32_16x16x32_bf16 v[52:55], v[100:103], v[140:143], v[52:55]
    ds_read_b64_tr_b16 v[84:85], v213 offset:0
    buffer_load_dwordx4 v[128:131], v214, s[12:15], s55 offen offset:2048 sc1
    v_mfma_f32_16x16x32_bf16 v[36:39], v[100:103], v[136:139], v[36:39]
    ds_read_b64_tr_b16 v[86:87], v213 offset:2048
    s_waitcnt lgkmcnt(8)
    v_mfma_f32_16x16x32_bf16 v[24:27], v[56:59], v[144:147], v[24:27]
    ds_read_b64_tr_b16 v[88:89], v210 offset:4096
    buffer_load_dwordx4 v[132:135], v214, s[12:15], s55 offen offset:3072 sc1
    v_mfma_f32_16x16x32_bf16 v[40:43], v[56:59], v[148:151], v[40:43]
    ds_read_b64_tr_b16 v[90:91], v210 offset:6144
    s_waitcnt vmcnt(12)
    v_mfma_f32_16x16x32_bf16 v[44:47], v[60:63], v[148:151], v[44:47]
    ds_read_b64_tr_b16 v[92:93], v211 offset:4096
    v_bitop3_b32 v216, v152, v156, s22 bitop3:0x7e
    v_mfma_f32_16x16x32_bf16 v[28:31], v[60:63], v[144:147], v[28:31]
    ds_read_b64_tr_b16 v[94:95], v211 offset:6144
    v_bitop3_b32 v217, v160, v164, s22 bitop3:0x7e
    v_mfma_f32_16x16x32_bf16 v[32:35], v[64:67], v[144:147], v[32:35]
    ds_read_b64_tr_b16 v[96:97], v212 offset:4096
    v_bitop3_b32 v216, v216, v217, 1 bitop3:0xa8
    v_mfma_f32_16x16x32_bf16 v[48:51], v[64:67], v[148:151], v[48:51]
    ds_read_b64_tr_b16 v[98:99], v212 offset:6144
    v_cmp_ne_u32 vcc, 0, v216
    v_mfma_f32_16x16x32_bf16 v[52:55], v[68:71], v[148:151], v[52:55]
    ds_read_b64_tr_b16 v[100:101], v213 offset:4096
    v_mfma_f32_16x16x32_bf16 v[36:39], v[68:71], v[144:147], v[36:39]
    ds_read_b64_tr_b16 v[102:103], v213 offset:6144
    s_waitcnt lgkmcnt(8)
    s_cbranch_vccnz Lock_125
Look_126:
    v_mfma_f32_16x16x32_bf16 v[24:27], v[72:75], v[152:155], v[24:27]
    ds_read_b64_tr_b16 v[56:57], v210 offset:8192
    s_add_u32 s55, s55, 4096
    v_mfma_f32_16x16x32_bf16 v[40:43], v[72:75], v[156:159], v[40:43]
    ds_read_b64_tr_b16 v[58:59], v210 offset:10240
    s_and_b32 s55, s55, 0xffff
    v_mfma_f32_16x16x32_bf16 v[44:47], v[76:79], v[156:159], v[44:47]
    ds_read_b64_tr_b16 v[60:61], v211 offset:8192
    buffer_load_dwordx4 v[136:139], v214, s[12:15], s55 offen offset:0 sc1
    v_mfma_f32_16x16x32_bf16 v[28:31], v[76:79], v[152:155], v[28:31]
    ds_read_b64_tr_b16 v[62:63], v211 offset:10240
    v_mfma_f32_16x16x32_bf16 v[32:35], v[80:83], v[152:155], v[32:35]
    ds_read_b64_tr_b16 v[64:65], v212 offset:8192
    buffer_load_dwordx4 v[140:143], v214, s[12:15], s55 offen offset:1024 sc1
    v_mfma_f32_16x16x32_bf16 v[48:51], v[80:83], v[156:159], v[48:51]
    ds_read_b64_tr_b16 v[66:67], v212 offset:10240
    v_mfma_f32_16x16x32_bf16 v[52:55], v[84:87], v[156:159], v[52:55]
    ds_read_b64_tr_b16 v[68:69], v213 offset:8192
    buffer_load_dwordx4 v[144:147], v214, s[12:15], s55 offen offset:2048 sc1
    v_mfma_f32_16x16x32_bf16 v[36:39], v[84:87], v[152:155], v[36:39]
    ds_read_b64_tr_b16 v[70:71], v213 offset:10240
    s_waitcnt lgkmcnt(8)
    v_mfma_f32_16x16x32_bf16 v[24:27], v[88:91], v[160:163], v[24:27]
    ds_read_b64_tr_b16 v[72:73], v210 offset:12288
    buffer_load_dwordx4 v[148:151], v214, s[12:15], s55 offen offset:3072 sc1
    v_mfma_f32_16x16x32_bf16 v[40:43], v[88:91], v[164:167], v[40:43]
    ds_read_b64_tr_b16 v[74:75], v210 offset:14336
    s_waitcnt vmcnt(12)
    v_mfma_f32_16x16x32_bf16 v[44:47], v[92:95], v[164:167], v[44:47]
    ds_read_b64_tr_b16 v[76:77], v211 offset:12288
    v_bitop3_b32 v216, v168, v172, s22 bitop3:0x7e
    v_mfma_f32_16x16x32_bf16 v[28:31], v[92:95], v[160:163], v[28:31]
    ds_read_b64_tr_b16 v[78:79], v211 offset:14336
    v_bitop3_b32 v217, v176, v180, s22 bitop3:0x7e
    v_mfma_f32_16x16x32_bf16 v[32:35], v[96:99], v[160:163], v[32:35]
    ds_read_b64_tr_b16 v[80:81], v212 offset:12288
    v_bitop3_b32 v216, v216, v217, 1 bitop3:0xa8
    v_mfma_f32_16x16x32_bf16 v[48:51], v[96:99], v[164:167], v[48:51]
    ds_read_b64_tr_b16 v[82:83], v212 offset:14336
    v_cmp_ne_u32 vcc, 0, v216
    v_mfma_f32_16x16x32_bf16 v[52:55], v[100:103], v[164:167], v[52:55]
    ds_read_b64_tr_b16 v[84:85], v213 offset:12288
    v_mfma_f32_16x16x32_bf16 v[36:39], v[100:103], v[160:163], v[36:39]
    ds_read_b64_tr_b16 v[86:87], v213 offset:14336
    s_waitcnt lgkmcnt(8)
    s_cbranch_vccnz Lock_127
Look_128:
    v_mfma_f32_16x16x32_bf16 v[24:27], v[56:59], v[168:171], v[24:27]
    ds_read_b64_tr_b16 v[88:89], v210 offset:16384
    s_add_u32 s55, s55, 4096
    v_mfma_f32_16x16x32_bf16 v[40:43], v[56:59], v[172:175], v[40:43]
    ds_read_b64_tr_b16 v[90:91], v210 offset:18432
    s_and_b32 s55, s55, 0xffff
    v_mfma_f32_16x16x32_bf16 v[44:47], v[60:63], v[172:175], v[44:47]
    ds_read_b64_tr_b16 v[92:93], v211 offset:16384
    buffer_load_dwordx4 v[152:155], v214, s[12:15], s55 offen offset:0 sc1
    v_mfma_f32_16x16x32_bf16 v[28:31], v[60:63], v[168:171], v[28:31]
    ds_read_b64_tr_b16 v[94:95], v211 offset:18432
    v_mfma_f32_16x16x32_bf16 v[32:35], v[64:67], v[168:171], v[32:35]
    ds_read_b64_tr_b16 v[96:97], v212 offset:16384
    buffer_load_dwordx4 v[156:159], v214, s[12:15], s55 offen offset:1024 sc1
    v_mfma_f32_16x16x32_bf16 v[48:51], v[64:67], v[172:175], v[48:51]
    ds_read_b64_tr_b16 v[98:99], v212 offset:18432
    v_mfma_f32_16x16x32_bf16 v[52:55], v[68:71], v[172:175], v[52:55]
    ds_read_b64_tr_b16 v[100:101], v213 offset:16384
    buffer_load_dwordx4 v[160:163], v214, s[12:15], s55 offen offset:2048 sc1
    v_mfma_f32_16x16x32_bf16 v[36:39], v[68:71], v[168:171], v[36:39]
    ds_read_b64_tr_b16 v[102:103], v213 offset:18432
    s_waitcnt lgkmcnt(8)
    v_mfma_f32_16x16x32_bf16 v[24:27], v[72:75], v[176:179], v[24:27]
    ds_read_b64_tr_b16 v[56:57], v210 offset:20480
    buffer_load_dwordx4 v[164:167], v214, s[12:15], s55 offen offset:3072 sc1
    v_mfma_f32_16x16x32_bf16 v[40:43], v[72:75], v[180:183], v[40:43]
    ds_read_b64_tr_b16 v[58:59], v210 offset:22528
    s_waitcnt vmcnt(12)
    v_mfma_f32_16x16x32_bf16 v[44:47], v[76:79], v[180:183], v[44:47]
    ds_read_b64_tr_b16 v[60:61], v211 offset:20480
    v_bitop3_b32 v216, v104, v108, s22 bitop3:0x7e
    v_mfma_f32_16x16x32_bf16 v[28:31], v[76:79], v[176:179], v[28:31]
    ds_read_b64_tr_b16 v[62:63], v211 offset:22528
    v_bitop3_b32 v217, v112, v116, s22 bitop3:0x7e
    v_mfma_f32_16x16x32_bf16 v[32:35], v[80:83], v[176:179], v[32:35]
    ds_read_b64_tr_b16 v[64:65], v212 offset:20480
    v_bitop3_b32 v216, v216, v217, 1 bitop3:0xa8
    v_mfma_f32_16x16x32_bf16 v[48:51], v[80:83], v[180:183], v[48:51]
    ds_read_b64_tr_b16 v[66:67], v212 offset:22528
    v_cmp_ne_u32 vcc, 0, v216
    v_mfma_f32_16x16x32_bf16 v[52:55], v[84:87], v[180:183], v[52:55]
    ds_read_b64_tr_b16 v[68:69], v213 offset:20480
    v_mfma_f32_16x16x32_bf16 v[36:39], v[84:87], v[176:179], v[36:39]
    ds_read_b64_tr_b16 v[70:71], v213 offset:22528
    s_waitcnt lgkmcnt(8)
    s_cbranch_vccnz Lock_129
Look_130:
    v_mfma_f32_16x16x32_bf16 v[24:27], v[88:91], v[104:107], v[24:27]
    ds_read_b64_tr_b16 v[72:73], v210 offset:24576
    s_add_u32 s55, s55, 4096
    v_mfma_f32_16x16x32_bf16 v[40:43], v[88:91], v[108:111], v[40:43]
    ds_read_b64_tr_b16 v[74:75], v210 offset:26624
    s_and_b32 s55, s55, 0xffff
    v_mfma_f32_16x16x32_bf16 v[44:47], v[92:95], v[108:111], v[44:47]
    ds_read_b64_tr_b16 v[76:77], v211 offset:24576
    buffer_load_dwordx4 v[168:171], v214, s[12:15], s55 offen offset:0 sc1
    v_mfma_f32_16x16x32_bf16 v[28:31], v[92:95], v[104:107], v[28:31]
    ds_read_b64_tr_b16 v[78:79], v211 offset:26624
    v_mfma_f32_16x16x32_bf16 v[32:35], v[96:99], v[104:107], v[32:35]
    ds_read_b64_tr_b16 v[80:81], v212 offset:24576
    buffer_load_dwordx4 v[172:175], v214, s[12:15], s55 offen offset:1024 sc1
    v_mfma_f32_16x16x32_bf16 v[48:51], v[96:99], v[108:111], v[48:51]
    ds_read_b64_tr_b16 v[82:83], v212 offset:26624
    v_mfma_f32_16x16x32_bf16 v[52:55], v[100:103], v[108:111], v[52:55]
    ds_read_b64_tr_b16 v[84:85], v213 offset:24576
    buffer_load_dwordx4 v[176:179], v214, s[12:15], s55 offen offset:2048 sc1
    v_mfma_f32_16x16x32_bf16 v[36:39], v[100:103], v[104:107], v[36:39]
    ds_read_b64_tr_b16 v[86:87], v213 offset:26624
    s_waitcnt lgkmcnt(8)
    v_mfma_f32_16x16x32_bf16 v[24:27], v[56:59], v[112:115], v[24:27]
    ds_read_b64_tr_b16 v[88:89], v210 offset:28672
    buffer_load_dwordx4 v[180:183], v214, s[12:15], s55 offen offset:3072 sc1
    v_mfma_f32_16x16x32_bf16 v[40:43], v[56:59], v[116:119], v[40:43]
    ds_read_b64_tr_b16 v[90:91], v210 offset:30720
    s_waitcnt vmcnt(12)
    v_mfma_f32_16x16x32_bf16 v[44:47], v[60:63], v[116:119], v[44:47]
    ds_read_b64_tr_b16 v[92:93], v211 offset:28672
    v_bitop3_b32 v216, v120, v124, s22 bitop3:0x7e
    v_mfma_f32_16x16x32_bf16 v[28:31], v[60:63], v[112:115], v[28:31]
    ds_read_b64_tr_b16 v[94:95], v211 offset:30720
    v_bitop3_b32 v217, v128, v132, s22 bitop3:0x7e
    v_mfma_f32_16x16x32_bf16 v[32:35], v[64:67], v[112:115], v[32:35]
    ds_read_b64_tr_b16 v[96:97], v212 offset:28672
    v_bitop3_b32 v216, v216, v217, 1 bitop3:0xa8
    v_mfma_f32_16x16x32_bf16 v[48:51], v[64:67], v[116:119], v[48:51]
    ds_read_b64_tr_b16 v[98:99], v212 offset:30720
    v_cmp_ne_u32 vcc, 0, v216
    v_mfma_f32_16x16x32_bf16 v[52:55], v[68:71], v[116:119], v[52:55]
    ds_read_b64_tr_b16 v[100:101], v213 offset:28672
    v_mfma_f32_16x16x32_bf16 v[36:39], v[68:71], v[112:115], v[36:39]
    ds_read_b64_tr_b16 v[102:103], v213 offset:30720
    s_waitcnt lgkmcnt(8)
    s_cbranch_vccnz Lock_131
Look_132:
    v_mfma_f32_16x16x32_bf16 v[24:27], v[72:75], v[120:123], v[24:27]
    ds_read_b64_tr_b16 v[56:57], v210 offset:32768
    s_add_u32 s55, s55, 4096
    v_mfma_f32_16x16x32_bf16 v[40:43], v[72:75], v[124:127], v[40:43]
    ds_read_b64_tr_b16 v[58:59], v210 offset:34816
    s_and_b32 s55, s55, 0xffff
    v_mfma_f32_16x16x32_bf16 v[44:47], v[76:79], v[124:127], v[44:47]
    ds_read_b64_tr_b16 v[60:61], v211 offset:32768
    buffer_load_dwordx4 v[104:107], v214, s[12:15], s55 offen offset:0 sc1
    v_mfma_f32_16x16x32_bf16 v[28:31], v[76:79], v[120:123], v[28:31]
    ds_read_b64_tr_b16 v[62:63], v211 offset:34816
    v_mfma_f32_16x16x32_bf16 v[32:35], v[80:83], v[120:123], v[32:35]
    ds_read_b64_tr_b16 v[64:65], v212 offset:32768
    buffer_load_dwordx4 v[108:111], v214, s[12:15], s55 offen offset:1024 sc1
    v_mfma_f32_16x16x32_bf16 v[48:51], v[80:83], v[124:127], v[48:51]
    ds_read_b64_tr_b16 v[66:67], v212 offset:34816
    s_barrier
    v_mfma_f32_16x16x32_bf16 v[52:55], v[84:87], v[124:127], v[52:55]
    ds_read_b64_tr_b16 v[68:69], v213 offset:32768
    buffer_load_dwordx4 v[112:115], v214, s[12:15], s55 offen offset:2048 sc1
    v_mfma_f32_16x16x32_bf16 v[36:39], v[84:87], v[120:123], v[36:39]
    ds_read_b64_tr_b16 v[70:71], v213 offset:34816
    s_waitcnt lgkmcnt(8)
    v_mfma_f32_16x16x32_bf16 v[24:27], v[88:91], v[128:131], v[24:27]
    ds_read_b64_tr_b16 v[72:73], v210 offset:36864
    buffer_load_dwordx4 v[116:119], v214, s[12:15], s55 offen offset:3072 sc1
    v_mfma_f32_16x16x32_bf16 v[40:43], v[88:91], v[132:135], v[40:43]
    ds_read_b64_tr_b16 v[74:75], v210 offset:38912
    s_waitcnt vmcnt(12)
    v_mfma_f32_16x16x32_bf16 v[44:47], v[92:95], v[132:135], v[44:47]
    ds_read_b64_tr_b16 v[76:77], v211 offset:36864
    v_bitop3_b32 v216, v136, v140, s22 bitop3:0x7e
    v_mfma_f32_16x16x32_bf16 v[28:31], v[92:95], v[128:131], v[28:31]
    ds_read_b64_tr_b16 v[78:79], v211 offset:38912
    v_bitop3_b32 v217, v144, v148, s22 bitop3:0x7e
    v_mfma_f32_16x16x32_bf16 v[32:35], v[96:99], v[128:131], v[32:35]
    ds_read_b64_tr_b16 v[80:81], v212 offset:36864
    v_bitop3_b32 v216, v216, v217, 1 bitop3:0xa8
    v_mfma_f32_16x16x32_bf16 v[48:51], v[96:99], v[132:135], v[48:51]
    ds_read_b64_tr_b16 v[82:83], v212 offset:38912
    v_cmp_ne_u32 vcc, 0, v216
    v_mfma_f32_16x16x32_bf16 v[52:55], v[100:103], v[132:135], v[52:55]
    ds_read_b64_tr_b16 v[84:85], v213 offset:36864
    v_mfma_f32_16x16x32_bf16 v[36:39], v[100:103], v[128:131], v[36:39]
    ds_read_b64_tr_b16 v[86:87], v213 offset:38912
    s_waitcnt lgkmcnt(8)
    s_cbranch_vccnz Lock_133
Look_134:
    v_mfma_f32_16x16x32_bf16 v[24:27], v[56:59], v[136:139], v[24:27]
    ds_read_b64_tr_b16 v[88:89], v210 offset:40960
    v_mfma_f32_16x16x32_bf16 v[40:43], v[56:59], v[140:143], v[40:43]
    ds_read_b64_tr_b16 v[90:91], v210 offset:43008
    v_mfma_f32_16x16x32_bf16 v[44:47], v[60:63], v[140:143], v[44:47]
    ds_read_b64_tr_b16 v[92:93], v211 offset:40960
    v_mfma_f32_16x16x32_bf16 v[28:31], v[60:63], v[136:139], v[28:31]
    ds_read_b64_tr_b16 v[94:95], v211 offset:43008
    v_mfma_f32_16x16x32_bf16 v[32:35], v[64:67], v[136:139], v[32:35]
    ds_read_b64_tr_b16 v[96:97], v212 offset:40960
    v_mfma_f32_16x16x32_bf16 v[48:51], v[64:67], v[140:143], v[48:51]
    ds_read_b64_tr_b16 v[98:99], v212 offset:43008
    v_mfma_f32_16x16x32_bf16 v[52:55], v[68:71], v[140:143], v[52:55]
    ds_read_b64_tr_b16 v[100:101], v213 offset:40960
    v_mfma_f32_16x16x32_bf16 v[36:39], v[68:71], v[136:139], v[36:39]
    ds_read_b64_tr_b16 v[102:103], v213 offset:43008
    s_waitcnt lgkmcnt(8)
    v_mfma_f32_16x16x32_bf16 v[24:27], v[72:75], v[144:147], v[24:27]
    ds_read_b64_tr_b16 v[56:57], v210 offset:45056
    v_mfma_f32_16x16x32_bf16 v[40:43], v[72:75], v[148:151], v[40:43]
    ds_read_b64_tr_b16 v[58:59], v210 offset:47104
    s_waitcnt vmcnt(8)
    v_mfma_f32_16x16x32_bf16 v[44:47], v[76:79], v[148:151], v[44:47]
    ds_read_b64_tr_b16 v[60:61], v211 offset:45056
    v_bitop3_b32 v216, v152, v156, s22 bitop3:0x7e
    v_mfma_f32_16x16x32_bf16 v[28:31], v[76:79], v[144:147], v[28:31]
    ds_read_b64_tr_b16 v[62:63], v211 offset:47104
    v_bitop3_b32 v217, v160, v164, s22 bitop3:0x7e
    v_mfma_f32_16x16x32_bf16 v[32:35], v[80:83], v[144:147], v[32:35]
    ds_read_b64_tr_b16 v[64:65], v212 offset:45056
    v_bitop3_b32 v216, v216, v217, 1 bitop3:0xa8
    v_mfma_f32_16x16x32_bf16 v[48:51], v[80:83], v[148:151], v[48:51]
    ds_read_b64_tr_b16 v[66:67], v212 offset:47104
    v_cmp_ne_u32 vcc, 0, v216
    v_mfma_f32_16x16x32_bf16 v[52:55], v[84:87], v[148:151], v[52:55]
    ds_read_b64_tr_b16 v[68:69], v213 offset:45056
    v_mfma_f32_16x16x32_bf16 v[36:39], v[84:87], v[144:147], v[36:39]
    ds_read_b64_tr_b16 v[70:71], v213 offset:47104
    s_waitcnt lgkmcnt(8)
    s_cbranch_vccnz Lock_135
Look_136:
    v_mfma_f32_16x16x32_bf16 v[24:27], v[88:91], v[152:155], v[24:27]
    ds_read_b64_tr_b16 v[72:73], v210 offset:49152
    v_mfma_f32_16x16x32_bf16 v[40:43], v[88:91], v[156:159], v[40:43]
    ds_read_b64_tr_b16 v[74:75], v210 offset:51200
    v_mfma_f32_16x16x32_bf16 v[44:47], v[92:95], v[156:159], v[44:47]
    ds_read_b64_tr_b16 v[76:77], v211 offset:49152
    v_mfma_f32_16x16x32_bf16 v[28:31], v[92:95], v[152:155], v[28:31]
    ds_read_b64_tr_b16 v[78:79], v211 offset:51200
    v_mfma_f32_16x16x32_bf16 v[32:35], v[96:99], v[152:155], v[32:35]
    ds_read_b64_tr_b16 v[80:81], v212 offset:49152
    v_mfma_f32_16x16x32_bf16 v[48:51], v[96:99], v[156:159], v[48:51]
    ds_read_b64_tr_b16 v[82:83], v212 offset:51200
    v_mfma_f32_16x16x32_bf16 v[52:55], v[100:103], v[156:159], v[52:55]
    ds_read_b64_tr_b16 v[84:85], v213 offset:49152
    v_mfma_f32_16x16x32_bf16 v[36:39], v[100:103], v[152:155], v[36:39]
    ds_read_b64_tr_b16 v[86:87], v213 offset:51200
    s_waitcnt lgkmcnt(8)
    v_mfma_f32_16x16x32_bf16 v[24:27], v[56:59], v[160:163], v[24:27]
    ds_read_b64_tr_b16 v[88:89], v210 offset:53248
    v_mfma_f32_16x16x32_bf16 v[40:43], v[56:59], v[164:167], v[40:43]
    ds_read_b64_tr_b16 v[90:91], v210 offset:55296
    s_waitcnt vmcnt(4)
    v_mfma_f32_16x16x32_bf16 v[44:47], v[60:63], v[164:167], v[44:47]
    ds_read_b64_tr_b16 v[92:93], v211 offset:53248
    v_bitop3_b32 v216, v168, v172, s22 bitop3:0x7e
    v_mfma_f32_16x16x32_bf16 v[28:31], v[60:63], v[160:163], v[28:31]
    ds_read_b64_tr_b16 v[94:95], v211 offset:55296
    v_bitop3_b32 v217, v176, v180, s22 bitop3:0x7e
    v_mfma_f32_16x16x32_bf16 v[32:35], v[64:67], v[160:163], v[32:35]
    ds_read_b64_tr_b16 v[96:97], v212 offset:53248
    v_bitop3_b32 v216, v216, v217, 1 bitop3:0xa8
    v_mfma_f32_16x16x32_bf16 v[48:51], v[64:67], v[164:167], v[48:51]
    ds_read_b64_tr_b16 v[98:99], v212 offset:55296
    v_cmp_ne_u32 vcc, 0, v216
    v_mfma_f32_16x16x32_bf16 v[52:55], v[68:71], v[164:167], v[52:55]
    ds_read_b64_tr_b16 v[100:101], v213 offset:53248
    v_mfma_f32_16x16x32_bf16 v[36:39], v[68:71], v[160:163], v[36:39]
    ds_read_b64_tr_b16 v[102:103], v213 offset:55296
    s_waitcnt lgkmcnt(8)
    s_cbranch_vccnz Lock_137
Look_138:
    v_mfma_f32_16x16x32_bf16 v[24:27], v[72:75], v[168:171], v[24:27]
    ds_read_b64_tr_b16 v[56:57], v210 offset:57344
    v_mfma_f32_16x16x32_bf16 v[40:43], v[72:75], v[172:175], v[40:43]
    ds_read_b64_tr_b16 v[58:59], v210 offset:59392
    v_mfma_f32_16x16x32_bf16 v[44:47], v[76:79], v[172:175], v[44:47]
    ds_read_b64_tr_b16 v[60:61], v211 offset:57344
    v_mfma_f32_16x16x32_bf16 v[28:31], v[76:79], v[168:171], v[28:31]
    ds_read_b64_tr_b16 v[62:63], v211 offset:59392
    v_mfma_f32_16x16x32_bf16 v[32:35], v[80:83], v[168:171], v[32:35]
    ds_read_b64_tr_b16 v[64:65], v212 offset:57344
    v_mfma_f32_16x16x32_bf16 v[48:51], v[80:83], v[172:175], v[48:51]
    ds_read_b64_tr_b16 v[66:67], v212 offset:59392
    v_mfma_f32_16x16x32_bf16 v[52:55], v[84:87], v[172:175], v[52:55]
    ds_read_b64_tr_b16 v[68:69], v213 offset:57344
    v_mfma_f32_16x16x32_bf16 v[36:39], v[84:87], v[168:171], v[36:39]
    ds_read_b64_tr_b16 v[70:71], v213 offset:59392
    s_waitcnt lgkmcnt(8)
    v_mfma_f32_16x16x32_bf16 v[24:27], v[88:91], v[176:179], v[24:27]
    ds_read_b64_tr_b16 v[72:73], v210 offset:61440
    v_mfma_f32_16x16x32_bf16 v[40:43], v[88:91], v[180:183], v[40:43]
    ds_read_b64_tr_b16 v[74:75], v210 offset:63488
    s_waitcnt vmcnt(0)
    v_mfma_f32_16x16x32_bf16 v[44:47], v[92:95], v[180:183], v[44:47]
    ds_read_b64_tr_b16 v[76:77], v211 offset:61440
    v_bitop3_b32 v216, v104, v108, s22 bitop3:0x7e
    v_mfma_f32_16x16x32_bf16 v[28:31], v[92:95], v[176:179], v[28:31]
    ds_read_b64_tr_b16 v[78:79], v211 offset:63488
    v_bitop3_b32 v217, v112, v116, s22 bitop3:0x7e
    v_mfma_f32_16x16x32_bf16 v[32:35], v[96:99], v[176:179], v[32:35]
    ds_read_b64_tr_b16 v[80:81], v212 offset:61440
    v_bitop3_b32 v216, v216, v217, 1 bitop3:0xa8
    v_mfma_f32_16x16x32_bf16 v[48:51], v[96:99], v[180:183], v[48:51]
    ds_read_b64_tr_b16 v[82:83], v212 offset:63488
    v_cmp_ne_u32 vcc, 0, v216
    v_mfma_f32_16x16x32_bf16 v[52:55], v[100:103], v[180:183], v[52:55]
    ds_read_b64_tr_b16 v[84:85], v213 offset:61440
    v_mfma_f32_16x16x32_bf16 v[36:39], v[100:103], v[176:179], v[36:39]
    ds_read_b64_tr_b16 v[86:87], v213 offset:63488
    s_waitcnt lgkmcnt(8)
    s_cbranch_vccnz Lock_139
Look_140:
    v_mfma_f32_16x16x32_bf16 v[24:27], v[56:59], v[104:107], v[24:27]
    v_mfma_f32_16x16x32_bf16 v[40:43], v[56:59], v[108:111], v[40:43]
    v_mfma_f32_16x16x32_bf16 v[44:47], v[60:63], v[108:111], v[44:47]
    v_mfma_f32_16x16x32_bf16 v[28:31], v[60:63], v[104:107], v[28:31]
    v_mfma_f32_16x16x32_bf16 v[32:35], v[64:67], v[104:107], v[32:35]
    v_mfma_f32_16x16x32_bf16 v[48:51], v[64:67], v[108:111], v[48:51]
    v_mfma_f32_16x16x32_bf16 v[52:55], v[68:71], v[108:111], v[52:55]
    v_mfma_f32_16x16x32_bf16 v[36:39], v[68:71], v[104:107], v[36:39]
    s_waitcnt lgkmcnt(0)
    v_mfma_f32_16x16x32_bf16 v[24:27], v[72:75], v[112:115], v[24:27]
    v_mfma_f32_16x16x32_bf16 v[40:43], v[72:75], v[116:119], v[40:43]
    v_mfma_f32_16x16x32_bf16 v[44:47], v[76:79], v[116:119], v[44:47]
    v_mfma_f32_16x16x32_bf16 v[28:31], v[76:79], v[112:115], v[28:31]
    v_mfma_f32_16x16x32_bf16 v[32:35], v[80:83], v[112:115], v[32:35]
    v_mfma_f32_16x16x32_bf16 v[48:51], v[80:83], v[116:119], v[48:51]
    v_mfma_f32_16x16x32_bf16 v[52:55], v[84:87], v[116:119], v[52:55]
    v_mfma_f32_16x16x32_bf16 v[36:39], v[84:87], v[112:115], v[36:39]
    s_bitcmp1_b32 s22, 0
    s_cbranch_scc1 L_xodd
    s_cmp_eq_u32 s23, 0
    s_cbranch_scc1 Lslow_141
    v_add_u32 v241, 0x10000, v24
    v_cvt_pk_bf16_f32 v8, v24, v25
    v_cvt_pk_bf16_f32 v9, v26, v27
    v_and_b32_sdwa v8, v241, -2 dst_sel:WORD_0 dst_unused:UNUSED_PRESERVE src0_sel:WORD_1 src1_sel:DWORD
    v_cvt_pk_bf16_f32 v10, v28, v29
    v_cvt_pk_bf16_f32 v11, v30, v31
    buffer_store_dwordx4 v[8:11], v0, s[16:19], s71 offen offset:0
    ds_write_b128 v240, v[8:11] offset:0
    v_add_u32 v241, 0x10000, v40
    v_cvt_pk_bf16_f32 v16, v40, v41
    v_cvt_pk_bf16_f32 v17, v42, v43
    v_and_b32_sdwa v16, v241, -2 dst_sel:WORD_0 dst_unused:UNUSED_PRESERVE src0_sel:WORD_1 src1_sel:DWORD
    v_cvt_pk_bf16_f32 v18, v44, v45
    v_cvt_pk_bf16_f32 v19, v46, v47
    buffer_store_dwordx4 v[16:19], v0, s[16:19], s71 offen offset:2048
    ds_write_b128 v240, v[16:19] offset:2048
    v_add_u32 v241, 0x10000, v32
    v_cvt_pk_bf16_f32 v12, v32, v33
    v_cvt_pk_bf16_f32 v13, v34, v35
    v_and_b32_sdwa v12, v241, -2 dst_sel:WORD_0 dst_unused:UNUSED_PRESERVE src0_sel:WORD_1 src1_sel:DWORD
    v_cvt_pk_bf16_f32 v14, v36, v37
    v_cvt_pk_bf16_f32 v15, v38, v39
    buffer_store_dwordx4 v[12:15], v0, s[16:19], s71 offen offset:1024
    ds_write_b128 v240, v[12:15] offset:1024
    v_add_u32 v241, 0x10000, v48
    v_cvt_pk_bf16_f32 v20, v48, v49
    v_cvt_pk_bf16_f32 v21, v50, v51
    v_and_b32_sdwa v20, v241, -2 dst_sel:WORD_0 dst_unused:UNUSED_PRESERVE src0_sel:WORD_1 src1_sel:DWORD
    v_cvt_pk_bf16_f32 v22, v52, v53
    v_cvt_pk_bf16_f32 v23, v54, v55
    buffer_store_dwordx4 v[20:23], v0, s[16:19], s71 offen offset:3072
    ds_write_b128 v240, v[20:23] offset:3072
Lback_142:
    v_cvt_pk_bf16_f32 v8, v24, v25
    v_cvt_pk_bf16_f32 v16, v40, v41
    v_cvt_pk_bf16_f32 v12, v32, v33
    v_cvt_pk_bf16_f32 v20, v48, v49
    v_mfma_f32_16x16x32_bf16 v[206:209], v[226:229], v[8:11], 0
    v_mfma_f32_16x16x32_bf16 v[210:213], v[8:11], v[8:11], 0
    v_mfma_f32_16x16x32_bf16 v[214:217], v[226:229], v[16:19], 0
    v_mfma_f32_16x16x32_bf16 v[218:221], v[16:19], v[16:19], 0
    v_mfma_f32_16x16x32_bf16 v[206:209], v[226:229], v[12:15], v[206:209]
    v_mfma_f32_16x16x32_bf16 v[210:213], v[12:15], v[12:15], v[210:213]
    v_mfma_f32_16x16x32_bf16 v[214:217], v[226:229], v[20:23], v[214:217]
    v_mfma_f32_16x16x32_bf16 v[218:221], v[20:23], v[20:23], v[218:221]
    s_add_u32 s22, s22, 1
    s_waitcnt lgkmcnt(0)
    s_branch L_cgo
L_xodd:
    s_cmp_eq_u32 s22, 3
    s_cbranch_scc1 L_final
    s_cmp_eq_u32 s23, 0
    s_cbranch_scc1 Lslow_143
    v_cvt_pk_bf16_f32 v8, v24, v25
    v_cvt_pk_bf16_f32 v9, v26, v27
    v_or_b32_sdwa v8, v24, 1 dst_sel:WORD_0 dst_unused:UNUSED_PRESERVE src0_sel:WORD_1 src1_sel:DWORD
    v_cvt_pk_bf16_f32 v10, v28, v29
    v_cvt_pk_bf16_f32 v11, v30, v31
    buffer_store_dwordx4 v[8:11], v0, s[16:19], s71 offen offset:0
    ds_write_b128 v240, v[8:11] offset:0
    v_cvt_pk_bf16_f32 v16, v40, v41
    v_cvt_pk_bf16_f32 v17, v42, v43
    v_or_b32_sdwa v16, v40, 1 dst_sel:WORD_0 dst_unused:UNUSED_PRESERVE src0_sel:WORD_1 src1_sel:DWORD
    v_cvt_pk_bf16_f32 v18, v44, v45
    v_cvt_pk_bf16_f32 v19, v46, v47
    buffer_store_dwordx4 v[16:19], v0, s[16:19], s71 offen offset:2048
    ds_write_b128 v240, v[16:19] offset:2048
    v_cvt_pk_bf16_f32 v12, v32, v33
    v_cvt_pk_bf16_f32 v13, v34, v35
    v_or_b32_sdwa v12, v32, 1 dst_sel:WORD_0 dst_unused:UNUSED_PRESERVE src0_sel:WORD_1 src1_sel:DWORD
    v_cvt_pk_bf16_f32 v14, v36, v37
    v_cvt_pk_bf16_f32 v15, v38, v39
    buffer_store_dwordx4 v[12:15], v0, s[16:19], s71 offen offset:1024
    ds_write_b128 v240, v[12:15] offset:1024
    v_cvt_pk_bf16_f32 v20, v48, v49
    v_cvt_pk_bf16_f32 v21, v50, v51
    v_or_b32_sdwa v20, v48, 1 dst_sel:WORD_0 dst_unused:UNUSED_PRESERVE src0_sel:WORD_1 src1_sel:DWORD
    v_cvt_pk_bf16_f32 v22, v52, v53
    v_cvt_pk_bf16_f32 v23, v54, v55
    buffer_store_dwordx4 v[20:23], v0, s[16:19], s71 offen offset:3072
    ds_write_b128 v240, v[20:23] offset:3072
Lback_144:
    v_cvt_pk_bf16_f32 v8, v24, v25
    v_cvt_pk_bf16_f32 v16, v40, v41
    v_cvt_pk_bf16_f32 v12, v32, v33
    v_cvt_pk_bf16_f32 v20, v48, v49
    v_mfma_f32_16x16x32_bf16 v[206:209], v[226:229], v[8:11], 0
    v_mfma_f32_16x16x32_bf16 v[210:213], v[8:11], v[8:11], 0
    v_mfma_f32_16x16x32_bf16 v[214:217], v[226:229], v[16:19], 0
    v_mfma_f32_16x16x32_bf16 v[218:221], v[16:19], v[16:19], 0
    v_mfma_f32_16x16x32_bf16 v[206:209], v[226:229], v[12:15], v[206:209]
    v_mfma_f32_16x16x32_bf16 v[210:213], v[12:15], v[12:15], v[210:213]
    v_mfma_f32_16x16x32_bf16 v[214:217], v[226:229], v[20:23], v[214:217]
    v_mfma_f32_16x16x32_bf16 v[218:221], v[20:23], v[20:23], v[218:221]
    s_add_u32 s22, s22, 1
    s_waitcnt lgkmcnt(0)
    s_branch L_cgo
L_final:
    s_lshl_b32 s27, s20, 2
    s_add_u32 s27, s27, s3
    s_lshl_b32 s27, s27, 16
    s_lshl_b32 s28, s21, 7
    s_add_u32 s27, s27, s28
    v_and_b32 v160, 15, v1
    v_lshlrev_b32 v160, 11, v160
    v_and_b32 v161, 48, v1
    v_add3_u32 v160, v160, v161, s27
    v_add_u32 v161, 32768, v160
    v_cvt_pk_bf16_f32 v8, v24, v25
    v_cvt_pk_bf16_f32 v9, v26, v27
    v_cvt_pk_bf16_f32 v10, v28, v29
    v_cvt_pk_bf16_f32 v11, v30, v31
    v_cvt_pk_bf16_f32 v16, v40, v41
    v_cvt_pk_bf16_f32 v17, v42, v43
    v_cvt_pk_bf16_f32 v18, v44, v45
    v_cvt_pk_bf16_f32 v19, v46, v47
    v_cvt_pk_bf16_f32 v12, v32, v33
    v_cvt_pk_bf16_f32 v13, v34, v35
    v_cvt_pk_bf16_f32 v14, v36, v37
    v_cvt_pk_bf16_f32 v15, v38, v39
    v_cvt_pk_bf16_f32 v20, v48, v49
    v_cvt_pk_bf16_f32 v21, v50, v51
    v_cvt_pk_bf16_f32 v22, v52, v53
    v_cvt_pk_bf16_f32 v23, v54, v55
    v_permlane32_swap_b32 v8, v10
    v_permlane32_swap_b32 v9, v11
    v_permlane32_swap_b32 v16, v18
    v_permlane32_swap_b32 v17, v19
    v_permlane32_swap_b32 v12, v14
    v_permlane32_swap_b32 v13, v15
    v_permlane32_swap_b32 v20, v22
    v_permlane32_swap_b32 v21, v23
    v_permlane16_swap_b32 v8, v10
    v_permlane16_swap_b32 v9, v11
    buffer_store_dwordx4 v[8:11], v160, s[16:19], 0 offen offset:0
    v_permlane16_swap_b32 v12, v14
    v_permlane16_swap_b32 v13, v15
    buffer_store_dwordx4 v[12:15], v160, s[16:19], 0 offen offset:64
    v_permlane16_swap_b32 v16, v18
    v_permlane16_swap_b32 v17, v19
    buffer_store_dwordx4 v[16:19], v161, s[16:19], 0 offen offset:0
    v_permlane16_swap_b32 v20, v22
    v_permlane16_swap_b32 v21, v23
    buffer_store_dwordx4 v[20:23], v161, s[16:19], 0 offen offset:64
L_out:
    s_endpgm
Lslow_9:
    buffer_store_dwordx4 v[176:179], v0, s[16:19], s27 offen offset:0 sc1
    s_branch Lback_10
Lslow_11:
    buffer_store_dwordx4 v[176:179], v0, s[16:19], s27 offen offset:1024 sc1
    s_branch Lback_12
Lslow_13:
    buffer_store_dwordx4 v[176:179], v0, s[16:19], s27 offen offset:2048 sc1
    s_branch Lback_14
Lslow_15:
    buffer_store_dwordx4 v[176:179], v0, s[16:19], s27 offen offset:3072 sc1
    s_branch Lback_16
Lxrt_18:
    s_mov_b32 s26, 0
    s_add_u32 s76, s55, 1
    s_cmp_ge_u32 s76, 16
    s_addc_u32 s76, s76, s21
    s_and_b32 s76, s76, 15
    s_lshl_b32 s76, s76, 12
Lxrt_18a:
    s_add_u32 m0, s78, 65536
    s_nop 0
    buffer_load_dwordx4 v8, s[16:19], s76 offen offset:0 sc1 lds
    buffer_load_dwordx4 v8, s[16:19], s76 offen offset:1024 sc1 lds
    buffer_load_dwordx4 v8, s[16:19], s76 offen offset:2048 sc1 lds
    buffer_load_dwordx4 v8, s[16:19], s76 offen offset:3072 sc1 lds
    s_waitcnt vmcnt(0)
    ds_read_b32 v40, v169 offset:16384
    ds_read_b32 v41, v169 offset:17408
    ds_read_b32 v42, v169 offset:18432
    ds_read_b32 v43, v169 offset:19456
    s_waitcnt lgkmcnt(0)
    v_or3_b32 v40, v40, v41, v42
    v_bitop3_b32 v40, v40, v43, 1 bitop3:0xa8
    v_cmp_ne_u32 vcc, 0, v40
    s_nop 0
    s_cbranch_vccz Lxok_17
    s_add_u32 s26, s26, 1
    s_cmp_lt_u32 s26, 262144
    s_cbranch_scc1 Lxrt_18a
    s_branch Lxok_17
Lxrt_21:
    s_mov_b32 s26, 0
    s_add_u32 s76, s55, 2
    s_cmp_ge_u32 s76, 16
    s_addc_u32 s76, s76, s21
    s_and_b32 s76, s76, 15
    s_lshl_b32 s76, s76, 12
Lxrt_21a:
    s_add_u32 m0, s78, 81920
    s_nop 0
    buffer_load_dwordx4 v8, s[16:19], s76 offen offset:0 sc1 lds
    buffer_load_dwordx4 v8, s[16:19], s76 offen offset:1024 sc1 lds
    buffer_load_dwordx4 v8, s[16:19], s76 offen offset:2048 sc1 lds
    buffer_load_dwordx4 v8, s[16:19], s76 offen offset:3072 sc1 lds
    s_waitcnt vmcnt(0)
    ds_read_b32 v40, v169 offset:32768
    ds_read_b32 v41, v169 offset:33792
    ds_read_b32 v42, v169 offset:34816
    ds_read_b32 v43, v169 offset:35840
    s_waitcnt lgkmcnt(0)
    v_or3_b32 v40, v40, v41, v42
    v_bitop3_b32 v40, v40, v43, 1 bitop3:0xa8
    v_cmp_ne_u32 vcc, 0, v40
    s_nop 0
    s_cbranch_vccz Lxok_20
    s_add_u32 s26, s26, 1
    s_cmp_lt_u32 s26, 262144
    s_cbranch_scc1 Lxrt_21a
    s_branch Lxok_20
Lxrt_24:
    s_mov_b32 s26, 0
    s_add_u32 s76, s55, 3
    s_cmp_ge_u32 s76, 16
    s_addc_u32 s76, s76, s21
    s_and_b32 s76, s76, 15
    s_lshl_b32 s76, s76, 12
Lxrt_24a:
    s_add_u32 m0, s78, 49152
    s_nop 0
    buffer_load_dwordx4 v8, s[16:19], s76 offen offset:0 sc1 lds
    buffer_load_dwordx4 v8, s[16:19], s76 offen offset:1024 sc1 lds
    buffer_load_dwordx4 v8, s[16:19], s76 offen offset:2048 sc1 lds
    buffer_load_dwordx4 v8, s[16:19], s76 offen offset:3072 sc1 lds
    s_waitcnt vmcnt(0)
    ds_read_b32 v40, v169 offset:0
    ds_read_b32 v41, v169 offset:1024
    ds_read_b32 v42, v169 offset:2048
    ds_read_b32 v43, v169 offset:3072
    s_waitcnt lgkmcnt(0)
    v_or3_b32 v40, v40, v41, v42
    v_bitop3_b32 v40, v40, v43, 1 bitop3:0xa8
    v_cmp_ne_u32 vcc, 0, v40
    s_nop 0
    s_cbranch_vccz Lxok_23
    s_add_u32 s26, s26, 1
    s_cmp_lt_u32 s26, 262144
    s_cbranch_scc1 Lxrt_24a
    s_branch Lxok_23
Lxrt_26:
    s_mov_b32 s26, 0
    s_add_u32 s76, s55, 4
    s_cmp_ge_u32 s76, 16
    s_addc_u32 s76, s76, s21
    s_and_b32 s76, s76, 15
    s_lshl_b32 s76, s76, 12
Lxrt_26a:
    s_add_u32 m0, s78, 65536
    s_nop 0
    buffer_load_dwordx4 v8, s[16:19], s76 offen offset:0 sc1 lds
    buffer_load_dwordx4 v8, s[16:19], s76 offen offset:1024 sc1 lds
    buffer_load_dwordx4 v8, s[16:19], s76 offen offset:2048 sc1 lds
    buffer_load_dwordx4 v8, s[16:19], s76 offen offset:3072 sc1 lds
    s_waitcnt vmcnt(0)
    ds_read_b32 v40, v169 offset:16384
    ds_read_b32 v41, v169 offset:17408
    ds_read_b32 v42, v169 offset:18432
    ds_read_b32 v43, v169 offset:19456
    s_waitcnt lgkmcnt(0)
    v_or3_b32 v40, v40, v41, v42
    v_bitop3_b32 v40, v40, v43, 1 bitop3:0xa8
    v_cmp_ne_u32 vcc, 0, v40
    s_nop 0
    s_cbranch_vccz Lxok_25
    s_add_u32 s26, s26, 1
    s_cmp_lt_u32 s26, 262144
    s_cbranch_scc1 Lxrt_26a
    s_branch Lxok_25
Lxrt_28:
    s_mov_b32 s26, 0
    s_add_u32 s76, s55, 5
    s_cmp_ge_u32 s76, 16
    s_addc_u32 s76, s76, s21
    s_and_b32 s76, s76, 15
    s_lshl_b32 s76, s76, 12
Lxrt_28a:
    s_add_u32 m0, s78, 81920
    s_nop 0
    buffer_load_dwordx4 v8, s[16:19], s76 offen offset:0 sc1 lds
    buffer_load_dwordx4 v8, s[16:19], s76 offen offset:1024 sc1 lds
    buffer_load_dwordx4 v8, s[16:19], s76 offen offset:2048 sc1 lds
    buffer_load_dwordx4 v8, s[16:19], s76 offen offset:3072 sc1 lds
    s_waitcnt vmcnt(0)
    ds_read_b32 v40, v169 offset:32768
    ds_read_b32 v41, v169 offset:33792
    ds_read_b32 v42, v169 offset:34816
    ds_read_b32 v43, v169 offset:35840
    s_waitcnt lgkmcnt(0)
    v_or3_b32 v40, v40, v41, v42
    v_bitop3_b32 v40, v40, v43, 1 bitop3:0xa8
    v_cmp_ne_u32 vcc, 0, v40
    s_nop 0
    s_cbranch_vccz Lxok_27
    s_add_u32 s26, s26, 1
    s_cmp_lt_u32 s26, 262144
    s_cbranch_scc1 Lxrt_28a
    s_branch Lxok_27
Lxrt_30:
    s_mov_b32 s26, 0
    s_add_u32 s76, s55, 6
    s_cmp_ge_u32 s76, 16
    s_addc_u32 s76, s76, s21
    s_and_b32 s76, s76, 15
    s_lshl_b32 s76, s76, 12
Lxrt_30a:
    s_add_u32 m0, s78, 49152
    s_nop 0
    buffer_load_dwordx4 v8, s[16:19], s76 offen offset:0 sc1 lds
    buffer_load_dwordx4 v8, s[16:19], s76 offen offset:1024 sc1 lds
    buffer_load_dwordx4 v8, s[16:19], s76 offen offset:2048 sc1 lds
    buffer_load_dwordx4 v8, s[16:19], s76 offen offset:3072 sc1 lds
    s_waitcnt vmcnt(0)
    ds_read_b32 v40, v169 offset:0
    ds_read_b32 v41, v169 offset:1024
    ds_read_b32 v42, v169 offset:2048
    ds_read_b32 v43, v169 offset:3072
    s_waitcnt lgkmcnt(0)
    v_or3_b32 v40, v40, v41, v42
    v_bitop3_b32 v40, v40, v43, 1 bitop3:0xa8
    v_cmp_ne_u32 vcc, 0, v40
    s_nop 0
    s_cbranch_vccz Lxok_29
    s_add_u32 s26, s26, 1
    s_cmp_lt_u32 s26, 262144
    s_cbranch_scc1 Lxrt_30a
    s_branch Lxok_29
Lxrt_32:
    s_mov_b32 s26, 0
    s_add_u32 s76, s55, 7
    s_cmp_ge_u32 s76, 16
    s_addc_u32 s76, s76, s21
    s_and_b32 s76, s76, 15
    s_lshl_b32 s76, s76, 12
Lxrt_32a:
    s_add_u32 m0, s78, 65536
    s_nop 0
    buffer_load_dwordx4 v8, s[16:19], s76 offen offset:0 sc1 lds
    buffer_load_dwordx4 v8, s[16:19], s76 offen offset:1024 sc1 lds
    buffer_load_dwordx4 v8, s[16:19], s76 offen offset:2048 sc1 lds
    buffer_load_dwordx4 v8, s[16:19], s76 offen offset:3072 sc1 lds
    s_waitcnt vmcnt(0)
    ds_read_b32 v40, v169 offset:16384
    ds_read_b32 v41, v169 offset:17408
    ds_read_b32 v42, v169 offset:18432
    ds_read_b32 v43, v169 offset:19456
    s_waitcnt lgkmcnt(0)
    v_or3_b32 v40, v40, v41, v42
    v_bitop3_b32 v40, v40, v43, 1 bitop3:0xa8
    v_cmp_ne_u32 vcc, 0, v40
    s_nop 0
    s_cbranch_vccz Lxok_31
    s_add_u32 s26, s26, 1
    s_cmp_lt_u32 s26, 262144
    s_cbranch_scc1 Lxrt_32a
    s_branch Lxok_31
Lxrt_37:
    s_mov_b32 s26, 0
    s_add_u32 s76, s55, 8
    s_cmp_ge_u32 s76, 16
    s_addc_u32 s76, s76, s21
    s_and_b32 s76, s76, 15
    s_lshl_b32 s76, s76, 12
Lxrt_37a:
    s_add_u32 m0, s78, 81920
    s_nop 0
    buffer_load_dwordx4 v8, s[16:19], s76 offen offset:0 sc1 lds
    buffer_load_dwordx4 v8, s[16:19], s76 offen offset:1024 sc1 lds
    buffer_load_dwordx4 v8, s[16:19], s76 offen offset:2048 sc1 lds
    buffer_load_dwordx4 v8, s[16:19], s76 offen offset:3072 sc1 lds
    s_waitcnt vmcnt(0)
    ds_read_b32 v40, v169 offset:32768
    ds_read_b32 v41, v169 offset:33792
    ds_read_b32 v42, v169 offset:34816
    ds_read_b32 v43, v169 offset:35840
    s_waitcnt lgkmcnt(0)
    v_or3_b32 v40, v40, v41, v42
    v_bitop3_b32 v40, v40, v43, 1 bitop3:0xa8
    v_cmp_ne_u32 vcc, 0, v40
    s_nop 0
    s_cbranch_vccz Lxok_36
    s_add_u32 s26, s26, 1
    s_cmp_lt_u32 s26, 262144
    s_cbranch_scc1 Lxrt_37a
    s_branch Lxok_36
Lxrt_42:
    s_mov_b32 s26, 0
    s_add_u32 s76, s21, 1
    s_and_b32 s76, s76, 15
    s_lshl_b32 s76, s76, 12
Lxrt_42a:
    s_add_u32 m0, s78, 65536
    s_nop 0
    buffer_load_dwordx4 v8, s[16:19], s76 offen offset:0 sc1 lds
    buffer_load_dwordx4 v8, s[16:19], s76 offen offset:1024 sc1 lds
    buffer_load_dwordx4 v8, s[16:19], s76 offen offset:2048 sc1 lds
    buffer_load_dwordx4 v8, s[16:19], s76 offen offset:3072 sc1 lds
    s_waitcnt vmcnt(0)
    ds_read_b32 v40, v169 offset:16384
    ds_read_b32 v41, v169 offset:17408
    ds_read_b32 v42, v169 offset:18432
    ds_read_b32 v43, v169 offset:19456
    s_waitcnt lgkmcnt(0)
    v_bitop3_b32 v40, v40, v41, v42 bitop3:0x80
    v_bitop3_b32 v40, v40, v43, 1 bitop3:0x80
    v_cmp_eq_u32 vcc, 0, v40
    s_nop 0
    s_cbranch_vccz Lxok_41
    s_add_u32 s26, s26, 1
    s_cmp_lt_u32 s26, 262144
    s_cbranch_scc1 Lxrt_42a
    s_branch Lxok_41
Lxrt_44:
    s_mov_b32 s26, 0
    s_add_u32 s76, s21, 2
    s_and_b32 s76, s76, 15
    s_lshl_b32 s76, s76, 12
Lxrt_44a:
    s_add_u32 m0, s78, 81920
    s_nop 0
    buffer_load_dwordx4 v8, s[16:19], s76 offen offset:0 sc1 lds
    buffer_load_dwordx4 v8, s[16:19], s76 offen offset:1024 sc1 lds
    buffer_load_dwordx4 v8, s[16:19], s76 offen offset:2048 sc1 lds
    buffer_load_dwordx4 v8, s[16:19], s76 offen offset:3072 sc1 lds
    s_waitcnt vmcnt(0)
    ds_read_b32 v40, v169 offset:32768
    ds_read_b32 v41, v169 offset:33792
    ds_read_b32 v42, v169 offset:34816
    ds_read_b32 v43, v169 offset:35840
    s_waitcnt lgkmcnt(0)
    v_bitop3_b32 v40, v40, v41, v42 bitop3:0x80
    v_bitop3_b32 v40, v40, v43, 1 bitop3:0x80
    v_cmp_eq_u32 vcc, 0, v40
    s_nop 0
    s_cbranch_vccz Lxok_43
    s_add_u32 s26, s26, 1
    s_cmp_lt_u32 s26, 262144
    s_cbranch_scc1 Lxrt_44a
    s_branch Lxok_43
Lxrt_46:
    s_mov_b32 s26, 0
    s_add_u32 s76, s21, 3
    s_and_b32 s76, s76, 15
    s_lshl_b32 s76, s76, 12
Lxrt_46a:
    s_add_u32 m0, s78, 49152
    s_nop 0
    buffer_load_dwordx4 v8, s[16:19], s76 offen offset:0 sc1 lds
    buffer_load_dwordx4 v8, s[16:19], s76 offen offset:1024 sc1 lds
    buffer_load_dwordx4 v8, s[16:19], s76 offen offset:2048 sc1 lds
    buffer_load_dwordx4 v8, s[16:19], s76 offen offset:3072 sc1 lds
    s_waitcnt vmcnt(0)
    ds_read_b32 v40, v169 offset:0
    ds_read_b32 v41, v169 offset:1024
    ds_read_b32 v42, v169 offset:2048
    ds_read_b32 v43, v169 offset:3072
    s_waitcnt lgkmcnt(0)
    v_bitop3_b32 v40, v40, v41, v42 bitop3:0x80
    v_bitop3_b32 v40, v40, v43, 1 bitop3:0x80
    v_cmp_eq_u32 vcc, 0, v40
    s_nop 0
    s_cbranch_vccz Lxok_45
    s_add_u32 s26, s26, 1
    s_cmp_lt_u32 s26, 262144
    s_cbranch_scc1 Lxrt_46a
    s_branch Lxok_45
Lxrt_48:
    s_mov_b32 s26, 0
    s_add_u32 s76, s21, 4
    s_and_b32 s76, s76, 15
    s_lshl_b32 s76, s76, 12
Lxrt_48a:
    s_add_u32 m0, s78, 65536
    s_nop 0
    buffer_load_dwordx4 v8, s[16:19], s76 offen offset:0 sc1 lds
    buffer_load_dwordx4 v8, s[16:19], s76 offen offset:1024 sc1 lds
    buffer_load_dwordx4 v8, s[16:19], s76 offen offset:2048 sc1 lds
    buffer_load_dwordx4 v8, s[16:19], s76 offen offset:3072 sc1 lds
    s_waitcnt vmcnt(0)
    ds_read_b32 v40, v169 offset:16384
    ds_read_b32 v41, v169 offset:17408
    ds_read_b32 v42, v169 offset:18432
    ds_read_b32 v43, v169 offset:19456
    s_waitcnt lgkmcnt(0)
    v_bitop3_b32 v40, v40, v41, v42 bitop3:0x80
    v_bitop3_b32 v40, v40, v43, 1 bitop3:0x80
    v_cmp_eq_u32 vcc, 0, v40
    s_nop 0
    s_cbranch_vccz Lxok_47
    s_add_u32 s26, s26, 1
    s_cmp_lt_u32 s26, 262144
    s_cbranch_scc1 Lxrt_48a
    s_branch Lxok_47
Lxrt_50:
    s_mov_b32 s26, 0
    s_add_u32 s76, s21, 5
    s_and_b32 s76, s76, 15
    s_lshl_b32 s76, s76, 12
Lxrt_50a:
    s_add_u32 m0, s78, 81920
    s_nop 0
    buffer_load_dwordx4 v8, s[16:19], s76 offen offset:0 sc1 lds
    buffer_load_dwordx4 v8, s[16:19], s76 offen offset:1024 sc1 lds
    buffer_load_dwordx4 v8, s[16:19], s76 offen offset:2048 sc1 lds
    buffer_load_dwordx4 v8, s[16:19], s76 offen offset:3072 sc1 lds
    s_waitcnt vmcnt(0)
    ds_read_b32 v40, v169 offset:32768
    ds_read_b32 v41, v169 offset:33792
    ds_read_b32 v42, v169 offset:34816
    ds_read_b32 v43, v169 offset:35840
    s_waitcnt lgkmcnt(0)
    v_bitop3_b32 v40, v40, v41, v42 bitop3:0x80
    v_bitop3_b32 v40, v40, v43, 1 bitop3:0x80
    v_cmp_eq_u32 vcc, 0, v40
    s_nop 0
    s_cbranch_vccz Lxok_49
    s_add_u32 s26, s26, 1
    s_cmp_lt_u32 s26, 262144
    s_cbranch_scc1 Lxrt_50a
    s_branch Lxok_49
Lxrt_52:
    s_mov_b32 s26, 0
    s_add_u32 s76, s21, 6
    s_and_b32 s76, s76, 15
    s_lshl_b32 s76, s76, 12
Lxrt_52a:
    s_add_u32 m0, s78, 49152
    s_nop 0
    buffer_load_dwordx4 v8, s[16:19], s76 offen offset:0 sc1 lds
    buffer_load_dwordx4 v8, s[16:19], s76 offen offset:1024 sc1 lds
    buffer_load_dwordx4 v8, s[16:19], s76 offen offset:2048 sc1 lds
    buffer_load_dwordx4 v8, s[16:19], s76 offen offset:3072 sc1 lds
    s_waitcnt vmcnt(0)
    ds_read_b32 v40, v169 offset:0
    ds_read_b32 v41, v169 offset:1024
    ds_read_b32 v42, v169 offset:2048
    ds_read_b32 v43, v169 offset:3072
    s_waitcnt lgkmcnt(0)
    v_bitop3_b32 v40, v40, v41, v42 bitop3:0x80
    v_bitop3_b32 v40, v40, v43, 1 bitop3:0x80
    v_cmp_eq_u32 vcc, 0, v40
    s_nop 0
    s_cbranch_vccz Lxok_51
    s_add_u32 s26, s26, 1
    s_cmp_lt_u32 s26, 262144
    s_cbranch_scc1 Lxrt_52a
    s_branch Lxok_51
Lxrt_54:
    s_mov_b32 s26, 0
    s_add_u32 s76, s21, 7
    s_and_b32 s76, s76, 15
    s_lshl_b32 s76, s76, 12
Lxrt_54a:
    s_add_u32 m0, s78, 65536
    s_nop 0
    buffer_load_dwordx4 v8, s[16:19], s76 offen offset:0 sc1 lds
    buffer_load_dwordx4 v8, s[16:19], s76 offen offset:1024 sc1 lds
    buffer_load_dwordx4 v8, s[16:19], s76 offen offset:2048 sc1 lds
    buffer_load_dwordx4 v8, s[16:19], s76 offen offset:3072 sc1 lds
    s_waitcnt vmcnt(0)
    ds_read_b32 v40, v169 offset:16384
    ds_read_b32 v41, v169 offset:17408
    ds_read_b32 v42, v169 offset:18432
    ds_read_b32 v43, v169 offset:19456
    s_waitcnt lgkmcnt(0)
    v_bitop3_b32 v40, v40, v41, v42 bitop3:0x80
    v_bitop3_b32 v40, v40, v43, 1 bitop3:0x80
    v_cmp_eq_u32 vcc, 0, v40
    s_nop 0
    s_cbranch_vccz Lxok_53
    s_add_u32 s26, s26, 1
    s_cmp_lt_u32 s26, 262144
    s_cbranch_scc1 Lxrt_54a
    s_branch Lxok_53
Lxrt_59:
    s_mov_b32 s26, 0
    s_add_u32 s76, s21, 8
    s_and_b32 s76, s76, 15
    s_lshl_b32 s76, s76, 12
Lxrt_59a:
    s_add_u32 m0, s78, 81920
    s_nop 0
    buffer_load_dwordx4 v8, s[16:19], s76 offen offset:0 sc1 lds
    buffer_load_dwordx4 v8, s[16:19], s76 offen offset:1024 sc1 lds
    buffer_load_dwordx4 v8, s[16:19], s76 offen offset:2048 sc1 lds
    buffer_load_dwordx4 v8, s[16:19], s76 offen offset:3072 sc1 lds
    s_waitcnt vmcnt(0)
    ds_read_b32 v40, v169 offset:32768
    ds_read_b32 v41, v169 offset:33792
    ds_read_b32 v42, v169 offset:34816
    ds_read_b32 v43, v169 offset:35840
    s_waitcnt lgkmcnt(0)
    v_bitop3_b32 v40, v40, v41, v42 bitop3:0x80
    v_bitop3_b32 v40, v40, v43, 1 bitop3:0x80
    v_cmp_eq_u32 vcc, 0, v40
    s_nop 0
    s_cbranch_vccz Lxok_58
    s_add_u32 s26, s26, 1
    s_cmp_lt_u32 s26, 262144
    s_cbranch_scc1 Lxrt_59a
    s_branch Lxok_58
Lxrt_61:
    s_mov_b32 s26, 0
    s_add_u32 s76, s21, 1
    s_and_b32 s76, s76, 15
    s_lshl_b32 s76, s76, 12
Lxrt_61a:
    s_add_u32 m0, s78, 65536
    s_nop 0
    buffer_load_dwordx4 v8, s[16:19], s76 offen offset:0 sc1 lds
    buffer_load_dwordx4 v8, s[16:19], s76 offen offset:1024 sc1 lds
    buffer_load_dwordx4 v8, s[16:19], s76 offen offset:2048 sc1 lds
    buffer_load_dwordx4 v8, s[16:19], s76 offen offset:3072 sc1 lds
    s_waitcnt vmcnt(0)
    ds_read_b32 v40, v169 offset:16384
    ds_read_b32 v41, v169 offset:17408
    ds_read_b32 v42, v169 offset:18432
    ds_read_b32 v43, v169 offset:19456
    s_waitcnt lgkmcnt(0)
    v_or3_b32 v40, v40, v41, v42
    v_bitop3_b32 v40, v40, v43, 1 bitop3:0xa8
    v_cmp_ne_u32 vcc, 0, v40
    s_nop 0
    s_cbranch_vccz Lxok_60
    s_add_u32 s26, s26, 1
    s_cmp_lt_u32 s26, 262144
    s_cbranch_scc1 Lxrt_61a
    s_branch Lxok_60
Lxrt_63:
    s_mov_b32 s26, 0
    s_add_u32 s76, s21, 2
    s_and_b32 s76, s76, 15
    s_lshl_b32 s76, s76, 12
Lxrt_63a:
    s_add_u32 m0, s78, 81920
    s_nop 0
    buffer_load_dwordx4 v8, s[16:19], s76 offen offset:0 sc1 lds
    buffer_load_dwordx4 v8, s[16:19], s76 offen offset:1024 sc1 lds
    buffer_load_dwordx4 v8, s[16:19], s76 offen offset:2048 sc1 lds
    buffer_load_dwordx4 v8, s[16:19], s76 offen offset:3072 sc1 lds
    s_waitcnt vmcnt(0)
    ds_read_b32 v40, v169 offset:32768
    ds_read_b32 v41, v169 offset:33792
    ds_read_b32 v42, v169 offset:34816
    ds_read_b32 v43, v169 offset:35840
    s_waitcnt lgkmcnt(0)
    v_or3_b32 v40, v40, v41, v42
    v_bitop3_b32 v40, v40, v43, 1 bitop3:0xa8
    v_cmp_ne_u32 vcc, 0, v40
    s_nop 0
    s_cbranch_vccz Lxok_62
    s_add_u32 s26, s26, 1
    s_cmp_lt_u32 s26, 262144
    s_cbranch_scc1 Lxrt_63a
    s_branch Lxok_62
Lxrt_65:
    s_mov_b32 s26, 0
    s_add_u32 s76, s21, 3
    s_and_b32 s76, s76, 15
    s_lshl_b32 s76, s76, 12
Lxrt_65a:
    s_add_u32 m0, s78, 49152
    s_nop 0
    buffer_load_dwordx4 v8, s[16:19], s76 offen offset:0 sc1 lds
    buffer_load_dwordx4 v8, s[16:19], s76 offen offset:1024 sc1 lds
    buffer_load_dwordx4 v8, s[16:19], s76 offen offset:2048 sc1 lds
    buffer_load_dwordx4 v8, s[16:19], s76 offen offset:3072 sc1 lds
    s_waitcnt vmcnt(0)
    ds_read_b32 v40, v169 offset:0
    ds_read_b32 v41, v169 offset:1024
    ds_read_b32 v42, v169 offset:2048
    ds_read_b32 v43, v169 offset:3072
    s_waitcnt lgkmcnt(0)
    v_or3_b32 v40, v40, v41, v42
    v_bitop3_b32 v40, v40, v43, 1 bitop3:0xa8
    v_cmp_ne_u32 vcc, 0, v40
    s_nop 0
    s_cbranch_vccz Lxok_64
    s_add_u32 s26, s26, 1
    s_cmp_lt_u32 s26, 262144
    s_cbranch_scc1 Lxrt_65a
    s_branch Lxok_64
Lxrt_67:
    s_mov_b32 s26, 0
    s_add_u32 s76, s21, 4
    s_and_b32 s76, s76, 15
    s_lshl_b32 s76, s76, 12
Lxrt_67a:
    s_add_u32 m0, s78, 65536
    s_nop 0
    buffer_load_dwordx4 v8, s[16:19], s76 offen offset:0 sc1 lds
    buffer_load_dwordx4 v8, s[16:19], s76 offen offset:1024 sc1 lds
    buffer_load_dwordx4 v8, s[16:19], s76 offen offset:2048 sc1 lds
    buffer_load_dwordx4 v8, s[16:19], s76 offen offset:3072 sc1 lds
    s_waitcnt vmcnt(0)
    ds_read_b32 v40, v169 offset:16384
    ds_read_b32 v41, v169 offset:17408
    ds_read_b32 v42, v169 offset:18432
    ds_read_b32 v43, v169 offset:19456
    s_waitcnt lgkmcnt(0)
    v_or3_b32 v40, v40, v41, v42
    v_bitop3_b32 v40, v40, v43, 1 bitop3:0xa8
    v_cmp_ne_u32 vcc, 0, v40
    s_nop 0
    s_cbranch_vccz Lxok_66
    s_add_u32 s26, s26, 1
    s_cmp_lt_u32 s26, 262144
    s_cbranch_scc1 Lxrt_67a
    s_branch Lxok_66
Lxrt_69:
    s_mov_b32 s26, 0
    s_add_u32 s76, s21, 5
    s_and_b32 s76, s76, 15
    s_lshl_b32 s76, s76, 12
Lxrt_69a:
    s_add_u32 m0, s78, 81920
    s_nop 0
    buffer_load_dwordx4 v8, s[16:19], s76 offen offset:0 sc1 lds
    buffer_load_dwordx4 v8, s[16:19], s76 offen offset:1024 sc1 lds
    buffer_load_dwordx4 v8, s[16:19], s76 offen offset:2048 sc1 lds
    buffer_load_dwordx4 v8, s[16:19], s76 offen offset:3072 sc1 lds
    s_waitcnt vmcnt(0)
    ds_read_b32 v40, v169 offset:32768
    ds_read_b32 v41, v169 offset:33792
    ds_read_b32 v42, v169 offset:34816
    ds_read_b32 v43, v169 offset:35840
    s_waitcnt lgkmcnt(0)
    v_or3_b32 v40, v40, v41, v42
    v_bitop3_b32 v40, v40, v43, 1 bitop3:0xa8
    v_cmp_ne_u32 vcc, 0, v40
    s_nop 0
    s_cbranch_vccz Lxok_68
    s_add_u32 s26, s26, 1
    s_cmp_lt_u32 s26, 262144
    s_cbranch_scc1 Lxrt_69a
    s_branch Lxok_68
Lxrt_71:
    s_mov_b32 s26, 0
    s_add_u32 s76, s21, 6
    s_and_b32 s76, s76, 15
    s_lshl_b32 s76, s76, 12
Lxrt_71a:
    s_add_u32 m0, s78, 49152
    s_nop 0
    buffer_load_dwordx4 v8, s[16:19], s76 offen offset:0 sc1 lds
    buffer_load_dwordx4 v8, s[16:19], s76 offen offset:1024 sc1 lds
    buffer_load_dwordx4 v8, s[16:19], s76 offen offset:2048 sc1 lds
    buffer_load_dwordx4 v8, s[16:19], s76 offen offset:3072 sc1 lds
    s_waitcnt vmcnt(0)
    ds_read_b32 v40, v169 offset:0
    ds_read_b32 v41, v169 offset:1024
    ds_read_b32 v42, v169 offset:2048
    ds_read_b32 v43, v169 offset:3072
    s_waitcnt lgkmcnt(0)
    v_or3_b32 v40, v40, v41, v42
    v_bitop3_b32 v40, v40, v43, 1 bitop3:0xa8
    v_cmp_ne_u32 vcc, 0, v40
    s_nop 0
    s_cbranch_vccz Lxok_70
    s_add_u32 s26, s26, 1
    s_cmp_lt_u32 s26, 262144
    s_cbranch_scc1 Lxrt_71a
    s_branch Lxok_70
Lxrt_73:
    s_mov_b32 s26, 0
    s_add_u32 s76, s21, 7
    s_and_b32 s76, s76, 15
    s_lshl_b32 s76, s76, 12
Lxrt_73a:
    s_add_u32 m0, s78, 65536
    s_nop 0
    buffer_load_dwordx4 v8, s[16:19], s76 offen offset:0 sc1 lds
    buffer_load_dwordx4 v8, s[16:19], s76 offen offset:1024 sc1 lds
    buffer_load_dwordx4 v8, s[16:19], s76 offen offset:2048 sc1 lds
    buffer_load_dwordx4 v8, s[16:19], s76 offen offset:3072 sc1 lds
    s_waitcnt vmcnt(0)
    ds_read_b32 v40, v169 offset:16384
    ds_read_b32 v41, v169 offset:17408
    ds_read_b32 v42, v169 offset:18432
    ds_read_b32 v43, v169 offset:19456
    s_waitcnt lgkmcnt(0)
    v_or3_b32 v40, v40, v41, v42
    v_bitop3_b32 v40, v40, v43, 1 bitop3:0xa8
    v_cmp_ne_u32 vcc, 0, v40
    s_nop 0
    s_cbranch_vccz Lxok_72
    s_add_u32 s26, s26, 1
    s_cmp_lt_u32 s26, 262144
    s_cbranch_scc1 Lxrt_73a
    s_branch Lxok_72
Lxrt_78:
    s_mov_b32 s26, 0
    s_add_u32 s76, s21, 8
    s_and_b32 s76, s76, 15
    s_lshl_b32 s76, s76, 12
Lxrt_78a:
    s_add_u32 m0, s78, 81920
    s_nop 0
    buffer_load_dwordx4 v8, s[16:19], s76 offen offset:0 sc1 lds
    buffer_load_dwordx4 v8, s[16:19], s76 offen offset:1024 sc1 lds
    buffer_load_dwordx4 v8, s[16:19], s76 offen offset:2048 sc1 lds
    buffer_load_dwordx4 v8, s[16:19], s76 offen offset:3072 sc1 lds
    s_waitcnt vmcnt(0)
    ds_read_b32 v40, v169 offset:32768
    ds_read_b32 v41, v169 offset:33792
    ds_read_b32 v42, v169 offset:34816
    ds_read_b32 v43, v169 offset:35840
    s_waitcnt lgkmcnt(0)
    v_or3_b32 v40, v40, v41, v42
    v_bitop3_b32 v40, v40, v43, 1 bitop3:0xa8
    v_cmp_ne_u32 vcc, 0, v40
    s_nop 0
    s_cbranch_vccz Lxok_77
    s_add_u32 s26, s26, 1
    s_cmp_lt_u32 s26, 262144
    s_cbranch_scc1 Lxrt_78a
    s_branch Lxok_77
Lslow_86:
    buffer_store_dwordx4 v[230:233], v237, s[12:15], s27 offen sc1
    s_branch Lback_87
Lslow_89:
    buffer_store_dwordx2 v[234:235], v236, s[12:15], 0 offen offset:0 sc1
    s_branch Lback_90
Lslow_96:
    buffer_store_dwordx4 v[144:147], v0, s[12:15], s72 offen offset:0 sc1
    buffer_store_dwordx4 v[152:155], v0, s[12:15], s72 offen offset:1024 sc1
    s_branch Lback_97
L_exact:
    s_lshl_b32 s38, s20, 2
    s_add_u32 s38, s38, s84
    s_mov_b32 s37, 0
    v_mov_b32 v226, 0x3f803f80
    v_mov_b32 v227, 0x3f803f80
    v_mov_b32 v228, 0x3f803f80
    v_mov_b32 v229, 0x3f803f80
    v_mov_b32 v180, 4048155338
    v_mov_b32 v245, 4048155338
    v_mov_b32 v246, 4048155338
    v_mov_b32 v144, 0
    v_mov_b32 v145, 0
    v_mov_b32 v146, 0
    v_mov_b32 v147, 0
    v_mov_b32 v148, 0
    v_mov_b32 v149, 0
    v_mov_b32 v150, 0
    v_mov_b32 v151, 0
    v_mov_b32 v152, 0
    v_mov_b32 v153, 0
    v_mov_b32 v154, 0
    v_mov_b32 v155, 0
    v_mov_b32 v156, 0
    v_mov_b32 v157, 0
    v_mov_b32 v158, 0
    v_mov_b32 v159, 0
    v_mov_b32 v160, 0
    v_mov_b32 v161, 0
    v_mov_b32 v162, 0
    v_mov_b32 v163, 0
    v_mov_b32 v164, 0
    v_mov_b32 v165, 0
    v_mov_b32 v166, 0
    v_mov_b32 v167, 0
L_expass:
    s_mov_b32 s39, 0
    v_mov_b32 v247, v4
L_exstep:
    s_sub_u32 s27, s38, s39
    s_lshr_b32 s28, s27, 2
    s_lshl_b32 s28, s28, 19
    s_and_b32 s27, s27, 3
    s_lshl_b32 s27, s27, 13
    s_add_u32 s27, s27, s28
    s_lshl_b32 s28, s21, 15
    s_add_u32 s27, s27, s28
    s_and_b32 s28, s3, 1
    s_lshl_b32 s28, s28, 12
    s_add_u32 s27, s27, s28
    s_add_u32 s27, s27, 14680064
    s_lshl_b32 s28, s22, 22
    s_add_u32 s27, s27, s28
    buffer_load_dwordx4 v[72:75], v0, s[12:15], s27 offen offset:0 sc1
    buffer_load_dwordx4 v[80:83], v0, s[12:15], s27 offen offset:1024 sc1
    buffer_load_dwordx4 v[100:103], v0, s[12:15], s27 offen offset:2048 sc1
    buffer_load_dwordx4 v[116:119], v0, s[12:15], s27 offen offset:3072 sc1
    s_waitcnt vmcnt(0)
    v_mfma_f32_16x16x32_bf16 v[120:123], v[72:75], v[40:43], 0
    v_mfma_f32_16x16x32_bf16 v[124:127], v[80:83], v[40:43], 0
    v_mfma_f32_16x16x32_bf16 v[128:131], v[72:75], v[48:51], 0
    v_mfma_f32_16x16x32_bf16 v[132:135], v[80:83], v[48:51], 0
    v_add_u32 v181, 0, v247
    v_cmp_gt_u32 vcc, 0x100, v181
    s_nop 2
    v_cndmask_b32 v120, v180, v120, vcc
    v_add_u32 v181, -1, v247
    v_cmp_gt_u32 vcc, 0x100, v181
    s_nop 1
    v_cndmask_b32 v121, v180, v121, vcc
    v_add_u32 v181, -2, v247
    v_cmp_gt_u32 vcc, 0x100, v181
    s_nop 1
    v_cndmask_b32 v122, v180, v122, vcc
    v_add_u32 v181, -3, v247
    v_cmp_gt_u32 vcc, 0x100, v181
    s_nop 1
    v_cndmask_b32 v123, v180, v123, vcc
    v_add_u32 v181, -16, v247
    v_cmp_gt_u32 vcc, 0x100, v181
    s_nop 1
    v_cndmask_b32 v124, v180, v124, vcc
    v_add_u32 v181, 4294967279, v247
    v_cmp_gt_u32 vcc, 0x100, v181
    s_nop 1
    v_cndmask_b32 v125, v180, v125, vcc
    v_add_u32 v181, 4294967278, v247
    v_cmp_gt_u32 vcc, 0x100, v181
    s_nop 1
    v_cndmask_b32 v126, v180, v126, vcc
    v_add_u32 v181, 4294967277, v247
    v_cmp_gt_u32 vcc, 0x100, v181
    s_nop 1
    v_cndmask_b32 v127, v180, v127, vcc
    v_add_u32 v181, 16, v247
    v_cmp_gt_u32 vcc, 0x100, v181
    s_nop 1
    v_cndmask_b32 v128, v180, v128, vcc
    v_add_u32 v181, 15, v247
    v_cmp_gt_u32 vcc, 0x100, v181
    s_nop 1
    v_cndmask_b32 v129, v180, v129, vcc
    v_add_u32 v181, 14, v247
    v_cmp_gt_u32 vcc, 0x100, v181
    s_nop 1
    v_cndmask_b32 v130, v180, v130, vcc
    v_add_u32 v181, 13, v247
    v_cmp_gt_u32 vcc, 0x100, v181
    s_nop 1
    v_cndmask_b32 v131, v180, v131, vcc
    v_add_u32 v181, 0, v247
    v_cmp_gt_u32 vcc, 0x100, v181
    s_nop 1
    v_cndmask_b32 v132, v180, v132, vcc
    v_add_u32 v181, -1, v247
    v_cmp_gt_u32 vcc, 0x100, v181
    s_nop 1
    v_cndmask_b32 v133, v180, v133, vcc
    v_add_u32 v181, -2, v247
    v_cmp_gt_u32 vcc, 0x100, v181
    s_nop 1
    v_cndmask_b32 v134, v180, v134, vcc
    v_add_u32 v181, -3, v247
    v_cmp_gt_u32 vcc, 0x100, v181
    s_nop 1
    v_cndmask_b32 v135, v180, v135, vcc
    s_cmp_lg_u32 s37, 0
    s_cbranch_scc1 L_exp2
    v_max3_f32 v245, v245, v120, v121
    v_max3_f32 v245, v245, v122, v123
    v_max3_f32 v245, v245, v124, v125
    v_max3_f32 v245, v245, v126, v127
    v_max3_f32 v246, v246, v128, v129
    v_max3_f32 v246, v246, v130, v131
    v_max3_f32 v246, v246, v132, v133
    v_max3_f32 v246, v246, v134, v135
    s_branch L_exnext
L_exp2:
    v_sub_f32 v120, v120, v245
    v_sub_f32 v121, v121, v245
    v_sub_f32 v122, v122, v245
    v_sub_f32 v123, v123, v245
    v_sub_f32 v124, v124, v245
    v_sub_f32 v125, v125, v245
    v_sub_f32 v126, v126, v245
    v_sub_f32 v127, v127, v245
    v_sub_f32 v128, v128, v246
    v_sub_f32 v129, v129, v246
    v_sub_f32 v130, v130, v246
    v_sub_f32 v131, v131, v246
    v_sub_f32 v132, v132, v246
    v_sub_f32 v133, v133, v246
    v_sub_f32 v134, v134, v246
    v_sub_f32 v135, v135, v246
    v_exp_f32 v120, v120
    v_exp_f32 v121, v121
    v_exp_f32 v122, v122
    v_exp_f32 v123, v123
    v_exp_f32 v124, v124
    v_exp_f32 v125, v125
    v_exp_f32 v126, v126
    v_exp_f32 v127, v127
    v_exp_f32 v128, v128
    v_exp_f32 v129, v129
    v_exp_f32 v130, v130
    v_exp_f32 v131, v131
    v_exp_f32 v132, v132
    v_exp_f32 v133, v133
    v_exp_f32 v134, v134
    v_exp_f32 v135, v135
    v_cvt_pk_bf16_f32 v136, v120, v121
    v_cvt_pk_bf16_f32 v137, v122, v123
    v_cvt_pk_bf16_f32 v138, v124, v125
    v_cvt_pk_bf16_f32 v139, v126, v127
    v_cvt_pk_bf16_f32 v140, v128, v129
    v_cvt_pk_bf16_f32 v141, v130, v131
    v_cvt_pk_bf16_f32 v142, v132, v133
    v_cvt_pk_bf16_f32 v143, v134, v135
    v_mfma_f32_16x16x32_bf16 v[144:147], v[100:103], v[136:139], v[144:147]
    v_mfma_f32_16x16x32_bf16 v[148:151], v[116:119], v[136:139], v[148:151]
    v_mfma_f32_16x16x32_bf16 v[160:163], v[226:229], v[136:139], v[160:163]
    v_mfma_f32_16x16x32_bf16 v[152:155], v[100:103], v[140:143], v[152:155]
    v_mfma_f32_16x16x32_bf16 v[156:159], v[116:119], v[140:143], v[156:159]
    v_mfma_f32_16x16x32_bf16 v[164:167], v[226:229], v[140:143], v[164:167]
L_exnext:
    v_add_u32 v247, 32, v247
    s_add_u32 s39, s39, 1
    s_min_u32 s27, s38, 8
    s_cmp_le_u32 s39, s27
    s_cbranch_scc1 L_exstep
    v_mov_b32 v181, v245
    s_nop 1
    v_permlane32_swap_b32 v245, v181
    v_max_f32 v245, v245, v181
    v_mov_b32 v181, v246
    s_nop 1
    v_permlane32_swap_b32 v246, v181
    v_max_f32 v246, v246, v181
    v_mov_b32 v181, v245
    s_nop 1
    v_permlane16_swap_b32 v245, v181
    v_max_f32 v245, v245, v181
    v_mov_b32 v181, v246
    s_nop 1
    v_permlane16_swap_b32 v246, v181
    v_max_f32 v246, v246, v181
    s_add_u32 s37, s37, 1
    s_cmp_lt_u32 s37, 2
    s_cbranch_scc1 L_expass
    v_rcp_f32 v245, v160
    s_nop 0
    v_mul_f32 v144, v144, v245
    v_mul_f32 v145, v145, v245
    v_mul_f32 v146, v146, v245
    v_mul_f32 v147, v147, v245
    v_mul_f32 v148, v148, v245
    v_mul_f32 v149, v149, v245
    v_mul_f32 v150, v150, v245
    v_mul_f32 v151, v151, v245
    v_add_u32 v247, 0x10000, v144
    v_cvt_pk_bf16_f32 v144, v144, v145
    v_cvt_pk_bf16_f32 v145, v146, v147
    v_and_b32_sdwa v144, v247, -2 dst_sel:WORD_0 dst_unused:UNUSED_PRESERVE src0_sel:WORD_1 src1_sel:DWORD
    v_cvt_pk_bf16_f32 v146, v148, v149
    v_cvt_pk_bf16_f32 v147, v150, v151
    v_rcp_f32 v246, v164
    s_nop 0
    v_mul_f32 v152, v152, v246
    v_mul_f32 v153, v153, v246
    v_mul_f32 v154, v154, v246
    v_mul_f32 v155, v155, v246
    v_mul_f32 v156, v156, v246
    v_mul_f32 v157, v157, v246
    v_mul_f32 v158, v158, v246
    v_mul_f32 v159, v159, v246
    v_add_u32 v247, 0x10000, v152
    v_cvt_pk_bf16_f32 v152, v152, v153
    v_cvt_pk_bf16_f32 v153, v154, v155
    v_and_b32_sdwa v152, v247, -2 dst_sel:WORD_0 dst_unused:UNUSED_PRESERVE src0_sel:WORD_1 src1_sel:DWORD
    v_cvt_pk_bf16_f32 v154, v156, v157
    v_cvt_pk_bf16_f32 v155, v158, v159
    s_branch L_ostore
Lslow_102:
    buffer_store_dwordx4 v[168:171], v0, s[12:15], s72 offen offset:1024 sc1
    buffer_store_dwordx4 v[152:155], v0, s[12:15], s72 offen offset:0 sc1
    buffer_store_dwordx4 v[136:139], v0, s[12:15], s28 offen offset:1024 sc1
    s_branch Lback_103
Lhrt_106:
    s_add_u32 s26, s26, 1
    s_cmp_ge_u32 s26, 262144
    s_cbranch_scc1 Lhok_105
    buffer_load_dwordx4 v[244:247], v0, s[12:15], s74 offen sc1
    buffer_load_dwordx4 v[240:243], v0, s[12:15], s74 offen offset:1024 sc1
    s_waitcnt vmcnt(0)
    s_branch Lhck_104
Lslow_107:
    buffer_store_dwordx4 v[120:123], v0, s[12:15], s28 offen offset:0 sc1
    s_branch Lback_108
Lock_109:
    s_mov_b32 s26, 0
    s_add_u32 s27, s21, 0
    s_and_b32 s27, s27, 15
    s_lshl_b32 s27, s27, 12
Lock_109a:
    buffer_load_dwordx4 v[104:107], v214, s[12:15], s27 offen offset:0 sc1
    buffer_load_dwordx4 v[108:111], v214, s[12:15], s27 offen offset:1024 sc1
    buffer_load_dwordx4 v[112:115], v214, s[12:15], s27 offen offset:2048 sc1
    buffer_load_dwordx4 v[116:119], v214, s[12:15], s27 offen offset:3072 sc1
    s_waitcnt vmcnt(0)
    v_bitop3_b32 v216, v104, v108, s22 bitop3:0x7e
    v_bitop3_b32 v217, v112, v116, s22 bitop3:0x7e
    v_bitop3_b32 v216, v216, v217, 1 bitop3:0xa8
    v_cmp_ne_u32 vcc, 0, v216
    s_nop 0
    s_cbranch_vccz Look_110
    s_add_u32 s26, s26, 1
    s_cmp_lt_u32 s26, 262144
    s_cbranch_scc1 Lock_109a
    s_branch Look_110
Lock_111:
    s_mov_b32 s26, 0
    s_add_u32 s27, s21, 1
    s_and_b32 s27, s27, 15
    s_lshl_b32 s27, s27, 12
Lock_111a:
    buffer_load_dwordx4 v[120:123], v214, s[12:15], s27 offen offset:0 sc1
    buffer_load_dwordx4 v[124:127], v214, s[12:15], s27 offen offset:1024 sc1
    buffer_load_dwordx4 v[128:131], v214, s[12:15], s27 offen offset:2048 sc1
    buffer_load_dwordx4 v[132:135], v214, s[12:15], s27 offen offset:3072 sc1
    s_waitcnt vmcnt(0)
    v_bitop3_b32 v216, v120, v124, s22 bitop3:0x7e
    v_bitop3_b32 v217, v128, v132, s22 bitop3:0x7e
    v_bitop3_b32 v216, v216, v217, 1 bitop3:0xa8
    v_cmp_ne_u32 vcc, 0, v216
    s_nop 0
    s_cbranch_vccz Look_112
    s_add_u32 s26, s26, 1
    s_cmp_lt_u32 s26, 262144
    s_cbranch_scc1 Lock_111a
    s_branch Look_112
Lock_113:
    s_mov_b32 s26, 0
    s_add_u32 s27, s21, 2
    s_and_b32 s27, s27, 15
    s_lshl_b32 s27, s27, 12
Lock_113a:
    buffer_load_dwordx4 v[136:139], v214, s[12:15], s27 offen offset:0 sc1
    buffer_load_dwordx4 v[140:143], v214, s[12:15], s27 offen offset:1024 sc1
    buffer_load_dwordx4 v[144:147], v214, s[12:15], s27 offen offset:2048 sc1
    buffer_load_dwordx4 v[148:151], v214, s[12:15], s27 offen offset:3072 sc1
    s_waitcnt vmcnt(0)
    v_bitop3_b32 v216, v136, v140, s22 bitop3:0x7e
    v_bitop3_b32 v217, v144, v148, s22 bitop3:0x7e
    v_bitop3_b32 v216, v216, v217, 1 bitop3:0xa8
    v_cmp_ne_u32 vcc, 0, v216
    s_nop 0
    s_cbranch_vccz Look_114
    s_add_u32 s26, s26, 1
    s_cmp_lt_u32 s26, 262144
    s_cbranch_scc1 Lock_113a
    s_branch Look_114
Lock_115:
    s_mov_b32 s26, 0
    s_add_u32 s27, s21, 3
    s_and_b32 s27, s27, 15
    s_lshl_b32 s27, s27, 12
Lock_115a:
    buffer_load_dwordx4 v[152:155], v214, s[12:15], s27 offen offset:0 sc1
    buffer_load_dwordx4 v[156:159], v214, s[12:15], s27 offen offset:1024 sc1
    buffer_load_dwordx4 v[160:163], v214, s[12:15], s27 offen offset:2048 sc1
    buffer_load_dwordx4 v[164:167], v214, s[12:15], s27 offen offset:3072 sc1
    s_waitcnt vmcnt(0)
    v_bitop3_b32 v216, v152, v156, s22 bitop3:0x7e
    v_bitop3_b32 v217, v160, v164, s22 bitop3:0x7e
    v_bitop3_b32 v216, v216, v217, 1 bitop3:0xa8
    v_cmp_ne_u32 vcc, 0, v216
    s_nop 0
    s_cbranch_vccz Look_116
    s_add_u32 s26, s26, 1
    s_cmp_lt_u32 s26, 262144
    s_cbranch_scc1 Lock_115a
    s_branch Look_116
Lock_117:
    s_mov_b32 s26, 0
    s_add_u32 s27, s21, 4
    s_and_b32 s27, s27, 15
    s_lshl_b32 s27, s27, 12
Lock_117a:
    buffer_load_dwordx4 v[168:171], v214, s[12:15], s27 offen offset:0 sc1
    buffer_load_dwordx4 v[172:175], v214, s[12:15], s27 offen offset:1024 sc1
    buffer_load_dwordx4 v[176:179], v214, s[12:15], s27 offen offset:2048 sc1
    buffer_load_dwordx4 v[180:183], v214, s[12:15], s27 offen offset:3072 sc1
    s_waitcnt vmcnt(0)
    v_bitop3_b32 v216, v168, v172, s22 bitop3:0x7e
    v_bitop3_b32 v217, v176, v180, s22 bitop3:0x7e
    v_bitop3_b32 v216, v216, v217, 1 bitop3:0xa8
    v_cmp_ne_u32 vcc, 0, v216
    s_nop 0
    s_cbranch_vccz Look_118
    s_add_u32 s26, s26, 1
    s_cmp_lt_u32 s26, 262144
    s_cbranch_scc1 Lock_117a
    s_branch Look_118
Lock_119:
    s_mov_b32 s26, 0
    s_add_u32 s27, s21, 5
    s_and_b32 s27, s27, 15
    s_lshl_b32 s27, s27, 12
Lock_119a:
    buffer_load_dwordx4 v[104:107], v214, s[12:15], s27 offen offset:0 sc1
    buffer_load_dwordx4 v[108:111], v214, s[12:15], s27 offen offset:1024 sc1
    buffer_load_dwordx4 v[112:115], v214, s[12:15], s27 offen offset:2048 sc1
    buffer_load_dwordx4 v[116:119], v214, s[12:15], s27 offen offset:3072 sc1
    s_waitcnt vmcnt(0)
    v_bitop3_b32 v216, v104, v108, s22 bitop3:0x7e
    v_bitop3_b32 v217, v112, v116, s22 bitop3:0x7e
    v_bitop3_b32 v216, v216, v217, 1 bitop3:0xa8
    v_cmp_ne_u32 vcc, 0, v216
    s_nop 0
    s_cbranch_vccz Look_120
    s_add_u32 s26, s26, 1
    s_cmp_lt_u32 s26, 262144
    s_cbranch_scc1 Lock_119a
    s_branch Look_120
Lock_121:
    s_mov_b32 s26, 0
    s_add_u32 s27, s21, 6
    s_and_b32 s27, s27, 15
    s_lshl_b32 s27, s27, 12
Lock_121a:
    buffer_load_dwordx4 v[120:123], v214, s[12:15], s27 offen offset:0 sc1
    buffer_load_dwordx4 v[124:127], v214, s[12:15], s27 offen offset:1024 sc1
    buffer_load_dwordx4 v[128:131], v214, s[12:15], s27 offen offset:2048 sc1
    buffer_load_dwordx4 v[132:135], v214, s[12:15], s27 offen offset:3072 sc1
    s_waitcnt vmcnt(0)
    v_bitop3_b32 v216, v120, v124, s22 bitop3:0x7e
    v_bitop3_b32 v217, v128, v132, s22 bitop3:0x7e
    v_bitop3_b32 v216, v216, v217, 1 bitop3:0xa8
    v_cmp_ne_u32 vcc, 0, v216
    s_nop 0
    s_cbranch_vccz Look_122
    s_add_u32 s26, s26, 1
    s_cmp_lt_u32 s26, 262144
    s_cbranch_scc1 Lock_121a
    s_branch Look_122
Lock_123:
    s_mov_b32 s26, 0
    s_add_u32 s27, s21, 7
    s_and_b32 s27, s27, 15
    s_lshl_b32 s27, s27, 12
Lock_123a:
    buffer_load_dwordx4 v[136:139], v214, s[12:15], s27 offen offset:0 sc1
    buffer_load_dwordx4 v[140:143], v214, s[12:15], s27 offen offset:1024 sc1
    buffer_load_dwordx4 v[144:147], v214, s[12:15], s27 offen offset:2048 sc1
    buffer_load_dwordx4 v[148:151], v214, s[12:15], s27 offen offset:3072 sc1
    s_waitcnt vmcnt(0)
    v_bitop3_b32 v216, v136, v140, s22 bitop3:0x7e
    v_bitop3_b32 v217, v144, v148, s22 bitop3:0x7e
    v_bitop3_b32 v216, v216, v217, 1 bitop3:0xa8
    v_cmp_ne_u32 vcc, 0, v216
    s_nop 0
    s_cbranch_vccz Look_124
    s_add_u32 s26, s26, 1
    s_cmp_lt_u32 s26, 262144
    s_cbranch_scc1 Lock_123a
    s_branch Look_124
Lock_125:
    s_mov_b32 s26, 0
    s_add_u32 s27, s21, 8
    s_and_b32 s27, s27, 15
    s_lshl_b32 s27, s27, 12
Lock_125a:
    buffer_load_dwordx4 v[152:155], v214, s[12:15], s27 offen offset:0 sc1
    buffer_load_dwordx4 v[156:159], v214, s[12:15], s27 offen offset:1024 sc1
    buffer_load_dwordx4 v[160:163], v214, s[12:15], s27 offen offset:2048 sc1
    buffer_load_dwordx4 v[164:167], v214, s[12:15], s27 offen offset:3072 sc1
    s_waitcnt vmcnt(0)
    v_bitop3_b32 v216, v152, v156, s22 bitop3:0x7e
    v_bitop3_b32 v217, v160, v164, s22 bitop3:0x7e
    v_bitop3_b32 v216, v216, v217, 1 bitop3:0xa8
    v_cmp_ne_u32 vcc, 0, v216
    s_nop 0
    s_cbranch_vccz Look_126
    s_add_u32 s26, s26, 1
    s_cmp_lt_u32 s26, 262144
    s_cbranch_scc1 Lock_125a
    s_branch Look_126
Lock_127:
    s_mov_b32 s26, 0
    s_add_u32 s27, s21, 9
    s_and_b32 s27, s27, 15
    s_lshl_b32 s27, s27, 12
Lock_127a:
    buffer_load_dwordx4 v[168:171], v214, s[12:15], s27 offen offset:0 sc1
    buffer_load_dwordx4 v[172:175], v214, s[12:15], s27 offen offset:1024 sc1
    buffer_load_dwordx4 v[176:179], v214, s[12:15], s27 offen offset:2048 sc1
    buffer_load_dwordx4 v[180:183], v214, s[12:15], s27 offen offset:3072 sc1
    s_waitcnt vmcnt(0)
    v_bitop3_b32 v216, v168, v172, s22 bitop3:0x7e
    v_bitop3_b32 v217, v176, v180, s22 bitop3:0x7e
    v_bitop3_b32 v216, v216, v217, 1 bitop3:0xa8
    v_cmp_ne_u32 vcc, 0, v216
    s_nop 0
    s_cbranch_vccz Look_128
    s_add_u32 s26, s26, 1
    s_cmp_lt_u32 s26, 262144
    s_cbranch_scc1 Lock_127a
    s_branch Look_128
Lock_129:
    s_mov_b32 s26, 0
    s_add_u32 s27, s21, 10
    s_and_b32 s27, s27, 15
    s_lshl_b32 s27, s27, 12
Lock_129a:
    buffer_load_dwordx4 v[104:107], v214, s[12:15], s27 offen offset:0 sc1
    buffer_load_dwordx4 v[108:111], v214, s[12:15], s27 offen offset:1024 sc1
    buffer_load_dwordx4 v[112:115], v214, s[12:15], s27 offen offset:2048 sc1
    buffer_load_dwordx4 v[116:119], v214, s[12:15], s27 offen offset:3072 sc1
    s_waitcnt vmcnt(0)
    v_bitop3_b32 v216, v104, v108, s22 bitop3:0x7e
    v_bitop3_b32 v217, v112, v116, s22 bitop3:0x7e
    v_bitop3_b32 v216, v216, v217, 1 bitop3:0xa8
    v_cmp_ne_u32 vcc, 0, v216
    s_nop 0
    s_cbranch_vccz Look_130
    s_add_u32 s26, s26, 1
    s_cmp_lt_u32 s26, 262144
    s_cbranch_scc1 Lock_129a
    s_branch Look_130
Lock_131:
    s_mov_b32 s26, 0
    s_add_u32 s27, s21, 11
    s_and_b32 s27, s27, 15
    s_lshl_b32 s27, s27, 12
Lock_131a:
    buffer_load_dwordx4 v[120:123], v214, s[12:15], s27 offen offset:0 sc1
    buffer_load_dwordx4 v[124:127], v214, s[12:15], s27 offen offset:1024 sc1
    buffer_load_dwordx4 v[128:131], v214, s[12:15], s27 offen offset:2048 sc1
    buffer_load_dwordx4 v[132:135], v214, s[12:15], s27 offen offset:3072 sc1
    s_waitcnt vmcnt(0)
    v_bitop3_b32 v216, v120, v124, s22 bitop3:0x7e
    v_bitop3_b32 v217, v128, v132, s22 bitop3:0x7e
    v_bitop3_b32 v216, v216, v217, 1 bitop3:0xa8
    v_cmp_ne_u32 vcc, 0, v216
    s_nop 0
    s_cbranch_vccz Look_132
    s_add_u32 s26, s26, 1
    s_cmp_lt_u32 s26, 262144
    s_cbranch_scc1 Lock_131a
    s_branch Look_132
Lock_133:
    s_mov_b32 s26, 0
    s_add_u32 s27, s21, 12
    s_and_b32 s27, s27, 15
    s_lshl_b32 s27, s27, 12
Lock_133a:
    buffer_load_dwordx4 v[136:139], v214, s[12:15], s27 offen offset:0 sc1
    buffer_load_dwordx4 v[140:143], v214, s[12:15], s27 offen offset:1024 sc1
    buffer_load_dwordx4 v[144:147], v214, s[12:15], s27 offen offset:2048 sc1
    buffer_load_dwordx4 v[148:151], v214, s[12:15], s27 offen offset:3072 sc1
    s_waitcnt vmcnt(0)
    v_bitop3_b32 v216, v136, v140, s22 bitop3:0x7e
    v_bitop3_b32 v217, v144, v148, s22 bitop3:0x7e
    v_bitop3_b32 v216, v216, v217, 1 bitop3:0xa8
    v_cmp_ne_u32 vcc, 0, v216
    s_nop 0
    s_cbranch_vccz Look_134
    s_add_u32 s26, s26, 1
    s_cmp_lt_u32 s26, 262144
    s_cbranch_scc1 Lock_133a
    s_branch Look_134
Lock_135:
    s_mov_b32 s26, 0
    s_add_u32 s27, s21, 13
    s_and_b32 s27, s27, 15
    s_lshl_b32 s27, s27, 12
Lock_135a:
    buffer_load_dwordx4 v[152:155], v214, s[12:15], s27 offen offset:0 sc1
    buffer_load_dwordx4 v[156:159], v214, s[12:15], s27 offen offset:1024 sc1
    buffer_load_dwordx4 v[160:163], v214, s[12:15], s27 offen offset:2048 sc1
    buffer_load_dwordx4 v[164:167], v214, s[12:15], s27 offen offset:3072 sc1
    s_waitcnt vmcnt(0)
    v_bitop3_b32 v216, v152, v156, s22 bitop3:0x7e
    v_bitop3_b32 v217, v160, v164, s22 bitop3:0x7e
    v_bitop3_b32 v216, v216, v217, 1 bitop3:0xa8
    v_cmp_ne_u32 vcc, 0, v216
    s_nop 0
    s_cbranch_vccz Look_136
    s_add_u32 s26, s26, 1
    s_cmp_lt_u32 s26, 262144
    s_cbranch_scc1 Lock_135a
    s_branch Look_136
Lock_137:
    s_mov_b32 s26, 0
    s_add_u32 s27, s21, 14
    s_and_b32 s27, s27, 15
    s_lshl_b32 s27, s27, 12
Lock_137a:
    buffer_load_dwordx4 v[168:171], v214, s[12:15], s27 offen offset:0 sc1
    buffer_load_dwordx4 v[172:175], v214, s[12:15], s27 offen offset:1024 sc1
    buffer_load_dwordx4 v[176:179], v214, s[12:15], s27 offen offset:2048 sc1
    buffer_load_dwordx4 v[180:183], v214, s[12:15], s27 offen offset:3072 sc1
    s_waitcnt vmcnt(0)
    v_bitop3_b32 v216, v168, v172, s22 bitop3:0x7e
    v_bitop3_b32 v217, v176, v180, s22 bitop3:0x7e
    v_bitop3_b32 v216, v216, v217, 1 bitop3:0xa8
    v_cmp_ne_u32 vcc, 0, v216
    s_nop 0
    s_cbranch_vccz Look_138
    s_add_u32 s26, s26, 1
    s_cmp_lt_u32 s26, 262144
    s_cbranch_scc1 Lock_137a
    s_branch Look_138
Lock_139:
    s_mov_b32 s26, 0
    s_add_u32 s27, s21, 15
    s_and_b32 s27, s27, 15
    s_lshl_b32 s27, s27, 12
Lock_139a:
    buffer_load_dwordx4 v[104:107], v214, s[12:15], s27 offen offset:0 sc1
    buffer_load_dwordx4 v[108:111], v214, s[12:15], s27 offen offset:1024 sc1
    buffer_load_dwordx4 v[112:115], v214, s[12:15], s27 offen offset:2048 sc1
    buffer_load_dwordx4 v[116:119], v214, s[12:15], s27 offen offset:3072 sc1
    s_waitcnt vmcnt(0)
    v_bitop3_b32 v216, v104, v108, s22 bitop3:0x7e
    v_bitop3_b32 v217, v112, v116, s22 bitop3:0x7e
    v_bitop3_b32 v216, v216, v217, 1 bitop3:0xa8
    v_cmp_ne_u32 vcc, 0, v216
    s_nop 0
    s_cbranch_vccz Look_140
    s_add_u32 s26, s26, 1
    s_cmp_lt_u32 s26, 262144
    s_cbranch_scc1 Lock_139a
    s_branch Look_140
Lslow_141:
    v_add_u32 v241, 0x10000, v24
    v_cvt_pk_bf16_f32 v8, v24, v25
    v_cvt_pk_bf16_f32 v9, v26, v27
    v_and_b32_sdwa v8, v241, -2 dst_sel:WORD_0 dst_unused:UNUSED_PRESERVE src0_sel:WORD_1 src1_sel:DWORD
    v_cvt_pk_bf16_f32 v10, v28, v29
    v_cvt_pk_bf16_f32 v11, v30, v31
    buffer_store_dwordx4 v[8:11], v0, s[16:19], s71 offen offset:0 sc1
    ds_write_b128 v240, v[8:11] offset:0
    v_add_u32 v241, 0x10000, v40
    v_cvt_pk_bf16_f32 v16, v40, v41
    v_cvt_pk_bf16_f32 v17, v42, v43
    v_and_b32_sdwa v16, v241, -2 dst_sel:WORD_0 dst_unused:UNUSED_PRESERVE src0_sel:WORD_1 src1_sel:DWORD
    v_cvt_pk_bf16_f32 v18, v44, v45
    v_cvt_pk_bf16_f32 v19, v46, v47
    buffer_store_dwordx4 v[16:19], v0, s[16:19], s71 offen offset:2048 sc1
    ds_write_b128 v240, v[16:19] offset:2048
    v_add_u32 v241, 0x10000, v32
    v_cvt_pk_bf16_f32 v12, v32, v33
    v_cvt_pk_bf16_f32 v13, v34, v35
    v_and_b32_sdwa v12, v241, -2 dst_sel:WORD_0 dst_unused:UNUSED_PRESERVE src0_sel:WORD_1 src1_sel:DWORD
    v_cvt_pk_bf16_f32 v14, v36, v37
    v_cvt_pk_bf16_f32 v15, v38, v39
    buffer_store_dwordx4 v[12:15], v0, s[16:19], s71 offen offset:1024 sc1
    ds_write_b128 v240, v[12:15] offset:1024
    v_add_u32 v241, 0x10000, v48
    v_cvt_pk_bf16_f32 v20, v48, v49
    v_cvt_pk_bf16_f32 v21, v50, v51
    v_and_b32_sdwa v20, v241, -2 dst_sel:WORD_0 dst_unused:UNUSED_PRESERVE src0_sel:WORD_1 src1_sel:DWORD
    v_cvt_pk_bf16_f32 v22, v52, v53
    v_cvt_pk_bf16_f32 v23, v54, v55
    buffer_store_dwordx4 v[20:23], v0, s[16:19], s71 offen offset:3072 sc1
    ds_write_b128 v240, v[20:23] offset:3072
    s_branch Lback_142
Lslow_143:
    v_cvt_pk_bf16_f32 v8, v24, v25
    v_cvt_pk_bf16_f32 v9, v26, v27
    v_or_b32_sdwa v8, v24, 1 dst_sel:WORD_0 dst_unused:UNUSED_PRESERVE src0_sel:WORD_1 src1_sel:DWORD
    v_cvt_pk_bf16_f32 v10, v28, v29
    v_cvt_pk_bf16_f32 v11, v30, v31
    buffer_store_dwordx4 v[8:11], v0, s[16:19], s71 offen offset:0 sc1
    ds_write_b128 v240, v[8:11] offset:0
    v_cvt_pk_bf16_f32 v16, v40, v41
    v_cvt_pk_bf16_f32 v17, v42, v43
    v_or_b32_sdwa v16, v40, 1 dst_sel:WORD_0 dst_unused:UNUSED_PRESERVE src0_sel:WORD_1 src1_sel:DWORD
    v_cvt_pk_bf16_f32 v18, v44, v45
    v_cvt_pk_bf16_f32 v19, v46, v47
    buffer_store_dwordx4 v[16:19], v0, s[16:19], s71 offen offset:2048 sc1
    ds_write_b128 v240, v[16:19] offset:2048
    v_cvt_pk_bf16_f32 v12, v32, v33
    v_cvt_pk_bf16_f32 v13, v34, v35
    v_or_b32_sdwa v12, v32, 1 dst_sel:WORD_0 dst_unused:UNUSED_PRESERVE src0_sel:WORD_1 src1_sel:DWORD
    v_cvt_pk_bf16_f32 v14, v36, v37
    v_cvt_pk_bf16_f32 v15, v38, v39
    buffer_store_dwordx4 v[12:15], v0, s[16:19], s71 offen offset:1024 sc1
    ds_write_b128 v240, v[12:15] offset:1024
    v_cvt_pk_bf16_f32 v20, v48, v49
    v_cvt_pk_bf16_f32 v21, v50, v51
    v_or_b32_sdwa v20, v48, 1 dst_sel:WORD_0 dst_unused:UNUSED_PRESERVE src0_sel:WORD_1 src1_sel:DWORD
    v_cvt_pk_bf16_f32 v22, v52, v53
    v_cvt_pk_bf16_f32 v23, v54, v55
    buffer_store_dwordx4 v[20:23], v0, s[16:19], s71 offen offset:3072 sc1
    ds_write_b128 v240, v[20:23] offset:3072
    s_branch Lback_144
L_end:
    s_endpgm

.section .rodata,"a"
.p2align 6
.amdhsa_kernel interleave_layers__sliding_block__sliding_local_dilated__prompt_kernel
  .amdhsa_next_free_vgpr 256
  .amdhsa_next_free_sgpr 100
  .amdhsa_accum_offset 256
  .amdhsa_group_segment_fixed_size 0
  .amdhsa_kernarg_size 72
  .amdhsa_user_sgpr_count 2
  .amdhsa_user_sgpr_kernarg_segment_ptr 1
  .amdhsa_system_sgpr_workgroup_id_x 1
.end_amdhsa_kernel
```

```asm
; @launch grid=(256,1,1) block=(512,1,1) lds=163840
.amdgcn_target "amdgcn-amd-amdhsa--gfx950"
.text
.globl interleave_layers__sliding_block__sliding_local_dilated__prompt_kernel
.p2align 8
.type interleave_layers__sliding_block__sliding_local_dilated__prompt_kernel,@function
interleave_layers__sliding_block__sliding_local_dilated__prompt_kernel:
    s_cmp_ge_u32 s2, 256
    s_cbranch_scc1 L_end
    s_load_dwordx16 s[48:63], s[0:1], 0
    s_load_dwordx2 s[64:65], s[0:1], 64
    v_lshrrev_b32 v1, 6, v0
    s_nop 0
    v_readfirstlane_b32 s3, v1
    v_and_b32 v1, 63, v0
    v_lshlrev_b32 v0, 4, v1
    s_cmp_eq_u32 s3, 3
    s_cbranch_scc0 Lw_1
    s_getpc_b64 s[40:41]
L_pc:
    s_lshr_b32 s27, s2, 3
    s_mul_i32 s27, s27, 1920
    v_lshlrev_b32 v28, 7, v1
    v_add_u32 v28, s27, v28
    s_mov_b32 s27, L_end - L_pc
    v_min_u32 v28, s27, v28
    v_mov_b32 v29, s41
    v_add_co_u32 v28, vcc, s40, v28
    s_nop 1
    v_addc_co_u32 v29, vcc, 0, v29, vcc
    s_mov_b64 exec, 32767
    global_load_dword v255, v[28:29], off
    s_mov_b64 exec, -1
Lw_1:
    s_and_b32 s27, s2, 7
    s_lshr_b32 s28, s2, 3
    s_lshl_b32 s20, s27, 1
    s_and_b32 s27, s28, 1
    s_add_u32 s20, s20, s27
    s_lshr_b32 s21, s28, 1
    s_and_b32 s75, s3, 3
    v_lshrrev_b32 v16, 4, v1
    v_lshlrev_b32 v16, 1, v16
    v_and_b32 v17, 7, v1
    v_xor_b32 v16, v16, v17
    v_lshlrev_b32 v173, 4, v16
    s_cmp_lt_u32 s3, 4
    s_cbranch_scc1 L_cstart
    s_lshl_b32 s78, s75, 12
    s_mul_i32 s79, s75, 6144
    v_lshrrev_b32 v12, 3, v1
    v_lshrrev_b32 v13, 5, v1
    v_lshl_add_u32 v12, v13, 2, v12
    s_lshr_b32 s27, s75, 1
    s_lshl_b32 s27, s27, 3
    s_and_b32 s28, s75, 1
    s_add_u32 s27, s27, s28
    s_mul_i32 s27, s27, 24576
    v_mul_u32_u24 v12, 6144, v12
    s_lshl_b32 s28, s21, 7
    s_add_u32 s27, s27, s28
    v_add3_u32 v12, v12, v173, s27
    v_add_u32 v13, 1024, v12
    v_add_u32 v14, 2048, v12
    v_add_u32 v15, 98304, v12
    v_add_u32 v16, 99328, v12
    v_add_u32 v17, 100352, v12
    s_lshl_b32 s27, s20, 2
    s_add_u32 s27, s27, s75
    s_lshl_b32 s27, s27, 16
    v_lshrrev_b32 v9, 4, v1
    v_and_b32 v10, 7, v1
    v_xor_b32 v9, v9, v10
    v_lshlrev_b32 v9, 4, v9
    v_lshrrev_b32 v10, 3, v1
    v_lshlrev_b32 v10, 11, v10
    v_add3_u32 v8, v9, v10, s27
    v_xor_b32 v9, 64, v8
    v_add_u32 v10, 30720, v8
    v_add_u32 v11, 46080, v9
    v_add_u32 v9, 15360, v9
    s_waitcnt lgkmcnt(0)
    s_mov_b32 s88, s48
    s_mov_b32 s89, s49
    s_mov_b32 s90, 4194304
    s_mov_b32 s91, 0x00020000
    s_mov_b32 s4, s50
    s_mov_b32 s5, s51
    s_mov_b32 s6, 6291456
    s_mov_b32 s7, 0x00020000
    s_andn2_b32 s55, s20, 1
    s_and_b32 s54, s20, 1
    s_lshr_b32 s27, s2, 3
    s_mul_i32 s27, s27, 12
    s_mul_i32 s28, s75, 3
    s_add_u32 s27, s27, s28
    v_mul_u32_u24 v19, 21846, v1
    v_lshrrev_b32 v19, 16, v19
    v_mul_u32_u24 v28, 3, v19
    v_sub_u32 v28, v1, v28
    v_add_u32 v28, s27, v28
    s_lshr_b32 s30, s4, 7
    s_sub_u32 s30, 3, s30
    s_and_b32 s30, s30, 7
    s_lshl_b32 s30, s30, 7
    v_and_b32 v18, 1, v28
    v_lshlrev_b32 v18, 10, v18
    v_lshrrev_b32 v28, 1, v28
    v_lshlrev_b32 v28, 11, v28
    v_add3_u32 v18, v18, v28, s30
    s_and_b32 s27, s20, 14
    v_add_u32 v19, s27, v19
    v_add_u32 v28, 0, v19
    v_and_b32 v28, 15, v28
    s_mov_b32 s27, 393216
    v_mad_u32_u24 v28, v28, s27, v18
    s_mov_b64 exec, 32767
    buffer_load_dword v255, v28, s[4:7], 0 offen
    s_mov_b64 exec, -1
    s_add_u32 s76, s55, 0
    s_and_b32 s76, s76, 15
    s_mul_i32 s77, s76, 393216
    s_lshl_b32 s76, s76, 7
    s_add_u32 m0, s79, 139264
    s_nop 0
    buffer_load_dwordx4 v12, s[4:7], s77 offen offset:0 lds
    buffer_load_dwordx4 v13, s[4:7], s77 offen offset:1024 lds
    buffer_load_dwordx4 v14, s[4:7], s77 offen offset:2048 lds
    s_add_u32 m0, s79, 142336
    s_nop 0
    buffer_load_dwordx4 v15, s[4:7], s77 offen offset:0 lds
    buffer_load_dwordx4 v16, s[4:7], s77 offen offset:1024 lds
    buffer_load_dwordx4 v17, s[4:7], s77 offen offset:2048 lds
    s_add_u32 m0, s78, 49152
    s_nop 0
    buffer_load_dwordx4 v8, s[88:91], s76 offen offset:0 sc1 lds
    buffer_load_dwordx4 v9, s[88:91], s76 offen offset:1024 sc1 lds
    buffer_load_dwordx4 v10, s[88:91], s76 offen offset:2048 sc1 lds
    buffer_load_dwordx4 v11, s[88:91], s76 offen offset:3072 sc1 lds
    s_andn2_b32 s84, 2, s75
    s_mov_b32 s12, s64
    s_mov_b32 s13, s65
    s_mov_b32 s14, 167772160
    s_mov_b32 s15, 0x00020000
    v_mov_b32 v28, 843776
    buffer_load_dwordx2 v[26:27], v28, s[12:15], 0 offen sc1
    s_mov_b32 s8, s52
    s_mov_b32 s9, s53
    s_mov_b32 s10, 2097152
    s_mov_b32 s11, 0x00020000
    s_mov_b32 s22, 0
    s_mov_b32 s23, 0
    v_mov_b32 v6, 0
    v_bfe_u32 v28, v1, 2, 3
    v_bfe_u32 v29, v1, 3, 2
    v_and_b32 v30, 3, v1
    v_lshlrev_b32 v28, 7, v28
    v_lshlrev_b32 v29, 5, v29
    v_lshlrev_b32 v30, 3, v30
    v_add3_u32 v2, v28, v29, v30
    v_and_b32 v28, 15, v1
    v_lshrrev_b32 v29, 4, v1
    v_lshlrev_b32 v29, 2, v29
    v_sub_u32 v4, v28, v29
    s_lshl_b32 s85, s75, 10
    s_lshl_b32 s86, s21, 17
    s_lshl_b32 s27, s75, 14
    s_lshl_b32 s28, s21, 7
    s_add_u32 s27, s27, s28
    v_lshrrev_b32 v3, 3, v1
    v_lshlrev_b32 v3, 11, v3
    v_add3_u32 v3, v3, v173, s27
    s_lshl_b32 s27, s20, 18
    s_lshl_b32 s28, s21, 12
    s_add_u32 s27, s27, s28
    s_lshl_b32 s28, s75, 16
    s_add_u32 s71, s27, s28
    s_lshl_b32 s28, s84, 16
    s_add_u32 s27, s27, s28
    s_and_b32 s28, s75, 1
    s_lshl_b32 s29, s28, 11
    s_add_u32 s27, s27, s29
    s_add_u32 s72, s27, 2097152
    s_lshl_b32 s33, s28, 12
    s_sub_u32 s29, 0, s64
    s_and_b32 s29, s29, 0x3ff00
    s_add_u32 s29, s29, 83886080
    s_sub_u32 s27, s20, 0
    s_lshl_b32 s73, s27, 4
    s_add_u32 s73, s73, s21
    s_lshl_b32 s73, s73, 18
    s_add_u32 s73, s73, s29
    s_sub_u32 s27, s20, 1
    s_lshl_b32 s87, s27, 4
    s_add_u32 s87, s87, s21
    s_lshl_b32 s87, s87, 18
    s_add_u32 s87, s87, s29
    s_cmp_lt_u32 s20, 1
    s_cselect_b32 s87, 1073741824, s87
    s_sub_u32 s27, s20, 2
    s_lshl_b32 s34, s27, 4
    s_add_u32 s34, s34, s21
    s_lshl_b32 s34, s34, 18
    s_add_u32 s34, s34, s29
    s_cmp_lt_u32 s20, 2
    s_cselect_b32 s34, 1073741824, s34
    v_mov_b32 v176, -1
    v_mov_b32 v177, -1
    v_mov_b32 v178, -1
    v_mov_b32 v179, -1
    v_subrev_u32 v222, 0, v4
    v_ashrrev_i32 v222, 31, v222
    v_and_b32 v222, 4048155338, v222
    v_subrev_u32 v223, 1, v4
    v_ashrrev_i32 v223, 31, v223
    v_and_b32 v223, 4048155338, v223
    v_subrev_u32 v224, 2, v4
    v_ashrrev_i32 v224, 31, v224
    v_and_b32 v224, 4048155338, v224
    v_subrev_u32 v225, 3, v4
    v_ashrrev_i32 v225, 31, v225
    v_and_b32 v225, 4048155338, v225
    s_mov_b32 s16, s60
    s_mov_b32 s17, s61
    s_mov_b32 s18, 4194304
    s_mov_b32 s19, 0x00020000
    s_lshr_b32 s27, s71, 16
    s_lshl_b32 s27, s27, 7
    s_add_u32 s27, s27, 786432
    v_and_b32 v28, 15, v1
    v_lshl_add_u32 v168, v28, 3, s27
    s_add_u32 s27, s78, 49152
    v_add_u32 v169, s27, v0
    s_lshl_b32 s27, s75, 7
    s_add_u32 s27, s27, 131072
    v_lshrrev_b32 v29, 5, v1
    v_lshl_add_u32 v29, v29, 4, v28
    v_lshl_add_u32 v170, v29, 2, s27
    s_min_u32 s27, s75, 2
    s_lshl_b32 s27, s27, 8
    s_add_u32 s27, s27, 132096
    v_lshrrev_b32 v29, 4, v1
    v_lshl_add_u32 v29, v28, 2, v29
    v_lshl_add_u32 v171, v29, 2, s27
    s_add_u32 s76, s55, 1
    s_and_b32 s76, s76, 15
    s_mul_i32 s77, s76, 393216
    s_lshl_b32 s76, s76, 7
    s_add_u32 m0, s79, 0
    s_nop 0
    buffer_load_dwordx4 v12, s[4:7], s77 offen offset:0 lds
    buffer_load_dwordx4 v13, s[4:7], s77 offen offset:1024 lds
    buffer_load_dwordx4 v14, s[4:7], s77 offen offset:2048 lds
    s_add_u32 m0, s79, 3072
    s_nop 0
    buffer_load_dwordx4 v15, s[4:7], s77 offen offset:0 lds
    buffer_load_dwordx4 v16, s[4:7], s77 offen offset:1024 lds
    buffer_load_dwordx4 v17, s[4:7], s77 offen offset:2048 lds
    s_waitcnt vmcnt(6)
    v_readfirstlane_b32 s24, v26
    v_readfirstlane_b32 s25, v27
    s_add_u32 s24, s24, 1
    s_add_u32 s25, s25, 32
    s_and_b32 s25, s25, 0xffffffe0
    s_getreg_b32 s27, hwreg(HW_REG_XCC_ID, 0, 4)
    s_or_b32 s25, s25, s27
    s_barrier
    s_add_u32 m0, s78, 65536
    s_nop 0
    buffer_load_dwordx4 v8, s[88:91], s76 offen offset:0 sc1 lds
    buffer_load_dwordx4 v9, s[88:91], s76 offen offset:1024 sc1 lds
    buffer_load_dwordx4 v10, s[88:91], s76 offen offset:2048 sc1 lds
    buffer_load_dwordx4 v11, s[88:91], s76 offen offset:3072 sc1 lds
    s_add_u32 s76, s55, 2
    s_and_b32 s76, s76, 15
    s_mul_i32 s77, s76, 393216
    s_lshl_b32 s76, s76, 7
    s_add_u32 m0, s79, 24576
    s_nop 0
    buffer_load_dwordx4 v12, s[4:7], s77 offen offset:0 lds
    buffer_load_dwordx4 v13, s[4:7], s77 offen offset:1024 lds
    buffer_load_dwordx4 v14, s[4:7], s77 offen offset:2048 lds
    s_add_u32 m0, s79, 27648
    s_nop 0
    buffer_load_dwordx4 v15, s[4:7], s77 offen offset:0 lds
    buffer_load_dwordx4 v16, s[4:7], s77 offen offset:1024 lds
    buffer_load_dwordx4 v17, s[4:7], s77 offen offset:2048 lds
    s_add_u32 s76, s55, 2
    s_and_b32 s76, s76, 15
    s_lshl_b32 s76, s76, 7
    s_add_u32 m0, s78, 81920
    s_nop 0
    buffer_load_dwordx4 v8, s[88:91], s76 offen offset:0 sc1 lds
    v_mov_b32 v22, 132896
    ds_read_b128 v[72:75], v22
    ds_read_b128 v[76:79], v22 offset:16
    v_add_u32 v45, 5, v19
    v_and_b32 v45, 15, v45
    s_mov_b32 s27, 393216
    v_mad_u32_u24 v45, v45, s27, v18
    buffer_load_dwordx4 v9, s[88:91], s76 offen offset:1024 sc1 lds
    s_mov_b64 exec, 4095
    buffer_load_dword v255, v45, s[4:7], 0 offen
    s_mov_b64 exec, -1
    buffer_load_dwordx4 v10, s[88:91], s76 offen offset:2048 sc1 lds
    s_cmp_eq_u32 s54, 0
    s_cbranch_scc0 Lw_2
    v_lshrrev_b32 v116, 5, v1
    v_mul_u32_u24 v116, 3072, v116
    s_add_u32 s27, s79, 139264
    v_add3_u32 v116, v116, v2, s27
    v_xor_b32 v117, 32, v116
    v_xor_b32 v118, 64, v116
    v_xor_b32 v119, 96, v116
    ds_read_b64_tr_b16 v[80:81], v116 offset:0
    ds_read_b64_tr_b16 v[82:83], v117 offset:0
    ds_read_b64_tr_b16 v[84:85], v118 offset:0
    ds_read_b64_tr_b16 v[86:87], v119 offset:0
    ds_read_b64_tr_b16 v[88:89], v116 offset:1024
    ds_read_b64_tr_b16 v[90:91], v117 offset:1024
    ds_read_b64_tr_b16 v[92:93], v118 offset:1024
    ds_read_b64_tr_b16 v[94:95], v119 offset:1024
    ds_read_b64_tr_b16 v[96:97], v116 offset:2048
    ds_read_b64_tr_b16 v[98:99], v117 offset:2048
    ds_read_b64_tr_b16 v[100:101], v118 offset:2048
    ds_read_b64_tr_b16 v[102:103], v119 offset:2048
Lw_2:
    buffer_load_dwordx4 v11, s[88:91], s76 offen offset:3072 sc1 lds
    s_waitcnt lgkmcnt(0)
    s_add_u32 s76, s55, 3
    s_and_b32 s76, s76, 15
    s_mul_i32 s77, s76, 393216
    s_lshl_b32 s76, s76, 7
    s_add_u32 m0, s78, 49152
    s_waitcnt vmcnt(11)
    s_barrier
    s_waitcnt vmcnt(5)
    buffer_load_dwordx4 v8, s[88:91], s76 offen offset:0 sc1 lds
    s_lshl_b32 s27, s75, 8
    s_add_u32 s27, s27, 137216
    v_add_u32 v28, s27, v0
    ds_read_b128 v[24:27], v28
    s_waitcnt vmcnt(5)
    buffer_load_dwordx4 v9, s[88:91], s76 offen offset:1024 sc1 lds
    s_waitcnt vmcnt(5)
    buffer_load_dwordx4 v10, s[88:91], s76 offen offset:2048 sc1 lds
    s_waitcnt vmcnt(5)
    buffer_load_dwordx4 v11, s[88:91], s76 offen offset:3072 sc1 lds
    s_add_u32 m0, s79, 139264
    s_waitcnt vmcnt(5)
    buffer_load_dwordx4 v12, s[4:7], s77 offen offset:0 lds
    s_lshr_b32 s27, s71, 4
    s_waitcnt lgkmcnt(0)
    s_mov_b64 exec, 0xffff
    s_cmp_eq_u32 s23, 0
    s_cbranch_scc1 Lslow_3
    buffer_store_dwordx4 v[24:27], v0, s[12:15], s27 offen
Lback_4:
    s_mov_b64 exec, -1
    s_waitcnt vmcnt(5)
    buffer_load_dwordx4 v13, s[4:7], s77 offen offset:1024 lds
    s_waitcnt vmcnt(5)
    buffer_load_dwordx4 v14, s[4:7], s77 offen offset:2048 lds
    s_cmp_eq_u32 s54, 1
    s_cbranch_scc0 Lw_5
    v_lshrrev_b32 v116, 5, v1
    v_mul_u32_u24 v116, 3072, v116
    s_add_u32 s27, s79, 0
    v_add3_u32 v116, v116, v2, s27
    v_xor_b32 v117, 32, v116
    v_xor_b32 v118, 64, v116
    v_xor_b32 v119, 96, v116
    ds_read_b64_tr_b16 v[80:81], v116 offset:0
    ds_read_b64_tr_b16 v[82:83], v117 offset:0
    ds_read_b64_tr_b16 v[84:85], v118 offset:0
    ds_read_b64_tr_b16 v[86:87], v119 offset:0
    ds_read_b64_tr_b16 v[88:89], v116 offset:1024
    ds_read_b64_tr_b16 v[90:91], v117 offset:1024
    ds_read_b64_tr_b16 v[92:93], v118 offset:1024
    ds_read_b64_tr_b16 v[94:95], v119 offset:1024
    ds_read_b64_tr_b16 v[96:97], v116 offset:2048
    ds_read_b64_tr_b16 v[98:99], v117 offset:2048
    ds_read_b64_tr_b16 v[100:101], v118 offset:2048
    ds_read_b64_tr_b16 v[102:103], v119 offset:2048
Lw_5:
    s_add_u32 m0, s79, 142336
    s_waitcnt vmcnt(5)
    buffer_load_dwordx4 v15, s[4:7], s77 offen offset:0 lds
    s_waitcnt vmcnt(5)
    buffer_load_dwordx4 v16, s[4:7], s77 offen offset:1024 lds
    s_waitcnt vmcnt(5)
    buffer_load_dwordx4 v17, s[4:7], s77 offen offset:2048 lds
    s_waitcnt lgkmcnt(0)
    s_add_u32 s76, s55, 4
    s_and_b32 s76, s76, 15
    s_mul_i32 s77, s76, 393216
    s_lshl_b32 s76, s76, 7
    s_add_u32 m0, s78, 65536
    s_waitcnt vmcnt(11)
    s_barrier
    s_waitcnt vmcnt(5)
    buffer_load_dwordx4 v8, s[88:91], s76 offen offset:0 sc1 lds
    v_min3_u32 v72, v72, v73, v74
    v_min3_u32 v76, v76, v77, v78
    v_min_u32 v72, v72, v75
    v_min_u32 v76, v76, v79
    s_waitcnt vmcnt(5)
    buffer_load_dwordx4 v9, s[88:91], s76 offen offset:1024 sc1 lds
    v_sub_u32 v72, v76, v72
    v_lshrrev_b32 v72, 31, v72
    s_waitcnt vmcnt(5)
    buffer_load_dwordx4 v10, s[88:91], s76 offen offset:2048 sc1 lds
    v_lshlrev_b32 v22, 4, v72
    s_waitcnt vmcnt(5)
    buffer_load_dwordx4 v11, s[88:91], s76 offen offset:3072 sc1 lds
    v_bfe_u32 v104, v1, 2, 2
    v_lshlrev_b32 v104, v104, 1
    v_bfe_i32 v120, v104, 0, 1
    v_and_b32 v120, 0x3f803f80, v120
    s_add_u32 m0, s79, 0
    s_waitcnt vmcnt(5)
    buffer_load_dwordx4 v12, s[4:7], s77 offen offset:0 lds
    v_mov_b32 v121, v120
    v_bfe_i32 v122, v104, 1, 1
    v_and_b32 v122, 0x3f803f80, v122
    v_mov_b32 v123, v122
    v_bfe_i32 v124, v104, 2, 1
    v_and_b32 v124, 0x3f803f80, v124
    v_mov_b32 v125, v124
    v_bfe_i32 v126, v104, 3, 1
    s_waitcnt vmcnt(5)
    buffer_load_dwordx4 v13, s[4:7], s77 offen offset:1024 lds
    v_and_b32 v126, 0x3f803f80, v126
    v_mov_b32 v127, v126
    s_waitcnt lgkmcnt(0)
    v_mfma_f32_16x16x32_bf16 v[104:107], v[120:123], v[80:83], 0
    s_waitcnt vmcnt(5)
    buffer_load_dwordx4 v14, s[4:7], s77 offen offset:2048 lds
    v_mfma_f32_16x16x32_bf16 v[108:111], v[120:123], v[88:91], 0
    v_mfma_f32_16x16x32_bf16 v[112:115], v[120:123], v[96:99], 0
    v_mfma_f32_16x16x32_bf16 v[104:107], v[124:127], v[84:87], v[104:107]
    v_mfma_f32_16x16x32_bf16 v[108:111], v[124:127], v[92:95], v[108:111]
    s_add_u32 m0, s79, 3072
    s_waitcnt vmcnt(5)
    buffer_load_dwordx4 v15, s[4:7], s77 offen offset:0 lds
    v_mfma_f32_16x16x32_bf16 v[112:115], v[124:127], v[100:103], v[112:115]
    s_mul_i32 s27, s75, 768
    s_add_u32 s27, s27, 133120
    v_lshl_add_u32 v116, v1, 2, s27
    s_waitcnt vmcnt(5)
    buffer_load_dwordx4 v16, s[4:7], s77 offen offset:1024 lds
    ds_write_b32 v116, v104 offset:0
    ds_write_b32 v116, v108 offset:256
    s_nop 0
    ds_write_b32 v116, v112 offset:512
    s_waitcnt lgkmcnt(0)
    s_waitcnt vmcnt(5)
    buffer_load_dwordx4 v17, s[4:7], s77 offen offset:2048 lds
    s_add_u32 s76, s55, 5
    s_and_b32 s76, s76, 15
    s_mul_i32 s77, s76, 393216
    s_lshl_b32 s76, s76, 7
    s_add_u32 m0, s78, 81920
    s_waitcnt vmcnt(17)
    s_waitcnt vmcnt(10)
    s_barrier
    s_waitcnt vmcnt(5)
    buffer_load_dwordx4 v8, s[88:91], s76 offen offset:0 sc1 lds
    s_add_u32 s27, s71, 2097152
    buffer_store_dwordx4 v[176:179], v0, s[12:15], s27 offen offset:0 sc1
    s_waitcnt vmcnt(5)
    buffer_load_dwordx4 v9, s[88:91], s76 offen offset:1024 sc1 lds
    s_min_u32 s27, s75, 2
    s_lshl_b32 s27, s27, 8
    s_add_u32 s27, s27, 133120
    v_lshl_add_u32 v80, v1, 2, s27
    s_waitcnt vmcnt(5)
    buffer_load_dwordx4 v10, s[88:91], s76 offen offset:2048 sc1 lds
    ds_read_b32 v81, v80 offset:0
    ds_read_b32 v82, v80 offset:768
    ds_read_b32 v83, v80 offset:1536
    ds_read_b32 v84, v80 offset:2304
    s_waitcnt vmcnt(5)
    buffer_load_dwordx4 v11, s[88:91], s76 offen offset:3072 sc1 lds
    s_lshl_b32 s27, s21, 2
    s_add_u32 s27, s27, s75
    s_mul_i32 s27, s27, 4096
    s_add_u32 s27, s27, 262144
    s_add_u32 m0, s79, 24576
    s_waitcnt vmcnt(5)
    buffer_load_dwordx4 v12, s[4:7], s77 offen offset:0 lds
    s_waitcnt vmcnt(5)
    buffer_load_dwordx4 v13, s[4:7], s77 offen offset:1024 lds
    s_lshl_b32 s28, s20, 8
    s_add_u32 s27, s27, s28
    v_lshlrev_b32 v80, 2, v1
    s_waitcnt lgkmcnt(0)
    s_waitcnt vmcnt(5)
    buffer_load_dwordx4 v14, s[4:7], s77 offen offset:2048 lds
    v_add_f32 v81, v81, v82
    s_add_u32 m0, s79, 27648
    s_waitcnt vmcnt(5)
    buffer_load_dwordx4 v15, s[4:7], s77 offen offset:0 lds
    v_add_f32 v83, v83, v84
    v_add_f32 v81, v81, v83
    buffer_store_dword v81, v80, s[12:15], s27 offen sc1
    s_waitcnt vmcnt(5)
    buffer_load_dwordx4 v16, s[4:7], s77 offen offset:1024 lds
    s_waitcnt vmcnt(5)
    buffer_load_dwordx4 v17, s[4:7], s77 offen offset:2048 lds
    s_add_u32 s76, s55, 6
    s_and_b32 s76, s76, 15
    s_mul_i32 s77, s76, 393216
    s_lshl_b32 s76, s76, 7
    s_add_u32 m0, s78, 49152
    s_waitcnt vmcnt(18)
    s_waitcnt vmcnt(12)
    s_barrier
    s_waitcnt vmcnt(5)
    buffer_load_dwordx4 v8, s[88:91], s76 offen offset:0 sc1 lds
    s_add_u32 s27, s71, 2097152
    buffer_store_dwordx4 v[176:179], v0, s[12:15], s27 offen offset:1024 sc1
    s_waitcnt vmcnt(5)
    buffer_load_dwordx4 v9, s[88:91], s76 offen offset:1024 sc1 lds
    s_waitcnt vmcnt(5)
    buffer_load_dwordx4 v10, s[88:91], s76 offen offset:2048 sc1 lds
    s_waitcnt vmcnt(5)
    buffer_load_dwordx4 v11, s[88:91], s76 offen offset:3072 sc1 lds
    v_add_u32 v45, 9, v19
    v_and_b32 v45, 15, v45
    s_mov_b32 s27, 393216
    v_mad_u32_u24 v45, v45, s27, v18
    s_add_u32 m0, s79, 139264
    s_waitcnt vmcnt(5)
    buffer_load_dwordx4 v12, s[4:7], s77 offen offset:0 lds
    s_waitcnt vmcnt(5)
    buffer_load_dwordx4 v13, s[4:7], s77 offen offset:1024 lds
    s_waitcnt vmcnt(5)
    buffer_load_dwordx4 v14, s[4:7], s77 offen offset:2048 lds
    s_mov_b64 exec, 4095
    buffer_load_dword v255, v45, s[4:7], 0 offen
    s_mov_b64 exec, -1
    s_add_u32 m0, s79, 142336
    s_waitcnt vmcnt(5)
    buffer_load_dwordx4 v15, s[4:7], s77 offen offset:0 lds
    s_waitcnt vmcnt(5)
    buffer_load_dwordx4 v16, s[4:7], s77 offen offset:1024 lds
    s_waitcnt vmcnt(5)
    buffer_load_dwordx4 v17, s[4:7], s77 offen offset:2048 lds
    s_add_u32 s76, s55, 7
    s_and_b32 s76, s76, 15
    s_mul_i32 s77, s76, 393216
    s_lshl_b32 s76, s76, 7
    s_add_u32 m0, s78, 65536
    s_waitcnt vmcnt(19)
    s_waitcnt vmcnt(12)
    s_barrier
    s_waitcnt vmcnt(5)
    buffer_load_dwordx4 v8, s[88:91], s76 offen offset:0 sc1 lds
    s_add_u32 s27, s71, 2097152
    buffer_store_dwordx4 v[176:179], v0, s[12:15], s27 offen offset:2048 sc1
    s_waitcnt vmcnt(5)
    buffer_load_dwordx4 v9, s[88:91], s76 offen offset:1024 sc1 lds
    s_waitcnt vmcnt(5)
    buffer_load_dwordx4 v10, s[88:91], s76 offen offset:2048 sc1 lds
    s_waitcnt vmcnt(5)
    buffer_load_dwordx4 v11, s[88:91], s76 offen offset:3072 sc1 lds
    s_lshl_b32 s27, s21, 2
    s_add_u32 s27, s27, s75
    s_mul_i32 s27, s27, 128
    s_add_u32 s27, s27, 819200
    s_add_u32 m0, s79, 0
    s_waitcnt vmcnt(5)
    buffer_load_dwordx4 v12, s[4:7], s77 offen offset:0 lds
    v_and_b32 v172, 15, v1
    v_lshl_add_u32 v172, v172, 3, s27
    s_lshl_b32 s28, s20, 3
    s_add_u32 s27, s27, s28
    s_waitcnt vmcnt(5)
    buffer_load_dwordx4 v13, s[4:7], s77 offen offset:1024 lds
    s_waitcnt vmcnt(5)
    buffer_load_dwordx4 v14, s[4:7], s77 offen offset:2048 lds
    v_mov_b32 v46, s27
    v_mov_b32 v44, s24
    v_mov_b32 v45, s25
    v_or_b32 v45, v45, v22
    s_add_u32 m0, s79, 3072
    s_waitcnt vmcnt(5)
    buffer_load_dwordx4 v15, s[4:7], s77 offen offset:0 lds
    s_mov_b64 exec, 1
    buffer_store_dwordx2 v[44:45], v46, s[12:15], 0 offen offset:0 sc1
    s_mov_b64 exec, -1
    s_waitcnt vmcnt(5)
    buffer_load_dwordx4 v16, s[4:7], s77 offen offset:1024 lds
    s_waitcnt vmcnt(5)
    buffer_load_dwordx4 v17, s[4:7], s77 offen offset:2048 lds
    s_add_u32 s76, s55, 8
    s_and_b32 s76, s76, 15
    s_mul_i32 s77, s76, 393216
    s_lshl_b32 s76, s76, 7
    s_add_u32 m0, s78, 81920
    s_waitcnt vmcnt(19)
    s_waitcnt vmcnt(12)
    s_barrier
    s_waitcnt vmcnt(5)
    buffer_load_dwordx4 v8, s[88:91], s76 offen offset:0 sc1 lds
    s_add_u32 s27, s71, 2097152
    buffer_store_dwordx4 v[176:179], v0, s[12:15], s27 offen offset:3072 sc1
    s_waitcnt vmcnt(5)
    buffer_load_dwordx4 v9, s[88:91], s76 offen offset:1024 sc1 lds
    s_lshl_b32 s27, s2, 2
    s_add_u32 s27, s27, s75
    s_waitcnt vmcnt(5)
    buffer_load_dwordx4 v10, s[88:91], s76 offen offset:2048 sc1 lds
    s_mul_i32 s27, s27, 2048
    s_nop 0
    s_waitcnt vmcnt(5)
    buffer_load_dwordx4 v11, s[88:91], s76 offen offset:3072 sc1 lds
    s_add_u32 s44, s52, s27
    s_addc_u32 s45, s53, 0
    s_add_u32 m0, s79, 24576
    s_waitcnt vmcnt(5)
    buffer_load_dwordx4 v12, s[4:7], s77 offen offset:0 lds
    s_load_dword s46, s[44:45], 0
    s_load_dword s46, s[44:45], 64
    s_waitcnt vmcnt(5)
    buffer_load_dwordx4 v13, s[4:7], s77 offen offset:1024 lds
    s_load_dword s46, s[44:45], 128
    s_load_dword s46, s[44:45], 192
    s_waitcnt vmcnt(5)
    buffer_load_dwordx4 v14, s[4:7], s77 offen offset:2048 lds
    s_load_dword s46, s[44:45], 256
    s_load_dword s46, s[44:45], 320
    s_add_u32 m0, s79, 27648
    s_waitcnt vmcnt(5)
    buffer_load_dwordx4 v15, s[4:7], s77 offen offset:0 lds
    s_load_dword s46, s[44:45], 384
    s_load_dword s46, s[44:45], 448
    s_waitcnt vmcnt(5)
    buffer_load_dwordx4 v16, s[4:7], s77 offen offset:1024 lds
    s_waitcnt vmcnt(5)
    buffer_load_dwordx4 v17, s[4:7], s77 offen offset:2048 lds
    s_add_u32 s76, s55, 9
    s_and_b32 s76, s76, 15
    s_mul_i32 s77, s76, 393216
    s_lshl_b32 s76, s76, 7
    s_add_u32 m0, s78, 49152
    s_waitcnt vmcnt(18)
    s_waitcnt vmcnt(11)
    s_barrier
    buffer_load_dwordx4 v8, s[88:91], s76 offen offset:0 sc1 lds
    s_lshl_b32 s27, s2, 2
    s_add_u32 s27, s27, s75
    buffer_load_dwordx4 v9, s[88:91], s76 offen offset:1024 sc1 lds
    s_mul_i32 s27, s27, 2048
    s_nop 0
    buffer_load_dwordx4 v10, s[88:91], s76 offen offset:2048 sc1 lds
    s_add_u32 s44, s52, s27
    s_addc_u32 s45, s53, 0
    buffer_load_dwordx4 v11, s[88:91], s76 offen offset:3072 sc1 lds
    s_load_dword s46, s[44:45], 512
    s_load_dword s46, s[44:45], 576
    s_add_u32 m0, s79, 139264
    s_nop 0
    buffer_load_dwordx4 v12, s[4:7], s77 offen offset:0 lds
    buffer_load_dwordx4 v13, s[4:7], s77 offen offset:1024 lds
    s_load_dword s46, s[44:45], 640
    s_load_dword s46, s[44:45], 704
    buffer_load_dwordx4 v14, s[4:7], s77 offen offset:2048 lds
    s_load_dword s46, s[44:45], 768
    s_load_dword s46, s[44:45], 832
    s_add_u32 m0, s79, 142336
    s_nop 0
    buffer_load_dwordx4 v15, s[4:7], s77 offen offset:0 lds
    s_load_dword s46, s[44:45], 896
    s_load_dword s46, s[44:45], 960
    buffer_load_dwordx4 v16, s[4:7], s77 offen offset:1024 lds
    buffer_load_dwordx4 v17, s[4:7], s77 offen offset:2048 lds
    s_add_u32 s76, s55, 10
    s_and_b32 s76, s76, 15
    s_mul_i32 s77, s76, 393216
    s_lshl_b32 s76, s76, 7
    s_add_u32 m0, s78, 65536
    s_waitcnt vmcnt(16)
    s_waitcnt vmcnt(10)
    s_barrier
    buffer_load_dwordx4 v8, s[88:91], s76 offen offset:0 sc1 lds
    s_lshr_b32 s27, s71, 9
    s_add_u32 s27, s27, 786432
    v_mov_b32 v46, s27
    v_mov_b32 v44, s24
    v_mov_b32 v45, s25
    s_mov_b64 exec, 1
    s_cmp_eq_u32 s23, 0
    s_cbranch_scc1 Lslow_6
    buffer_store_dwordx2 v[44:45], v46, s[12:15], 0 offen offset:0
Lback_7:
    s_mov_b64 exec, -1
    v_add_u32 v45, 13, v19
    v_and_b32 v45, 15, v45
    s_mov_b32 s27, 393216
    v_mad_u32_u24 v45, v45, s27, v18
    buffer_load_dwordx4 v9, s[88:91], s76 offen offset:1024 sc1 lds
    s_mov_b64 exec, 4095
    buffer_load_dword v255, v45, s[4:7], 0 offen
    s_mov_b64 exec, -1
    buffer_load_dwordx4 v10, s[88:91], s76 offen offset:2048 sc1 lds
    s_lshl_b32 s27, s2, 2
    s_add_u32 s27, s27, s75
    buffer_load_dwordx4 v11, s[88:91], s76 offen offset:3072 sc1 lds
    s_mul_i32 s27, s27, 2048
    s_nop 0
    s_add_u32 m0, s79, 0
    s_nop 0
    buffer_load_dwordx4 v12, s[4:7], s77 offen offset:0 lds
    s_add_u32 s44, s52, s27
    s_addc_u32 s45, s53, 0
    buffer_load_dwordx4 v13, s[4:7], s77 offen offset:1024 lds
    s_load_dword s46, s[44:45], 1024
    s_load_dword s46, s[44:45], 1088
    buffer_load_dwordx4 v14, s[4:7], s77 offen offset:2048 lds
    s_load_dword s46, s[44:45], 1152
    s_load_dword s46, s[44:45], 1216
    s_add_u32 m0, s79, 3072
    s_nop 0
    buffer_load_dwordx4 v15, s[4:7], s77 offen offset:0 lds
    s_load_dword s46, s[44:45], 1280
    s_load_dword s46, s[44:45], 1344
    buffer_load_dwordx4 v16, s[4:7], s77 offen offset:1024 lds
    s_load_dword s46, s[44:45], 1408
    s_load_dword s46, s[44:45], 1472
    buffer_load_dwordx4 v17, s[4:7], s77 offen offset:2048 lds
    s_add_u32 s76, s55, 11
    s_and_b32 s76, s76, 15
    s_mul_i32 s77, s76, 393216
    s_lshl_b32 s76, s76, 7
    s_add_u32 m0, s78, 81920
    s_waitcnt vmcnt(18)
    s_waitcnt vmcnt(12)
    s_barrier
    buffer_load_dwordx4 v8, s[88:91], s76 offen offset:0 sc1 lds
    buffer_load_dwordx2 v[64:65], v172, s[12:15], 0 offen offset:0 sc1
    buffer_load_dwordx4 v9, s[88:91], s76 offen offset:1024 sc1 lds
    s_lshl_b32 s27, s2, 2
    s_add_u32 s27, s27, s75
    buffer_load_dwordx4 v10, s[88:91], s76 offen offset:2048 sc1 lds
    s_mul_i32 s27, s27, 2048
    s_nop 0
    buffer_load_dwordx4 v11, s[88:91], s76 offen offset:3072 sc1 lds
    s_add_u32 s44, s52, s27
    s_addc_u32 s45, s53, 0
    s_add_u32 m0, s79, 24576
    s_nop 0
    buffer_load_dwordx4 v12, s[4:7], s77 offen offset:0 lds
    s_load_dword s46, s[44:45], 1536
    s_load_dword s46, s[44:45], 1600
    buffer_load_dwordx4 v13, s[4:7], s77 offen offset:1024 lds
    s_load_dword s46, s[44:45], 1664
    s_load_dword s46, s[44:45], 1728
    buffer_load_dwordx4 v14, s[4:7], s77 offen offset:2048 lds
    s_load_dword s46, s[44:45], 1792
    s_load_dword s46, s[44:45], 1856
    s_add_u32 m0, s79, 27648
    s_nop 0
    buffer_load_dwordx4 v15, s[4:7], s77 offen offset:0 lds
    s_load_dword s46, s[44:45], 1920
    s_load_dword s46, s[44:45], 1984
    buffer_load_dwordx4 v16, s[4:7], s77 offen offset:1024 lds
    buffer_load_dwordx4 v17, s[4:7], s77 offen offset:2048 lds
    s_add_u32 s76, s55, 12
    s_and_b32 s76, s76, 15
    s_mul_i32 s77, s76, 393216
    s_lshl_b32 s76, s76, 7
    s_add_u32 m0, s78, 49152
    s_waitcnt vmcnt(17)
    s_waitcnt vmcnt(11)
    s_barrier
    buffer_load_dwordx4 v8, s[88:91], s76 offen offset:0 sc1 lds
    buffer_load_dwordx2 v[24:25], v168, s[12:15], 0 offen offset:0 sc1
    buffer_load_dwordx4 v9, s[88:91], s76 offen offset:1024 sc1 lds
    s_waitcnt vmcnt(12)
    v_xor_b32 v66, s24, v64
    v_xor_b32 v67, s25, v65
    v_lshrrev_b32 v67, 5, v67
    v_or_b32 v66, v66, v67
    v_cmp_ne_u32 vcc, 0, v66
    s_nop 0
    s_cbranch_vccz Lcsok_8
    s_mov_b32 s26, 0
Lpoll_9:
    buffer_load_dwordx2 v[64:65], v172, s[12:15], 0 offen offset:0 sc1
    s_waitcnt vmcnt(0)
    v_xor_b32 v66, s24, v64
    v_xor_b32 v67, s25, v65
    v_lshrrev_b32 v67, 5, v67
    v_or_b32 v66, v66, v67
    v_cmp_ne_u32 vcc, 0, v66
    s_nop 0
    s_cbranch_vccz Lok_10
    s_add_u32 s26, s26, 1
    s_cmp_lt_u32 s26, 262144
    s_cbranch_scc1 Lpoll_9
Lok_10:
Lcsok_8:
    buffer_load_dwordx4 v10, s[88:91], s76 offen offset:2048 sc1 lds
    s_lshl_b32 s31, s21, 2
    s_add_u32 s31, s31, s75
    s_mul_i32 s31, s31, 4096
    s_add_u32 s31, s31, 262144
    buffer_load_dwordx4 v11, s[88:91], s76 offen offset:3072 sc1 lds
    v_and_b32 v66, 16, v65
    v_cmp_ne_u32 vcc, 0, v66
    s_nop 0
    s_lshl_b32 s47, vcc_lo, 15
    s_lshr_b32 s47, s47, s20
    s_and_b32 s47, s47, 0xe000
    s_lshr_b32 s27, s47, 2
    s_and_b32 s27, s27, 8192
    s_add_u32 s73, s73, s27
    s_lshr_b32 s27, s47, 1
    s_and_b32 s27, s27, 8192
    s_add_u32 s87, s87, s27
    s_lshr_b32 s27, s47, 0
    s_and_b32 s27, s27, 8192
    s_add_u32 s34, s34, s27
    s_add_u32 m0, s79, 139264
    s_nop 0
    buffer_load_dwordx4 v12, s[4:7], s77 offen offset:0 lds
    buffer_load_dwordx4 v[48:51], v0, s[12:15], s31 offen offset:0 sc1
    buffer_load_dwordx4 v13, s[4:7], s77 offen offset:1024 lds
    buffer_load_dwordx4 v[52:55], v0, s[12:15], s31 offen offset:1024 sc1
    buffer_load_dwordx4 v14, s[4:7], s77 offen offset:2048 lds
    buffer_load_dwordx4 v[56:59], v0, s[12:15], s31 offen offset:2048 sc1
    s_add_u32 m0, s79, 142336
    s_nop 0
    buffer_load_dwordx4 v15, s[4:7], s77 offen offset:0 lds
    buffer_load_dwordx4 v[60:63], v0, s[12:15], s31 offen offset:3072 sc1
    buffer_load_dwordx4 v16, s[4:7], s77 offen offset:1024 lds
    buffer_load_dwordx4 v17, s[4:7], s77 offen offset:2048 lds
    s_add_u32 s76, s55, 13
    s_and_b32 s76, s76, 15
    s_mul_i32 s77, s76, 393216
    s_lshl_b32 s76, s76, 7
    s_add_u32 m0, s78, 65536
    s_waitcnt vmcnt(21)
    s_waitcnt vmcnt(15)
    s_barrier
    buffer_load_dwordx4 v8, s[88:91], s76 offen offset:0 sc1 lds
    s_waitcnt vmcnt(14)
    v_xor_b32 v26, s24, v24
    v_xor_b32 v27, s25, v25
    v_lshrrev_b32 v27, 5, v27
    v_or_b32 v26, v26, v27
    v_cmp_ne_u32 vcc, 0, v26
    s_nop 0
    s_cbranch_vccz Lsok_11
    s_mov_b32 s26, 0
Lpoll_12:
    buffer_load_dwordx2 v[24:25], v168, s[12:15], 0 offen offset:0 sc1
    s_waitcnt vmcnt(0)
    v_xor_b32 v26, s24, v24
    v_xor_b32 v27, s25, v25
    v_lshrrev_b32 v27, 5, v27
    v_or_b32 v26, v26, v27
    v_cmp_ne_u32 vcc, 0, v26
    s_nop 0
    s_cbranch_vccz Lok_13
    s_add_u32 s26, s26, 1
    s_cmp_lt_u32 s26, 262144
    s_cbranch_scc1 Lpoll_12
Lok_13:
Lsok_11:
    buffer_load_dwordx4 v9, s[88:91], s76 offen offset:1024 sc1 lds
    buffer_load_dwordx4 v10, s[88:91], s76 offen offset:2048 sc1 lds
    v_cmp_ne_u32 vcc, s25, v25
    s_nop 0
    s_cmp_eq_u64 vcc, 0
    s_cselect_b32 s23, 1, 0
    s_or_b32 s27, s23, s47
    v_mov_b32 v42, s27
    v_mov_b32 v43, 132864
    ds_write_b32 v43, v42
    buffer_load_dwordx4 v11, s[88:91], s76 offen offset:3072 sc1 lds
    s_add_u32 m0, s79, 0
    s_nop 0
    buffer_load_dwordx4 v12, s[4:7], s77 offen offset:0 lds
    s_lshr_b32 s27, s71, 16
    s_lshl_b32 s27, s27, 12
    buffer_load_dwordx4 v[24:27], v0, s[12:15], s27 offen offset:0 sc1
    buffer_load_dwordx4 v13, s[4:7], s77 offen offset:1024 lds
    buffer_load_dwordx4 v14, s[4:7], s77 offen offset:2048 lds
    s_lshr_b32 s27, s71, 16
    s_lshl_b32 s27, s27, 12
    buffer_load_dwordx4 v[28:31], v0, s[12:15], s27 offen offset:1024 sc1
    s_add_u32 m0, s79, 3072
    s_nop 0
    buffer_load_dwordx4 v15, s[4:7], s77 offen offset:0 lds
    buffer_load_dwordx4 v16, s[4:7], s77 offen offset:1024 lds
    buffer_load_dwordx4 v17, s[4:7], s77 offen offset:2048 lds
    s_add_u32 s76, s55, 14
    s_and_b32 s76, s76, 15
    s_mul_i32 s77, s76, 393216
    s_lshl_b32 s76, s76, 7
    s_add_u32 m0, s78, 81920
    s_waitcnt vmcnt(22)
    s_waitcnt vmcnt(12)
    s_barrier
    buffer_load_dwordx4 v8, s[88:91], s76 offen offset:0 sc1 lds
    s_lshr_b32 s27, s71, 16
    s_lshl_b32 s27, s27, 12
    buffer_load_dwordx4 v[32:35], v0, s[12:15], s27 offen offset:2048 sc1
    s_lshr_b32 s27, s71, 16
    s_lshl_b32 s27, s27, 12
    buffer_load_dwordx4 v[36:39], v0, s[12:15], s27 offen offset:3072 sc1
    buffer_load_dwordx4 v9, s[88:91], s76 offen offset:1024 sc1 lds
    buffer_load_dwordx4 v10, s[88:91], s76 offen offset:2048 sc1 lds
    v_add_f32 v48, v48, v56
    v_add_f32 v49, v49, v57
    v_add_f32 v50, v50, v58
    buffer_load_dwordx4 v11, s[88:91], s76 offen offset:3072 sc1 lds
    v_add_f32 v51, v51, v59
    v_add_f32 v52, v52, v60
    v_add_f32 v53, v53, v61
    s_add_u32 m0, s79, 24576
    s_nop 0
    buffer_load_dwordx4 v12, s[4:7], s77 offen offset:0 lds
    v_add_f32 v54, v54, v62
    v_add_f32 v55, v55, v63
    v_add_f32 v48, v48, v52
    buffer_load_dwordx4 v13, s[4:7], s77 offen offset:1024 lds
    v_add_f32 v49, v49, v53
    v_add_f32 v50, v50, v54
    v_add_f32 v51, v51, v55
    buffer_load_dwordx4 v14, s[4:7], s77 offen offset:2048 lds
    v_permlane32_swap_b32 v48, v50
    v_permlane32_swap_b32 v49, v51
    v_add_f32 v48, v48, v50
    s_add_u32 m0, s79, 27648
    s_nop 0
    buffer_load_dwordx4 v15, s[4:7], s77 offen offset:0 lds
    v_add_f32 v49, v49, v51
    s_nop 1
    v_permlane16_swap_b32 v48, v49
    v_add_f32 v20, v48, v49
    buffer_load_dwordx4 v16, s[4:7], s77 offen offset:1024 lds
    ds_write_b32 v171, v20
    buffer_load_dwordx4 v17, s[4:7], s77 offen offset:2048 lds
    s_add_u32 s76, s55, 15
    s_and_b32 s76, s76, 15
    s_mul_i32 s77, s76, 393216
    s_lshl_b32 s76, s76, 7
    s_add_u32 m0, s78, 49152
    s_waitcnt vmcnt(20)
    s_waitcnt vmcnt(12)
    s_barrier
    buffer_load_dwordx4 v8, s[88:91], s76 offen offset:0 sc1 lds
    buffer_load_dwordx4 v9, s[88:91], s76 offen offset:1024 sc1 lds
    buffer_load_dwordx4 v10, s[88:91], s76 offen offset:2048 sc1 lds
    buffer_load_dwordx4 v11, s[88:91], s76 offen offset:3072 sc1 lds
    s_add_u32 m0, s79, 139264
    s_nop 0
    buffer_load_dwordx4 v12, s[4:7], s77 offen offset:0 lds
    buffer_load_dwordx4 v13, s[4:7], s77 offen offset:1024 lds
    buffer_load_dwordx4 v14, s[4:7], s77 offen offset:2048 lds
    s_add_u32 m0, s79, 142336
    s_nop 0
    buffer_load_dwordx4 v15, s[4:7], s77 offen offset:0 lds
    buffer_load_dwordx4 v16, s[4:7], s77 offen offset:1024 lds
    buffer_load_dwordx4 v17, s[4:7], s77 offen offset:2048 lds
    s_waitcnt vmcnt(16)
    s_waitcnt vmcnt(10)
    s_waitcnt lgkmcnt(0)
    s_barrier
    s_add_u32 m0, s85, 0
    s_add_u32 s36, s86, 0
    s_and_b32 s36, s36, 0x1fffff
    buffer_load_dwordx4 v3, s[8:11], s36 offen lds
    v_add_f32 v24, v24, v32
    v_add_f32 v25, v25, v33
    v_add_f32 v26, v26, v34
    v_add_f32 v27, v27, v35
    v_add_f32 v28, v28, v36
    v_add_f32 v29, v29, v37
    v_add_f32 v30, v30, v38
    v_add_f32 v31, v31, v39
    v_add_f32 v24, v24, v28
    s_add_u32 m0, s85, 4096
    s_add_u32 s36, s86, 65536
    s_and_b32 s36, s36, 0x1fffff
    buffer_load_dwordx4 v3, s[8:11], s36 offen lds
    v_add_f32 v25, v25, v29
    v_add_f32 v26, v26, v30
    v_add_f32 v27, v27, v31
    s_nop 0
    v_permlane32_swap_b32 v24, v26
    v_permlane32_swap_b32 v25, v27
    v_add_f32 v24, v24, v26
    v_add_f32 v25, v25, v27
    v_mov_b32 v26, v24
    v_mov_b32 v27, v25
    s_nop 0
    v_permlane16_swap_b32 v24, v26
    v_permlane16_swap_b32 v25, v27
    s_add_u32 m0, s85, 8192
    s_add_u32 s36, s86, 131072
    s_and_b32 s36, s36, 0x1fffff
    buffer_load_dwordx4 v3, s[8:11], s36 offen lds
    v_add_f32 v24, v24, v26
    v_add_f32 v25, v25, v27
    v_mul_f32 v24, 0xba800000, v24
    v_mul_f32 v25, 0x3a800000, v25
    v_fma_f32 v25, -v24, v24, v25
    v_max_f32 v25, 0, v25
    v_add_f32 v25, 0x3727c5ac, v25
    v_rsq_f32 v25, v25
    s_add_u32 m0, s85, 12288
    s_add_u32 s36, s86, 196608
    s_and_b32 s36, s36, 0x1fffff
    buffer_load_dwordx4 v3, s[8:11], s36 offen lds
    v_mul_f32 v24, v24, v25
    ds_write_b32 v170, v25
    ds_write_b32 v170, v24 offset:512
    s_lshr_b32 s27, s2, 3
    s_lshl_b32 s27, s27, 6
    s_lshl_b32 s28, s75, 4
    s_add_u32 s27, s27, s28
    v_add_u32 v44, s27, v1
    s_lshr_b32 s30, s8, 7
    s_sub_u32 s30, 3, s30
    s_and_b32 s30, s30, 7
    s_add_u32 m0, s85, 16384
    s_add_u32 s36, s86, 262144
    s_and_b32 s36, s36, 0x1fffff
    buffer_load_dwordx4 v3, s[8:11], s36 offen lds
    s_lshl_b32 s30, s30, 7
    v_and_b32 v45, 1, v44
    v_lshlrev_b32 v45, 10, v45
    v_lshrrev_b32 v44, 1, v44
    v_lshlrev_b32 v44, 11, v44
    v_add3_u32 v45, v45, v44, s30
    s_mov_b64 exec, 0xffff
    buffer_load_dword v255, v45, s[8:11], 0 offen
    s_mov_b64 exec, -1
    s_add_u32 m0, s85, 20480
    s_add_u32 s36, s86, 327680
    s_and_b32 s36, s36, 0x1fffff
    buffer_load_dwordx4 v3, s[8:11], s36 offen lds
    s_waitcnt vmcnt(13)
    s_waitcnt vmcnt(7)
    s_waitcnt lgkmcnt(0)
    s_barrier
    s_add_u32 m0, s85, 24576
    s_add_u32 s36, s86, 393216
    s_and_b32 s36, s36, 0x1fffff
    buffer_load_dwordx4 v3, s[8:11], s36 offen lds
    s_add_u32 m0, s85, 28672
    s_add_u32 s36, s86, 458752
    s_and_b32 s36, s36, 0x1fffff
    buffer_load_dwordx4 v3, s[8:11], s36 offen lds
    s_add_u32 m0, s85, 32768
    s_add_u32 s36, s86, 524288
    s_and_b32 s36, s36, 0x1fffff
    buffer_load_dwordx4 v3, s[8:11], s36 offen lds
    s_add_u32 m0, s85, 36864
    s_add_u32 s36, s86, 589824
    s_and_b32 s36, s36, 0x1fffff
    buffer_load_dwordx4 v3, s[8:11], s36 offen lds
    s_add_u32 m0, s85, 40960
    s_add_u32 s36, s86, 655360
    s_and_b32 s36, s36, 0x1fffff
    buffer_load_dwordx4 v3, s[8:11], s36 offen lds
    s_add_u32 m0, s85, 45056
    s_add_u32 s36, s86, 720896
    s_and_b32 s36, s36, 0x1fffff
    buffer_load_dwordx4 v3, s[8:11], s36 offen lds
    s_barrier
    s_branch L_attL
L_between0:
    s_add_u32 m0, s85, 122880
    s_add_u32 s36, s86, 1966080
    s_and_b32 s36, s36, 0x1fffff
    buffer_load_dwordx4 v3, s[8:11], s36 offen lds
    s_add_u32 m0, s85, 126976
    s_add_u32 s36, s86, 2031616
    s_and_b32 s36, s36, 0x1fffff
    buffer_load_dwordx4 v3, s[8:11], s36 offen lds
    s_mov_b32 s22, 1
    s_mov_b32 s4, s56
    s_mov_b32 s5, s57
    v_lshrrev_b32 v12, 3, v1
    s_mul_i32 s27, s75, 98304
    v_mul_u32_u24 v12, 6144, v12
    s_lshl_b32 s28, s21, 7
    s_add_u32 s27, s27, s28
    v_add3_u32 v12, v12, v173, s27
    v_add_u32 v13, 1024, v12
    v_add_u32 v14, 2048, v12
    v_add_u32 v15, 49152, v12
    v_add_u32 v16, 50176, v12
    v_add_u32 v17, 51200, v12
    s_lshl_b32 s27, s20, 2
    s_add_u32 s27, s27, s75
    s_lshl_b32 s27, s27, 16
    v_add_u32 v8, s27, v0
    s_andn2_b32 s55, s20, 1
    s_cmp_eq_u32 s55, 15
    s_cselect_b32 s55, 0, s55
    s_and_b32 s54, s20, 1
    s_add_u32 s54, s54, 1
    s_cmp_eq_u32 s20, 15
    s_cselect_b32 s54, 0, s54
    v_add_u32 v168, 8192, v168
    s_lshr_b32 s27, s2, 3
    s_mul_i32 s27, s27, 12
    s_mul_i32 s28, s75, 3
    s_add_u32 s27, s27, s28
    v_mul_u32_u24 v19, 21846, v1
    v_lshrrev_b32 v19, 16, v19
    v_mul_u32_u24 v24, 3, v19
    v_sub_u32 v24, v1, v24
    v_add_u32 v24, s27, v24
    s_lshr_b32 s30, s4, 7
    s_sub_u32 s30, 3, s30
    s_and_b32 s30, s30, 7
    s_lshl_b32 s30, s30, 7
    v_and_b32 v18, 1, v24
    v_lshlrev_b32 v18, 10, v18
    v_lshrrev_b32 v24, 1, v24
    v_lshlrev_b32 v24, 11, v24
    v_add3_u32 v18, v18, v24, s30
    s_and_b32 s27, s20, 14
    v_add_u32 v19, s27, v19
    v_add_u32 v24, 1, v19
    v_lshrrev_b32 v25, 4, v24
    v_lshrrev_b32 v26, 7, v18
    v_add3_u32 v24, v24, v25, v26
    v_and_b32 v24, 15, v24
    s_mov_b32 s27, 393216
    v_mad_u32_u24 v24, v24, s27, v18
    s_mov_b64 exec, 32767
    buffer_load_dword v255, v24, s[4:7], 0 offen
    s_mov_b64 exec, -1
    s_add_u32 s77, s21, 0
    s_and_b32 s77, s77, 15
    s_mul_i32 s77, s77, 393216
    s_add_u32 m0, s79, 139264
    s_nop 0
    buffer_load_dwordx4 v12, s[4:7], s77 offen offset:0 lds
    buffer_load_dwordx4 v13, s[4:7], s77 offen offset:1024 lds
    buffer_load_dwordx4 v14, s[4:7], s77 offen offset:2048 lds
    s_add_u32 m0, s79, 142336
    s_nop 0
    buffer_load_dwordx4 v15, s[4:7], s77 offen offset:0 lds
    buffer_load_dwordx4 v16, s[4:7], s77 offen offset:1024 lds
    buffer_load_dwordx4 v17, s[4:7], s77 offen offset:2048 lds
    s_barrier
    s_waitcnt vmcnt(7)
    s_mov_b32 s8, s58
    s_mov_b32 s9, s59
    s_barrier
    s_add_u32 s77, s55, 1
    s_cmp_ge_u32 s77, 16
    s_addc_u32 s77, s77, s21
    s_and_b32 s77, s77, 15
    s_mul_i32 s77, s77, 393216
    s_add_u32 m0, s79, 0
    s_nop 0
    buffer_load_dwordx4 v12, s[4:7], s77 offen offset:0 lds
    buffer_load_dwordx4 v13, s[4:7], s77 offen offset:1024 lds
    buffer_load_dwordx4 v14, s[4:7], s77 offen offset:2048 lds
    s_add_u32 m0, s79, 3072
    s_nop 0
    buffer_load_dwordx4 v15, s[4:7], s77 offen offset:0 lds
    buffer_load_dwordx4 v16, s[4:7], s77 offen offset:1024 lds
    buffer_load_dwordx4 v17, s[4:7], s77 offen offset:2048 lds
    s_add_u32 s77, s55, 2
    s_cmp_ge_u32 s77, 16
    s_addc_u32 s77, s77, s21
    s_and_b32 s77, s77, 15
    s_mul_i32 s77, s77, 393216
    s_add_u32 m0, s79, 24576
    s_nop 0
    buffer_load_dwordx4 v12, s[4:7], s77 offen offset:0 lds
    buffer_load_dwordx4 v13, s[4:7], s77 offen offset:1024 lds
    buffer_load_dwordx4 v14, s[4:7], s77 offen offset:2048 lds
    s_add_u32 m0, s79, 27648
    s_nop 0
    buffer_load_dwordx4 v15, s[4:7], s77 offen offset:0 lds
    buffer_load_dwordx4 v16, s[4:7], s77 offen offset:1024 lds
    buffer_load_dwordx4 v17, s[4:7], s77 offen offset:2048 lds
    s_waitcnt vmcnt(12)
    s_add_u32 s76, s55, 1
    s_cmp_ge_u32 s76, 16
    s_addc_u32 s76, s76, s21
    s_and_b32 s76, s76, 15
    s_lshl_b32 s76, s76, 12
    s_barrier
    s_add_u32 m0, s78, 65536
    s_nop 0
    buffer_load_dwordx4 v8, s[16:19], s76 offen offset:0 sc1 lds
    buffer_load_dwordx4 v8, s[16:19], s76 offen offset:1024 sc1 lds
    buffer_load_dwordx4 v8, s[16:19], s76 offen offset:2048 sc1 lds
    buffer_load_dwordx4 v8, s[16:19], s76 offen offset:3072 sc1 lds
    s_add_u32 s76, s55, 2
    s_cmp_ge_u32 s76, 16
    s_addc_u32 s76, s76, s21
    s_and_b32 s76, s76, 15
    s_lshl_b32 s76, s76, 12
    s_add_u32 m0, s78, 81920
    s_nop 0
    buffer_load_dwordx4 v8, s[16:19], s76 offen offset:0 sc1 lds
    v_add_u32 v45, 5, v19
    v_lshrrev_b32 v46, 4, v45
    v_lshrrev_b32 v47, 7, v18
    v_add3_u32 v45, v45, v46, v47
    v_and_b32 v45, 15, v45
    s_mov_b32 s27, 393216
    v_mad_u32_u24 v45, v45, s27, v18
    buffer_load_dwordx4 v8, s[16:19], s76 offen offset:1024 sc1 lds
    s_mov_b64 exec, 4095
    buffer_load_dword v255, v45, s[4:7], 0 offen
    s_mov_b64 exec, -1
    buffer_load_dwordx4 v8, s[16:19], s76 offen offset:2048 sc1 lds
    s_cmp_eq_u32 s54, 0
    s_cbranch_scc0 Lw_16
    v_lshrrev_b32 v116, 5, v1
    v_mul_u32_u24 v116, 3072, v116
    s_add_u32 s27, s79, 139264
    v_add3_u32 v116, v116, v2, s27
    v_xor_b32 v117, 32, v116
    v_xor_b32 v118, 64, v116
    v_xor_b32 v119, 96, v116
    ds_read_b64_tr_b16 v[80:81], v116 offset:0
    ds_read_b64_tr_b16 v[82:83], v117 offset:0
    ds_read_b64_tr_b16 v[84:85], v118 offset:0
    ds_read_b64_tr_b16 v[86:87], v119 offset:0
    ds_read_b64_tr_b16 v[88:89], v116 offset:1024
    ds_read_b64_tr_b16 v[90:91], v117 offset:1024
    ds_read_b64_tr_b16 v[92:93], v118 offset:1024
    ds_read_b64_tr_b16 v[94:95], v119 offset:1024
    ds_read_b64_tr_b16 v[96:97], v116 offset:2048
    ds_read_b64_tr_b16 v[98:99], v117 offset:2048
    ds_read_b64_tr_b16 v[100:101], v118 offset:2048
    ds_read_b64_tr_b16 v[102:103], v119 offset:2048
Lw_16:
    buffer_load_dwordx4 v8, s[16:19], s76 offen offset:3072 sc1 lds
    s_waitcnt lgkmcnt(0)
    s_waitcnt vmcnt(5)
    ds_read2st64_b32 v[40:41], v169 offset0:64 offset1:68
    ds_read2st64_b32 v[42:43], v169 offset0:72 offset1:76
    s_waitcnt lgkmcnt(0)
    v_or3_b32 v40, v40, v41, v42
    v_bitop3_b32 v40, v40, v43, 1 bitop3:0xa8
    v_cmp_ne_u32 vcc, 0, v40
    s_nop 0
    s_cbranch_vccnz Lxrt_15
Lxok_14:
    s_add_u32 s76, s55, 3
    s_cmp_ge_u32 s76, 16
    s_addc_u32 s76, s76, s21
    s_and_b32 s76, s76, 15
    s_mul_i32 s77, s76, 393216
    s_lshl_b32 s76, s76, 12
    s_add_u32 m0, s78, 49152
    s_barrier
    buffer_load_dwordx4 v8, s[16:19], s76 offen offset:0 sc1 lds
    s_lshl_b32 s27, s75, 8
    s_add_u32 s27, s27, 137216
    v_add_u32 v28, s27, v0
    ds_read_b128 v[24:27], v28
    buffer_load_dwordx4 v8, s[16:19], s76 offen offset:1024 sc1 lds
    s_waitcnt vmcnt(2)
    ds_read2st64_b32 v[40:41], v169 offset0:128 offset1:132
    ds_read2st64_b32 v[42:43], v169 offset0:136 offset1:140
    buffer_load_dwordx4 v8, s[16:19], s76 offen offset:2048 sc1 lds
    buffer_load_dwordx4 v8, s[16:19], s76 offen offset:3072 sc1 lds
    s_lshr_b32 s27, s71, 4
    s_waitcnt lgkmcnt(0)
    s_mov_b64 exec, 0xffff
    s_cmp_eq_u32 s23, 0
    s_cbranch_scc1 Lslow_19
    buffer_store_dwordx4 v[24:27], v0, s[12:15], s27 offen
Lback_20:
    s_mov_b64 exec, -1
    s_add_u32 m0, s79, 139264
    s_nop 0
    buffer_load_dwordx4 v12, s[4:7], s77 offen offset:0 lds
    buffer_load_dwordx4 v13, s[4:7], s77 offen offset:1024 lds
    s_waitcnt lgkmcnt(0)
    v_or3_b32 v40, v40, v41, v42
    v_bitop3_b32 v40, v40, v43, 1 bitop3:0xa8
    v_cmp_ne_u32 vcc, 0, v40
    buffer_load_dwordx4 v14, s[4:7], s77 offen offset:2048 lds
    s_cbranch_vccnz Lxrt_18
Lxok_17:
    s_add_u32 m0, s79, 142336
    s_nop 0
    buffer_load_dwordx4 v15, s[4:7], s77 offen offset:0 lds
    s_cmp_eq_u32 s54, 1
    s_cbranch_scc0 Lw_21
    v_lshrrev_b32 v116, 5, v1
    v_mul_u32_u24 v116, 3072, v116
    s_add_u32 s27, s79, 0
    v_add3_u32 v116, v116, v2, s27
    v_xor_b32 v117, 32, v116
    v_xor_b32 v118, 64, v116
    v_xor_b32 v119, 96, v116
    ds_read_b64_tr_b16 v[80:81], v116 offset:0
    ds_read_b64_tr_b16 v[82:83], v117 offset:0
    ds_read_b64_tr_b16 v[84:85], v118 offset:0
    ds_read_b64_tr_b16 v[86:87], v119 offset:0
    ds_read_b64_tr_b16 v[88:89], v116 offset:1024
    ds_read_b64_tr_b16 v[90:91], v117 offset:1024
    ds_read_b64_tr_b16 v[92:93], v118 offset:1024
    ds_read_b64_tr_b16 v[94:95], v119 offset:1024
    ds_read_b64_tr_b16 v[96:97], v116 offset:2048
    ds_read_b64_tr_b16 v[98:99], v117 offset:2048
    ds_read_b64_tr_b16 v[100:101], v118 offset:2048
    ds_read_b64_tr_b16 v[102:103], v119 offset:2048
Lw_21:
    buffer_load_dwordx4 v16, s[4:7], s77 offen offset:1024 lds
    buffer_load_dwordx4 v17, s[4:7], s77 offen offset:2048 lds
    s_waitcnt lgkmcnt(0)
    s_add_u32 s76, s55, 4
    s_cmp_ge_u32 s76, 16
    s_addc_u32 s76, s76, s21
    s_and_b32 s76, s76, 15
    s_mul_i32 s77, s76, 393216
    s_lshl_b32 s76, s76, 12
    s_add_u32 m0, s78, 65536
    s_barrier
    buffer_load_dwordx4 v8, s[16:19], s76 offen offset:0 sc1 lds
    s_lshr_b32 s27, s71, 9
    s_add_u32 s27, s27, 794624
    v_mov_b32 v46, s27
    v_mov_b32 v44, s24
    v_mov_b32 v45, s25
    s_waitcnt vmcnt(7)
    s_mov_b64 exec, 1
    s_cmp_eq_u32 s23, 0
    s_cbranch_scc1 Lslow_24
    buffer_store_dwordx2 v[44:45], v46, s[12:15], 0 offen offset:0
Lback_25:
    s_mov_b64 exec, -1
    buffer_load_dwordx4 v8, s[16:19], s76 offen offset:1024 sc1 lds
    ds_read2st64_b32 v[40:41], v169 offset0:0 offset1:4
    ds_read2st64_b32 v[42:43], v169 offset0:8 offset1:12
    buffer_load_dwordx4 v8, s[16:19], s76 offen offset:2048 sc1 lds
    buffer_load_dwordx4 v8, s[16:19], s76 offen offset:3072 sc1 lds
    s_cmp_eq_u32 s54, 2
    s_cbranch_scc0 Lw_26
    v_lshrrev_b32 v116, 5, v1
    v_mul_u32_u24 v116, 3072, v116
    s_add_u32 s27, s79, 24576
    v_add3_u32 v116, v116, v2, s27
    v_xor_b32 v117, 32, v116
    v_xor_b32 v118, 64, v116
    v_xor_b32 v119, 96, v116
    ds_read_b64_tr_b16 v[80:81], v116 offset:0
    ds_read_b64_tr_b16 v[82:83], v117 offset:0
    ds_read_b64_tr_b16 v[84:85], v118 offset:0
    ds_read_b64_tr_b16 v[86:87], v119 offset:0
    ds_read_b64_tr_b16 v[88:89], v116 offset:1024
    ds_read_b64_tr_b16 v[90:91], v117 offset:1024
    ds_read_b64_tr_b16 v[92:93], v118 offset:1024
    ds_read_b64_tr_b16 v[94:95], v119 offset:1024
    ds_read_b64_tr_b16 v[96:97], v116 offset:2048
    ds_read_b64_tr_b16 v[98:99], v117 offset:2048
    ds_read_b64_tr_b16 v[100:101], v118 offset:2048
    ds_read_b64_tr_b16 v[102:103], v119 offset:2048
Lw_26:
    s_add_u32 m0, s79, 0
    s_nop 0
    buffer_load_dwordx4 v12, s[4:7], s77 offen offset:0 lds
    buffer_load_dwordx4 v13, s[4:7], s77 offen offset:1024 lds
    s_waitcnt lgkmcnt(0)
    v_or3_b32 v40, v40, v41, v42
    v_bitop3_b32 v40, v40, v43, 1 bitop3:0xa8
    v_cmp_ne_u32 vcc, 0, v40
    buffer_load_dwordx4 v14, s[4:7], s77 offen offset:2048 lds
    s_cbranch_vccnz Lxrt_23
Lxok_22:
    s_add_u32 m0, s79, 3072
    s_nop 0
    buffer_load_dwordx4 v15, s[4:7], s77 offen offset:0 lds
    buffer_load_dwordx4 v16, s[4:7], s77 offen offset:1024 lds
    buffer_load_dwordx4 v17, s[4:7], s77 offen offset:2048 lds
    s_waitcnt lgkmcnt(0)
    s_add_u32 s76, s55, 5
    s_cmp_ge_u32 s76, 16
    s_addc_u32 s76, s76, s21
    s_and_b32 s76, s76, 15
    s_mul_i32 s77, s76, 393216
    s_lshl_b32 s76, s76, 12
    s_add_u32 m0, s78, 81920
    s_waitcnt vmcnt(11)
    s_barrier
    buffer_load_dwordx4 v8, s[16:19], s76 offen offset:0 sc1 lds
    v_bfe_u32 v104, v1, 2, 2
    v_lshlrev_b32 v104, v104, 1
    v_bfe_i32 v120, v104, 0, 1
    v_and_b32 v120, 0x3f803f80, v120
    buffer_load_dwordx4 v8, s[16:19], s76 offen offset:1024 sc1 lds
    s_waitcnt vmcnt(8)
    ds_read2st64_b32 v[40:41], v169 offset0:64 offset1:68
    ds_read2st64_b32 v[42:43], v169 offset0:72 offset1:76
    v_mov_b32 v121, v120
    v_bfe_i32 v122, v104, 1, 1
    v_and_b32 v122, 0x3f803f80, v122
    v_mov_b32 v123, v122
    buffer_load_dwordx4 v8, s[16:19], s76 offen offset:2048 sc1 lds
    v_bfe_i32 v124, v104, 2, 1
    v_and_b32 v124, 0x3f803f80, v124
    v_mov_b32 v125, v124
    v_bfe_i32 v126, v104, 3, 1
    buffer_load_dwordx4 v8, s[16:19], s76 offen offset:3072 sc1 lds
    v_and_b32 v126, 0x3f803f80, v126
    v_mov_b32 v127, v126
    s_waitcnt lgkmcnt(0)
    v_mfma_f32_16x16x32_bf16 v[104:107], v[120:123], v[80:83], 0
    s_add_u32 m0, s79, 24576
    s_nop 0
    buffer_load_dwordx4 v12, s[4:7], s77 offen offset:0 lds
    v_mfma_f32_16x16x32_bf16 v[108:111], v[120:123], v[88:91], 0
    v_mfma_f32_16x16x32_bf16 v[112:115], v[120:123], v[96:99], 0
    v_mfma_f32_16x16x32_bf16 v[104:107], v[124:127], v[84:87], v[104:107]
    v_mfma_f32_16x16x32_bf16 v[108:111], v[124:127], v[92:95], v[108:111]
    buffer_load_dwordx4 v13, s[4:7], s77 offen offset:1024 lds
    s_waitcnt lgkmcnt(0)
    v_or3_b32 v40, v40, v41, v42
    v_bitop3_b32 v40, v40, v43, 1 bitop3:0xa8
    v_cmp_ne_u32 vcc, 0, v40
    buffer_load_dwordx4 v14, s[4:7], s77 offen offset:2048 lds
    s_cbranch_vccnz Lxrt_28
Lxok_27:
    s_add_u32 m0, s79, 27648
    s_nop 0
    buffer_load_dwordx4 v15, s[4:7], s77 offen offset:0 lds
    v_mfma_f32_16x16x32_bf16 v[112:115], v[124:127], v[100:103], v[112:115]
    s_mul_i32 s27, s75, 768
    s_add_u32 s27, s27, 133120
    v_lshl_add_u32 v116, v1, 2, s27
    buffer_load_dwordx4 v16, s[4:7], s77 offen offset:1024 lds
    ds_write_b32 v116, v104 offset:0
    ds_write_b32 v116, v108 offset:256
    s_nop 1
    ds_write_b32 v116, v112 offset:512
    s_waitcnt lgkmcnt(0)
    buffer_load_dwordx4 v17, s[4:7], s77 offen offset:2048 lds
    s_add_u32 s76, s55, 6
    s_cmp_ge_u32 s76, 16
    s_addc_u32 s76, s76, s21
    s_and_b32 s76, s76, 15
    s_mul_i32 s77, s76, 393216
    s_lshl_b32 s76, s76, 12
    s_add_u32 m0, s78, 49152
    s_waitcnt vmcnt(10)
    s_barrier
    buffer_load_dwordx4 v8, s[16:19], s76 offen offset:0 sc1 lds
    v_add_u32 v45, 9, v19
    v_lshrrev_b32 v46, 4, v45
    v_lshrrev_b32 v47, 7, v18
    v_add3_u32 v45, v45, v46, v47
    v_and_b32 v45, 15, v45
    s_mov_b32 s27, 393216
    v_mad_u32_u24 v45, v45, s27, v18
    buffer_load_dwordx4 v8, s[16:19], s76 offen offset:1024 sc1 lds
    s_waitcnt vmcnt(8)
    ds_read2st64_b32 v[40:41], v169 offset0:128 offset1:132
    ds_read2st64_b32 v[42:43], v169 offset0:136 offset1:140
    s_mov_b64 exec, 4095
    buffer_load_dword v255, v45, s[4:7], 0 offen
    s_mov_b64 exec, -1
    buffer_load_dwordx4 v8, s[16:19], s76 offen offset:2048 sc1 lds
    s_min_u32 s27, s75, 2
    s_lshl_b32 s27, s27, 8
    s_add_u32 s27, s27, 133120
    v_lshl_add_u32 v80, v1, 2, s27
    buffer_load_dwordx4 v8, s[16:19], s76 offen offset:3072 sc1 lds
    ds_read_b32 v81, v80 offset:0
    ds_read_b32 v82, v80 offset:768
    ds_read_b32 v83, v80 offset:1536
    ds_read_b32 v84, v80 offset:2304
    s_lshl_b32 s27, s21, 2
    s_add_u32 s27, s27, s75
    s_mul_i32 s27, s27, 4096
    s_add_u32 s27, s27, 524288
    s_add_u32 m0, s79, 139264
    s_nop 0
    buffer_load_dwordx4 v12, s[4:7], s77 offen offset:0 lds
    s_lshl_b32 s28, s20, 8
    s_add_u32 s27, s27, s28
    v_lshlrev_b32 v80, 2, v1
    s_waitcnt lgkmcnt(0)
    buffer_load_dwordx4 v13, s[4:7], s77 offen offset:1024 lds
    s_waitcnt lgkmcnt(0)
    v_or3_b32 v40, v40, v41, v42
    v_bitop3_b32 v40, v40, v43, 1 bitop3:0xa8
    v_cmp_ne_u32 vcc, 0, v40
    buffer_load_dwordx4 v14, s[4:7], s77 offen offset:2048 lds
    s_cbranch_vccnz Lxrt_30
Lxok_29:
    s_add_u32 m0, s79, 142336
    s_nop 0
    buffer_load_dwordx4 v15, s[4:7], s77 offen offset:0 lds
    v_add_f32 v81, v81, v82
    buffer_load_dwordx4 v16, s[4:7], s77 offen offset:1024 lds
    v_add_f32 v83, v83, v84
    v_add_f32 v81, v81, v83
    buffer_store_dword v81, v80, s[12:15], s27 offen sc1
    buffer_load_dwordx4 v17, s[4:7], s77 offen offset:2048 lds
    s_add_u32 s76, s55, 7
    s_cmp_ge_u32 s76, 16
    s_addc_u32 s76, s76, s21
    s_and_b32 s76, s76, 15
    s_mul_i32 s77, s76, 393216
    s_lshl_b32 s76, s76, 12
    s_add_u32 m0, s78, 65536
    s_waitcnt vmcnt(12)
    s_barrier
    s_waitcnt vmcnt(6)
    buffer_load_dwordx4 v8, s[16:19], s76 offen offset:0 sc1 lds
    buffer_load_dwordx2 v[24:25], v168, s[12:15], 0 offen offset:0 sc1
    s_waitcnt vmcnt(6)
    buffer_load_dwordx4 v8, s[16:19], s76 offen offset:1024 sc1 lds
    s_waitcnt vmcnt(10)
    ds_read2st64_b32 v[40:41], v169 offset0:0 offset1:4
    ds_read2st64_b32 v[42:43], v169 offset0:8 offset1:12
    s_waitcnt vmcnt(6)
    buffer_load_dwordx4 v8, s[16:19], s76 offen offset:2048 sc1 lds
    s_waitcnt vmcnt(6)
    buffer_load_dwordx4 v8, s[16:19], s76 offen offset:3072 sc1 lds
    s_add_u32 m0, s79, 0
    s_waitcnt vmcnt(6)
    buffer_load_dwordx4 v12, s[4:7], s77 offen offset:0 lds
    s_waitcnt vmcnt(6)
    buffer_load_dwordx4 v13, s[4:7], s77 offen offset:1024 lds
    s_waitcnt lgkmcnt(0)
    v_or3_b32 v40, v40, v41, v42
    v_bitop3_b32 v40, v40, v43, 1 bitop3:0xa8
    v_cmp_ne_u32 vcc, 0, v40
    s_waitcnt vmcnt(6)
    buffer_load_dwordx4 v14, s[4:7], s77 offen offset:2048 lds
    s_cbranch_vccnz Lxrt_32
Lxok_31:
    s_add_u32 m0, s79, 3072
    s_waitcnt vmcnt(6)
    buffer_load_dwordx4 v15, s[4:7], s77 offen offset:0 lds
    s_waitcnt vmcnt(6)
    buffer_load_dwordx4 v16, s[4:7], s77 offen offset:1024 lds
    s_waitcnt vmcnt(6)
    buffer_load_dwordx4 v17, s[4:7], s77 offen offset:2048 lds
    s_add_u32 s76, s55, 8
    s_cmp_ge_u32 s76, 16
    s_addc_u32 s76, s76, s21
    s_and_b32 s76, s76, 15
    s_mul_i32 s77, s76, 393216
    s_lshl_b32 s76, s76, 12
    s_add_u32 m0, s78, 81920
    s_waitcnt vmcnt(11)
    s_barrier
    s_waitcnt vmcnt(6)
    buffer_load_dwordx4 v8, s[16:19], s76 offen offset:0 sc1 lds
    s_waitcnt vmcnt(10)
    v_xor_b32 v26, s24, v24
    v_xor_b32 v27, s25, v25
    v_lshrrev_b32 v27, 5, v27
    v_or_b32 v26, v26, v27
    v_cmp_ne_u32 vcc, 0, v26
    s_nop 0
    s_cbranch_vccz Lsok_35
    s_mov_b32 s26, 0
Lpoll_36:
    buffer_load_dwordx2 v[24:25], v168, s[12:15], 0 offen offset:0 sc1
    s_waitcnt vmcnt(0)
    v_xor_b32 v26, s24, v24
    v_xor_b32 v27, s25, v25
    v_lshrrev_b32 v27, 5, v27
    v_or_b32 v26, v26, v27
    v_cmp_ne_u32 vcc, 0, v26
    s_nop 0
    s_cbranch_vccz Lok_37
    s_add_u32 s26, s26, 1
    s_cmp_lt_u32 s26, 262144
    s_cbranch_scc1 Lpoll_36
Lok_37:
Lsok_35:
    s_waitcnt vmcnt(6)
    buffer_load_dwordx4 v8, s[16:19], s76 offen offset:1024 sc1 lds
    s_waitcnt vmcnt(8)
    ds_read2st64_b32 v[40:41], v169 offset0:64 offset1:68
    ds_read2st64_b32 v[42:43], v169 offset0:72 offset1:76
    s_waitcnt vmcnt(6)
    buffer_load_dwordx4 v8, s[16:19], s76 offen offset:2048 sc1 lds
    s_lshl_b32 s27, s21, 2
    s_add_u32 s27, s27, s75
    s_mul_i32 s27, s27, 128
    s_add_u32 s27, s27, 827392
    s_waitcnt vmcnt(6)
    buffer_load_dwordx4 v8, s[16:19], s76 offen offset:3072 sc1 lds
    v_and_b32 v172, 15, v1
    v_lshl_add_u32 v172, v172, 3, s27
    s_lshl_b32 s28, s20, 3
    s_add_u32 s27, s27, s28
    s_add_u32 m0, s79, 24576
    s_waitcnt vmcnt(6)
    buffer_load_dwordx4 v12, s[4:7], s77 offen offset:0 lds
    v_mov_b32 v46, s27
    v_mov_b32 v44, s24
    v_mov_b32 v45, s25
    s_waitcnt vmcnt(6)
    buffer_load_dwordx4 v13, s[4:7], s77 offen offset:1024 lds
    s_waitcnt lgkmcnt(0)
    v_or3_b32 v40, v40, v41, v42
    v_bitop3_b32 v40, v40, v43, 1 bitop3:0xa8
    v_cmp_ne_u32 vcc, 0, v40
    s_waitcnt vmcnt(6)
    buffer_load_dwordx4 v14, s[4:7], s77 offen offset:2048 lds
    s_cbranch_vccnz Lxrt_34
Lxok_33:
    s_add_u32 m0, s79, 27648
    s_waitcnt vmcnt(6)
    buffer_load_dwordx4 v15, s[4:7], s77 offen offset:0 lds
    s_mov_b64 exec, 1
    buffer_store_dwordx2 v[44:45], v46, s[12:15], 0 offen offset:0 sc1
    s_mov_b64 exec, -1
    s_waitcnt vmcnt(6)
    buffer_load_dwordx4 v16, s[4:7], s77 offen offset:1024 lds
    s_waitcnt vmcnt(6)
    buffer_load_dwordx4 v17, s[4:7], s77 offen offset:2048 lds
    s_add_u32 s76, s55, 9
    s_cmp_ge_u32 s76, 16
    s_addc_u32 s76, s76, s21
    s_and_b32 s76, s76, 15
    s_mul_i32 s77, s76, 393216
    s_lshl_b32 s76, s76, 12
    s_add_u32 m0, s78, 49152
    s_waitcnt vmcnt(11)
    s_barrier
    s_waitcnt vmcnt(6)
    buffer_load_dwordx4 v8, s[16:19], s76 offen offset:0 sc1 lds
    s_waitcnt vmcnt(6)
    buffer_load_dwordx4 v8, s[16:19], s76 offen offset:1024 sc1 lds
    s_waitcnt vmcnt(9)
    ds_read2st64_b32 v[40:41], v169 offset0:128 offset1:132
    ds_read2st64_b32 v[42:43], v169 offset0:136 offset1:140
    s_waitcnt vmcnt(6)
    buffer_load_dwordx4 v8, s[16:19], s76 offen offset:2048 sc1 lds
    s_waitcnt vmcnt(6)
    buffer_load_dwordx4 v8, s[16:19], s76 offen offset:3072 sc1 lds
    s_add_u32 m0, s79, 139264
    s_waitcnt vmcnt(6)
    buffer_load_dwordx4 v12, s[4:7], s77 offen offset:0 lds
    s_waitcnt vmcnt(6)
    buffer_load_dwordx4 v13, s[4:7], s77 offen offset:1024 lds
    s_waitcnt lgkmcnt(0)
    v_or3_b32 v40, v40, v41, v42
    v_bitop3_b32 v40, v40, v43, 1 bitop3:0xa8
    v_cmp_ne_u32 vcc, 0, v40
    s_waitcnt vmcnt(6)
    buffer_load_dwordx4 v14, s[4:7], s77 offen offset:2048 lds
    s_cbranch_vccnz Lxrt_39
Lxok_38:
    s_add_u32 m0, s79, 142336
    s_waitcnt vmcnt(6)
    buffer_load_dwordx4 v15, s[4:7], s77 offen offset:0 lds
    s_waitcnt vmcnt(6)
    buffer_load_dwordx4 v16, s[4:7], s77 offen offset:1024 lds
    s_waitcnt vmcnt(6)
    buffer_load_dwordx4 v17, s[4:7], s77 offen offset:2048 lds
    s_add_u32 s76, s55, 10
    s_cmp_ge_u32 s76, 16
    s_addc_u32 s76, s76, s21
    s_and_b32 s76, s76, 15
    s_mul_i32 s77, s76, 393216
    s_lshl_b32 s76, s76, 12
    s_add_u32 m0, s78, 65536
    s_waitcnt vmcnt(10)
    s_barrier
    s_waitcnt vmcnt(6)
    buffer_load_dwordx4 v8, s[16:19], s76 offen offset:0 sc1 lds
    s_lshr_b32 s27, s71, 16
    s_lshl_b32 s27, s27, 12
    buffer_load_dwordx4 v[24:27], v0, s[12:15], s27 offen offset:0 sc1
    v_add_u32 v45, 13, v19
    v_lshrrev_b32 v46, 4, v45
    v_lshrrev_b32 v47, 7, v18
    v_add3_u32 v45, v45, v46, v47
    s_waitcnt vmcnt(6)
    buffer_load_dwordx4 v8, s[16:19], s76 offen offset:1024 sc1 lds
    v_and_b32 v45, 15, v45
    s_mov_b32 s27, 393216
    v_mad_u32_u24 v45, v45, s27, v18
    s_waitcnt vmcnt(6)
    buffer_load_dwordx4 v8, s[16:19], s76 offen offset:2048 sc1 lds
    s_mov_b64 exec, 4095
    buffer_load_dword v255, v45, s[4:7], 0 offen
    s_mov_b64 exec, -1
    s_waitcnt vmcnt(6)
    buffer_load_dwordx4 v8, s[16:19], s76 offen offset:3072 sc1 lds
    s_lshl_b32 s27, s2, 2
    s_add_u32 s27, s27, s75
    s_add_u32 m0, s79, 0
    s_waitcnt vmcnt(6)
    buffer_load_dwordx4 v12, s[4:7], s77 offen offset:0 lds
    s_mul_i32 s27, s27, 2048
    s_nop 0
    s_add_u32 s44, s58, s27
    s_addc_u32 s45, s59, 0
    s_waitcnt vmcnt(6)
    buffer_load_dwordx4 v13, s[4:7], s77 offen offset:1024 lds
    s_load_dword s46, s[44:45], 0
    s_load_dword s46, s[44:45], 64
    s_waitcnt vmcnt(6)
    buffer_load_dwordx4 v14, s[4:7], s77 offen offset:2048 lds
    s_load_dword s46, s[44:45], 128
    s_load_dword s46, s[44:45], 192
    s_add_u32 m0, s79, 3072
    s_waitcnt vmcnt(6)
    buffer_load_dwordx4 v15, s[4:7], s77 offen offset:0 lds
    s_load_dword s46, s[44:45], 256
    s_load_dword s46, s[44:45], 320
    s_waitcnt vmcnt(6)
    buffer_load_dwordx4 v16, s[4:7], s77 offen offset:1024 lds
    s_load_dword s46, s[44:45], 384
    s_load_dword s46, s[44:45], 448
    s_waitcnt vmcnt(6)
    buffer_load_dwordx4 v17, s[4:7], s77 offen offset:2048 lds
    s_add_u32 s76, s55, 11
    s_cmp_ge_u32 s76, 16
    s_addc_u32 s76, s76, s21
    s_and_b32 s76, s76, 15
    s_mul_i32 s77, s76, 393216
    s_lshl_b32 s76, s76, 12
    s_add_u32 m0, s78, 81920
    s_waitcnt vmcnt(18)
    s_waitcnt vmcnt(12)
    s_barrier
    s_waitcnt vmcnt(6)
    buffer_load_dwordx4 v8, s[16:19], s76 offen offset:0 sc1 lds
    s_lshr_b32 s27, s71, 16
    s_lshl_b32 s27, s27, 12
    buffer_load_dwordx4 v[28:31], v0, s[12:15], s27 offen offset:1024 sc1
    s_waitcnt vmcnt(6)
    buffer_load_dwordx4 v8, s[16:19], s76 offen offset:1024 sc1 lds
    s_lshl_b32 s27, s2, 2
    s_add_u32 s27, s27, s75
    s_waitcnt vmcnt(6)
    buffer_load_dwordx4 v8, s[16:19], s76 offen offset:2048 sc1 lds
    s_mul_i32 s27, s27, 2048
    s_nop 0
    s_waitcnt vmcnt(6)
    buffer_load_dwordx4 v8, s[16:19], s76 offen offset:3072 sc1 lds
    s_add_u32 s44, s58, s27
    s_addc_u32 s45, s59, 0
    s_add_u32 m0, s79, 24576
    s_waitcnt vmcnt(6)
    buffer_load_dwordx4 v12, s[4:7], s77 offen offset:0 lds
    s_load_dword s46, s[44:45], 512
    s_load_dword s46, s[44:45], 576
    s_waitcnt vmcnt(6)
    buffer_load_dwordx4 v13, s[4:7], s77 offen offset:1024 lds
    s_load_dword s46, s[44:45], 640
    s_load_dword s46, s[44:45], 704
    s_waitcnt vmcnt(6)
    buffer_load_dwordx4 v14, s[4:7], s77 offen offset:2048 lds
    s_load_dword s46, s[44:45], 768
    s_load_dword s46, s[44:45], 832
    s_add_u32 m0, s79, 27648
    s_waitcnt vmcnt(6)
    buffer_load_dwordx4 v15, s[4:7], s77 offen offset:0 lds
    s_load_dword s46, s[44:45], 896
    s_load_dword s46, s[44:45], 960
    s_waitcnt vmcnt(6)
    buffer_load_dwordx4 v16, s[4:7], s77 offen offset:1024 lds
    s_waitcnt vmcnt(6)
    buffer_load_dwordx4 v17, s[4:7], s77 offen offset:2048 lds
    s_add_u32 s76, s55, 12
    s_cmp_ge_u32 s76, 16
    s_addc_u32 s76, s76, s21
    s_and_b32 s76, s76, 15
    s_mul_i32 s77, s76, 393216
    s_lshl_b32 s76, s76, 12
    s_add_u32 m0, s78, 49152
    s_waitcnt vmcnt(17)
    s_waitcnt vmcnt(11)
    s_barrier
    buffer_load_dwordx4 v8, s[16:19], s76 offen offset:0 sc1 lds
    buffer_load_dwordx2 v[64:65], v172, s[12:15], 0 offen offset:0 sc1
    buffer_load_dwordx4 v8, s[16:19], s76 offen offset:1024 sc1 lds
    s_lshr_b32 s27, s71, 16
    s_lshl_b32 s27, s27, 12
    buffer_load_dwordx4 v[32:35], v0, s[12:15], s27 offen offset:2048 sc1
    buffer_load_dwordx4 v8, s[16:19], s76 offen offset:2048 sc1 lds
    s_lshl_b32 s27, s2, 2
    s_add_u32 s27, s27, s75
    buffer_load_dwordx4 v8, s[16:19], s76 offen offset:3072 sc1 lds
    s_mul_i32 s27, s27, 2048
    s_nop 0
    s_add_u32 m0, s79, 139264
    s_nop 0
    buffer_load_dwordx4 v12, s[4:7], s77 offen offset:0 lds
    s_add_u32 s44, s58, s27
    s_addc_u32 s45, s59, 0
    buffer_load_dwordx4 v13, s[4:7], s77 offen offset:1024 lds
    s_load_dword s46, s[44:45], 1024
    s_load_dword s46, s[44:45], 1088
    buffer_load_dwordx4 v14, s[4:7], s77 offen offset:2048 lds
    s_load_dword s46, s[44:45], 1152
    s_load_dword s46, s[44:45], 1216
    s_add_u32 m0, s79, 142336
    s_nop 0
    buffer_load_dwordx4 v15, s[4:7], s77 offen offset:0 lds
    s_load_dword s46, s[44:45], 1280
    s_load_dword s46, s[44:45], 1344
    buffer_load_dwordx4 v16, s[4:7], s77 offen offset:1024 lds
    s_load_dword s46, s[44:45], 1408
    s_load_dword s46, s[44:45], 1472
    buffer_load_dwordx4 v17, s[4:7], s77 offen offset:2048 lds
    s_add_u32 s76, s55, 13
    s_cmp_ge_u32 s76, 16
    s_addc_u32 s76, s76, s21
    s_and_b32 s76, s76, 15
    s_mul_i32 s77, s76, 393216
    s_lshl_b32 s76, s76, 12
    s_add_u32 m0, s78, 65536
    s_waitcnt vmcnt(18)
    s_waitcnt vmcnt(12)
    s_barrier
    buffer_load_dwordx4 v8, s[16:19], s76 offen offset:0 sc1 lds
    s_lshr_b32 s27, s71, 16
    s_lshl_b32 s27, s27, 12
    buffer_load_dwordx4 v[36:39], v0, s[12:15], s27 offen offset:3072 sc1
    s_lshl_b32 s27, s2, 2
    s_add_u32 s27, s27, s75
    buffer_load_dwordx4 v8, s[16:19], s76 offen offset:1024 sc1 lds
    s_mul_i32 s27, s27, 2048
    s_nop 0
    s_add_u32 s44, s58, s27
    s_addc_u32 s45, s59, 0
    buffer_load_dwordx4 v8, s[16:19], s76 offen offset:2048 sc1 lds
    s_load_dword s46, s[44:45], 1536
    s_load_dword s46, s[44:45], 1600
    buffer_load_dwordx4 v8, s[16:19], s76 offen offset:3072 sc1 lds
    s_load_dword s46, s[44:45], 1664
    s_load_dword s46, s[44:45], 1728
    s_load_dword s46, s[44:45], 1792
    s_load_dword s46, s[44:45], 1856
    s_add_u32 m0, s79, 0
    s_nop 0
    buffer_load_dwordx4 v12, s[4:7], s77 offen offset:0 lds
    s_load_dword s46, s[44:45], 1920
    s_load_dword s46, s[44:45], 1984
    buffer_load_dwordx4 v13, s[4:7], s77 offen offset:1024 lds
    s_waitcnt vmcnt(17)
    v_xor_b32 v66, s24, v64
    v_xor_b32 v67, s25, v65
    v_lshrrev_b32 v67, 5, v67
    v_or_b32 v66, v66, v67
    v_cmp_ne_u32 vcc, 0, v66
    s_nop 0
    s_cbranch_vccz Lcsok_40
    s_mov_b32 s26, 0
Lpoll_41:
    buffer_load_dwordx2 v[64:65], v172, s[12:15], 0 offen offset:0 sc1
    s_waitcnt vmcnt(0)
    v_xor_b32 v66, s24, v64
    v_xor_b32 v67, s25, v65
    v_lshrrev_b32 v67, 5, v67
    v_or_b32 v66, v66, v67
    v_cmp_ne_u32 vcc, 0, v66
    s_nop 0
    s_cbranch_vccz Lok_42
    s_add_u32 s26, s26, 1
    s_cmp_lt_u32 s26, 262144
    s_cbranch_scc1 Lpoll_41
Lok_42:
Lcsok_40:
    s_lshl_b32 s31, s21, 2
    s_add_u32 s31, s31, s75
    s_mul_i32 s31, s31, 4096
    s_add_u32 s31, s31, 524288
    buffer_load_dwordx4 v14, s[4:7], s77 offen offset:2048 lds
    buffer_load_dwordx4 v[48:51], v0, s[12:15], s31 offen offset:0 sc1
    s_add_u32 m0, s79, 3072
    s_nop 0
    buffer_load_dwordx4 v15, s[4:7], s77 offen offset:0 lds
    buffer_load_dwordx4 v[52:55], v0, s[12:15], s31 offen offset:1024 sc1
    buffer_load_dwordx4 v[56:59], v0, s[12:15], s31 offen offset:2048 sc1
    buffer_load_dwordx4 v16, s[4:7], s77 offen offset:1024 lds
    buffer_load_dwordx4 v[60:63], v0, s[12:15], s31 offen offset:3072 sc1
    buffer_load_dwordx4 v17, s[4:7], s77 offen offset:2048 lds
    s_add_u32 s76, s55, 14
    s_cmp_ge_u32 s76, 16
    s_addc_u32 s76, s76, s21
    s_and_b32 s76, s76, 15
    s_mul_i32 s77, s76, 393216
    s_lshl_b32 s76, s76, 12
    s_add_u32 m0, s78, 81920
    s_waitcnt vmcnt(21)
    s_waitcnt vmcnt(15)
    s_barrier
    buffer_load_dwordx4 v8, s[16:19], s76 offen offset:0 sc1 lds
    buffer_load_dwordx4 v8, s[16:19], s76 offen offset:1024 sc1 lds
    buffer_load_dwordx4 v8, s[16:19], s76 offen offset:2048 sc1 lds
    buffer_load_dwordx4 v8, s[16:19], s76 offen offset:3072 sc1 lds
    s_add_u32 m0, s79, 24576
    s_nop 0
    buffer_load_dwordx4 v12, s[4:7], s77 offen offset:0 lds
    buffer_load_dwordx4 v13, s[4:7], s77 offen offset:1024 lds
    buffer_load_dwordx4 v14, s[4:7], s77 offen offset:2048 lds
    s_add_u32 m0, s79, 27648
    s_nop 0
    buffer_load_dwordx4 v15, s[4:7], s77 offen offset:0 lds
    buffer_load_dwordx4 v16, s[4:7], s77 offen offset:1024 lds
    buffer_load_dwordx4 v17, s[4:7], s77 offen offset:2048 lds
    s_add_u32 s76, s55, 15
    s_cmp_ge_u32 s76, 16
    s_addc_u32 s76, s76, s21
    s_and_b32 s76, s76, 15
    s_mul_i32 s77, s76, 393216
    s_lshl_b32 s76, s76, 12
    s_add_u32 m0, s78, 49152
    s_waitcnt vmcnt(20)
    s_waitcnt vmcnt(10)
    s_barrier
    buffer_load_dwordx4 v8, s[16:19], s76 offen offset:0 sc1 lds
    v_add_f32 v24, v24, v32
    v_add_f32 v25, v25, v33
    v_add_f32 v26, v26, v34
    buffer_load_dwordx4 v8, s[16:19], s76 offen offset:1024 sc1 lds
    v_add_f32 v27, v27, v35
    v_add_f32 v28, v28, v36
    v_add_f32 v29, v29, v37
    v_add_f32 v30, v30, v38
    v_add_f32 v31, v31, v39
    v_add_f32 v24, v24, v28
    buffer_load_dwordx4 v8, s[16:19], s76 offen offset:2048 sc1 lds
    v_add_f32 v25, v25, v29
    v_add_f32 v26, v26, v30
    v_add_f32 v27, v27, v31
    buffer_load_dwordx4 v8, s[16:19], s76 offen offset:3072 sc1 lds
    v_permlane32_swap_b32 v24, v26
    v_permlane32_swap_b32 v25, v27
    v_add_f32 v24, v24, v26
    v_add_f32 v25, v25, v27
    v_mov_b32 v26, v24
    v_mov_b32 v27, v25
    s_add_u32 m0, s79, 139264
    s_nop 0
    buffer_load_dwordx4 v12, s[4:7], s77 offen offset:0 lds
    v_add_f32 v48, v48, v56
    v_add_f32 v49, v49, v57
    v_add_f32 v50, v50, v58
    buffer_load_dwordx4 v13, s[4:7], s77 offen offset:1024 lds
    v_add_f32 v51, v51, v59
    v_add_f32 v52, v52, v60
    v_add_f32 v53, v53, v61
    buffer_load_dwordx4 v14, s[4:7], s77 offen offset:2048 lds
    v_add_f32 v54, v54, v62
    v_add_f32 v55, v55, v63
    v_add_f32 v48, v48, v52
    v_add_f32 v49, v49, v53
    v_add_f32 v50, v50, v54
    v_add_f32 v51, v51, v55
    s_add_u32 m0, s79, 142336
    s_nop 0
    buffer_load_dwordx4 v15, s[4:7], s77 offen offset:0 lds
    v_permlane32_swap_b32 v48, v50
    v_permlane32_swap_b32 v49, v51
    v_add_f32 v48, v48, v50
    v_add_f32 v49, v49, v51
    s_nop 1
    v_permlane16_swap_b32 v48, v49
    v_add_f32 v21, v48, v49
    buffer_load_dwordx4 v16, s[4:7], s77 offen offset:1024 lds
    ds_write_b32 v171, v21
    buffer_load_dwordx4 v17, s[4:7], s77 offen offset:2048 lds
    s_waitcnt vmcnt(16)
    s_waitcnt vmcnt(10)
    s_barrier
    s_add_u32 m0, s85, 0
    s_add_u32 s36, s86, 0
    s_and_b32 s36, s36, 0x1fffff
    buffer_load_dwordx4 v3, s[8:11], s36 offen lds
    v_permlane16_swap_b32 v24, v26
    v_permlane16_swap_b32 v25, v27
    v_add_f32 v24, v24, v26
    v_add_f32 v25, v25, v27
    s_add_u32 m0, s85, 4096
    s_add_u32 s36, s86, 65536
    s_and_b32 s36, s36, 0x1fffff
    buffer_load_dwordx4 v3, s[8:11], s36 offen lds
    v_mul_f32 v24, 0xba800000, v24
    v_mul_f32 v25, 0x3a800000, v25
    s_add_u32 m0, s85, 8192
    s_add_u32 s36, s86, 131072
    s_and_b32 s36, s36, 0x1fffff
    buffer_load_dwordx4 v3, s[8:11], s36 offen lds
    v_fma_f32 v25, -v24, v24, v25
    v_max_f32 v25, 0, v25
    s_add_u32 m0, s85, 12288
    s_add_u32 s36, s86, 196608
    s_and_b32 s36, s36, 0x1fffff
    buffer_load_dwordx4 v3, s[8:11], s36 offen lds
    v_add_f32 v25, 0x3727c5ac, v25
    v_rsq_f32 v25, v25
    s_nop 0
    v_mul_f32 v24, v24, v25
    ds_write_b32 v170, v25
    s_add_u32 m0, s85, 16384
    s_add_u32 s36, s86, 262144
    s_and_b32 s36, s36, 0x1fffff
    buffer_load_dwordx4 v3, s[8:11], s36 offen lds
    ds_write_b32 v170, v24 offset:512
    s_add_u32 m0, s85, 20480
    s_add_u32 s36, s86, 327680
    s_and_b32 s36, s36, 0x1fffff
    buffer_load_dwordx4 v3, s[8:11], s36 offen lds
    s_lshr_b32 s27, s2, 3
    s_lshl_b32 s27, s27, 6
    s_lshl_b32 s28, s75, 4
    s_add_u32 s27, s27, s28
    s_add_u32 m0, s85, 65536
    s_add_u32 s36, s86, 1048576
    s_and_b32 s36, s36, 0x1fffff
    buffer_load_dwordx4 v3, s[8:11], s36 offen lds
    v_add_u32 v44, s27, v1
    s_lshr_b32 s30, s8, 7
    s_sub_u32 s30, 3, s30
    s_and_b32 s30, s30, 7
    s_lshl_b32 s30, s30, 7
    v_and_b32 v45, 1, v44
    v_lshlrev_b32 v45, 10, v45
    v_lshrrev_b32 v44, 1, v44
    s_add_u32 m0, s85, 69632
    s_add_u32 s36, s86, 1114112
    s_and_b32 s36, s36, 0x1fffff
    buffer_load_dwordx4 v3, s[8:11], s36 offen lds
    v_lshlrev_b32 v44, 11, v44
    v_add3_u32 v45, v45, v44, s30
    s_add_u32 m0, s85, 73728
    s_add_u32 s36, s86, 1179648
    s_and_b32 s36, s36, 0x1fffff
    buffer_load_dwordx4 v3, s[8:11], s36 offen lds
    s_mov_b64 exec, 0xffff
    buffer_load_dword v255, v45, s[8:11], 0 offen
    s_mov_b64 exec, -1
    s_add_u32 m0, s85, 77824
    s_add_u32 s36, s86, 1245184
    s_and_b32 s36, s36, 0x1fffff
    buffer_load_dwordx4 v3, s[8:11], s36 offen lds
    s_waitcnt vmcnt(17)
    s_waitcnt vmcnt(11)
    s_waitcnt lgkmcnt(0)
    s_barrier
    s_add_u32 m0, s85, 24576
    s_add_u32 s36, s86, 393216
    s_and_b32 s36, s36, 0x1fffff
    buffer_load_dwordx4 v3, s[8:11], s36 offen lds
    s_add_u32 m0, s85, 28672
    s_add_u32 s36, s86, 458752
    s_and_b32 s36, s36, 0x1fffff
    buffer_load_dwordx4 v3, s[8:11], s36 offen lds
    s_add_u32 m0, s85, 32768
    s_add_u32 s36, s86, 524288
    s_and_b32 s36, s36, 0x1fffff
    buffer_load_dwordx4 v3, s[8:11], s36 offen lds
    s_add_u32 m0, s85, 36864
    s_add_u32 s36, s86, 589824
    s_and_b32 s36, s36, 0x1fffff
    buffer_load_dwordx4 v3, s[8:11], s36 offen lds
    s_add_u32 m0, s85, 40960
    s_add_u32 s36, s86, 655360
    s_and_b32 s36, s36, 0x1fffff
    buffer_load_dwordx4 v3, s[8:11], s36 offen lds
    s_add_u32 m0, s85, 45056
    s_add_u32 s36, s86, 720896
    s_and_b32 s36, s36, 0x1fffff
    buffer_load_dwordx4 v3, s[8:11], s36 offen lds
    s_add_u32 m0, s85, 81920
    s_add_u32 s36, s86, 1310720
    s_and_b32 s36, s36, 0x1fffff
    buffer_load_dwordx4 v3, s[8:11], s36 offen lds
    s_add_u32 m0, s85, 86016
    s_add_u32 s36, s86, 1376256
    s_and_b32 s36, s36, 0x1fffff
    buffer_load_dwordx4 v3, s[8:11], s36 offen lds
    s_add_u32 m0, s85, 90112
    s_add_u32 s36, s86, 1441792
    s_and_b32 s36, s36, 0x1fffff
    buffer_load_dwordx4 v3, s[8:11], s36 offen lds
    s_add_u32 m0, s85, 94208
    s_add_u32 s36, s86, 1507328
    s_and_b32 s36, s36, 0x1fffff
    buffer_load_dwordx4 v3, s[8:11], s36 offen lds
    s_barrier
    s_add_u32 m0, s85, 49152
    s_add_u32 s36, s86, 786432
    s_and_b32 s36, s36, 0x1fffff
    buffer_load_dwordx4 v3, s[8:11], s36 offen lds
    s_add_u32 m0, s85, 53248
    s_add_u32 s36, s86, 851968
    s_and_b32 s36, s36, 0x1fffff
    buffer_load_dwordx4 v3, s[8:11], s36 offen lds
    s_add_u32 m0, s85, 57344
    s_add_u32 s36, s86, 917504
    s_and_b32 s36, s36, 0x1fffff
    buffer_load_dwordx4 v3, s[8:11], s36 offen lds
    s_add_u32 m0, s85, 61440
    s_add_u32 s36, s86, 983040
    s_and_b32 s36, s36, 0x1fffff
    buffer_load_dwordx4 v3, s[8:11], s36 offen lds
    s_add_u32 m0, s85, 98304
    s_add_u32 s36, s86, 1572864
    s_and_b32 s36, s36, 0x1fffff
    buffer_load_dwordx4 v3, s[8:11], s36 offen lds
    s_add_u32 m0, s85, 102400
    s_add_u32 s36, s86, 1638400
    s_and_b32 s36, s36, 0x1fffff
    buffer_load_dwordx4 v3, s[8:11], s36 offen lds
    s_add_u32 m0, s85, 106496
    s_add_u32 s36, s86, 1703936
    s_and_b32 s36, s36, 0x1fffff
    buffer_load_dwordx4 v3, s[8:11], s36 offen lds
    s_add_u32 m0, s85, 110592
    s_add_u32 s36, s86, 1769472
    s_and_b32 s36, s36, 0x1fffff
    buffer_load_dwordx4 v3, s[8:11], s36 offen lds
    s_add_u32 m0, s85, 114688
    s_add_u32 s36, s86, 1835008
    s_and_b32 s36, s36, 0x1fffff
    buffer_load_dwordx4 v3, s[8:11], s36 offen lds
    s_add_u32 m0, s85, 118784
    s_add_u32 s36, s86, 1900544
    s_and_b32 s36, s36, 0x1fffff
    buffer_load_dwordx4 v3, s[8:11], s36 offen lds
    s_add_u32 m0, s85, 122880
    s_add_u32 s36, s86, 1966080
    s_and_b32 s36, s36, 0x1fffff
    buffer_load_dwordx4 v3, s[8:11], s36 offen lds
    s_add_u32 m0, s85, 126976
    s_add_u32 s36, s86, 2031616
    s_and_b32 s36, s36, 0x1fffff
    buffer_load_dwordx4 v3, s[8:11], s36 offen lds
    s_waitcnt vmcnt(16)
    s_barrier
    s_mov_b32 s22, 2
    s_mov_b32 s4, s50
    s_mov_b32 s5, s51
    v_add_u32 v168, 8192, v168
    s_lshr_b32 s27, s2, 3
    s_mul_i32 s27, s27, 12
    s_mul_i32 s28, s75, 3
    s_add_u32 s27, s27, s28
    v_mul_u32_u24 v19, 21846, v1
    v_lshrrev_b32 v19, 16, v19
    v_mul_u32_u24 v24, 3, v19
    v_sub_u32 v24, v1, v24
    v_add_u32 v24, s27, v24
    s_lshr_b32 s30, s4, 7
    s_sub_u32 s30, 3, s30
    s_and_b32 s30, s30, 7
    s_lshl_b32 s30, s30, 7
    v_and_b32 v18, 1, v24
    v_lshlrev_b32 v18, 10, v18
    v_lshrrev_b32 v24, 1, v24
    v_lshlrev_b32 v24, 11, v24
    v_add3_u32 v18, v18, v24, s30
    v_bfe_u32 v24, v18, 7, 4
    v_add_u32 v19, v19, v24
    s_waitcnt vmcnt(0)
    s_barrier
    v_add_u32 v24, 0, v19
    v_and_b32 v24, 15, v24
    s_mov_b32 s27, 393216
    v_mad_u32_u24 v24, v24, s27, v18
    s_mov_b64 exec, 32767
    buffer_load_dword v255, v24, s[4:7], 0 offen
    s_mov_b64 exec, -1
    s_add_u32 s77, s21, 0
    s_and_b32 s77, s77, 15
    s_mul_i32 s77, s77, 393216
    s_add_u32 m0, s79, 139264
    s_nop 0
    buffer_load_dwordx4 v12, s[4:7], s77 offen offset:0 lds
    buffer_load_dwordx4 v13, s[4:7], s77 offen offset:1024 lds
    buffer_load_dwordx4 v14, s[4:7], s77 offen offset:2048 lds
    s_add_u32 m0, s79, 142336
    s_nop 0
    buffer_load_dwordx4 v15, s[4:7], s77 offen offset:0 lds
    buffer_load_dwordx4 v16, s[4:7], s77 offen offset:1024 lds
    buffer_load_dwordx4 v17, s[4:7], s77 offen offset:2048 lds
    s_mov_b32 s8, s52
    s_mov_b32 s9, s53
    s_barrier
    s_add_u32 s77, s21, 1
    s_and_b32 s77, s77, 15
    s_mul_i32 s77, s77, 393216
    s_add_u32 m0, s79, 0
    s_nop 0
    buffer_load_dwordx4 v12, s[4:7], s77 offen offset:0 lds
    buffer_load_dwordx4 v13, s[4:7], s77 offen offset:1024 lds
    buffer_load_dwordx4 v14, s[4:7], s77 offen offset:2048 lds
    s_add_u32 m0, s79, 3072
    s_nop 0
    buffer_load_dwordx4 v15, s[4:7], s77 offen offset:0 lds
    buffer_load_dwordx4 v16, s[4:7], s77 offen offset:1024 lds
    buffer_load_dwordx4 v17, s[4:7], s77 offen offset:2048 lds
    s_add_u32 s77, s21, 2
    s_and_b32 s77, s77, 15
    s_mul_i32 s77, s77, 393216
    s_add_u32 m0, s79, 24576
    s_nop 0
    buffer_load_dwordx4 v12, s[4:7], s77 offen offset:0 lds
    buffer_load_dwordx4 v13, s[4:7], s77 offen offset:1024 lds
    buffer_load_dwordx4 v14, s[4:7], s77 offen offset:2048 lds
    s_add_u32 m0, s79, 27648
    s_nop 0
    buffer_load_dwordx4 v15, s[4:7], s77 offen offset:0 lds
    buffer_load_dwordx4 v16, s[4:7], s77 offen offset:1024 lds
    buffer_load_dwordx4 v17, s[4:7], s77 offen offset:2048 lds
    s_waitcnt vmcnt(12)
    s_add_u32 s76, s21, 1
    s_and_b32 s76, s76, 15
    s_lshl_b32 s76, s76, 12
    s_barrier
    s_add_u32 m0, s78, 65536
    s_nop 0
    buffer_load_dwordx4 v8, s[16:19], s76 offen offset:0 sc1 lds
    buffer_load_dwordx4 v8, s[16:19], s76 offen offset:1024 sc1 lds
    buffer_load_dwordx4 v8, s[16:19], s76 offen offset:2048 sc1 lds
    buffer_load_dwordx4 v8, s[16:19], s76 offen offset:3072 sc1 lds
    s_add_u32 s76, s21, 2
    s_and_b32 s76, s76, 15
    s_lshl_b32 s76, s76, 12
    s_add_u32 m0, s78, 81920
    s_nop 0
    buffer_load_dwordx4 v8, s[16:19], s76 offen offset:0 sc1 lds
    v_add_u32 v45, 5, v19
    v_and_b32 v45, 15, v45
    s_mov_b32 s27, 393216
    v_mad_u32_u24 v45, v45, s27, v18
    buffer_load_dwordx4 v8, s[16:19], s76 offen offset:1024 sc1 lds
    s_mov_b64 exec, 4095
    buffer_load_dword v255, v45, s[4:7], 0 offen
    s_mov_b64 exec, -1
    buffer_load_dwordx4 v8, s[16:19], s76 offen offset:2048 sc1 lds
    buffer_load_dwordx4 v8, s[16:19], s76 offen offset:3072 sc1 lds
    s_waitcnt vmcnt(5)
    ds_read2st64_b32 v[40:41], v169 offset0:64 offset1:68
    ds_read2st64_b32 v[42:43], v169 offset0:72 offset1:76
    s_waitcnt lgkmcnt(0)
    v_bitop3_b32 v40, v40, v41, v42 bitop3:0x80
    v_bitop3_b32 v40, v40, v43, 1 bitop3:0x80
    v_cmp_eq_u32 vcc, 0, v40
    s_nop 0
    s_cbranch_vccnz Lxrt_44
Lxok_43:
    s_add_u32 s76, s21, 3
    s_and_b32 s76, s76, 15
    s_mul_i32 s77, s76, 393216
    s_lshl_b32 s76, s76, 12
    s_add_u32 m0, s78, 49152
    s_barrier
    buffer_load_dwordx4 v8, s[16:19], s76 offen offset:0 sc1 lds
    s_lshl_b32 s27, s75, 8
    s_add_u32 s27, s27, 137216
    v_add_u32 v28, s27, v0
    ds_read_b128 v[24:27], v28
    buffer_load_dwordx4 v8, s[16:19], s76 offen offset:1024 sc1 lds
    s_waitcnt vmcnt(2)
    ds_read2st64_b32 v[40:41], v169 offset0:128 offset1:132
    ds_read2st64_b32 v[42:43], v169 offset0:136 offset1:140
    buffer_load_dwordx4 v8, s[16:19], s76 offen offset:2048 sc1 lds
    buffer_load_dwordx4 v8, s[16:19], s76 offen offset:3072 sc1 lds
    s_add_u32 m0, s79, 139264
    s_nop 0
    buffer_load_dwordx4 v12, s[4:7], s77 offen offset:0 lds
    s_lshr_b32 s27, s71, 4
    s_waitcnt lgkmcnt(0)
    s_mov_b64 exec, 0xffff
    s_cmp_eq_u32 s23, 0
    s_cbranch_scc1 Lslow_47
    buffer_store_dwordx4 v[24:27], v0, s[12:15], s27 offen
Lback_48:
    s_mov_b64 exec, -1
    buffer_load_dwordx4 v13, s[4:7], s77 offen offset:1024 lds
    s_waitcnt lgkmcnt(0)
    v_bitop3_b32 v40, v40, v41, v42 bitop3:0x80
    v_bitop3_b32 v40, v40, v43, 1 bitop3:0x80
    v_cmp_eq_u32 vcc, 0, v40
    buffer_load_dwordx4 v14, s[4:7], s77 offen offset:2048 lds
    s_cbranch_vccnz Lxrt_46
Lxok_45:
    s_add_u32 m0, s79, 142336
    s_nop 0
    buffer_load_dwordx4 v15, s[4:7], s77 offen offset:0 lds
    buffer_load_dwordx4 v16, s[4:7], s77 offen offset:1024 lds
    buffer_load_dwordx4 v17, s[4:7], s77 offen offset:2048 lds
    s_add_u32 s76, s21, 4
    s_and_b32 s76, s76, 15
    s_mul_i32 s77, s76, 393216
    s_lshl_b32 s76, s76, 12
    s_add_u32 m0, s78, 65536
    s_barrier
    buffer_load_dwordx4 v8, s[16:19], s76 offen offset:0 sc1 lds
    s_lshr_b32 s27, s71, 9
    s_add_u32 s27, s27, 802816
    v_mov_b32 v46, s27
    v_mov_b32 v44, s24
    v_mov_b32 v45, s25
    s_waitcnt vmcnt(6)
    s_mov_b64 exec, 1
    s_cmp_eq_u32 s23, 0
    s_cbranch_scc1 Lslow_51
    buffer_store_dwordx2 v[44:45], v46, s[12:15], 0 offen offset:0
Lback_52:
    s_mov_b64 exec, -1
    buffer_load_dwordx4 v8, s[16:19], s76 offen offset:1024 sc1 lds
    ds_read2st64_b32 v[40:41], v169 offset0:0 offset1:4
    ds_read2st64_b32 v[42:43], v169 offset0:8 offset1:12
    buffer_load_dwordx4 v8, s[16:19], s76 offen offset:2048 sc1 lds
    buffer_load_dwordx4 v8, s[16:19], s76 offen offset:3072 sc1 lds
    s_add_u32 m0, s79, 0
    s_nop 0
    buffer_load_dwordx4 v12, s[4:7], s77 offen offset:0 lds
    buffer_load_dwordx4 v13, s[4:7], s77 offen offset:1024 lds
    s_waitcnt lgkmcnt(0)
    v_bitop3_b32 v40, v40, v41, v42 bitop3:0x80
    v_bitop3_b32 v40, v40, v43, 1 bitop3:0x80
    v_cmp_eq_u32 vcc, 0, v40
    buffer_load_dwordx4 v14, s[4:7], s77 offen offset:2048 lds
    s_cbranch_vccnz Lxrt_50
Lxok_49:
    s_add_u32 m0, s79, 3072
    s_nop 0
    buffer_load_dwordx4 v15, s[4:7], s77 offen offset:0 lds
    buffer_load_dwordx4 v16, s[4:7], s77 offen offset:1024 lds
    buffer_load_dwordx4 v17, s[4:7], s77 offen offset:2048 lds
    s_add_u32 s76, s21, 5
    s_and_b32 s76, s76, 15
    s_mul_i32 s77, s76, 393216
    s_lshl_b32 s76, s76, 12
    s_add_u32 m0, s78, 81920
    s_waitcnt vmcnt(11)
    s_barrier
    buffer_load_dwordx4 v8, s[16:19], s76 offen offset:0 sc1 lds
    buffer_load_dwordx4 v8, s[16:19], s76 offen offset:1024 sc1 lds
    s_waitcnt vmcnt(8)
    ds_read2st64_b32 v[40:41], v169 offset0:64 offset1:68
    ds_read2st64_b32 v[42:43], v169 offset0:72 offset1:76
    buffer_load_dwordx4 v8, s[16:19], s76 offen offset:2048 sc1 lds
    buffer_load_dwordx4 v8, s[16:19], s76 offen offset:3072 sc1 lds
    s_add_u32 m0, s79, 24576
    s_nop 0
    buffer_load_dwordx4 v12, s[4:7], s77 offen offset:0 lds
    buffer_load_dwordx4 v13, s[4:7], s77 offen offset:1024 lds
    s_waitcnt lgkmcnt(0)
    v_bitop3_b32 v40, v40, v41, v42 bitop3:0x80
    v_bitop3_b32 v40, v40, v43, 1 bitop3:0x80
    v_cmp_eq_u32 vcc, 0, v40
    buffer_load_dwordx4 v14, s[4:7], s77 offen offset:2048 lds
    s_cbranch_vccnz Lxrt_54
Lxok_53:
    s_add_u32 m0, s79, 27648
    s_nop 0
    buffer_load_dwordx4 v15, s[4:7], s77 offen offset:0 lds
    buffer_load_dwordx4 v16, s[4:7], s77 offen offset:1024 lds
    buffer_load_dwordx4 v17, s[4:7], s77 offen offset:2048 lds
    s_add_u32 s76, s21, 6
    s_and_b32 s76, s76, 15
    s_mul_i32 s77, s76, 393216
    s_lshl_b32 s76, s76, 12
    s_add_u32 m0, s78, 49152
    s_waitcnt vmcnt(10)
    s_barrier
    buffer_load_dwordx4 v8, s[16:19], s76 offen offset:0 sc1 lds
    v_add_u32 v45, 9, v19
    v_and_b32 v45, 15, v45
    s_mov_b32 s27, 393216
    v_mad_u32_u24 v45, v45, s27, v18
    buffer_load_dwordx4 v8, s[16:19], s76 offen offset:1024 sc1 lds
    s_waitcnt vmcnt(8)
    ds_read2st64_b32 v[40:41], v169 offset0:128 offset1:132
    ds_read2st64_b32 v[42:43], v169 offset0:136 offset1:140
    buffer_load_dwordx4 v8, s[16:19], s76 offen offset:2048 sc1 lds
    buffer_load_dwordx4 v8, s[16:19], s76 offen offset:3072 sc1 lds
    s_mov_b64 exec, 4095
    buffer_load_dword v255, v45, s[4:7], 0 offen
    s_mov_b64 exec, -1
    s_add_u32 m0, s79, 139264
    s_nop 0
    buffer_load_dwordx4 v12, s[4:7], s77 offen offset:0 lds
    buffer_load_dwordx4 v13, s[4:7], s77 offen offset:1024 lds
    s_waitcnt lgkmcnt(0)
    v_bitop3_b32 v40, v40, v41, v42 bitop3:0x80
    v_bitop3_b32 v40, v40, v43, 1 bitop3:0x80
    v_cmp_eq_u32 vcc, 0, v40
    buffer_load_dwordx4 v14, s[4:7], s77 offen offset:2048 lds
    s_cbranch_vccnz Lxrt_56
Lxok_55:
    s_add_u32 m0, s79, 142336
    s_nop 0
    buffer_load_dwordx4 v15, s[4:7], s77 offen offset:0 lds
    buffer_load_dwordx4 v16, s[4:7], s77 offen offset:1024 lds
    buffer_load_dwordx4 v17, s[4:7], s77 offen offset:2048 lds
    s_add_u32 s76, s21, 7
    s_and_b32 s76, s76, 15
    s_mul_i32 s77, s76, 393216
    s_lshl_b32 s76, s76, 12
    s_add_u32 m0, s78, 65536
    s_waitcnt vmcnt(11)
    s_barrier
    buffer_load_dwordx4 v8, s[16:19], s76 offen offset:0 sc1 lds
    buffer_load_dwordx2 v[24:25], v168, s[12:15], 0 offen offset:0 sc1
    buffer_load_dwordx4 v8, s[16:19], s76 offen offset:1024 sc1 lds
    s_waitcnt vmcnt(10)
    ds_read2st64_b32 v[40:41], v169 offset0:0 offset1:4
    ds_read2st64_b32 v[42:43], v169 offset0:8 offset1:12
    buffer_load_dwordx4 v8, s[16:19], s76 offen offset:2048 sc1 lds
    buffer_load_dwordx4 v8, s[16:19], s76 offen offset:3072 sc1 lds
    s_add_u32 m0, s79, 0
    s_nop 0
    buffer_load_dwordx4 v12, s[4:7], s77 offen offset:0 lds
    buffer_load_dwordx4 v13, s[4:7], s77 offen offset:1024 lds
    s_waitcnt lgkmcnt(0)
    v_bitop3_b32 v40, v40, v41, v42 bitop3:0x80
    v_bitop3_b32 v40, v40, v43, 1 bitop3:0x80
    v_cmp_eq_u32 vcc, 0, v40
    buffer_load_dwordx4 v14, s[4:7], s77 offen offset:2048 lds
    s_cbranch_vccnz Lxrt_58
Lxok_57:
    s_add_u32 m0, s79, 3072
    s_nop 0
    buffer_load_dwordx4 v15, s[4:7], s77 offen offset:0 lds
    buffer_load_dwordx4 v16, s[4:7], s77 offen offset:1024 lds
    buffer_load_dwordx4 v17, s[4:7], s77 offen offset:2048 lds
    s_add_u32 s76, s21, 8
    s_and_b32 s76, s76, 15
    s_mul_i32 s77, s76, 393216
    s_lshl_b32 s76, s76, 12
    s_add_u32 m0, s78, 81920
    s_waitcnt vmcnt(11)
    s_barrier
    buffer_load_dwordx4 v8, s[16:19], s76 offen offset:0 sc1 lds
    s_waitcnt vmcnt(10)
    v_xor_b32 v26, s24, v24
    v_xor_b32 v27, s25, v25
    v_lshrrev_b32 v27, 5, v27
    v_or_b32 v26, v26, v27
    v_cmp_ne_u32 vcc, 0, v26
    s_nop 0
    s_cbranch_vccz Lsok_61
    s_mov_b32 s26, 0
Lpoll_62:
    buffer_load_dwordx2 v[24:25], v168, s[12:15], 0 offen offset:0 sc1
    s_waitcnt vmcnt(0)
    v_xor_b32 v26, s24, v24
    v_xor_b32 v27, s25, v25
    v_lshrrev_b32 v27, 5, v27
    v_or_b32 v26, v26, v27
    v_cmp_ne_u32 vcc, 0, v26
    s_nop 0
    s_cbranch_vccz Lok_63
    s_add_u32 s26, s26, 1
    s_cmp_lt_u32 s26, 262144
    s_cbranch_scc1 Lpoll_62
Lok_63:
Lsok_61:
    buffer_load_dwordx4 v8, s[16:19], s76 offen offset:1024 sc1 lds
    s_waitcnt vmcnt(8)
    ds_read2st64_b32 v[40:41], v169 offset0:64 offset1:68
    ds_read2st64_b32 v[42:43], v169 offset0:72 offset1:76
    buffer_load_dwordx4 v8, s[16:19], s76 offen offset:2048 sc1 lds
    buffer_load_dwordx4 v8, s[16:19], s76 offen offset:3072 sc1 lds
    s_add_u32 m0, s79, 24576
    s_nop 0
    buffer_load_dwordx4 v12, s[4:7], s77 offen offset:0 lds
    buffer_load_dwordx4 v13, s[4:7], s77 offen offset:1024 lds
    s_waitcnt lgkmcnt(0)
    v_bitop3_b32 v40, v40, v41, v42 bitop3:0x80
    v_bitop3_b32 v40, v40, v43, 1 bitop3:0x80
    v_cmp_eq_u32 vcc, 0, v40
    buffer_load_dwordx4 v14, s[4:7], s77 offen offset:2048 lds
    s_cbranch_vccnz Lxrt_60
Lxok_59:
    s_add_u32 m0, s79, 27648
    s_nop 0
    buffer_load_dwordx4 v15, s[4:7], s77 offen offset:0 lds
    buffer_load_dwordx4 v16, s[4:7], s77 offen offset:1024 lds
    buffer_load_dwordx4 v17, s[4:7], s77 offen offset:2048 lds
    s_add_u32 s76, s21, 9
    s_and_b32 s76, s76, 15
    s_mul_i32 s77, s76, 393216
    s_lshl_b32 s76, s76, 12
    s_add_u32 m0, s78, 49152
    s_waitcnt vmcnt(10)
    s_barrier
    buffer_load_dwordx4 v8, s[16:19], s76 offen offset:0 sc1 lds
    buffer_load_dwordx4 v8, s[16:19], s76 offen offset:1024 sc1 lds
    s_waitcnt vmcnt(8)
    ds_read2st64_b32 v[40:41], v169 offset0:128 offset1:132
    ds_read2st64_b32 v[42:43], v169 offset0:136 offset1:140
    buffer_load_dwordx4 v8, s[16:19], s76 offen offset:2048 sc1 lds
    buffer_load_dwordx4 v8, s[16:19], s76 offen offset:3072 sc1 lds
    s_add_u32 m0, s79, 139264
    s_nop 0
    buffer_load_dwordx4 v12, s[4:7], s77 offen offset:0 lds
    buffer_load_dwordx4 v13, s[4:7], s77 offen offset:1024 lds
    s_waitcnt lgkmcnt(0)
    v_bitop3_b32 v40, v40, v41, v42 bitop3:0x80
    v_bitop3_b32 v40, v40, v43, 1 bitop3:0x80
    v_cmp_eq_u32 vcc, 0, v40
    buffer_load_dwordx4 v14, s[4:7], s77 offen offset:2048 lds
    s_cbranch_vccnz Lxrt_65
Lxok_64:
    s_add_u32 m0, s79, 142336
    s_nop 0
    buffer_load_dwordx4 v15, s[4:7], s77 offen offset:0 lds
    buffer_load_dwordx4 v16, s[4:7], s77 offen offset:1024 lds
    buffer_load_dwordx4 v17, s[4:7], s77 offen offset:2048 lds
    s_add_u32 s76, s21, 10
    s_and_b32 s76, s76, 15
    s_mul_i32 s77, s76, 393216
    s_lshl_b32 s76, s76, 12
    s_add_u32 m0, s78, 65536
    s_waitcnt vmcnt(10)
    s_barrier
    buffer_load_dwordx4 v8, s[16:19], s76 offen offset:0 sc1 lds
    s_lshr_b32 s27, s71, 16
    s_lshl_b32 s27, s27, 12
    buffer_load_dwordx4 v[24:27], v0, s[12:15], s27 offen offset:0 sc1
    buffer_load_dwordx4 v8, s[16:19], s76 offen offset:1024 sc1 lds
    buffer_load_dwordx4 v8, s[16:19], s76 offen offset:2048 sc1 lds
    buffer_load_dwordx4 v8, s[16:19], s76 offen offset:3072 sc1 lds
    v_add_u32 v45, 13, v19
    v_and_b32 v45, 15, v45
    s_mov_b32 s27, 393216
    v_mad_u32_u24 v45, v45, s27, v18
    s_add_u32 m0, s79, 0
    s_nop 0
    buffer_load_dwordx4 v12, s[4:7], s77 offen offset:0 lds
    buffer_load_dwordx4 v13, s[4:7], s77 offen offset:1024 lds
    buffer_load_dwordx4 v14, s[4:7], s77 offen offset:2048 lds
    s_mov_b64 exec, 4095
    buffer_load_dword v255, v45, s[4:7], 0 offen
    s_mov_b64 exec, -1
    s_add_u32 m0, s79, 3072
    s_nop 0
    buffer_load_dwordx4 v15, s[4:7], s77 offen offset:0 lds
    buffer_load_dwordx4 v16, s[4:7], s77 offen offset:1024 lds
    buffer_load_dwordx4 v17, s[4:7], s77 offen offset:2048 lds
    s_add_u32 s76, s21, 11
    s_and_b32 s76, s76, 15
    s_mul_i32 s77, s76, 393216
    s_lshl_b32 s76, s76, 12
    s_add_u32 m0, s78, 81920
    s_waitcnt vmcnt(18)
    s_waitcnt vmcnt(12)
    s_barrier
    buffer_load_dwordx4 v8, s[16:19], s76 offen offset:0 sc1 lds
    s_lshr_b32 s27, s71, 16
    s_lshl_b32 s27, s27, 12
    buffer_load_dwordx4 v[28:31], v0, s[12:15], s27 offen offset:1024 sc1
    buffer_load_dwordx4 v8, s[16:19], s76 offen offset:1024 sc1 lds
    buffer_load_dwordx4 v8, s[16:19], s76 offen offset:2048 sc1 lds
    buffer_load_dwordx4 v8, s[16:19], s76 offen offset:3072 sc1 lds
    s_add_u32 m0, s79, 24576
    s_nop 0
    buffer_load_dwordx4 v12, s[4:7], s77 offen offset:0 lds
    buffer_load_dwordx4 v13, s[4:7], s77 offen offset:1024 lds
    buffer_load_dwordx4 v14, s[4:7], s77 offen offset:2048 lds
    s_add_u32 m0, s79, 27648
    s_nop 0
    buffer_load_dwordx4 v15, s[4:7], s77 offen offset:0 lds
    buffer_load_dwordx4 v16, s[4:7], s77 offen offset:1024 lds
    buffer_load_dwordx4 v17, s[4:7], s77 offen offset:2048 lds
    s_add_u32 s76, s21, 12
    s_and_b32 s76, s76, 15
    s_mul_i32 s77, s76, 393216
    s_lshl_b32 s76, s76, 12
    s_add_u32 m0, s78, 49152
    s_waitcnt vmcnt(18)
    s_waitcnt vmcnt(11)
    s_barrier
    buffer_load_dwordx4 v8, s[16:19], s76 offen offset:0 sc1 lds
    s_lshr_b32 s27, s71, 16
    s_lshl_b32 s27, s27, 12
    buffer_load_dwordx4 v[32:35], v0, s[12:15], s27 offen offset:2048 sc1
    buffer_load_dwordx4 v8, s[16:19], s76 offen offset:1024 sc1 lds
    buffer_load_dwordx4 v8, s[16:19], s76 offen offset:2048 sc1 lds
    buffer_load_dwordx4 v8, s[16:19], s76 offen offset:3072 sc1 lds
    s_add_u32 m0, s79, 139264
    s_nop 0
    buffer_load_dwordx4 v12, s[4:7], s77 offen offset:0 lds
    buffer_load_dwordx4 v13, s[4:7], s77 offen offset:1024 lds
    buffer_load_dwordx4 v14, s[4:7], s77 offen offset:2048 lds
    s_add_u32 m0, s79, 142336
    s_nop 0
    buffer_load_dwordx4 v15, s[4:7], s77 offen offset:0 lds
    buffer_load_dwordx4 v16, s[4:7], s77 offen offset:1024 lds
    buffer_load_dwordx4 v17, s[4:7], s77 offen offset:2048 lds
    s_add_u32 s76, s21, 13
    s_and_b32 s76, s76, 15
    s_mul_i32 s77, s76, 393216
    s_lshl_b32 s76, s76, 12
    s_add_u32 m0, s78, 65536
    s_waitcnt vmcnt(17)
    s_waitcnt vmcnt(11)
    s_barrier
    buffer_load_dwordx4 v8, s[16:19], s76 offen offset:0 sc1 lds
    s_lshr_b32 s27, s71, 16
    s_lshl_b32 s27, s27, 12
    buffer_load_dwordx4 v[36:39], v0, s[12:15], s27 offen offset:3072 sc1
    buffer_load_dwordx4 v8, s[16:19], s76 offen offset:1024 sc1 lds
    buffer_load_dwordx4 v8, s[16:19], s76 offen offset:2048 sc1 lds
    buffer_load_dwordx4 v8, s[16:19], s76 offen offset:3072 sc1 lds
    s_add_u32 m0, s79, 0
    s_nop 0
    buffer_load_dwordx4 v12, s[4:7], s77 offen offset:0 lds
    buffer_load_dwordx4 v13, s[4:7], s77 offen offset:1024 lds
    buffer_load_dwordx4 v14, s[4:7], s77 offen offset:2048 lds
    s_add_u32 m0, s79, 3072
    s_nop 0
    buffer_load_dwordx4 v15, s[4:7], s77 offen offset:0 lds
    buffer_load_dwordx4 v16, s[4:7], s77 offen offset:1024 lds
    buffer_load_dwordx4 v17, s[4:7], s77 offen offset:2048 lds
    s_add_u32 s76, s21, 14
    s_and_b32 s76, s76, 15
    s_mul_i32 s77, s76, 393216
    s_lshl_b32 s76, s76, 12
    s_add_u32 m0, s78, 81920
    s_waitcnt vmcnt(17)
    s_waitcnt vmcnt(11)
    s_barrier
    buffer_load_dwordx4 v8, s[16:19], s76 offen offset:0 sc1 lds
    buffer_load_dwordx4 v8, s[16:19], s76 offen offset:1024 sc1 lds
    buffer_load_dwordx4 v8, s[16:19], s76 offen offset:2048 sc1 lds
    buffer_load_dwordx4 v8, s[16:19], s76 offen offset:3072 sc1 lds
    s_add_u32 m0, s79, 24576
    s_nop 0
    buffer_load_dwordx4 v12, s[4:7], s77 offen offset:0 lds
    buffer_load_dwordx4 v13, s[4:7], s77 offen offset:1024 lds
    buffer_load_dwordx4 v14, s[4:7], s77 offen offset:2048 lds
    s_add_u32 m0, s79, 27648
    s_nop 0
    buffer_load_dwordx4 v15, s[4:7], s77 offen offset:0 lds
    buffer_load_dwordx4 v16, s[4:7], s77 offen offset:1024 lds
    buffer_load_dwordx4 v17, s[4:7], s77 offen offset:2048 lds
    s_add_u32 s76, s21, 15
    s_and_b32 s76, s76, 15
    s_mul_i32 s77, s76, 393216
    s_lshl_b32 s76, s76, 12
    s_add_u32 m0, s78, 49152
    s_waitcnt vmcnt(16)
    s_waitcnt vmcnt(10)
    s_barrier
    buffer_load_dwordx4 v8, s[16:19], s76 offen offset:0 sc1 lds
    buffer_load_dwordx4 v8, s[16:19], s76 offen offset:1024 sc1 lds
    v_add_f32 v24, v24, v32
    v_add_f32 v25, v25, v33
    v_add_f32 v26, v26, v34
    buffer_load_dwordx4 v8, s[16:19], s76 offen offset:2048 sc1 lds
    v_add_f32 v27, v27, v35
    v_add_f32 v28, v28, v36
    v_add_f32 v29, v29, v37
    buffer_load_dwordx4 v8, s[16:19], s76 offen offset:3072 sc1 lds
    v_add_f32 v30, v30, v38
    v_add_f32 v31, v31, v39
    v_add_f32 v24, v24, v28
    s_add_u32 m0, s79, 139264
    s_nop 0
    buffer_load_dwordx4 v12, s[4:7], s77 offen offset:0 lds
    buffer_load_dwordx4 v13, s[4:7], s77 offen offset:1024 lds
    v_add_f32 v25, v25, v29
    v_add_f32 v26, v26, v30
    v_add_f32 v27, v27, v31
    buffer_load_dwordx4 v14, s[4:7], s77 offen offset:2048 lds
    v_permlane32_swap_b32 v24, v26
    v_permlane32_swap_b32 v25, v27
    v_add_f32 v24, v24, v26
    s_add_u32 m0, s79, 142336
    s_nop 0
    buffer_load_dwordx4 v15, s[4:7], s77 offen offset:0 lds
    v_add_f32 v25, v25, v27
    v_mov_b32 v26, v24
    v_mov_b32 v27, v25
    buffer_load_dwordx4 v16, s[4:7], s77 offen offset:1024 lds
    buffer_load_dwordx4 v17, s[4:7], s77 offen offset:2048 lds
    s_waitcnt vmcnt(16)
    s_waitcnt vmcnt(10)
    s_barrier
    s_add_u32 m0, s85, 0
    s_add_u32 s36, s86, 0
    s_and_b32 s36, s36, 0x1fffff
    buffer_load_dwordx4 v3, s[8:11], s36 offen lds
    v_permlane16_swap_b32 v24, v26
    v_permlane16_swap_b32 v25, v27
    v_add_f32 v24, v24, v26
    v_add_f32 v25, v25, v27
    v_mul_f32 v24, 0xba800000, v24
    v_mul_f32 v25, 0x3a800000, v25
    s_add_u32 m0, s85, 4096
    s_add_u32 s36, s86, 65536
    s_and_b32 s36, s36, 0x1fffff
    buffer_load_dwordx4 v3, s[8:11], s36 offen lds
    v_fma_f32 v25, -v24, v24, v25
    v_max_f32 v25, 0, v25
    v_add_f32 v25, 0x3727c5ac, v25
    v_rsq_f32 v25, v25
    s_add_u32 m0, s85, 8192
    s_add_u32 s36, s86, 131072
    s_and_b32 s36, s36, 0x1fffff
    buffer_load_dwordx4 v3, s[8:11], s36 offen lds
    v_mul_f32 v24, v24, v25
    ds_write_b32 v170, v25
    ds_write_b32 v170, v24 offset:512
    ds_write_b32 v171, v20
    s_lshr_b32 s27, s2, 3
    s_lshl_b32 s27, s27, 6
    s_lshl_b32 s28, s75, 4
    s_add_u32 s27, s27, s28
    s_add_u32 m0, s85, 12288
    s_add_u32 s36, s86, 196608
    s_and_b32 s36, s36, 0x1fffff
    buffer_load_dwordx4 v3, s[8:11], s36 offen lds
    v_add_u32 v44, s27, v1
    s_lshr_b32 s30, s8, 7
    s_sub_u32 s30, 3, s30
    s_and_b32 s30, s30, 7
    s_lshl_b32 s30, s30, 7
    v_and_b32 v45, 1, v44
    v_lshlrev_b32 v45, 10, v45
    v_lshrrev_b32 v44, 1, v44
    s_add_u32 m0, s85, 16384
    s_add_u32 s36, s86, 262144
    s_and_b32 s36, s36, 0x1fffff
    buffer_load_dwordx4 v3, s[8:11], s36 offen lds
    v_lshlrev_b32 v44, 11, v44
    v_add3_u32 v45, v45, v44, s30
    s_mov_b64 exec, 0xffff
    buffer_load_dword v255, v45, s[8:11], 0 offen
    s_mov_b64 exec, -1
    s_add_u32 m0, s85, 20480
    s_add_u32 s36, s86, 327680
    s_and_b32 s36, s36, 0x1fffff
    buffer_load_dwordx4 v3, s[8:11], s36 offen lds
    s_waitcnt vmcnt(13)
    s_waitcnt vmcnt(7)
    s_waitcnt lgkmcnt(0)
    s_barrier
    s_add_u32 m0, s85, 24576
    s_add_u32 s36, s86, 393216
    s_and_b32 s36, s36, 0x1fffff
    buffer_load_dwordx4 v3, s[8:11], s36 offen lds
    s_add_u32 m0, s85, 28672
    s_add_u32 s36, s86, 458752
    s_and_b32 s36, s36, 0x1fffff
    buffer_load_dwordx4 v3, s[8:11], s36 offen lds
    s_add_u32 m0, s85, 32768
    s_add_u32 s36, s86, 524288
    s_and_b32 s36, s36, 0x1fffff
    buffer_load_dwordx4 v3, s[8:11], s36 offen lds
    s_add_u32 m0, s85, 36864
    s_add_u32 s36, s86, 589824
    s_and_b32 s36, s36, 0x1fffff
    buffer_load_dwordx4 v3, s[8:11], s36 offen lds
    s_add_u32 m0, s85, 40960
    s_add_u32 s36, s86, 655360
    s_and_b32 s36, s36, 0x1fffff
    buffer_load_dwordx4 v3, s[8:11], s36 offen lds
    s_add_u32 m0, s85, 45056
    s_add_u32 s36, s86, 720896
    s_and_b32 s36, s36, 0x1fffff
    buffer_load_dwordx4 v3, s[8:11], s36 offen lds
    s_barrier
    s_branch L_attL
L_between2:
    s_add_u32 m0, s85, 122880
    s_add_u32 s36, s86, 1966080
    s_and_b32 s36, s36, 0x1fffff
    buffer_load_dwordx4 v3, s[8:11], s36 offen lds
    s_add_u32 m0, s85, 126976
    s_add_u32 s36, s86, 2031616
    s_and_b32 s36, s36, 0x1fffff
    buffer_load_dwordx4 v3, s[8:11], s36 offen lds
    s_mov_b32 s22, 3
    s_mov_b32 s4, s56
    s_mov_b32 s5, s57
    v_add_u32 v168, 8192, v168
    s_lshr_b32 s27, s2, 3
    s_mul_i32 s27, s27, 12
    s_mul_i32 s28, s75, 3
    s_add_u32 s27, s27, s28
    v_mul_u32_u24 v19, 21846, v1
    v_lshrrev_b32 v19, 16, v19
    v_mul_u32_u24 v24, 3, v19
    v_sub_u32 v24, v1, v24
    v_add_u32 v24, s27, v24
    s_lshr_b32 s30, s4, 7
    s_sub_u32 s30, 3, s30
    s_and_b32 s30, s30, 7
    s_lshl_b32 s30, s30, 7
    v_and_b32 v18, 1, v24
    v_lshlrev_b32 v18, 10, v18
    v_lshrrev_b32 v24, 1, v24
    v_lshlrev_b32 v24, 11, v24
    v_add3_u32 v18, v18, v24, s30
    v_bfe_u32 v24, v18, 7, 4
    v_add_u32 v19, v19, v24
    v_add_u32 v24, 0, v19
    v_and_b32 v24, 15, v24
    s_mov_b32 s27, 393216
    v_mad_u32_u24 v24, v24, s27, v18
    s_mov_b64 exec, 32767
    buffer_load_dword v255, v24, s[4:7], 0 offen
    s_mov_b64 exec, -1
    s_add_u32 s77, s21, 0
    s_and_b32 s77, s77, 15
    s_mul_i32 s77, s77, 393216
    s_add_u32 m0, s79, 139264
    s_nop 0
    buffer_load_dwordx4 v12, s[4:7], s77 offen offset:0 lds
    buffer_load_dwordx4 v13, s[4:7], s77 offen offset:1024 lds
    buffer_load_dwordx4 v14, s[4:7], s77 offen offset:2048 lds
    s_add_u32 m0, s79, 142336
    s_nop 0
    buffer_load_dwordx4 v15, s[4:7], s77 offen offset:0 lds
    buffer_load_dwordx4 v16, s[4:7], s77 offen offset:1024 lds
    buffer_load_dwordx4 v17, s[4:7], s77 offen offset:2048 lds
    s_barrier
    s_waitcnt vmcnt(7)
    s_mov_b32 s8, s58
    s_mov_b32 s9, s59
    s_barrier
    s_add_u32 s77, s21, 1
    s_and_b32 s77, s77, 15
    s_mul_i32 s77, s77, 393216
    s_add_u32 m0, s79, 0
    s_nop 0
    buffer_load_dwordx4 v12, s[4:7], s77 offen offset:0 lds
    buffer_load_dwordx4 v13, s[4:7], s77 offen offset:1024 lds
    buffer_load_dwordx4 v14, s[4:7], s77 offen offset:2048 lds
    s_add_u32 m0, s79, 3072
    s_nop 0
    buffer_load_dwordx4 v15, s[4:7], s77 offen offset:0 lds
    buffer_load_dwordx4 v16, s[4:7], s77 offen offset:1024 lds
    buffer_load_dwordx4 v17, s[4:7], s77 offen offset:2048 lds
    s_add_u32 s77, s21, 2
    s_and_b32 s77, s77, 15
    s_mul_i32 s77, s77, 393216
    s_add_u32 m0, s79, 24576
    s_nop 0
    buffer_load_dwordx4 v12, s[4:7], s77 offen offset:0 lds
    buffer_load_dwordx4 v13, s[4:7], s77 offen offset:1024 lds
    buffer_load_dwordx4 v14, s[4:7], s77 offen offset:2048 lds
    s_add_u32 m0, s79, 27648
    s_nop 0
    buffer_load_dwordx4 v15, s[4:7], s77 offen offset:0 lds
    buffer_load_dwordx4 v16, s[4:7], s77 offen offset:1024 lds
    buffer_load_dwordx4 v17, s[4:7], s77 offen offset:2048 lds
    s_waitcnt vmcnt(12)
    s_add_u32 s76, s21, 1
    s_and_b32 s76, s76, 15
    s_lshl_b32 s76, s76, 12
    s_barrier
    s_add_u32 m0, s78, 65536
    s_nop 0
    buffer_load_dwordx4 v8, s[16:19], s76 offen offset:0 sc1 lds
    buffer_load_dwordx4 v8, s[16:19], s76 offen offset:1024 sc1 lds
    buffer_load_dwordx4 v8, s[16:19], s76 offen offset:2048 sc1 lds
    buffer_load_dwordx4 v8, s[16:19], s76 offen offset:3072 sc1 lds
    s_add_u32 s76, s21, 2
    s_and_b32 s76, s76, 15
    s_lshl_b32 s76, s76, 12
    s_add_u32 m0, s78, 81920
    s_nop 0
    buffer_load_dwordx4 v8, s[16:19], s76 offen offset:0 sc1 lds
    v_add_u32 v45, 5, v19
    v_and_b32 v45, 15, v45
    s_mov_b32 s27, 393216
    v_mad_u32_u24 v45, v45, s27, v18
    buffer_load_dwordx4 v8, s[16:19], s76 offen offset:1024 sc1 lds
    s_mov_b64 exec, 4095
    buffer_load_dword v255, v45, s[4:7], 0 offen
    s_mov_b64 exec, -1
    buffer_load_dwordx4 v8, s[16:19], s76 offen offset:2048 sc1 lds
    buffer_load_dwordx4 v8, s[16:19], s76 offen offset:3072 sc1 lds
    s_waitcnt vmcnt(5)
    ds_read2st64_b32 v[40:41], v169 offset0:64 offset1:68
    ds_read2st64_b32 v[42:43], v169 offset0:72 offset1:76
    s_waitcnt lgkmcnt(0)
    v_or3_b32 v40, v40, v41, v42
    v_bitop3_b32 v40, v40, v43, 1 bitop3:0xa8
    v_cmp_ne_u32 vcc, 0, v40
    s_nop 0
    s_cbranch_vccnz Lxrt_67
Lxok_66:
    s_add_u32 s76, s21, 3
    s_and_b32 s76, s76, 15
    s_mul_i32 s77, s76, 393216
    s_lshl_b32 s76, s76, 12
    s_add_u32 m0, s78, 49152
    s_barrier
    buffer_load_dwordx4 v8, s[16:19], s76 offen offset:0 sc1 lds
    s_lshl_b32 s27, s75, 8
    s_add_u32 s27, s27, 137216
    v_add_u32 v28, s27, v0
    ds_read_b128 v[24:27], v28
    buffer_load_dwordx4 v8, s[16:19], s76 offen offset:1024 sc1 lds
    s_waitcnt vmcnt(2)
    ds_read2st64_b32 v[40:41], v169 offset0:128 offset1:132
    ds_read2st64_b32 v[42:43], v169 offset0:136 offset1:140
    buffer_load_dwordx4 v8, s[16:19], s76 offen offset:2048 sc1 lds
    buffer_load_dwordx4 v8, s[16:19], s76 offen offset:3072 sc1 lds
    s_add_u32 m0, s79, 139264
    s_nop 0
    buffer_load_dwordx4 v12, s[4:7], s77 offen offset:0 lds
    s_lshr_b32 s27, s71, 4
    s_waitcnt lgkmcnt(0)
    s_mov_b64 exec, 0xffff
    s_cmp_eq_u32 s23, 0
    s_cbranch_scc1 Lslow_70
    buffer_store_dwordx4 v[24:27], v0, s[12:15], s27 offen
Lback_71:
    s_mov_b64 exec, -1
    buffer_load_dwordx4 v13, s[4:7], s77 offen offset:1024 lds
    s_waitcnt lgkmcnt(0)
    v_or3_b32 v40, v40, v41, v42
    v_bitop3_b32 v40, v40, v43, 1 bitop3:0xa8
    v_cmp_ne_u32 vcc, 0, v40
    buffer_load_dwordx4 v14, s[4:7], s77 offen offset:2048 lds
    s_cbranch_vccnz Lxrt_69
Lxok_68:
    s_add_u32 m0, s79, 142336
    s_nop 0
    buffer_load_dwordx4 v15, s[4:7], s77 offen offset:0 lds
    buffer_load_dwordx4 v16, s[4:7], s77 offen offset:1024 lds
    buffer_load_dwordx4 v17, s[4:7], s77 offen offset:2048 lds
    s_add_u32 s76, s21, 4
    s_and_b32 s76, s76, 15
    s_mul_i32 s77, s76, 393216
    s_lshl_b32 s76, s76, 12
    s_add_u32 m0, s78, 65536
    s_barrier
    buffer_load_dwordx4 v8, s[16:19], s76 offen offset:0 sc1 lds
    s_lshr_b32 s27, s71, 9
    s_add_u32 s27, s27, 811008
    v_mov_b32 v46, s27
    v_mov_b32 v44, s24
    v_mov_b32 v45, s25
    s_waitcnt vmcnt(6)
    s_mov_b64 exec, 1
    s_cmp_eq_u32 s23, 0
    s_cbranch_scc1 Lslow_74
    buffer_store_dwordx2 v[44:45], v46, s[12:15], 0 offen offset:0
Lback_75:
    s_mov_b64 exec, -1
    buffer_load_dwordx4 v8, s[16:19], s76 offen offset:1024 sc1 lds
    ds_read2st64_b32 v[40:41], v169 offset0:0 offset1:4
    ds_read2st64_b32 v[42:43], v169 offset0:8 offset1:12
    buffer_load_dwordx4 v8, s[16:19], s76 offen offset:2048 sc1 lds
    buffer_load_dwordx4 v8, s[16:19], s76 offen offset:3072 sc1 lds
    s_add_u32 m0, s79, 0
    s_nop 0
    buffer_load_dwordx4 v12, s[4:7], s77 offen offset:0 lds
    buffer_load_dwordx4 v13, s[4:7], s77 offen offset:1024 lds
    s_waitcnt lgkmcnt(0)
    v_or3_b32 v40, v40, v41, v42
    v_bitop3_b32 v40, v40, v43, 1 bitop3:0xa8
    v_cmp_ne_u32 vcc, 0, v40
    buffer_load_dwordx4 v14, s[4:7], s77 offen offset:2048 lds
    s_cbranch_vccnz Lxrt_73
Lxok_72:
    s_add_u32 m0, s79, 3072
    s_nop 0
    buffer_load_dwordx4 v15, s[4:7], s77 offen offset:0 lds
    buffer_load_dwordx4 v16, s[4:7], s77 offen offset:1024 lds
    buffer_load_dwordx4 v17, s[4:7], s77 offen offset:2048 lds
    s_add_u32 s76, s21, 5
    s_and_b32 s76, s76, 15
    s_mul_i32 s77, s76, 393216
    s_lshl_b32 s76, s76, 12
    s_add_u32 m0, s78, 81920
    s_waitcnt vmcnt(11)
    s_barrier
    buffer_load_dwordx4 v8, s[16:19], s76 offen offset:0 sc1 lds
    buffer_load_dwordx4 v8, s[16:19], s76 offen offset:1024 sc1 lds
    s_waitcnt vmcnt(8)
    ds_read2st64_b32 v[40:41], v169 offset0:64 offset1:68
    ds_read2st64_b32 v[42:43], v169 offset0:72 offset1:76
    buffer_load_dwordx4 v8, s[16:19], s76 offen offset:2048 sc1 lds
    buffer_load_dwordx4 v8, s[16:19], s76 offen offset:3072 sc1 lds
    s_add_u32 m0, s79, 24576
    s_nop 0
    buffer_load_dwordx4 v12, s[4:7], s77 offen offset:0 lds
    buffer_load_dwordx4 v13, s[4:7], s77 offen offset:1024 lds
    s_waitcnt lgkmcnt(0)
    v_or3_b32 v40, v40, v41, v42
    v_bitop3_b32 v40, v40, v43, 1 bitop3:0xa8
    v_cmp_ne_u32 vcc, 0, v40
    buffer_load_dwordx4 v14, s[4:7], s77 offen offset:2048 lds
    s_cbranch_vccnz Lxrt_77
Lxok_76:
    s_add_u32 m0, s79, 27648
    s_nop 0
    buffer_load_dwordx4 v15, s[4:7], s77 offen offset:0 lds
    buffer_load_dwordx4 v16, s[4:7], s77 offen offset:1024 lds
    buffer_load_dwordx4 v17, s[4:7], s77 offen offset:2048 lds
    s_add_u32 s76, s21, 6
    s_and_b32 s76, s76, 15
    s_mul_i32 s77, s76, 393216
    s_lshl_b32 s76, s76, 12
    s_add_u32 m0, s78, 49152
    s_waitcnt vmcnt(10)
    s_barrier
    buffer_load_dwordx4 v8, s[16:19], s76 offen offset:0 sc1 lds
    v_add_u32 v45, 9, v19
    v_and_b32 v45, 15, v45
    s_mov_b32 s27, 393216
    v_mad_u32_u24 v45, v45, s27, v18
    buffer_load_dwordx4 v8, s[16:19], s76 offen offset:1024 sc1 lds
    s_waitcnt vmcnt(8)
    ds_read2st64_b32 v[40:41], v169 offset0:128 offset1:132
    ds_read2st64_b32 v[42:43], v169 offset0:136 offset1:140
    buffer_load_dwordx4 v8, s[16:19], s76 offen offset:2048 sc1 lds
    buffer_load_dwordx4 v8, s[16:19], s76 offen offset:3072 sc1 lds
    s_mov_b64 exec, 4095
    buffer_load_dword v255, v45, s[4:7], 0 offen
    s_mov_b64 exec, -1
    s_add_u32 m0, s79, 139264
    s_nop 0
    buffer_load_dwordx4 v12, s[4:7], s77 offen offset:0 lds
    buffer_load_dwordx4 v13, s[4:7], s77 offen offset:1024 lds
    s_waitcnt lgkmcnt(0)
    v_or3_b32 v40, v40, v41, v42
    v_bitop3_b32 v40, v40, v43, 1 bitop3:0xa8
    v_cmp_ne_u32 vcc, 0, v40
    buffer_load_dwordx4 v14, s[4:7], s77 offen offset:2048 lds
    s_cbranch_vccnz Lxrt_79
Lxok_78:
    s_add_u32 m0, s79, 142336
    s_nop 0
    buffer_load_dwordx4 v15, s[4:7], s77 offen offset:0 lds
    buffer_load_dwordx4 v16, s[4:7], s77 offen offset:1024 lds
    buffer_load_dwordx4 v17, s[4:7], s77 offen offset:2048 lds
    s_add_u32 s76, s21, 7
    s_and_b32 s76, s76, 15
    s_mul_i32 s77, s76, 393216
    s_lshl_b32 s76, s76, 12
    s_add_u32 m0, s78, 65536
    s_waitcnt vmcnt(11)
    s_barrier
    buffer_load_dwordx4 v8, s[16:19], s76 offen offset:0 sc1 lds
    buffer_load_dwordx2 v[24:25], v168, s[12:15], 0 offen offset:0 sc1
    buffer_load_dwordx4 v8, s[16:19], s76 offen offset:1024 sc1 lds
    s_waitcnt vmcnt(10)
    ds_read2st64_b32 v[40:41], v169 offset0:0 offset1:4
    ds_read2st64_b32 v[42:43], v169 offset0:8 offset1:12
    buffer_load_dwordx4 v8, s[16:19], s76 offen offset:2048 sc1 lds
    buffer_load_dwordx4 v8, s[16:19], s76 offen offset:3072 sc1 lds
    s_add_u32 m0, s79, 0
    s_nop 0
    buffer_load_dwordx4 v12, s[4:7], s77 offen offset:0 lds
    buffer_load_dwordx4 v13, s[4:7], s77 offen offset:1024 lds
    s_waitcnt lgkmcnt(0)
    v_or3_b32 v40, v40, v41, v42
    v_bitop3_b32 v40, v40, v43, 1 bitop3:0xa8
    v_cmp_ne_u32 vcc, 0, v40
    buffer_load_dwordx4 v14, s[4:7], s77 offen offset:2048 lds
    s_cbranch_vccnz Lxrt_81
Lxok_80:
    s_add_u32 m0, s79, 3072
    s_nop 0
    buffer_load_dwordx4 v15, s[4:7], s77 offen offset:0 lds
    buffer_load_dwordx4 v16, s[4:7], s77 offen offset:1024 lds
    buffer_load_dwordx4 v17, s[4:7], s77 offen offset:2048 lds
    s_add_u32 s76, s21, 8
    s_and_b32 s76, s76, 15
    s_mul_i32 s77, s76, 393216
    s_lshl_b32 s76, s76, 12
    s_add_u32 m0, s78, 81920
    s_waitcnt vmcnt(11)
    s_barrier
    buffer_load_dwordx4 v8, s[16:19], s76 offen offset:0 sc1 lds
    s_waitcnt vmcnt(10)
    v_xor_b32 v26, s24, v24
    v_xor_b32 v27, s25, v25
    v_lshrrev_b32 v27, 5, v27
    v_or_b32 v26, v26, v27
    v_cmp_ne_u32 vcc, 0, v26
    s_nop 0
    s_cbranch_vccz Lsok_84
    s_mov_b32 s26, 0
Lpoll_85:
    buffer_load_dwordx2 v[24:25], v168, s[12:15], 0 offen offset:0 sc1
    s_waitcnt vmcnt(0)
    v_xor_b32 v26, s24, v24
    v_xor_b32 v27, s25, v25
    v_lshrrev_b32 v27, 5, v27
    v_or_b32 v26, v26, v27
    v_cmp_ne_u32 vcc, 0, v26
    s_nop 0
    s_cbranch_vccz Lok_86
    s_add_u32 s26, s26, 1
    s_cmp_lt_u32 s26, 262144
    s_cbranch_scc1 Lpoll_85
Lok_86:
Lsok_84:
    buffer_load_dwordx4 v8, s[16:19], s76 offen offset:1024 sc1 lds
    s_waitcnt vmcnt(8)
    ds_read2st64_b32 v[40:41], v169 offset0:64 offset1:68
    ds_read2st64_b32 v[42:43], v169 offset0:72 offset1:76
    buffer_load_dwordx4 v8, s[16:19], s76 offen offset:2048 sc1 lds
    buffer_load_dwordx4 v8, s[16:19], s76 offen offset:3072 sc1 lds
    s_add_u32 m0, s79, 24576
    s_nop 0
    buffer_load_dwordx4 v12, s[4:7], s77 offen offset:0 lds
    buffer_load_dwordx4 v13, s[4:7], s77 offen offset:1024 lds
    s_waitcnt lgkmcnt(0)
    v_or3_b32 v40, v40, v41, v42
    v_bitop3_b32 v40, v40, v43, 1 bitop3:0xa8
    v_cmp_ne_u32 vcc, 0, v40
    buffer_load_dwordx4 v14, s[4:7], s77 offen offset:2048 lds
    s_cbranch_vccnz Lxrt_83
Lxok_82:
    s_add_u32 m0, s79, 27648
    s_nop 0
    buffer_load_dwordx4 v15, s[4:7], s77 offen offset:0 lds
    buffer_load_dwordx4 v16, s[4:7], s77 offen offset:1024 lds
    buffer_load_dwordx4 v17, s[4:7], s77 offen offset:2048 lds
    s_add_u32 s76, s21, 9
    s_and_b32 s76, s76, 15
    s_mul_i32 s77, s76, 393216
    s_lshl_b32 s76, s76, 12
    s_add_u32 m0, s78, 49152
    s_waitcnt vmcnt(10)
    s_barrier
    buffer_load_dwordx4 v8, s[16:19], s76 offen offset:0 sc1 lds
    buffer_load_dwordx4 v8, s[16:19], s76 offen offset:1024 sc1 lds
    s_waitcnt vmcnt(8)
    ds_read2st64_b32 v[40:41], v169 offset0:128 offset1:132
    ds_read2st64_b32 v[42:43], v169 offset0:136 offset1:140
    buffer_load_dwordx4 v8, s[16:19], s76 offen offset:2048 sc1 lds
    buffer_load_dwordx4 v8, s[16:19], s76 offen offset:3072 sc1 lds
    s_add_u32 m0, s79, 139264
    s_nop 0
    buffer_load_dwordx4 v12, s[4:7], s77 offen offset:0 lds
    buffer_load_dwordx4 v13, s[4:7], s77 offen offset:1024 lds
    s_waitcnt lgkmcnt(0)
    v_or3_b32 v40, v40, v41, v42
    v_bitop3_b32 v40, v40, v43, 1 bitop3:0xa8
    v_cmp_ne_u32 vcc, 0, v40
    buffer_load_dwordx4 v14, s[4:7], s77 offen offset:2048 lds
    s_cbranch_vccnz Lxrt_88
Lxok_87:
    s_add_u32 m0, s79, 142336
    s_nop 0
    buffer_load_dwordx4 v15, s[4:7], s77 offen offset:0 lds
    buffer_load_dwordx4 v16, s[4:7], s77 offen offset:1024 lds
    buffer_load_dwordx4 v17, s[4:7], s77 offen offset:2048 lds
    s_add_u32 s76, s21, 10
    s_and_b32 s76, s76, 15
    s_mul_i32 s77, s76, 393216
    s_lshl_b32 s76, s76, 12
    s_add_u32 m0, s78, 65536
    s_waitcnt vmcnt(10)
    s_barrier
    buffer_load_dwordx4 v8, s[16:19], s76 offen offset:0 sc1 lds
    s_lshr_b32 s27, s71, 16
    s_lshl_b32 s27, s27, 12
    buffer_load_dwordx4 v[24:27], v0, s[12:15], s27 offen offset:0 sc1
    buffer_load_dwordx4 v8, s[16:19], s76 offen offset:1024 sc1 lds
    buffer_load_dwordx4 v8, s[16:19], s76 offen offset:2048 sc1 lds
    buffer_load_dwordx4 v8, s[16:19], s76 offen offset:3072 sc1 lds
    v_add_u32 v45, 13, v19
    v_and_b32 v45, 15, v45
    s_mov_b32 s27, 393216
    v_mad_u32_u24 v45, v45, s27, v18
    s_add_u32 m0, s79, 0
    s_nop 0
    buffer_load_dwordx4 v12, s[4:7], s77 offen offset:0 lds
    buffer_load_dwordx4 v13, s[4:7], s77 offen offset:1024 lds
    buffer_load_dwordx4 v14, s[4:7], s77 offen offset:2048 lds
    s_mov_b64 exec, 4095
    buffer_load_dword v255, v45, s[4:7], 0 offen
    s_mov_b64 exec, -1
    s_add_u32 m0, s79, 3072
    s_nop 0
    buffer_load_dwordx4 v15, s[4:7], s77 offen offset:0 lds
    buffer_load_dwordx4 v16, s[4:7], s77 offen offset:1024 lds
    buffer_load_dwordx4 v17, s[4:7], s77 offen offset:2048 lds
    s_add_u32 s76, s21, 11
    s_and_b32 s76, s76, 15
    s_mul_i32 s77, s76, 393216
    s_lshl_b32 s76, s76, 12
    s_add_u32 m0, s78, 81920
    s_waitcnt vmcnt(18)
    s_waitcnt vmcnt(12)
    s_barrier
    buffer_load_dwordx4 v8, s[16:19], s76 offen offset:0 sc1 lds
    s_lshr_b32 s27, s71, 16
    s_lshl_b32 s27, s27, 12
    buffer_load_dwordx4 v[28:31], v0, s[12:15], s27 offen offset:1024 sc1
    buffer_load_dwordx4 v8, s[16:19], s76 offen offset:1024 sc1 lds
    buffer_load_dwordx4 v8, s[16:19], s76 offen offset:2048 sc1 lds
    buffer_load_dwordx4 v8, s[16:19], s76 offen offset:3072 sc1 lds
    s_add_u32 m0, s79, 24576
    s_nop 0
    buffer_load_dwordx4 v12, s[4:7], s77 offen offset:0 lds
    buffer_load_dwordx4 v13, s[4:7], s77 offen offset:1024 lds
    buffer_load_dwordx4 v14, s[4:7], s77 offen offset:2048 lds
    s_add_u32 m0, s79, 27648
    s_nop 0
    buffer_load_dwordx4 v15, s[4:7], s77 offen offset:0 lds
    buffer_load_dwordx4 v16, s[4:7], s77 offen offset:1024 lds
    buffer_load_dwordx4 v17, s[4:7], s77 offen offset:2048 lds
    s_add_u32 s76, s21, 12
    s_and_b32 s76, s76, 15
    s_mul_i32 s77, s76, 393216
    s_lshl_b32 s76, s76, 12
    s_add_u32 m0, s78, 49152
    s_waitcnt vmcnt(18)
    s_waitcnt vmcnt(11)
    s_barrier
    buffer_load_dwordx4 v8, s[16:19], s76 offen offset:0 sc1 lds
    s_lshr_b32 s27, s71, 16
    s_lshl_b32 s27, s27, 12
    buffer_load_dwordx4 v[32:35], v0, s[12:15], s27 offen offset:2048 sc1
    buffer_load_dwordx4 v8, s[16:19], s76 offen offset:1024 sc1 lds
    buffer_load_dwordx4 v8, s[16:19], s76 offen offset:2048 sc1 lds
    buffer_load_dwordx4 v8, s[16:19], s76 offen offset:3072 sc1 lds
    s_add_u32 m0, s79, 139264
    s_nop 0
    buffer_load_dwordx4 v12, s[4:7], s77 offen offset:0 lds
    buffer_load_dwordx4 v13, s[4:7], s77 offen offset:1024 lds
    buffer_load_dwordx4 v14, s[4:7], s77 offen offset:2048 lds
    s_add_u32 m0, s79, 142336
    s_nop 0
    buffer_load_dwordx4 v15, s[4:7], s77 offen offset:0 lds
    buffer_load_dwordx4 v16, s[4:7], s77 offen offset:1024 lds
    buffer_load_dwordx4 v17, s[4:7], s77 offen offset:2048 lds
    s_add_u32 s76, s21, 13
    s_and_b32 s76, s76, 15
    s_mul_i32 s77, s76, 393216
    s_lshl_b32 s76, s76, 12
    s_add_u32 m0, s78, 65536
    s_waitcnt vmcnt(17)
    s_waitcnt vmcnt(11)
    s_barrier
    buffer_load_dwordx4 v8, s[16:19], s76 offen offset:0 sc1 lds
    s_lshr_b32 s27, s71, 16
    s_lshl_b32 s27, s27, 12
    buffer_load_dwordx4 v[36:39], v0, s[12:15], s27 offen offset:3072 sc1
    buffer_load_dwordx4 v8, s[16:19], s76 offen offset:1024 sc1 lds
    buffer_load_dwordx4 v8, s[16:19], s76 offen offset:2048 sc1 lds
    buffer_load_dwordx4 v8, s[16:19], s76 offen offset:3072 sc1 lds
    s_add_u32 m0, s79, 0
    s_nop 0
    buffer_load_dwordx4 v12, s[4:7], s77 offen offset:0 lds
    buffer_load_dwordx4 v13, s[4:7], s77 offen offset:1024 lds
    buffer_load_dwordx4 v14, s[4:7], s77 offen offset:2048 lds
    s_add_u32 m0, s79, 3072
    s_nop 0
    buffer_load_dwordx4 v15, s[4:7], s77 offen offset:0 lds
    buffer_load_dwordx4 v16, s[4:7], s77 offen offset:1024 lds
    buffer_load_dwordx4 v17, s[4:7], s77 offen offset:2048 lds
    s_add_u32 s76, s21, 14
    s_and_b32 s76, s76, 15
    s_mul_i32 s77, s76, 393216
    s_lshl_b32 s76, s76, 12
    s_add_u32 m0, s78, 81920
    s_waitcnt vmcnt(17)
    s_waitcnt vmcnt(11)
    s_barrier
    buffer_load_dwordx4 v8, s[16:19], s76 offen offset:0 sc1 lds
    buffer_load_dwordx4 v8, s[16:19], s76 offen offset:1024 sc1 lds
    buffer_load_dwordx4 v8, s[16:19], s76 offen offset:2048 sc1 lds
    buffer_load_dwordx4 v8, s[16:19], s76 offen offset:3072 sc1 lds
    s_add_u32 m0, s79, 24576
    s_nop 0
    buffer_load_dwordx4 v12, s[4:7], s77 offen offset:0 lds
    buffer_load_dwordx4 v13, s[4:7], s77 offen offset:1024 lds
    buffer_load_dwordx4 v14, s[4:7], s77 offen offset:2048 lds
    s_add_u32 m0, s79, 27648
    s_nop 0
    buffer_load_dwordx4 v15, s[4:7], s77 offen offset:0 lds
    buffer_load_dwordx4 v16, s[4:7], s77 offen offset:1024 lds
    buffer_load_dwordx4 v17, s[4:7], s77 offen offset:2048 lds
    s_add_u32 s76, s21, 15
    s_and_b32 s76, s76, 15
    s_mul_i32 s77, s76, 393216
    s_lshl_b32 s76, s76, 12
    s_add_u32 m0, s78, 49152
    s_waitcnt vmcnt(16)
    s_waitcnt vmcnt(10)
    s_barrier
    buffer_load_dwordx4 v8, s[16:19], s76 offen offset:0 sc1 lds
    buffer_load_dwordx4 v8, s[16:19], s76 offen offset:1024 sc1 lds
    v_add_f32 v24, v24, v32
    v_add_f32 v25, v25, v33
    v_add_f32 v26, v26, v34
    buffer_load_dwordx4 v8, s[16:19], s76 offen offset:2048 sc1 lds
    v_add_f32 v27, v27, v35
    v_add_f32 v28, v28, v36
    v_add_f32 v29, v29, v37
    buffer_load_dwordx4 v8, s[16:19], s76 offen offset:3072 sc1 lds
    v_add_f32 v30, v30, v38
    v_add_f32 v31, v31, v39
    v_add_f32 v24, v24, v28
    s_add_u32 m0, s79, 139264
    s_nop 0
    buffer_load_dwordx4 v12, s[4:7], s77 offen offset:0 lds
    buffer_load_dwordx4 v13, s[4:7], s77 offen offset:1024 lds
    v_add_f32 v25, v25, v29
    v_add_f32 v26, v26, v30
    v_add_f32 v27, v27, v31
    buffer_load_dwordx4 v14, s[4:7], s77 offen offset:2048 lds
    v_permlane32_swap_b32 v24, v26
    v_permlane32_swap_b32 v25, v27
    v_add_f32 v24, v24, v26
    s_add_u32 m0, s79, 142336
    s_nop 0
    buffer_load_dwordx4 v15, s[4:7], s77 offen offset:0 lds
    v_add_f32 v25, v25, v27
    v_mov_b32 v26, v24
    v_mov_b32 v27, v25
    buffer_load_dwordx4 v16, s[4:7], s77 offen offset:1024 lds
    buffer_load_dwordx4 v17, s[4:7], s77 offen offset:2048 lds
    s_waitcnt vmcnt(16)
    s_waitcnt vmcnt(10)
    s_barrier
    s_add_u32 m0, s85, 0
    s_add_u32 s36, s86, 0
    s_and_b32 s36, s36, 0x1fffff
    buffer_load_dwordx4 v3, s[8:11], s36 offen lds
    v_permlane16_swap_b32 v24, v26
    v_permlane16_swap_b32 v25, v27
    v_add_f32 v24, v24, v26
    v_add_f32 v25, v25, v27
    s_add_u32 m0, s85, 4096
    s_add_u32 s36, s86, 65536
    s_and_b32 s36, s36, 0x1fffff
    buffer_load_dwordx4 v3, s[8:11], s36 offen lds
    v_mul_f32 v24, 0xba800000, v24
    v_mul_f32 v25, 0x3a800000, v25
    s_add_u32 m0, s85, 8192
    s_add_u32 s36, s86, 131072
    s_and_b32 s36, s36, 0x1fffff
    buffer_load_dwordx4 v3, s[8:11], s36 offen lds
    v_fma_f32 v25, -v24, v24, v25
    v_max_f32 v25, 0, v25
    s_add_u32 m0, s85, 12288
    s_add_u32 s36, s86, 196608
    s_and_b32 s36, s36, 0x1fffff
    buffer_load_dwordx4 v3, s[8:11], s36 offen lds
    v_add_f32 v25, 0x3727c5ac, v25
    v_rsq_f32 v25, v25
    s_nop 0
    v_mul_f32 v24, v24, v25
    ds_write_b32 v170, v25
    s_add_u32 m0, s85, 16384
    s_add_u32 s36, s86, 262144
    s_and_b32 s36, s36, 0x1fffff
    buffer_load_dwordx4 v3, s[8:11], s36 offen lds
    ds_write_b32 v170, v24 offset:512
    ds_write_b32 v171, v21
    s_add_u32 m0, s85, 20480
    s_add_u32 s36, s86, 327680
    s_and_b32 s36, s36, 0x1fffff
    buffer_load_dwordx4 v3, s[8:11], s36 offen lds
    s_lshr_b32 s27, s2, 3
    s_lshl_b32 s27, s27, 6
    s_lshl_b32 s28, s75, 4
    s_add_u32 s27, s27, s28
    s_add_u32 m0, s85, 65536
    s_add_u32 s36, s86, 1048576
    s_and_b32 s36, s36, 0x1fffff
    buffer_load_dwordx4 v3, s[8:11], s36 offen lds
    v_add_u32 v44, s27, v1
    s_lshr_b32 s30, s8, 7
    s_sub_u32 s30, 3, s30
    s_and_b32 s30, s30, 7
    s_lshl_b32 s30, s30, 7
    v_and_b32 v45, 1, v44
    v_lshlrev_b32 v45, 10, v45
    v_lshrrev_b32 v44, 1, v44
    s_add_u32 m0, s85, 69632
    s_add_u32 s36, s86, 1114112
    s_and_b32 s36, s36, 0x1fffff
    buffer_load_dwordx4 v3, s[8:11], s36 offen lds
    v_lshlrev_b32 v44, 11, v44
    v_add3_u32 v45, v45, v44, s30
    s_add_u32 m0, s85, 73728
    s_add_u32 s36, s86, 1179648
    s_and_b32 s36, s36, 0x1fffff
    buffer_load_dwordx4 v3, s[8:11], s36 offen lds
    s_mov_b64 exec, 0xffff
    buffer_load_dword v255, v45, s[8:11], 0 offen
    s_mov_b64 exec, -1
    s_add_u32 m0, s85, 77824
    s_add_u32 s36, s86, 1245184
    s_and_b32 s36, s36, 0x1fffff
    buffer_load_dwordx4 v3, s[8:11], s36 offen lds
    s_waitcnt vmcnt(17)
    s_waitcnt vmcnt(11)
    s_waitcnt lgkmcnt(0)
    s_barrier
    s_add_u32 m0, s85, 24576
    s_add_u32 s36, s86, 393216
    s_and_b32 s36, s36, 0x1fffff
    buffer_load_dwordx4 v3, s[8:11], s36 offen lds
    s_add_u32 m0, s85, 28672
    s_add_u32 s36, s86, 458752
    s_and_b32 s36, s36, 0x1fffff
    buffer_load_dwordx4 v3, s[8:11], s36 offen lds
    s_add_u32 m0, s85, 32768
    s_add_u32 s36, s86, 524288
    s_and_b32 s36, s36, 0x1fffff
    buffer_load_dwordx4 v3, s[8:11], s36 offen lds
    s_add_u32 m0, s85, 36864
    s_add_u32 s36, s86, 589824
    s_and_b32 s36, s36, 0x1fffff
    buffer_load_dwordx4 v3, s[8:11], s36 offen lds
    s_add_u32 m0, s85, 40960
    s_add_u32 s36, s86, 655360
    s_and_b32 s36, s36, 0x1fffff
    buffer_load_dwordx4 v3, s[8:11], s36 offen lds
    s_add_u32 m0, s85, 45056
    s_add_u32 s36, s86, 720896
    s_and_b32 s36, s36, 0x1fffff
    buffer_load_dwordx4 v3, s[8:11], s36 offen lds
    s_add_u32 m0, s85, 81920
    s_add_u32 s36, s86, 1310720
    s_and_b32 s36, s36, 0x1fffff
    buffer_load_dwordx4 v3, s[8:11], s36 offen lds
    s_add_u32 m0, s85, 86016
    s_add_u32 s36, s86, 1376256
    s_and_b32 s36, s36, 0x1fffff
    buffer_load_dwordx4 v3, s[8:11], s36 offen lds
    s_add_u32 m0, s85, 90112
    s_add_u32 s36, s86, 1441792
    s_and_b32 s36, s36, 0x1fffff
    buffer_load_dwordx4 v3, s[8:11], s36 offen lds
    s_add_u32 m0, s85, 94208
    s_add_u32 s36, s86, 1507328
    s_and_b32 s36, s36, 0x1fffff
    buffer_load_dwordx4 v3, s[8:11], s36 offen lds
    s_barrier
    s_add_u32 m0, s85, 49152
    s_add_u32 s36, s86, 786432
    s_and_b32 s36, s36, 0x1fffff
    buffer_load_dwordx4 v3, s[8:11], s36 offen lds
    s_add_u32 m0, s85, 53248
    s_add_u32 s36, s86, 851968
    s_and_b32 s36, s36, 0x1fffff
    buffer_load_dwordx4 v3, s[8:11], s36 offen lds
    s_add_u32 m0, s85, 57344
    s_add_u32 s36, s86, 917504
    s_and_b32 s36, s36, 0x1fffff
    buffer_load_dwordx4 v3, s[8:11], s36 offen lds
    s_add_u32 m0, s85, 61440
    s_add_u32 s36, s86, 983040
    s_and_b32 s36, s36, 0x1fffff
    buffer_load_dwordx4 v3, s[8:11], s36 offen lds
    s_add_u32 m0, s85, 98304
    s_add_u32 s36, s86, 1572864
    s_and_b32 s36, s36, 0x1fffff
    buffer_load_dwordx4 v3, s[8:11], s36 offen lds
    s_add_u32 m0, s85, 102400
    s_add_u32 s36, s86, 1638400
    s_and_b32 s36, s36, 0x1fffff
    buffer_load_dwordx4 v3, s[8:11], s36 offen lds
    s_add_u32 m0, s85, 106496
    s_add_u32 s36, s86, 1703936
    s_and_b32 s36, s36, 0x1fffff
    buffer_load_dwordx4 v3, s[8:11], s36 offen lds
    s_add_u32 m0, s85, 110592
    s_add_u32 s36, s86, 1769472
    s_and_b32 s36, s36, 0x1fffff
    buffer_load_dwordx4 v3, s[8:11], s36 offen lds
    s_add_u32 m0, s85, 114688
    s_add_u32 s36, s86, 1835008
    s_and_b32 s36, s36, 0x1fffff
    buffer_load_dwordx4 v3, s[8:11], s36 offen lds
    s_add_u32 m0, s85, 118784
    s_add_u32 s36, s86, 1900544
    s_and_b32 s36, s36, 0x1fffff
    buffer_load_dwordx4 v3, s[8:11], s36 offen lds
    s_add_u32 m0, s85, 122880
    s_add_u32 s36, s86, 1966080
    s_and_b32 s36, s36, 0x1fffff
    buffer_load_dwordx4 v3, s[8:11], s36 offen lds
    s_add_u32 m0, s85, 126976
    s_add_u32 s36, s86, 2031616
    s_and_b32 s36, s36, 0x1fffff
    buffer_load_dwordx4 v3, s[8:11], s36 offen lds
    s_waitcnt vmcnt(16)
    s_barrier
    s_waitcnt vmcnt(0)
    s_barrier
    s_barrier
    s_or_b32 s27, s2, s75
    s_cmp_lg_u32 s27, 0
    s_cbranch_scc1 L_out
    v_mov_b32 v22, 843776
    v_mov_b32 v24, s24
    v_mov_b32 v25, s25
    s_mov_b64 exec, 1
    buffer_store_dwordx2 v[24:25], v22, s[12:15], 0 offen offset:0 sc1
    s_mov_b64 exec, -1
    s_branch L_out
L_attL:
    v_mov_b32 v226, 0x3f803f80
    v_mov_b32 v227, 0x3f803f80
    v_mov_b32 v228, 0x3f803f80
    v_mov_b32 v229, 0x3f803f80
    v_mov_b32 v144, 0
    v_mov_b32 v145, 0
    v_mov_b32 v146, 0
    v_mov_b32 v147, 0
    v_mov_b32 v148, 0
    v_mov_b32 v149, 0
    v_mov_b32 v150, 0
    v_mov_b32 v151, 0
    v_mov_b32 v152, 0
    v_mov_b32 v153, 0
    v_mov_b32 v154, 0
    v_mov_b32 v155, 0
    v_mov_b32 v156, 0
    v_mov_b32 v157, 0
    v_mov_b32 v158, 0
    v_mov_b32 v159, 0
    v_mov_b32 v160, 0
    v_mov_b32 v161, 0
    v_mov_b32 v162, 0
    v_mov_b32 v163, 0
    v_mov_b32 v164, 0
    v_mov_b32 v165, 0
    v_mov_b32 v166, 0
    v_mov_b32 v167, 0
    s_lshl_b32 s27, s75, 11
    s_add_u32 s27, s27, 49152
    v_add_u32 v245, s27, v0
    s_lshl_b32 s27, s84, 1
    s_and_b32 s28, s75, 1
    s_add_u32 s27, s27, s28
    s_lshl_b32 s27, s27, 12
    s_add_u32 s27, s27, 40960
    v_add_u32 v244, s27, v0
    s_cmp_eq_u32 s84, 0
    s_cbranch_scc1 L_attA0
    s_barrier
    ds_read_b128 v[40:43], v245 offset:0
    ds_read_b128 v[48:51], v245 offset:1024
    ds_read_b128 v[72:75], v244 offset:24576
    ds_read_b128 v[80:83], v244 offset:25600
    ds_read_b128 v[100:103], v244 offset:26624
    ds_read_b128 v[116:119], v244 offset:27648
    s_waitcnt lgkmcnt(2)
    v_mfma_f32_16x16x32_bf16 v[120:123], v[72:75], v[40:43], v[222:225]
    v_mfma_f32_16x16x32_bf16 v[128:131], v[72:75], v[48:51], 0
    ds_read_b128 v[56:59], v244 offset:16384
    s_nop 5
    v_exp_f32 v120, v120
    v_mfma_f32_16x16x32_bf16 v[132:135], v[80:83], v[48:51], v[222:225]
    ds_read_b128 v[64:67], v244 offset:17408
    v_exp_f32 v121, v121
    v_mov_b32 v139, 0
    v_exp_f32 v122, v122
    v_cvt_pk_bf16_f32 v136, v120, v121
    v_exp_f32 v123, v123
    v_mov_b32 v138, 0
    v_cvt_pk_bf16_f32 v137, v122, v123
    s_waitcnt lgkmcnt(0)
    v_mfma_f32_16x16x32_bf16 v[120:123], v[56:59], v[40:43], 0
    v_exp_f32 v128, v128
    v_exp_f32 v129, v129
    v_mfma_f32_16x16x32_bf16 v[124:127], v[64:67], v[40:43], 0
    v_exp_f32 v130, v130
    v_cvt_pk_bf16_f32 v140, v128, v129
    v_mfma_f32_16x16x32_bf16 v[144:147], v[100:103], v[136:139], v[144:147]
    v_exp_f32 v131, v131
    v_exp_f32 v132, v132
    v_cvt_pk_bf16_f32 v141, v130, v131
    v_mfma_f32_16x16x32_bf16 v[148:151], v[116:119], v[136:139], v[148:151]
    ds_read_b128 v[96:99], v244 offset:18432
    v_exp_f32 v133, v133
    v_exp_f32 v134, v134
    v_cvt_pk_bf16_f32 v142, v132, v133
    v_exp_f32 v135, v135
    v_mfma_f32_16x16x32_bf16 v[160:163], v[226:229], v[136:139], v[160:163]
    ds_read_b128 v[112:115], v244 offset:19456
    v_cvt_pk_bf16_f32 v143, v134, v135
    v_mfma_f32_16x16x32_bf16 v[128:131], v[56:59], v[48:51], 0
    ds_read_b128 v[72:75], v244 offset:8192
    v_exp_f32 v120, v120
    v_exp_f32 v121, v121
    v_mfma_f32_16x16x32_bf16 v[132:135], v[64:67], v[48:51], 0
    ds_read_b128 v[80:83], v244 offset:9216
    v_exp_f32 v122, v122
    v_cvt_pk_bf16_f32 v136, v120, v121
    v_mfma_f32_16x16x32_bf16 v[152:155], v[100:103], v[140:143], v[152:155]
    v_exp_f32 v123, v123
    v_exp_f32 v124, v124
    v_cvt_pk_bf16_f32 v137, v122, v123
    v_mfma_f32_16x16x32_bf16 v[156:159], v[116:119], v[140:143], v[156:159]
    v_exp_f32 v125, v125
    v_exp_f32 v126, v126
    v_cvt_pk_bf16_f32 v138, v124, v125
    v_exp_f32 v127, v127
    v_mfma_f32_16x16x32_bf16 v[164:167], v[226:229], v[140:143], v[164:167]
    v_cvt_pk_bf16_f32 v139, v126, v127
    s_waitcnt lgkmcnt(0)
    v_mfma_f32_16x16x32_bf16 v[120:123], v[72:75], v[40:43], 0
    v_exp_f32 v128, v128
    v_exp_f32 v129, v129
    v_mfma_f32_16x16x32_bf16 v[124:127], v[80:83], v[40:43], 0
    v_exp_f32 v130, v130
    v_cvt_pk_bf16_f32 v140, v128, v129
    v_mfma_f32_16x16x32_bf16 v[144:147], v[96:99], v[136:139], v[144:147]
    v_exp_f32 v131, v131
    v_exp_f32 v132, v132
    v_cvt_pk_bf16_f32 v141, v130, v131
    v_mfma_f32_16x16x32_bf16 v[148:151], v[112:115], v[136:139], v[148:151]
    ds_read_b128 v[100:103], v244 offset:10240
    v_exp_f32 v133, v133
    v_exp_f32 v134, v134
    v_cvt_pk_bf16_f32 v142, v132, v133
    v_exp_f32 v135, v135
    v_mfma_f32_16x16x32_bf16 v[160:163], v[226:229], v[136:139], v[160:163]
    ds_read_b128 v[116:119], v244 offset:11264
    v_cvt_pk_bf16_f32 v143, v134, v135
    s_add_u32 m0, s85, 90112
    s_add_u32 s36, s86, 1441792
    s_and_b32 s36, s36, 0x1fffff
    buffer_load_dwordx4 v3, s[8:11], s36 offen lds
    s_add_u32 m0, s85, 94208
    s_add_u32 s36, s86, 1507328
    s_and_b32 s36, s36, 0x1fffff
    buffer_load_dwordx4 v3, s[8:11], s36 offen lds
    s_add_u32 m0, s85, 57344
    s_add_u32 s36, s86, 917504
    s_and_b32 s36, s36, 0x1fffff
    buffer_load_dwordx4 v3, s[8:11], s36 offen lds
    s_add_u32 m0, s85, 61440
    s_add_u32 s36, s86, 983040
    s_and_b32 s36, s36, 0x1fffff
    buffer_load_dwordx4 v3, s[8:11], s36 offen lds
    v_mfma_f32_16x16x32_bf16 v[128:131], v[72:75], v[48:51], 0
    v_exp_f32 v120, v120
    v_exp_f32 v121, v121
    v_mfma_f32_16x16x32_bf16 v[132:135], v[80:83], v[48:51], 0
    v_exp_f32 v122, v122
    v_cvt_pk_bf16_f32 v136, v120, v121
    v_mfma_f32_16x16x32_bf16 v[152:155], v[96:99], v[140:143], v[152:155]
    v_exp_f32 v123, v123
    v_exp_f32 v124, v124
    v_cvt_pk_bf16_f32 v137, v122, v123
    v_mfma_f32_16x16x32_bf16 v[156:159], v[112:115], v[140:143], v[156:159]
    v_exp_f32 v125, v125
    v_exp_f32 v126, v126
    v_cvt_pk_bf16_f32 v138, v124, v125
    v_exp_f32 v127, v127
    v_mfma_f32_16x16x32_bf16 v[164:167], v[226:229], v[140:143], v[164:167]
    v_cvt_pk_bf16_f32 v139, v126, v127
    s_waitcnt lgkmcnt(0)
    s_nop 0
    v_mfma_f32_16x16x32_bf16 v[144:147], v[100:103], v[136:139], v[144:147]
    v_exp_f32 v128, v128
    v_exp_f32 v129, v129
    v_mfma_f32_16x16x32_bf16 v[148:151], v[116:119], v[136:139], v[148:151]
    v_exp_f32 v130, v130
    v_cvt_pk_bf16_f32 v140, v128, v129
    v_mfma_f32_16x16x32_bf16 v[160:163], v[226:229], v[136:139], v[160:163]
    v_exp_f32 v131, v131
    v_exp_f32 v132, v132
    v_cvt_pk_bf16_f32 v141, v130, v131
    v_exp_f32 v133, v133
    v_exp_f32 v134, v134
    v_cvt_pk_bf16_f32 v142, v132, v133
    v_exp_f32 v135, v135
    s_nop 0
    v_cvt_pk_bf16_f32 v143, v134, v135
    s_and_b32 s27, s33, 4096
    s_add_u32 s27, s27, 98304
    v_add_u32 v244, s27, v0
    v_xor_b32 v236, 4048155338, v222
    v_xor_b32 v237, 4048155338, v223
    v_xor_b32 v238, 4048155338, v224
    v_xor_b32 v239, 4048155338, v225
    s_barrier
    ds_read_b128 v[56:59], v244 offset:0
    ds_read_b128 v[64:67], v244 offset:1024
    ds_read_b128 v[96:99], v244 offset:2048
    ds_read_b128 v[112:115], v244 offset:3072
    v_add_u32 v245, s34, v0
    s_and_b32 s28, s33, 4096
    s_add_u32 m0, s28, 131072
    s_add_u32 s27, s33, 49152
    buffer_load_dwordx4 v245, s[12:15], s27 offen offset:0 sc1 lds
    buffer_load_dwordx4 v245, s[12:15], s27 offen offset:1024 sc1 lds
    buffer_load_dwordx4 v245, s[12:15], s27 offen offset:2048 sc1 lds
    buffer_load_dwordx4 v245, s[12:15], s27 offen offset:3072 sc1 lds
    s_waitcnt lgkmcnt(2)
    v_mfma_f32_16x16x32_bf16 v[120:123], v[56:59], v[40:43], 0
    v_mfma_f32_16x16x32_bf16 v[124:127], v[64:67], v[40:43], 0
    v_mfma_f32_16x16x32_bf16 v[128:131], v[56:59], v[48:51], 0
    ds_read_b128 v[72:75], v244 offset:8192
    s_nop 4
    v_exp_f32 v120, v120
    v_exp_f32 v121, v121
    v_mfma_f32_16x16x32_bf16 v[132:135], v[64:67], v[48:51], 0
    ds_read_b128 v[80:83], v244 offset:9216
    v_exp_f32 v122, v122
    v_cvt_pk_bf16_f32 v136, v120, v121
    v_mfma_f32_16x16x32_bf16 v[152:155], v[100:103], v[140:143], v[152:155]
    s_add_u32 m0, s28, 147456
    s_add_u32 s27, s33, 16384
    buffer_load_dwordx4 v245, s[12:15], s27 offen offset:0 sc1 lds
    v_exp_f32 v123, v123
    v_exp_f32 v124, v124
    v_cvt_pk_bf16_f32 v137, v122, v123
    v_mfma_f32_16x16x32_bf16 v[156:159], v[116:119], v[140:143], v[156:159]
    buffer_load_dwordx4 v245, s[12:15], s27 offen offset:1024 sc1 lds
    v_exp_f32 v125, v125
    v_exp_f32 v126, v126
    v_cvt_pk_bf16_f32 v138, v124, v125
    v_exp_f32 v127, v127
    v_mfma_f32_16x16x32_bf16 v[164:167], v[226:229], v[140:143], v[164:167]
    v_cvt_pk_bf16_f32 v139, v126, v127
    s_cmp_eq_u32 s20, 0
    s_cbranch_scc0 Lw_92
    v_mov_b32 v226, 0
    v_mov_b32 v227, 0
    v_mov_b32 v228, 0
    v_mov_b32 v229, 0
Lw_92:
    s_waitcnt lgkmcnt(0)
    v_mfma_f32_16x16x32_bf16 v[120:123], v[72:75], v[40:43], 0
    buffer_load_dwordx4 v245, s[12:15], s27 offen offset:2048 sc1 lds
    v_exp_f32 v128, v128
    v_exp_f32 v129, v129
    v_mfma_f32_16x16x32_bf16 v[124:127], v[80:83], v[40:43], 0
    buffer_load_dwordx4 v245, s[12:15], s27 offen offset:3072 sc1 lds
    v_exp_f32 v130, v130
    v_cvt_pk_bf16_f32 v140, v128, v129
    v_mfma_f32_16x16x32_bf16 v[144:147], v[96:99], v[136:139], v[144:147]
    v_exp_f32 v131, v131
    v_exp_f32 v132, v132
    v_cvt_pk_bf16_f32 v141, v130, v131
    v_mfma_f32_16x16x32_bf16 v[148:151], v[112:115], v[136:139], v[148:151]
    ds_read_b128 v[100:103], v244 offset:10240
    v_exp_f32 v133, v133
    v_exp_f32 v134, v134
    v_cvt_pk_bf16_f32 v142, v132, v133
    v_exp_f32 v135, v135
    v_mfma_f32_16x16x32_bf16 v[160:163], v[226:229], v[136:139], v[160:163]
    ds_read_b128 v[116:119], v244 offset:11264
    v_cvt_pk_bf16_f32 v143, v134, v135
    s_barrier
    v_mfma_f32_16x16x32_bf16 v[128:131], v[72:75], v[48:51], 0
    ds_read_b128 v[56:59], v244 offset:16384
    v_exp_f32 v120, v120
    v_exp_f32 v121, v121
    v_mfma_f32_16x16x32_bf16 v[132:135], v[80:83], v[48:51], 0
    ds_read_b128 v[64:67], v244 offset:17408
    v_exp_f32 v122, v122
    v_cvt_pk_bf16_f32 v136, v120, v121
    v_mfma_f32_16x16x32_bf16 v[152:155], v[96:99], v[140:143], v[152:155]
    s_add_u32 m0, s85, 49152
    s_add_u32 s36, s86, 786432
    s_and_b32 s36, s36, 0x1fffff
    buffer_load_dwordx4 v3, s[8:11], s36 offen lds
    v_exp_f32 v123, v123
    v_exp_f32 v124, v124
    v_cvt_pk_bf16_f32 v137, v122, v123
    v_mfma_f32_16x16x32_bf16 v[156:159], v[112:115], v[140:143], v[156:159]
    s_add_u32 m0, s85, 53248
    s_add_u32 s36, s86, 851968
    s_and_b32 s36, s36, 0x1fffff
    buffer_load_dwordx4 v3, s[8:11], s36 offen lds
    v_exp_f32 v125, v125
    v_exp_f32 v126, v126
    v_cvt_pk_bf16_f32 v138, v124, v125
    v_exp_f32 v127, v127
    v_mfma_f32_16x16x32_bf16 v[164:167], v[226:229], v[140:143], v[164:167]
    s_add_u32 m0, s85, 65536
    s_add_u32 s36, s86, 1048576
    s_and_b32 s36, s36, 0x1fffff
    buffer_load_dwordx4 v3, s[8:11], s36 offen lds
    v_cvt_pk_bf16_f32 v139, v126, v127
    s_waitcnt lgkmcnt(0)
    v_mfma_f32_16x16x32_bf16 v[120:123], v[56:59], v[40:43], 0
    s_add_u32 m0, s85, 69632
    s_add_u32 s36, s86, 1114112
    s_and_b32 s36, s36, 0x1fffff
    buffer_load_dwordx4 v3, s[8:11], s36 offen lds
    v_exp_f32 v128, v128
    v_exp_f32 v129, v129
    v_mfma_f32_16x16x32_bf16 v[124:127], v[64:67], v[40:43], 0
    s_add_u32 m0, s85, 73728
    s_add_u32 s36, s86, 1179648
    s_and_b32 s36, s36, 0x1fffff
    buffer_load_dwordx4 v3, s[8:11], s36 offen lds
    v_exp_f32 v130, v130
    v_cvt_pk_bf16_f32 v140, v128, v129
    v_mfma_f32_16x16x32_bf16 v[144:147], v[100:103], v[136:139], v[144:147]
    v_exp_f32 v131, v131
    v_exp_f32 v132, v132
    v_cvt_pk_bf16_f32 v141, v130, v131
    v_mfma_f32_16x16x32_bf16 v[148:151], v[116:119], v[136:139], v[148:151]
    ds_read_b128 v[96:99], v244 offset:18432
    v_exp_f32 v133, v133
    v_exp_f32 v134, v134
    v_cvt_pk_bf16_f32 v142, v132, v133
    v_exp_f32 v135, v135
    v_mfma_f32_16x16x32_bf16 v[160:163], v[226:229], v[136:139], v[160:163]
    ds_read_b128 v[112:115], v244 offset:19456
    v_cvt_pk_bf16_f32 v143, v134, v135
    v_mfma_f32_16x16x32_bf16 v[128:131], v[56:59], v[48:51], 0
    ds_read_b128 v[72:75], v244 offset:24576
    v_exp_f32 v120, v120
    v_exp_f32 v121, v121
    v_mfma_f32_16x16x32_bf16 v[132:135], v[64:67], v[48:51], 0
    ds_read_b128 v[80:83], v244 offset:25600
    v_exp_f32 v122, v122
    v_cvt_pk_bf16_f32 v136, v120, v121
    v_mfma_f32_16x16x32_bf16 v[152:155], v[100:103], v[140:143], v[152:155]
    s_add_u32 m0, s85, 77824
    s_add_u32 s36, s86, 1245184
    s_and_b32 s36, s36, 0x1fffff
    buffer_load_dwordx4 v3, s[8:11], s36 offen lds
    v_exp_f32 v123, v123
    v_exp_f32 v124, v124
    v_cvt_pk_bf16_f32 v137, v122, v123
    v_mfma_f32_16x16x32_bf16 v[156:159], v[116:119], v[140:143], v[156:159]
    s_add_u32 m0, s85, 81920
    s_add_u32 s36, s86, 1310720
    s_and_b32 s36, s36, 0x1fffff
    buffer_load_dwordx4 v3, s[8:11], s36 offen lds
    v_exp_f32 v125, v125
    v_exp_f32 v126, v126
    v_cvt_pk_bf16_f32 v138, v124, v125
    v_exp_f32 v127, v127
    v_mfma_f32_16x16x32_bf16 v[164:167], v[226:229], v[140:143], v[164:167]
    s_add_u32 m0, s85, 86016
    s_add_u32 s36, s86, 1376256
    s_and_b32 s36, s36, 0x1fffff
    buffer_load_dwordx4 v3, s[8:11], s36 offen lds
    v_cvt_pk_bf16_f32 v139, v126, v127
    s_waitcnt lgkmcnt(0)
    v_mfma_f32_16x16x32_bf16 v[120:123], v[72:75], v[40:43], 0
    s_add_u32 m0, s85, 98304
    s_add_u32 s36, s86, 1572864
    s_and_b32 s36, s36, 0x1fffff
    buffer_load_dwordx4 v3, s[8:11], s36 offen lds
    v_exp_f32 v128, v128
    v_exp_f32 v129, v129
    v_mfma_f32_16x16x32_bf16 v[124:127], v[80:83], v[40:43], 0
    s_add_u32 m0, s85, 102400
    s_add_u32 s36, s86, 1638400
    s_and_b32 s36, s36, 0x1fffff
    buffer_load_dwordx4 v3, s[8:11], s36 offen lds
    v_exp_f32 v130, v130
    v_cvt_pk_bf16_f32 v140, v128, v129
    v_mfma_f32_16x16x32_bf16 v[144:147], v[96:99], v[136:139], v[144:147]
    v_exp_f32 v131, v131
    v_exp_f32 v132, v132
    v_cvt_pk_bf16_f32 v141, v130, v131
    v_mfma_f32_16x16x32_bf16 v[148:151], v[112:115], v[136:139], v[148:151]
    ds_read_b128 v[100:103], v244 offset:26624
    v_exp_f32 v133, v133
    v_exp_f32 v134, v134
    v_cvt_pk_bf16_f32 v142, v132, v133
    v_exp_f32 v135, v135
    v_mfma_f32_16x16x32_bf16 v[160:163], v[226:229], v[136:139], v[160:163]
    ds_read_b128 v[116:119], v244 offset:27648
    v_cvt_pk_bf16_f32 v143, v134, v135
    s_waitcnt vmcnt(10)
    s_barrier
    v_mfma_f32_16x16x32_bf16 v[128:131], v[72:75], v[48:51], 0
    ds_read_b128 v[56:59], v244 offset:32768
    v_exp_f32 v120, v120
    v_exp_f32 v121, v121
    v_mfma_f32_16x16x32_bf16 v[132:135], v[80:83], v[48:51], 0
    ds_read_b128 v[64:67], v244 offset:33792
    v_exp_f32 v122, v122
    v_cvt_pk_bf16_f32 v136, v120, v121
    v_mfma_f32_16x16x32_bf16 v[152:155], v[96:99], v[140:143], v[152:155]
    s_add_u32 m0, s85, 106496
    s_add_u32 s36, s86, 1703936
    s_and_b32 s36, s36, 0x1fffff
    buffer_load_dwordx4 v3, s[8:11], s36 offen lds
    v_exp_f32 v123, v123
    v_exp_f32 v124, v124
    v_cvt_pk_bf16_f32 v137, v122, v123
    v_mfma_f32_16x16x32_bf16 v[156:159], v[112:115], v[140:143], v[156:159]
    s_add_u32 m0, s85, 110592
    s_add_u32 s36, s86, 1769472
    s_and_b32 s36, s36, 0x1fffff
    buffer_load_dwordx4 v3, s[8:11], s36 offen lds
    v_exp_f32 v125, v125
    v_exp_f32 v126, v126
    v_cvt_pk_bf16_f32 v138, v124, v125
    v_exp_f32 v127, v127
    v_mfma_f32_16x16x32_bf16 v[164:167], v[226:229], v[140:143], v[164:167]
    s_cmp_eq_u32 s22, 0
    s_cbranch_scc0 Lw_89
    s_add_u32 s27, s71, 0
    buffer_store_dwordx4 v[176:179], v0, s[16:19], s27 offen offset:0 sc1
    s_add_u32 s27, s71, 0
    buffer_store_dwordx4 v[176:179], v0, s[16:19], s27 offen offset:1024 sc1
Lw_89:
    v_cvt_pk_bf16_f32 v139, v126, v127
    s_waitcnt lgkmcnt(0)
    v_mfma_f32_16x16x32_bf16 v[120:123], v[56:59], v[40:43], 0
    s_add_u32 m0, s85, 114688
    s_add_u32 s36, s86, 1835008
    s_and_b32 s36, s36, 0x1fffff
    buffer_load_dwordx4 v3, s[8:11], s36 offen lds
    v_exp_f32 v128, v128
    v_exp_f32 v129, v129
    v_mfma_f32_16x16x32_bf16 v[124:127], v[64:67], v[40:43], 0
    s_cmp_eq_u32 s22, 0
    s_cbranch_scc0 Lw_90
    s_add_u32 s27, s71, 0
    buffer_store_dwordx4 v[176:179], v0, s[16:19], s27 offen offset:2048 sc1
    s_add_u32 s27, s71, 0
    buffer_store_dwordx4 v[176:179], v0, s[16:19], s27 offen offset:3072 sc1
Lw_90:
    v_exp_f32 v130, v130
    v_cvt_pk_bf16_f32 v140, v128, v129
    v_mfma_f32_16x16x32_bf16 v[144:147], v[100:103], v[136:139], v[144:147]
    v_exp_f32 v131, v131
    v_exp_f32 v132, v132
    v_cvt_pk_bf16_f32 v141, v130, v131
    v_mfma_f32_16x16x32_bf16 v[148:151], v[116:119], v[136:139], v[148:151]
    ds_read_b128 v[96:99], v244 offset:34816
    v_exp_f32 v133, v133
    v_exp_f32 v134, v134
    v_cvt_pk_bf16_f32 v142, v132, v133
    v_exp_f32 v135, v135
    v_mfma_f32_16x16x32_bf16 v[160:163], v[226:229], v[136:139], v[160:163]
    ds_read_b128 v[112:115], v244 offset:35840
    v_cvt_pk_bf16_f32 v143, v134, v135
    v_mfma_f32_16x16x32_bf16 v[128:131], v[56:59], v[48:51], 0
    ds_read_b128 v[72:75], v244 offset:40960
    v_exp_f32 v120, v120
    v_exp_f32 v121, v121
    v_mfma_f32_16x16x32_bf16 v[132:135], v[64:67], v[48:51], 0
    ds_read_b128 v[80:83], v244 offset:41984
    v_exp_f32 v122, v122
    v_cvt_pk_bf16_f32 v136, v120, v121
    v_mfma_f32_16x16x32_bf16 v[152:155], v[100:103], v[140:143], v[152:155]
    s_add_u32 m0, s85, 118784
    s_add_u32 s36, s86, 1900544
    s_and_b32 s36, s36, 0x1fffff
    buffer_load_dwordx4 v3, s[8:11], s36 offen lds
    v_exp_f32 v123, v123
    v_exp_f32 v124, v124
    v_cvt_pk_bf16_f32 v137, v122, v123
    v_mfma_f32_16x16x32_bf16 v[156:159], v[116:119], v[140:143], v[156:159]
    s_cmp_eq_u32 s22, 0
    s_cbranch_scc0 Lw_91
    s_add_u32 s27, s85, 131072
    s_add_u32 s27, s27, s73
    buffer_store_dwordx4 v[176:179], v0, s[12:15], s27 offen sc1
    s_add_u32 s27, s85, 135168
    s_add_u32 s27, s27, s73
    buffer_store_dwordx4 v[176:179], v0, s[12:15], s27 offen sc1
Lw_91:
    v_exp_f32 v125, v125
    v_exp_f32 v126, v126
    v_cvt_pk_bf16_f32 v138, v124, v125
    v_exp_f32 v127, v127
    v_mfma_f32_16x16x32_bf16 v[164:167], v[226:229], v[140:143], v[164:167]
    v_cvt_pk_bf16_f32 v139, v126, v127
    s_cmp_eq_u32 s20, 1
    s_cbranch_scc0 Lw_93
    v_mov_b32 v226, 0
    v_mov_b32 v227, 0
    v_mov_b32 v228, 0
    v_mov_b32 v229, 0
Lw_93:
    s_waitcnt lgkmcnt(0)
    v_mfma_f32_16x16x32_bf16 v[120:123], v[72:75], v[40:43], v[236:239]
    v_exp_f32 v128, v128
    v_exp_f32 v129, v129
    v_mfma_f32_16x16x32_bf16 v[124:127], v[80:83], v[40:43], 0
    v_exp_f32 v130, v130
    v_cvt_pk_bf16_f32 v140, v128, v129
    v_mfma_f32_16x16x32_bf16 v[144:147], v[96:99], v[136:139], v[144:147]
    v_exp_f32 v131, v131
    v_exp_f32 v132, v132
    v_cvt_pk_bf16_f32 v141, v130, v131
    v_mfma_f32_16x16x32_bf16 v[148:151], v[112:115], v[136:139], v[148:151]
    ds_read_b128 v[100:103], v244 offset:43008
    v_exp_f32 v133, v133
    v_exp_f32 v134, v134
    v_cvt_pk_bf16_f32 v142, v132, v133
    v_exp_f32 v135, v135
    v_mfma_f32_16x16x32_bf16 v[160:163], v[226:229], v[136:139], v[160:163]
    ds_read_b128 v[116:119], v244 offset:44032
    v_cvt_pk_bf16_f32 v143, v134, v135
    v_mfma_f32_16x16x32_bf16 v[132:135], v[80:83], v[48:51], v[236:239]
    v_exp_f32 v120, v120
    v_exp_f32 v121, v121
    v_mfma_f32_16x16x32_bf16 v[152:155], v[96:99], v[140:143], v[152:155]
    v_exp_f32 v122, v122
    v_cvt_pk_bf16_f32 v136, v120, v121
    v_mfma_f32_16x16x32_bf16 v[156:159], v[112:115], v[140:143], v[156:159]
    v_exp_f32 v123, v123
    v_exp_f32 v124, v124
    v_cvt_pk_bf16_f32 v137, v122, v123
    v_mfma_f32_16x16x32_bf16 v[164:167], v[226:229], v[140:143], v[164:167]
    v_exp_f32 v125, v125
    v_exp_f32 v126, v126
    v_cvt_pk_bf16_f32 v138, v124, v125
    v_exp_f32 v127, v127
    s_nop 0
    v_cvt_pk_bf16_f32 v139, v126, v127
    s_waitcnt lgkmcnt(0)
    s_nop 0
    v_mfma_f32_16x16x32_bf16 v[144:147], v[100:103], v[136:139], v[144:147]
    v_exp_f32 v132, v132
    v_mfma_f32_16x16x32_bf16 v[148:151], v[116:119], v[136:139], v[148:151]
    v_exp_f32 v133, v133
    v_mov_b32 v141, 0
    v_mfma_f32_16x16x32_bf16 v[160:163], v[226:229], v[136:139], v[160:163]
    v_exp_f32 v134, v134
    v_cvt_pk_bf16_f32 v142, v132, v133
    v_exp_f32 v135, v135
    v_mov_b32 v140, 0
    v_cvt_pk_bf16_f32 v143, v134, v135
    s_branch L_afin
L_attA0:
    s_setprio 1
    s_lshr_b32 s27, s33, 9
    s_add_u32 s27, s27, 147456
    v_and_b32 v180, 16, v0
    v_add_u32 v180, s27, v180
    s_cmp_ge_u32 s20, 2
    s_cselect_b32 s27, s34, s87
    s_sub_u32 s27, s27, s87
    v_bfe_i32 v174, v1, 1, 1
    v_and_b32 v174, s27, v174
    v_add3_u32 v174, v174, v180, s87
    s_mov_b64 exec, 15
    v_mov_b32 v182, 0
    v_mov_b32 v183, 0
    buffer_atomic_or_x2 v[182:183], v174, s[12:15], 0 offen sc0
    s_mov_b64 exec, -1
    s_barrier
    ds_read_b128 v[40:43], v245 offset:0
    ds_read_b128 v[48:51], v245 offset:1024
    ds_read_b128 v[72:75], v244 offset:24576
    ds_read_b128 v[80:83], v244 offset:25600
    ds_read_b128 v[100:103], v244 offset:26624
    ds_read_b128 v[116:119], v244 offset:27648
    s_waitcnt lgkmcnt(2)
    v_mfma_f32_16x16x32_bf16 v[120:123], v[72:75], v[40:43], v[222:225]
    v_mfma_f32_16x16x32_bf16 v[128:131], v[72:75], v[48:51], 0
    s_nop 6
    v_exp_f32 v120, v120
    v_mfma_f32_16x16x32_bf16 v[132:135], v[80:83], v[48:51], v[222:225]
    v_exp_f32 v121, v121
    v_mov_b32 v139, 0
    v_exp_f32 v122, v122
    v_cvt_pk_bf16_f32 v136, v120, v121
    v_exp_f32 v123, v123
    v_mov_b32 v138, 0
    v_cvt_pk_bf16_f32 v137, v122, v123
    s_waitcnt lgkmcnt(0)
    s_nop 0
    v_mfma_f32_16x16x32_bf16 v[144:147], v[100:103], v[136:139], v[144:147]
    v_exp_f32 v128, v128
    v_exp_f32 v129, v129
    v_mfma_f32_16x16x32_bf16 v[148:151], v[116:119], v[136:139], v[148:151]
    v_exp_f32 v130, v130
    v_cvt_pk_bf16_f32 v140, v128, v129
    v_mfma_f32_16x16x32_bf16 v[160:163], v[226:229], v[136:139], v[160:163]
    v_exp_f32 v131, v131
    v_exp_f32 v132, v132
    v_cvt_pk_bf16_f32 v141, v130, v131
    v_exp_f32 v133, v133
    v_exp_f32 v134, v134
    v_cvt_pk_bf16_f32 v142, v132, v133
    v_exp_f32 v135, v135
    s_nop 0
    v_cvt_pk_bf16_f32 v143, v134, v135
    s_mov_b64 exec, 15
    v_mov_b32 v180, 0
    v_mov_b32 v181, 0
    buffer_atomic_or_x2 v[180:181], v174, s[12:15], 0 offen sc0
    s_mov_b64 exec, -1
    s_add_u32 m0, s85, 90112
    s_add_u32 s36, s86, 1441792
    s_and_b32 s36, s36, 0x1fffff
    buffer_load_dwordx4 v3, s[8:11], s36 offen lds
    s_add_u32 m0, s85, 94208
    s_add_u32 s36, s86, 1507328
    s_and_b32 s36, s36, 0x1fffff
    buffer_load_dwordx4 v3, s[8:11], s36 offen lds
    s_add_u32 m0, s85, 57344
    s_add_u32 s36, s86, 917504
    s_and_b32 s36, s36, 0x1fffff
    buffer_load_dwordx4 v3, s[8:11], s36 offen lds
    s_add_u32 m0, s85, 61440
    s_add_u32 s36, s86, 983040
    s_and_b32 s36, s36, 0x1fffff
    buffer_load_dwordx4 v3, s[8:11], s36 offen lds
    s_cmp_lg_u32 s20, 0
    s_cbranch_scc0 Lw_94
    s_mov_b64 exec, 15
    s_waitcnt vmcnt(4)
    v_xor_b32 v182, s24, v180
    v_xor_b32 v183, s25, v181
    v_lshrrev_b32 v183, 5, v183
    v_or_b32 v182, v182, v183
    v_cmp_ne_u32 vcc, 0, v182
    s_nop 0
    s_cbranch_vccz Lw_94
    s_mov_b32 s26, 0
Lpoll_95:
    v_mov_b32 v180, 0
    v_mov_b32 v181, 0
    buffer_atomic_or_x2 v[180:181], v174, s[12:15], 0 offen sc0
    s_waitcnt vmcnt(0)
    v_xor_b32 v182, s24, v180
    v_xor_b32 v183, s25, v181
    v_lshrrev_b32 v183, 5, v183
    v_or_b32 v182, v182, v183
    v_cmp_ne_u32 vcc, 0, v182
    s_nop 0
    s_cbranch_vccz Lok_96
    s_add_u32 s26, s26, 1
    s_cmp_lt_u32 s26, 262144
    s_cbranch_scc1 Lpoll_95
Lok_96:
Lw_94:
    s_mov_b64 exec, -1
    v_add_u32 v184, s87, v0
    s_and_b32 s28, s33, 4096
    s_add_u32 m0, s28, 98304
    s_add_u32 s27, s33, 49152
    buffer_load_dwordx4 v184, s[12:15], s27 offen offset:0 sc1 lds
    buffer_load_dwordx4 v184, s[12:15], s27 offen offset:1024 sc1 lds
    buffer_load_dwordx4 v184, s[12:15], s27 offen offset:2048 sc1 lds
    buffer_load_dwordx4 v184, s[12:15], s27 offen offset:3072 sc1 lds
    s_add_u32 m0, s28, 106496
    s_add_u32 s27, s33, 32768
    buffer_load_dwordx4 v184, s[12:15], s27 offen offset:0 sc1 lds
    buffer_load_dwordx4 v184, s[12:15], s27 offen offset:1024 sc1 lds
    buffer_load_dwordx4 v184, s[12:15], s27 offen offset:2048 sc1 lds
    buffer_load_dwordx4 v184, s[12:15], s27 offen offset:3072 sc1 lds
    s_add_u32 m0, s28, 114688
    s_add_u32 s27, s33, 16384
    buffer_load_dwordx4 v184, s[12:15], s27 offen offset:0 sc1 lds
    buffer_load_dwordx4 v184, s[12:15], s27 offen offset:1024 sc1 lds
    buffer_load_dwordx4 v184, s[12:15], s27 offen offset:2048 sc1 lds
    buffer_load_dwordx4 v184, s[12:15], s27 offen offset:3072 sc1 lds
    s_add_u32 m0, s28, 122880
    s_add_u32 s27, s33, 0
    buffer_load_dwordx4 v184, s[12:15], s27 offen offset:0 sc1 lds
    buffer_load_dwordx4 v184, s[12:15], s27 offen offset:1024 sc1 lds
    buffer_load_dwordx4 v184, s[12:15], s27 offen offset:2048 sc1 lds
    buffer_load_dwordx4 v184, s[12:15], s27 offen offset:3072 sc1 lds
    s_and_b32 s27, s33, 4096
    s_add_u32 s27, s27, 98304
    v_add_u32 v244, s27, v0
    v_xor_b32 v236, 4048155338, v222
    v_xor_b32 v237, 4048155338, v223
    v_xor_b32 v238, 4048155338, v224
    v_xor_b32 v239, 4048155338, v225
    s_waitcnt vmcnt(8)
    s_barrier
    ds_read_b128 v[56:59], v244 offset:0
    ds_read_b128 v[64:67], v244 offset:1024
    ds_read_b128 v[96:99], v244 offset:2048
    ds_read_b128 v[112:115], v244 offset:3072
    s_waitcnt lgkmcnt(2)
    v_mfma_f32_16x16x32_bf16 v[120:123], v[56:59], v[40:43], 0
    v_mfma_f32_16x16x32_bf16 v[124:127], v[64:67], v[40:43], 0
    v_mfma_f32_16x16x32_bf16 v[128:131], v[56:59], v[48:51], 0
    ds_read_b128 v[72:75], v244 offset:8192
    s_nop 4
    v_exp_f32 v120, v120
    v_exp_f32 v121, v121
    v_mfma_f32_16x16x32_bf16 v[132:135], v[64:67], v[48:51], 0
    ds_read_b128 v[80:83], v244 offset:9216
    v_exp_f32 v122, v122
    v_cvt_pk_bf16_f32 v136, v120, v121
    v_mfma_f32_16x16x32_bf16 v[152:155], v[100:103], v[140:143], v[152:155]
    v_exp_f32 v123, v123
    v_exp_f32 v124, v124
    v_cvt_pk_bf16_f32 v137, v122, v123
    v_mfma_f32_16x16x32_bf16 v[156:159], v[116:119], v[140:143], v[156:159]
    v_exp_f32 v125, v125
    v_exp_f32 v126, v126
    v_cvt_pk_bf16_f32 v138, v124, v125
    v_exp_f32 v127, v127
    v_mfma_f32_16x16x32_bf16 v[164:167], v[226:229], v[140:143], v[164:167]
    v_cvt_pk_bf16_f32 v139, v126, v127
    s_cmp_eq_u32 s20, 0
    s_cbranch_scc0 Lw_100
    v_mov_b32 v226, 0
    v_mov_b32 v227, 0
    v_mov_b32 v228, 0
    v_mov_b32 v229, 0
Lw_100:
    s_waitcnt lgkmcnt(0)
    v_mfma_f32_16x16x32_bf16 v[120:123], v[72:75], v[40:43], 0
    v_exp_f32 v128, v128
    v_exp_f32 v129, v129
    v_mfma_f32_16x16x32_bf16 v[124:127], v[80:83], v[40:43], 0
    v_exp_f32 v130, v130
    v_cvt_pk_bf16_f32 v140, v128, v129
    v_mfma_f32_16x16x32_bf16 v[144:147], v[96:99], v[136:139], v[144:147]
    v_exp_f32 v131, v131
    v_exp_f32 v132, v132
    v_cvt_pk_bf16_f32 v141, v130, v131
    v_mfma_f32_16x16x32_bf16 v[148:151], v[112:115], v[136:139], v[148:151]
    ds_read_b128 v[100:103], v244 offset:10240
    v_exp_f32 v133, v133
    v_exp_f32 v134, v134
    v_cvt_pk_bf16_f32 v142, v132, v133
    v_exp_f32 v135, v135
    v_mfma_f32_16x16x32_bf16 v[160:163], v[226:229], v[136:139], v[160:163]
    ds_read_b128 v[116:119], v244 offset:11264
    v_cvt_pk_bf16_f32 v143, v134, v135
    s_waitcnt vmcnt(0)
    s_barrier
    v_mfma_f32_16x16x32_bf16 v[128:131], v[72:75], v[48:51], 0
    ds_read_b128 v[56:59], v244 offset:16384
    v_exp_f32 v120, v120
    v_exp_f32 v121, v121
    v_mfma_f32_16x16x32_bf16 v[132:135], v[80:83], v[48:51], 0
    ds_read_b128 v[64:67], v244 offset:17408
    v_exp_f32 v122, v122
    v_cvt_pk_bf16_f32 v136, v120, v121
    v_mfma_f32_16x16x32_bf16 v[152:155], v[96:99], v[140:143], v[152:155]
    v_exp_f32 v123, v123
    v_exp_f32 v124, v124
    v_cvt_pk_bf16_f32 v137, v122, v123
    v_mfma_f32_16x16x32_bf16 v[156:159], v[112:115], v[140:143], v[156:159]
    v_exp_f32 v125, v125
    v_exp_f32 v126, v126
    v_cvt_pk_bf16_f32 v138, v124, v125
    v_exp_f32 v127, v127
    v_mfma_f32_16x16x32_bf16 v[164:167], v[226:229], v[140:143], v[164:167]
    v_cvt_pk_bf16_f32 v139, v126, v127
    s_waitcnt lgkmcnt(0)
    v_mfma_f32_16x16x32_bf16 v[120:123], v[56:59], v[40:43], 0
    v_exp_f32 v128, v128
    v_exp_f32 v129, v129
    v_mfma_f32_16x16x32_bf16 v[124:127], v[64:67], v[40:43], 0
    v_exp_f32 v130, v130
    v_cvt_pk_bf16_f32 v140, v128, v129
    v_mfma_f32_16x16x32_bf16 v[144:147], v[100:103], v[136:139], v[144:147]
    v_exp_f32 v131, v131
    v_exp_f32 v132, v132
    v_cvt_pk_bf16_f32 v141, v130, v131
    v_mfma_f32_16x16x32_bf16 v[148:151], v[116:119], v[136:139], v[148:151]
    ds_read_b128 v[96:99], v244 offset:18432
    v_exp_f32 v133, v133
    v_exp_f32 v134, v134
    v_cvt_pk_bf16_f32 v142, v132, v133
    v_exp_f32 v135, v135
    v_mfma_f32_16x16x32_bf16 v[160:163], v[226:229], v[136:139], v[160:163]
    ds_read_b128 v[112:115], v244 offset:19456
    v_cvt_pk_bf16_f32 v143, v134, v135
    v_mfma_f32_16x16x32_bf16 v[128:131], v[56:59], v[48:51], 0
    ds_read_b128 v[72:75], v244 offset:24576
    v_exp_f32 v120, v120
    v_exp_f32 v121, v121
    v_mfma_f32_16x16x32_bf16 v[132:135], v[64:67], v[48:51], 0
    ds_read_b128 v[80:83], v244 offset:25600
    v_exp_f32 v122, v122
    v_cvt_pk_bf16_f32 v136, v120, v121
    v_mfma_f32_16x16x32_bf16 v[152:155], v[100:103], v[140:143], v[152:155]
    v_exp_f32 v123, v123
    v_exp_f32 v124, v124
    v_cvt_pk_bf16_f32 v137, v122, v123
    v_mfma_f32_16x16x32_bf16 v[156:159], v[116:119], v[140:143], v[156:159]
    v_exp_f32 v125, v125
    v_exp_f32 v126, v126
    v_cvt_pk_bf16_f32 v138, v124, v125
    v_exp_f32 v127, v127
    v_mfma_f32_16x16x32_bf16 v[164:167], v[226:229], v[140:143], v[164:167]
    v_cvt_pk_bf16_f32 v139, v126, v127
    s_waitcnt lgkmcnt(0)
    v_mfma_f32_16x16x32_bf16 v[120:123], v[72:75], v[40:43], 0
    v_exp_f32 v128, v128
    v_exp_f32 v129, v129
    v_mfma_f32_16x16x32_bf16 v[124:127], v[80:83], v[40:43], 0
    v_exp_f32 v130, v130
    v_cvt_pk_bf16_f32 v140, v128, v129
    v_mfma_f32_16x16x32_bf16 v[144:147], v[96:99], v[136:139], v[144:147]
    v_exp_f32 v131, v131
    v_exp_f32 v132, v132
    v_cvt_pk_bf16_f32 v141, v130, v131
    v_mfma_f32_16x16x32_bf16 v[148:151], v[112:115], v[136:139], v[148:151]
    ds_read_b128 v[100:103], v244 offset:26624
    v_exp_f32 v133, v133
    v_exp_f32 v134, v134
    v_cvt_pk_bf16_f32 v142, v132, v133
    v_exp_f32 v135, v135
    v_mfma_f32_16x16x32_bf16 v[160:163], v[226:229], v[136:139], v[160:163]
    ds_read_b128 v[116:119], v244 offset:27648
    v_cvt_pk_bf16_f32 v143, v134, v135
    s_barrier
    v_mfma_f32_16x16x32_bf16 v[128:131], v[72:75], v[48:51], 0
    ds_read_b128 v[56:59], v244 offset:32768
    v_exp_f32 v120, v120
    v_exp_f32 v121, v121
    v_mfma_f32_16x16x32_bf16 v[132:135], v[80:83], v[48:51], 0
    ds_read_b128 v[64:67], v244 offset:33792
    v_exp_f32 v122, v122
    v_cvt_pk_bf16_f32 v136, v120, v121
    v_mfma_f32_16x16x32_bf16 v[152:155], v[96:99], v[140:143], v[152:155]
    s_cmp_eq_u32 s22, 0
    s_cbranch_scc0 Lw_97
    s_add_u32 s27, s71, 0
    buffer_store_dwordx4 v[176:179], v0, s[16:19], s27 offen offset:0 sc1
    s_add_u32 s27, s71, 0
    buffer_store_dwordx4 v[176:179], v0, s[16:19], s27 offen offset:1024 sc1
Lw_97:
    v_exp_f32 v123, v123
    v_exp_f32 v124, v124
    v_cvt_pk_bf16_f32 v137, v122, v123
    v_mfma_f32_16x16x32_bf16 v[156:159], v[112:115], v[140:143], v[156:159]
    v_exp_f32 v125, v125
    v_exp_f32 v126, v126
    v_cvt_pk_bf16_f32 v138, v124, v125
    v_exp_f32 v127, v127
    v_mfma_f32_16x16x32_bf16 v[164:167], v[226:229], v[140:143], v[164:167]
    v_cvt_pk_bf16_f32 v139, v126, v127
    s_waitcnt lgkmcnt(0)
    v_mfma_f32_16x16x32_bf16 v[120:123], v[56:59], v[40:43], 0
    s_cmp_eq_u32 s22, 0
    s_cbranch_scc0 Lw_98
    s_add_u32 s27, s71, 0
    buffer_store_dwordx4 v[176:179], v0, s[16:19], s27 offen offset:2048 sc1
    s_add_u32 s27, s71, 0
    buffer_store_dwordx4 v[176:179], v0, s[16:19], s27 offen offset:3072 sc1
Lw_98:
    v_exp_f32 v128, v128
    v_exp_f32 v129, v129
    v_mfma_f32_16x16x32_bf16 v[124:127], v[64:67], v[40:43], 0
    v_exp_f32 v130, v130
    v_cvt_pk_bf16_f32 v140, v128, v129
    v_mfma_f32_16x16x32_bf16 v[144:147], v[100:103], v[136:139], v[144:147]
    v_exp_f32 v131, v131
    v_exp_f32 v132, v132
    v_cvt_pk_bf16_f32 v141, v130, v131
    v_mfma_f32_16x16x32_bf16 v[148:151], v[116:119], v[136:139], v[148:151]
    ds_read_b128 v[96:99], v244 offset:34816
    v_exp_f32 v133, v133
    v_exp_f32 v134, v134
    v_cvt_pk_bf16_f32 v142, v132, v133
    v_exp_f32 v135, v135
    v_mfma_f32_16x16x32_bf16 v[160:163], v[226:229], v[136:139], v[160:163]
    ds_read_b128 v[112:115], v244 offset:35840
    v_cvt_pk_bf16_f32 v143, v134, v135
    v_mfma_f32_16x16x32_bf16 v[128:131], v[56:59], v[48:51], 0
    ds_read_b128 v[72:75], v244 offset:40960
    v_exp_f32 v120, v120
    v_exp_f32 v121, v121
    v_mfma_f32_16x16x32_bf16 v[132:135], v[64:67], v[48:51], 0
    ds_read_b128 v[80:83], v244 offset:41984
    v_exp_f32 v122, v122
    v_cvt_pk_bf16_f32 v136, v120, v121
    v_mfma_f32_16x16x32_bf16 v[152:155], v[100:103], v[140:143], v[152:155]
    s_cmp_eq_u32 s22, 0
    s_cbranch_scc0 Lw_99
    s_add_u32 s27, s85, 131072
    s_add_u32 s27, s27, s73
    buffer_store_dwordx4 v[176:179], v0, s[12:15], s27 offen sc1
    s_add_u32 s27, s85, 135168
    s_add_u32 s27, s27, s73
    buffer_store_dwordx4 v[176:179], v0, s[12:15], s27 offen sc1
Lw_99:
    v_exp_f32 v123, v123
    v_exp_f32 v124, v124
    v_cvt_pk_bf16_f32 v137, v122, v123
    v_mfma_f32_16x16x32_bf16 v[156:159], v[116:119], v[140:143], v[156:159]
    v_exp_f32 v125, v125
    v_exp_f32 v126, v126
    v_cvt_pk_bf16_f32 v138, v124, v125
    v_exp_f32 v127, v127
    v_mfma_f32_16x16x32_bf16 v[164:167], v[226:229], v[140:143], v[164:167]
    v_cvt_pk_bf16_f32 v139, v126, v127
    s_cmp_eq_u32 s20, 1
    s_cbranch_scc0 Lw_101
    v_mov_b32 v226, 0
    v_mov_b32 v227, 0
    v_mov_b32 v228, 0
    v_mov_b32 v229, 0
Lw_101:
    s_waitcnt lgkmcnt(0)
    v_mfma_f32_16x16x32_bf16 v[120:123], v[72:75], v[40:43], 0
    v_exp_f32 v128, v128
    v_exp_f32 v129, v129
    v_mfma_f32_16x16x32_bf16 v[124:127], v[80:83], v[40:43], 0
    v_exp_f32 v130, v130
    v_cvt_pk_bf16_f32 v140, v128, v129
    v_mfma_f32_16x16x32_bf16 v[144:147], v[96:99], v[136:139], v[144:147]
    v_exp_f32 v131, v131
    v_exp_f32 v132, v132
    v_cvt_pk_bf16_f32 v141, v130, v131
    v_mfma_f32_16x16x32_bf16 v[148:151], v[112:115], v[136:139], v[148:151]
    ds_read_b128 v[100:103], v244 offset:43008
    v_exp_f32 v133, v133
    v_exp_f32 v134, v134
    v_cvt_pk_bf16_f32 v142, v132, v133
    v_exp_f32 v135, v135
    v_mfma_f32_16x16x32_bf16 v[160:163], v[226:229], v[136:139], v[160:163]
    ds_read_b128 v[116:119], v244 offset:44032
    v_cvt_pk_bf16_f32 v143, v134, v135
    v_mfma_f32_16x16x32_bf16 v[128:131], v[72:75], v[48:51], 0
    ds_read_b128 v[56:59], v244 offset:49152
    v_exp_f32 v120, v120
    v_exp_f32 v121, v121
    v_mfma_f32_16x16x32_bf16 v[132:135], v[80:83], v[48:51], 0
    ds_read_b128 v[64:67], v244 offset:50176
    v_exp_f32 v122, v122
    v_cvt_pk_bf16_f32 v136, v120, v121
    v_mfma_f32_16x16x32_bf16 v[152:155], v[96:99], v[140:143], v[152:155]
    v_exp_f32 v123, v123
    v_exp_f32 v124, v124
    v_cvt_pk_bf16_f32 v137, v122, v123
    v_mfma_f32_16x16x32_bf16 v[156:159], v[112:115], v[140:143], v[156:159]
    v_exp_f32 v125, v125
    v_exp_f32 v126, v126
    v_cvt_pk_bf16_f32 v138, v124, v125
    v_exp_f32 v127, v127
    v_mfma_f32_16x16x32_bf16 v[164:167], v[226:229], v[140:143], v[164:167]
    v_cvt_pk_bf16_f32 v139, v126, v127
    s_waitcnt lgkmcnt(0)
    v_mfma_f32_16x16x32_bf16 v[120:123], v[56:59], v[40:43], 0
    v_exp_f32 v128, v128
    v_exp_f32 v129, v129
    v_mfma_f32_16x16x32_bf16 v[124:127], v[64:67], v[40:43], 0
    v_exp_f32 v130, v130
    v_cvt_pk_bf16_f32 v140, v128, v129
    v_mfma_f32_16x16x32_bf16 v[144:147], v[100:103], v[136:139], v[144:147]
    v_exp_f32 v131, v131
    v_exp_f32 v132, v132
    v_cvt_pk_bf16_f32 v141, v130, v131
    v_mfma_f32_16x16x32_bf16 v[148:151], v[116:119], v[136:139], v[148:151]
    ds_read_b128 v[96:99], v244 offset:51200
    v_exp_f32 v133, v133
    v_exp_f32 v134, v134
    v_cvt_pk_bf16_f32 v142, v132, v133
    v_exp_f32 v135, v135
    v_mfma_f32_16x16x32_bf16 v[160:163], v[226:229], v[136:139], v[160:163]
    ds_read_b128 v[112:115], v244 offset:52224
    v_cvt_pk_bf16_f32 v143, v134, v135
    v_mfma_f32_16x16x32_bf16 v[128:131], v[56:59], v[48:51], 0
    ds_read_b128 v[72:75], v244 offset:57344
    v_exp_f32 v120, v120
    v_exp_f32 v121, v121
    v_mfma_f32_16x16x32_bf16 v[132:135], v[64:67], v[48:51], 0
    ds_read_b128 v[80:83], v244 offset:58368
    v_exp_f32 v122, v122
    v_cvt_pk_bf16_f32 v136, v120, v121
    v_mfma_f32_16x16x32_bf16 v[152:155], v[100:103], v[140:143], v[152:155]
    v_exp_f32 v123, v123
    v_exp_f32 v124, v124
    v_cvt_pk_bf16_f32 v137, v122, v123
    v_mfma_f32_16x16x32_bf16 v[156:159], v[116:119], v[140:143], v[156:159]
    v_exp_f32 v125, v125
    v_exp_f32 v126, v126
    v_cvt_pk_bf16_f32 v138, v124, v125
    v_exp_f32 v127, v127
    v_mfma_f32_16x16x32_bf16 v[164:167], v[226:229], v[140:143], v[164:167]
    v_cvt_pk_bf16_f32 v139, v126, v127
    s_waitcnt lgkmcnt(0)
    v_mfma_f32_16x16x32_bf16 v[120:123], v[72:75], v[40:43], v[236:239]
    v_exp_f32 v128, v128
    v_exp_f32 v129, v129
    v_mfma_f32_16x16x32_bf16 v[124:127], v[80:83], v[40:43], 0
    v_exp_f32 v130, v130
    v_cvt_pk_bf16_f32 v140, v128, v129
    v_mfma_f32_16x16x32_bf16 v[144:147], v[96:99], v[136:139], v[144:147]
    v_exp_f32 v131, v131
    v_exp_f32 v132, v132
    v_cvt_pk_bf16_f32 v141, v130, v131
    v_mfma_f32_16x16x32_bf16 v[148:151], v[112:115], v[136:139], v[148:151]
    ds_read_b128 v[100:103], v244 offset:59392
    v_exp_f32 v133, v133
    v_exp_f32 v134, v134
    v_cvt_pk_bf16_f32 v142, v132, v133
    v_exp_f32 v135, v135
    v_mfma_f32_16x16x32_bf16 v[160:163], v[226:229], v[136:139], v[160:163]
    ds_read_b128 v[116:119], v244 offset:60416
    v_cvt_pk_bf16_f32 v143, v134, v135
    v_mfma_f32_16x16x32_bf16 v[132:135], v[80:83], v[48:51], v[236:239]
    v_exp_f32 v120, v120
    v_exp_f32 v121, v121
    v_mfma_f32_16x16x32_bf16 v[152:155], v[96:99], v[140:143], v[152:155]
    v_exp_f32 v122, v122
    v_cvt_pk_bf16_f32 v136, v120, v121
    v_mfma_f32_16x16x32_bf16 v[156:159], v[112:115], v[140:143], v[156:159]
    v_exp_f32 v123, v123
    v_exp_f32 v124, v124
    v_cvt_pk_bf16_f32 v137, v122, v123
    v_mfma_f32_16x16x32_bf16 v[164:167], v[226:229], v[140:143], v[164:167]
    v_exp_f32 v125, v125
    v_exp_f32 v126, v126
    v_cvt_pk_bf16_f32 v138, v124, v125
    v_exp_f32 v127, v127
    s_nop 0
    v_cvt_pk_bf16_f32 v139, v126, v127
    s_waitcnt lgkmcnt(0)
    s_nop 0
    v_mfma_f32_16x16x32_bf16 v[144:147], v[100:103], v[136:139], v[144:147]
    v_exp_f32 v132, v132
    v_mfma_f32_16x16x32_bf16 v[148:151], v[116:119], v[136:139], v[148:151]
    v_exp_f32 v133, v133
    v_mov_b32 v141, 0
    v_mfma_f32_16x16x32_bf16 v[160:163], v[226:229], v[136:139], v[160:163]
    v_exp_f32 v134, v134
    v_cvt_pk_bf16_f32 v142, v132, v133
    v_exp_f32 v135, v135
    v_mov_b32 v140, 0
    v_cvt_pk_bf16_f32 v143, v134, v135
    s_branch L_afin
L_cstart:
    s_lshl_b32 s27, s20, 2
    s_add_u32 s27, s27, s3
    s_lshl_b32 s27, s27, 16
    s_lshl_b32 s28, s21, 7
    s_add_u32 s27, s27, s28
    v_and_b32 v24, 15, v1
    v_lshlrev_b32 v24, 11, v24
    v_and_b32 v25, 48, v1
    v_add3_u32 v24, v24, v25, s27
    v_add_u32 v25, 32768, v24
    s_lshl_b32 s47, s20, 4
    s_add_u32 s47, s47, s21
    s_lshl_b32 s47, s47, 11
    s_add_u32 s47, s47, s3
    s_lshl_b32 s47, s47, 7
    s_add_u32 s47, s47, 84034560
    v_lshrrev_b32 v32, 3, v1
    v_mul_u32_u24 v32, 8064, v32
    v_add_u32 v32, v32, v0
    v_mov_b32 v28, 0
    v_mov_b32 v29, 0
    v_mov_b32 v30, 0
    v_mov_b32 v31, 0
    s_waitcnt lgkmcnt(0)
    s_mov_b32 s12, s64
    s_mov_b32 s13, s65
    s_mov_b32 s14, 167772160
    s_mov_b32 s15, 0x00020000
    s_sub_u32 s27, 0, s64
    s_and_b32 s27, s27, 0x3ff00
    s_add_u32 s47, s47, s27
    s_mov_b64 exec, 0xffff
    buffer_store_dwordx4 v[28:31], v32, s[12:15], s47 offen sc1
    s_mov_b64 exec, -1
    s_mov_b32 s16, s48
    s_mov_b32 s17, s49
    s_mov_b32 s18, 4194304
    s_mov_b32 s19, 0x00020000
    buffer_load_dwordx4 v[8:11], v24, s[16:19], 0 offen offset:0
    buffer_load_dwordx4 v[12:15], v24, s[16:19], 0 offen offset:64
    buffer_load_dwordx4 v[16:19], v25, s[16:19], 0 offen offset:0
    buffer_load_dwordx4 v[20:23], v25, s[16:19], 0 offen offset:64
    s_or_b32 s84, s75, 1
    s_mov_b32 s12, s64
    s_mov_b32 s13, s65
    s_mov_b32 s14, 167772160
    s_mov_b32 s15, 0x00020000
    v_mov_b32 v28, 843776
    buffer_load_dwordx2 v[26:27], v28, s[12:15], 0 offen sc1
    s_mov_b32 s8, s52
    s_mov_b32 s9, s53
    s_mov_b32 s10, 2097152
    s_mov_b32 s11, 0x00020000
    s_mov_b32 s22, 0
    s_mov_b32 s23, 0
    v_mov_b32 v6, 0
    v_bfe_u32 v28, v1, 2, 3
    v_bfe_u32 v29, v1, 3, 2
    v_and_b32 v30, 3, v1
    v_lshlrev_b32 v28, 7, v28
    v_lshlrev_b32 v29, 5, v29
    v_lshlrev_b32 v30, 3, v30
    v_add3_u32 v2, v28, v29, v30
    v_and_b32 v28, 15, v1
    v_lshrrev_b32 v29, 4, v1
    v_lshlrev_b32 v29, 2, v29
    v_sub_u32 v4, v28, v29
    s_lshl_b32 s85, s75, 10
    s_lshl_b32 s86, s21, 17
    s_lshl_b32 s27, s75, 14
    s_lshl_b32 s28, s21, 7
    s_add_u32 s27, s27, s28
    v_lshrrev_b32 v3, 3, v1
    v_lshlrev_b32 v3, 11, v3
    v_add3_u32 v3, v3, v173, s27
    s_lshl_b32 s27, s20, 18
    s_lshl_b32 s28, s21, 12
    s_add_u32 s27, s27, s28
    s_lshl_b32 s28, s75, 16
    s_add_u32 s71, s27, s28
    s_lshl_b32 s28, s84, 16
    s_add_u32 s27, s27, s28
    s_and_b32 s28, s75, 1
    s_lshl_b32 s29, s28, 11
    s_add_u32 s27, s27, s29
    s_add_u32 s72, s27, 2097152
    s_lshl_b32 s33, s28, 12
    s_sub_u32 s29, 0, s64
    s_and_b32 s29, s29, 0x3ff00
    s_add_u32 s29, s29, 83886080
    s_sub_u32 s27, s20, 0
    s_lshl_b32 s73, s27, 4
    s_add_u32 s73, s73, s21
    s_lshl_b32 s73, s73, 18
    s_add_u32 s73, s73, s29
    s_sub_u32 s27, s20, 1
    s_lshl_b32 s87, s27, 4
    s_add_u32 s87, s87, s21
    s_lshl_b32 s87, s87, 18
    s_add_u32 s87, s87, s29
    s_cmp_lt_u32 s20, 1
    s_cselect_b32 s87, 1073741824, s87
    s_sub_u32 s27, s20, 2
    s_lshl_b32 s34, s27, 4
    s_add_u32 s34, s34, s21
    s_lshl_b32 s34, s34, 18
    s_add_u32 s34, s34, s29
    s_cmp_lt_u32 s20, 2
    s_cselect_b32 s34, 1073741824, s34
    v_mov_b32 v176, -1
    v_mov_b32 v177, -1
    v_mov_b32 v178, -1
    v_mov_b32 v179, -1
    v_subrev_u32 v222, 0, v4
    v_ashrrev_i32 v222, 31, v222
    v_and_b32 v222, 4048155338, v222
    v_subrev_u32 v223, 1, v4
    v_ashrrev_i32 v223, 31, v223
    v_and_b32 v223, 4048155338, v223
    v_subrev_u32 v224, 2, v4
    v_ashrrev_i32 v224, 31, v224
    v_and_b32 v224, 4048155338, v224
    v_subrev_u32 v225, 3, v4
    v_ashrrev_i32 v225, 31, v225
    v_and_b32 v225, 4048155338, v225
    s_mov_b32 s4, s50
    s_mov_b32 s5, s51
    s_mov_b32 s6, 6291456
    s_mov_b32 s7, 0x00020000
    s_mov_b32 s92, 2863311530
    s_mov_b32 s93, 2863311530
    s_mov_b32 s94, 3435973836
    s_mov_b32 s95, 3435973836
    s_mov_b32 s96, 983040
    s_mov_b32 s97, 268370175
    s_mov_b32 s98, 4128771
    s_mov_b32 s99, 1073677311
    s_lshr_b32 s27, s3, 1
    s_lshl_b32 s27, s27, 13
    s_add_u32 s27, s27, 49152
    v_and_b32 v200, 15, v1
    v_bfe_u32 v201, v1, 1, 3
    v_lshrrev_b32 v202, 4, v1
    v_xor_b32 v201, v201, v202
    v_lshlrev_b32 v200, 7, v200
    v_lshlrev_b32 v201, 4, v201
    v_add3_u32 v200, v200, v201, s27
    v_xor_b32 v201, 64, v200
    s_and_b32 s28, s3, 1
    s_lshl_b32 s29, s28, 6
    v_xor_b32 v202, s29, v2
    v_lshrrev_b32 v203, 5, v1
    v_mul_u32_u24 v203, 3072, v203
    v_add_u32 v202, v202, v203
    v_xor_b32 v203, 32, v202
    v_add_u32 v204, 139264, v202
    v_add_u32 v205, 139264, v203
    s_lshr_b32 s27, s3, 1
    s_lshl_b32 s27, s27, 8
    s_add_u32 s27, s27, 131072
    s_lshl_b32 s28, s28, 7
    s_add_u32 s28, s28, 132096
    v_and_b32 v251, 15, v1
    v_and_b32 v250, 48, v1
    v_lshl_add_u32 v248, v251, 2, s27
    v_add_u32 v249, s27, v250
    v_add_u32 v250, s28, v250
    v_lshl_add_u32 v251, v251, 2, s28
    v_mov_b32 v226, 0x3f803f80
    v_mov_b32 v227, 0x3f803f80
    v_mov_b32 v228, 0x3f803f80
    v_mov_b32 v229, 0x3f803f80
    s_add_u32 s0, s64, s47
    s_addc_u32 s1, s65, 0
    s_and_b32 s35, s3, 1
    s_lshl_b32 s36, s35, 13
    s_lshl_b32 s37, s3, 2
    s_lshl_b32 s35, s35, 4
    s_add_u32 s37, s37, s35
    s_add_u32 s37, s37, 132896
    v_mov_b32 v29, s37
    v_xor_b32 v31, 16, v29
    s_waitcnt vmcnt(5)
    s_memtime s[28:29]
    s_waitcnt lgkmcnt(0)
    s_load_dword s26, s[0:1], s36 offset:0
    s_waitcnt lgkmcnt(0)
    s_memtime s[30:31]
    s_xor_b32 s36, s36, 8192
    s_waitcnt lgkmcnt(0)
    s_sub_u32 s29, s30, s28
    s_mov_b32 s28, s30
    s_min_u32 s38, s29, s29
    s_load_dword s26, s[0:1], s36 offset:0
    s_waitcnt lgkmcnt(0)
    s_memtime s[30:31]
    s_xor_b32 s36, s36, 8192
    s_waitcnt lgkmcnt(0)
    s_sub_u32 s29, s30, s28
    s_mov_b32 s28, s30
    s_min_u32 s39, s29, s29
    s_load_dword s26, s[0:1], s36 offset:64
    s_waitcnt lgkmcnt(0)
    s_memtime s[30:31]
    s_xor_b32 s36, s36, 8192
    s_waitcnt lgkmcnt(0)
    s_sub_u32 s29, s30, s28
    s_mov_b32 s28, s30
    s_min_u32 s38, s29, s38
    s_load_dword s26, s[0:1], s36 offset:64
    s_waitcnt lgkmcnt(0)
    s_memtime s[30:31]
    s_xor_b32 s36, s36, 8192
    s_waitcnt lgkmcnt(0)
    s_sub_u32 s29, s30, s28
    s_mov_b32 s28, s30
    s_min_u32 s39, s29, s39
    v_mov_b32 v28, s38
    v_mov_b32 v30, s39
    ds_write_b32 v29, v28
    ds_write_b32 v31, v30
    s_waitcnt vmcnt(0) lgkmcnt(0)
    v_readfirstlane_b32 s24, v26
    v_readfirstlane_b32 s25, v27
    s_add_u32 s24, s24, 1
    s_add_u32 s25, s25, 32
    s_and_b32 s25, s25, 0xffffffe0
    s_getreg_b32 s27, hwreg(HW_REG_XCC_ID, 0, 4)
    s_or_b32 s25, s25, s27
    v_mfma_f32_16x16x32_bf16 v[206:209], v[226:229], v[8:11], 0
    v_mfma_f32_16x16x32_bf16 v[210:213], v[8:11], v[8:11], 0
    v_mfma_f32_16x16x32_bf16 v[214:217], v[226:229], v[16:19], 0
    v_mfma_f32_16x16x32_bf16 v[218:221], v[16:19], v[16:19], 0
    v_mfma_f32_16x16x32_bf16 v[206:209], v[226:229], v[12:15], v[206:209]
    v_mfma_f32_16x16x32_bf16 v[210:213], v[12:15], v[12:15], v[210:213]
    v_mfma_f32_16x16x32_bf16 v[214:217], v[226:229], v[20:23], v[214:217]
    v_mfma_f32_16x16x32_bf16 v[218:221], v[20:23], v[20:23], v[218:221]
    s_mov_b32 s16, s60
    s_mov_b32 s17, s61
    s_mov_b32 s18, 4194304
    s_mov_b32 s19, 0x00020000
    v_permlane16_swap_b32 v8, v10
    v_permlane16_swap_b32 v9, v11
    s_nop 0
    v_permlane32_swap_b32 v8, v10
    v_permlane32_swap_b32 v9, v11
    v_permlane16_swap_b32 v12, v14
    v_permlane16_swap_b32 v13, v15
    s_nop 0
    v_permlane32_swap_b32 v12, v14
    v_permlane32_swap_b32 v13, v15
    v_permlane16_swap_b32 v16, v18
    v_permlane16_swap_b32 v17, v19
    s_nop 0
    v_permlane32_swap_b32 v16, v18
    v_permlane32_swap_b32 v17, v19
    v_permlane16_swap_b32 v20, v22
    v_permlane16_swap_b32 v21, v23
    s_nop 0
    v_permlane32_swap_b32 v20, v22
    s_nop 0
    v_permlane32_swap_b32 v21, v23
L_cgo:
    s_barrier
    ds_read_b128 v[120:123], v200 offset:0
    ds_read_b64_tr_b16 v[136:137], v204 offset:0
    ds_read_b64_tr_b16 v[138:139], v204 offset:6144
    ds_read_b128 v[124:127], v200 offset:2048
    ds_read_b128 v[128:131], v200 offset:4096
    ds_read_b128 v[132:135], v200 offset:6144
    ds_read_b64_tr_b16 v[140:141], v205 offset:0
    ds_read_b64_tr_b16 v[142:143], v205 offset:6144
    ds_read_b64_tr_b16 v[144:145], v204 offset:1024
    ds_read_b64_tr_b16 v[146:147], v204 offset:7168
    ds_read_b64_tr_b16 v[148:149], v205 offset:1024
    ds_read_b64_tr_b16 v[150:151], v205 offset:7168
    ds_read_b64_tr_b16 v[152:153], v204 offset:2048
    ds_read_b64_tr_b16 v[154:155], v204 offset:8192
    ds_read_b64_tr_b16 v[156:157], v205 offset:2048
    ds_read_b64_tr_b16 v[158:159], v205 offset:8192
    s_waitcnt lgkmcnt(13)
    v_mfma_f32_16x16x32_bf16 v[24:27], v[136:139], v[120:123], 0
    ds_read_b128 v[160:163], v201 offset:0
    s_waitcnt lgkmcnt(13)
    v_mfma_f32_16x16x32_bf16 v[32:35], v[136:139], v[124:127], 0
    ds_read_b64_tr_b16 v[176:177], v204 offset:12288
    s_waitcnt lgkmcnt(13)
    v_mfma_f32_16x16x32_bf16 v[40:43], v[136:139], v[128:131], 0
    ds_read_b64_tr_b16 v[178:179], v204 offset:18432
    s_waitcnt lgkmcnt(13)
    v_mfma_f32_16x16x32_bf16 v[48:51], v[136:139], v[132:135], 0
    ds_read_b128 v[164:167], v201 offset:2048
    s_waitcnt lgkmcnt(12)
    v_mfma_f32_16x16x32_bf16 v[52:55], v[140:143], v[132:135], 0
    ds_read_b128 v[168:171], v201 offset:4096
    v_mfma_f32_16x16x32_bf16 v[44:47], v[140:143], v[128:131], 0
    ds_read_b128 v[172:175], v201 offset:6144
    v_mfma_f32_16x16x32_bf16 v[36:39], v[140:143], v[124:127], 0
    ds_read_b64_tr_b16 v[180:181], v205 offset:12288
    v_mfma_f32_16x16x32_bf16 v[28:31], v[140:143], v[120:123], 0
    ds_read_b64_tr_b16 v[182:183], v205 offset:18432
    s_waitcnt lgkmcnt(14)
    v_mfma_f32_16x16x32_bf16 v[56:59], v[144:147], v[120:123], 0
    ds_read_b64_tr_b16 v[184:185], v204 offset:13312
    v_mfma_f32_16x16x32_bf16 v[64:67], v[144:147], v[124:127], 0
    ds_read_b64_tr_b16 v[186:187], v204 offset:19456
    v_mfma_f32_16x16x32_bf16 v[72:75], v[144:147], v[128:131], 0
    ds_read_b64_tr_b16 v[188:189], v205 offset:13312
    v_mfma_f32_16x16x32_bf16 v[80:83], v[144:147], v[132:135], 0
    ds_read_b64_tr_b16 v[190:191], v205 offset:19456
    s_waitcnt lgkmcnt(15)
    v_mfma_f32_16x16x32_bf16 v[84:87], v[148:151], v[132:135], 0
    ds_read_b64_tr_b16 v[192:193], v204 offset:14336
    v_mfma_f32_16x16x32_bf16 v[76:79], v[148:151], v[128:131], 0
    ds_read_b64_tr_b16 v[194:195], v204 offset:20480
    v_mfma_f32_16x16x32_bf16 v[68:71], v[148:151], v[124:127], 0
    ds_read_b64_tr_b16 v[196:197], v205 offset:14336
    v_mfma_f32_16x16x32_bf16 v[60:63], v[148:151], v[120:123], 0
    ds_read_b64_tr_b16 v[198:199], v205 offset:20480
    s_waitcnt lgkmcnt(15)
    v_mfma_f32_16x16x32_bf16 v[88:91], v[120:123], v[152:155], 0
    v_cndmask_b32 v210, v210, v211, s[92:93]
    v_cndmask_b32 v212, v212, v213, s[92:93]
    v_mfma_f32_16x16x32_bf16 v[104:107], v[120:123], v[156:159], 0
    v_mov_b32 v230, v206
    v_cndmask_b32 v231, v210, v212, s[94:95]
    v_mfma_f32_16x16x32_bf16 v[108:111], v[124:127], v[156:159], 0
    v_cndmask_b32 v218, v218, v219, s[92:93]
    v_cndmask_b32 v220, v220, v221, s[92:93]
    v_mfma_f32_16x16x32_bf16 v[92:95], v[124:127], v[152:155], 0
    v_mov_b32 v232, v214
    v_cndmask_b32 v233, v218, v220, s[94:95]
    v_mfma_f32_16x16x32_bf16 v[96:99], v[128:131], v[152:155], 0
    v_and_b32 v236, 0xf0, v0
    s_lshl_b32 s27, s3, 8
    v_mfma_f32_16x16x32_bf16 v[112:115], v[128:131], v[156:159], 0
    s_add_u32 s27, s27, 137216
    v_add_u32 v236, s27, v236
    v_mfma_f32_16x16x32_bf16 v[116:119], v[132:135], v[156:159], 0
    v_mfma_f32_16x16x32_bf16 v[100:103], v[132:135], v[152:155], 0
    s_waitcnt lgkmcnt(4)
    v_mfma_f32_16x16x32_bf16 v[24:27], v[176:179], v[160:163], v[24:27]
    v_mfma_f32_16x16x32_bf16 v[32:35], v[176:179], v[164:167], v[32:35]
    s_mov_b32 exec_lo, 0x00f0000f
    s_mov_b32 exec_hi, 0xf0000f00
    ds_write_b128 v236, v[230:233]
    s_mov_b64 exec, -1
    v_mfma_f32_16x16x32_bf16 v[40:43], v[176:179], v[168:171], v[40:43]
    v_mfma_f32_16x16x32_bf16 v[48:51], v[176:179], v[172:175], v[48:51]
    s_mov_b32 s74, 0
    v_mfma_f32_16x16x32_bf16 v[52:55], v[180:183], v[172:175], v[52:55]
    v_mfma_f32_16x16x32_bf16 v[44:47], v[180:183], v[168:171], v[44:47]
    s_waitcnt lgkmcnt(0)
    v_mfma_f32_16x16x32_bf16 v[36:39], v[180:183], v[164:167], v[36:39]
    s_barrier
    v_mfma_f32_16x16x32_bf16 v[28:31], v[180:183], v[160:163], v[28:31]
    ds_read_b128 v[120:123], v200 offset:16384
    v_mfma_f32_16x16x32_bf16 v[56:59], v[184:187], v[160:163], v[56:59]
    ds_read_b64_tr_b16 v[136:137], v202 offset:0
    v_mfma_f32_16x16x32_bf16 v[64:67], v[184:187], v[164:167], v[64:67]
    ds_read_b64_tr_b16 v[138:139], v202 offset:6144
    v_mfma_f32_16x16x32_bf16 v[72:75], v[184:187], v[168:171], v[72:75]
    ds_read_b128 v[124:127], v200 offset:18432
    v_mfma_f32_16x16x32_bf16 v[80:83], v[184:187], v[172:175], v[80:83]
    ds_read_b128 v[128:131], v200 offset:20480
    v_mfma_f32_16x16x32_bf16 v[84:87], v[188:191], v[172:175], v[84:87]
    ds_read_b128 v[132:135], v200 offset:22528
    v_mfma_f32_16x16x32_bf16 v[76:79], v[188:191], v[168:171], v[76:79]
    ds_read_b64_tr_b16 v[140:141], v203 offset:0
    v_mfma_f32_16x16x32_bf16 v[68:71], v[188:191], v[164:167], v[68:71]
    ds_read_b64_tr_b16 v[142:143], v203 offset:6144
    v_mfma_f32_16x16x32_bf16 v[60:63], v[188:191], v[160:163], v[60:63]
    ds_read_b64_tr_b16 v[144:145], v202 offset:1024
    v_mfma_f32_16x16x32_bf16 v[88:91], v[160:163], v[192:195], v[88:91]
    ds_read_b64_tr_b16 v[146:147], v202 offset:7168
    v_mfma_f32_16x16x32_bf16 v[104:107], v[160:163], v[196:199], v[104:107]
    ds_read_b64_tr_b16 v[148:149], v203 offset:1024
    v_mfma_f32_16x16x32_bf16 v[108:111], v[164:167], v[196:199], v[108:111]
    ds_read_b64_tr_b16 v[150:151], v203 offset:7168
    v_mfma_f32_16x16x32_bf16 v[92:95], v[164:167], v[192:195], v[92:95]
    ds_read_b64_tr_b16 v[152:153], v202 offset:2048
    v_mfma_f32_16x16x32_bf16 v[96:99], v[168:171], v[192:195], v[96:99]
    ds_read_b64_tr_b16 v[154:155], v202 offset:8192
    v_mfma_f32_16x16x32_bf16 v[112:115], v[168:171], v[196:199], v[112:115]
    ds_read_b64_tr_b16 v[156:157], v203 offset:2048
    v_mfma_f32_16x16x32_bf16 v[116:119], v[172:175], v[196:199], v[116:119]
    ds_read_b64_tr_b16 v[158:159], v203 offset:8192
    v_mfma_f32_16x16x32_bf16 v[100:103], v[172:175], v[192:195], v[100:103]
    s_waitcnt lgkmcnt(4)
    v_mfma_f32_16x16x32_bf16 v[24:27], v[136:139], v[120:123], v[24:27]
    ds_read_b128 v[160:163], v201 offset:16384
    v_mfma_f32_16x16x32_bf16 v[32:35], v[136:139], v[124:127], v[32:35]
    ds_read_b64_tr_b16 v[176:177], v202 offset:12288
    v_mfma_f32_16x16x32_bf16 v[40:43], v[136:139], v[128:131], v[40:43]
    ds_read_b64_tr_b16 v[178:179], v202 offset:18432
    v_mfma_f32_16x16x32_bf16 v[48:51], v[136:139], v[132:135], v[48:51]
    ds_read_b128 v[164:167], v201 offset:18432
    v_mfma_f32_16x16x32_bf16 v[52:55], v[140:143], v[132:135], v[52:55]
    ds_read_b128 v[168:171], v201 offset:20480
    v_mfma_f32_16x16x32_bf16 v[44:47], v[140:143], v[128:131], v[44:47]
    ds_read_b128 v[172:175], v201 offset:22528
    v_mfma_f32_16x16x32_bf16 v[36:39], v[140:143], v[124:127], v[36:39]
    ds_read_b64_tr_b16 v[180:181], v203 offset:12288
    v_mfma_f32_16x16x32_bf16 v[28:31], v[140:143], v[120:123], v[28:31]
    ds_read_b64_tr_b16 v[182:183], v203 offset:18432
    s_waitcnt lgkmcnt(8)
    v_mfma_f32_16x16x32_bf16 v[56:59], v[144:147], v[120:123], v[56:59]
    ds_read_b64_tr_b16 v[184:185], v202 offset:13312
    v_mfma_f32_16x16x32_bf16 v[64:67], v[144:147], v[124:127], v[64:67]
    ds_read_b64_tr_b16 v[186:187], v202 offset:19456
    v_mfma_f32_16x16x32_bf16 v[72:75], v[144:147], v[128:131], v[72:75]
    ds_read_b64_tr_b16 v[188:189], v203 offset:13312
    v_mfma_f32_16x16x32_bf16 v[80:83], v[144:147], v[132:135], v[80:83]
    ds_read_b64_tr_b16 v[190:191], v203 offset:19456
    v_mfma_f32_16x16x32_bf16 v[84:87], v[148:151], v[132:135], v[84:87]
    ds_read_b64_tr_b16 v[192:193], v202 offset:14336
    v_mfma_f32_16x16x32_bf16 v[76:79], v[148:151], v[128:131], v[76:79]
    ds_read_b64_tr_b16 v[194:195], v202 offset:20480
    v_mfma_f32_16x16x32_bf16 v[68:71], v[148:151], v[124:127], v[68:71]
    ds_read_b64_tr_b16 v[196:197], v203 offset:14336
    v_mfma_f32_16x16x32_bf16 v[60:63], v[148:151], v[120:123], v[60:63]
    ds_read_b64_tr_b16 v[198:199], v203 offset:20480
    v_mfma_f32_16x16x32_bf16 v[88:91], v[120:123], v[152:155], v[88:91]
    v_mfma_f32_16x16x32_bf16 v[104:107], v[120:123], v[156:159], v[104:107]
    v_mfma_f32_16x16x32_bf16 v[108:111], v[124:127], v[156:159], v[108:111]
    v_mfma_f32_16x16x32_bf16 v[92:95], v[124:127], v[152:155], v[92:95]
    v_mfma_f32_16x16x32_bf16 v[96:99], v[128:131], v[152:155], v[96:99]
    v_mfma_f32_16x16x32_bf16 v[112:115], v[128:131], v[156:159], v[112:115]
    v_mfma_f32_16x16x32_bf16 v[116:119], v[132:135], v[156:159], v[116:119]
    s_waitcnt vmcnt(0)
    v_mfma_f32_16x16x32_bf16 v[100:103], v[132:135], v[152:155], v[100:103]
    s_waitcnt lgkmcnt(4)
    v_mfma_f32_16x16x32_bf16 v[24:27], v[176:179], v[160:163], v[24:27]
    s_waitcnt lgkmcnt(0)
    v_mfma_f32_16x16x32_bf16 v[32:35], v[176:179], v[164:167], v[32:35]
    s_barrier
    v_mfma_f32_16x16x32_bf16 v[40:43], v[176:179], v[168:171], v[40:43]
    ds_read_b128 v[120:123], v200 offset:32768
    v_mfma_f32_16x16x32_bf16 v[48:51], v[176:179], v[172:175], v[48:51]
    ds_read_b64_tr_b16 v[136:137], v202 offset:24576
    v_mfma_f32_16x16x32_bf16 v[52:55], v[180:183], v[172:175], v[52:55]
    ds_read_b64_tr_b16 v[138:139], v202 offset:30720
    v_mfma_f32_16x16x32_bf16 v[44:47], v[180:183], v[168:171], v[44:47]
    ds_read_b128 v[124:127], v200 offset:34816
    v_mfma_f32_16x16x32_bf16 v[36:39], v[180:183], v[164:167], v[36:39]
    ds_read_b128 v[128:131], v200 offset:36864
    v_mfma_f32_16x16x32_bf16 v[28:31], v[180:183], v[160:163], v[28:31]
    ds_read_b128 v[132:135], v200 offset:38912
    v_mfma_f32_16x16x32_bf16 v[56:59], v[184:187], v[160:163], v[56:59]
    ds_read_b64_tr_b16 v[140:141], v203 offset:24576
    v_mfma_f32_16x16x32_bf16 v[64:67], v[184:187], v[164:167], v[64:67]
    ds_read_b64_tr_b16 v[142:143], v203 offset:30720
    v_mfma_f32_16x16x32_bf16 v[72:75], v[184:187], v[168:171], v[72:75]
    ds_read_b64_tr_b16 v[144:145], v202 offset:25600
    v_mfma_f32_16x16x32_bf16 v[80:83], v[184:187], v[172:175], v[80:83]
    ds_read_b64_tr_b16 v[146:147], v202 offset:31744
    v_mfma_f32_16x16x32_bf16 v[84:87], v[188:191], v[172:175], v[84:87]
    ds_read_b64_tr_b16 v[148:149], v203 offset:25600
    v_mfma_f32_16x16x32_bf16 v[76:79], v[188:191], v[168:171], v[76:79]
    ds_read_b64_tr_b16 v[150:151], v203 offset:31744
    v_mfma_f32_16x16x32_bf16 v[68:71], v[188:191], v[164:167], v[68:71]
    ds_read_b64_tr_b16 v[152:153], v202 offset:26624
    v_mfma_f32_16x16x32_bf16 v[60:63], v[188:191], v[160:163], v[60:63]
    ds_read_b64_tr_b16 v[154:155], v202 offset:32768
    v_mfma_f32_16x16x32_bf16 v[88:91], v[160:163], v[192:195], v[88:91]
    ds_read_b64_tr_b16 v[156:157], v203 offset:26624
    v_mfma_f32_16x16x32_bf16 v[104:107], v[160:163], v[196:199], v[104:107]
    ds_read_b64_tr_b16 v[158:159], v203 offset:32768
    v_mfma_f32_16x16x32_bf16 v[108:111], v[164:167], v[196:199], v[108:111]
    v_mfma_f32_16x16x32_bf16 v[92:95], v[164:167], v[192:195], v[92:95]
    v_mfma_f32_16x16x32_bf16 v[96:99], v[168:171], v[192:195], v[96:99]
    v_mfma_f32_16x16x32_bf16 v[112:115], v[168:171], v[196:199], v[112:115]
    v_mfma_f32_16x16x32_bf16 v[116:119], v[172:175], v[196:199], v[116:119]
    s_waitcnt lgkmcnt(4)
    v_mfma_f32_16x16x32_bf16 v[100:103], v[172:175], v[192:195], v[100:103]
    .p2align 3
L_cloop:
    v_mfma_f32_16x16x32_bf16 v[24:27], v[136:139], v[120:123], v[24:27]
    ds_read_b128 v[160:163], v201 offset:32768
    v_mfma_f32_16x16x32_bf16 v[32:35], v[136:139], v[124:127], v[32:35]
    ds_read_b64_tr_b16 v[176:177], v202 offset:36864
    v_mfma_f32_16x16x32_bf16 v[40:43], v[136:139], v[128:131], v[40:43]
    ds_read_b64_tr_b16 v[178:179], v202 offset:43008
    v_mfma_f32_16x16x32_bf16 v[48:51], v[136:139], v[132:135], v[48:51]
    ds_read_b128 v[164:167], v201 offset:34816
    v_mfma_f32_16x16x32_bf16 v[52:55], v[140:143], v[132:135], v[52:55]
    ds_read_b128 v[168:171], v201 offset:36864
    v_mfma_f32_16x16x32_bf16 v[44:47], v[140:143], v[128:131], v[44:47]
    ds_read_b128 v[172:175], v201 offset:38912
    v_mfma_f32_16x16x32_bf16 v[36:39], v[140:143], v[124:127], v[36:39]
    ds_read_b64_tr_b16 v[180:181], v203 offset:36864
    v_mfma_f32_16x16x32_bf16 v[28:31], v[140:143], v[120:123], v[28:31]
    ds_read_b64_tr_b16 v[182:183], v203 offset:43008
    s_waitcnt lgkmcnt(8)
    v_mfma_f32_16x16x32_bf16 v[56:59], v[144:147], v[120:123], v[56:59]
    ds_read_b64_tr_b16 v[184:185], v202 offset:37888
    v_mfma_f32_16x16x32_bf16 v[64:67], v[144:147], v[124:127], v[64:67]
    ds_read_b64_tr_b16 v[186:187], v202 offset:44032
    v_mfma_f32_16x16x32_bf16 v[72:75], v[144:147], v[128:131], v[72:75]
    ds_read_b64_tr_b16 v[188:189], v203 offset:37888
    v_mfma_f32_16x16x32_bf16 v[80:83], v[144:147], v[132:135], v[80:83]
    ds_read_b64_tr_b16 v[190:191], v203 offset:44032
    v_mfma_f32_16x16x32_bf16 v[84:87], v[148:151], v[132:135], v[84:87]
    ds_read_b64_tr_b16 v[192:193], v202 offset:38912
    v_mfma_f32_16x16x32_bf16 v[76:79], v[148:151], v[128:131], v[76:79]
    ds_read_b64_tr_b16 v[194:195], v202 offset:45056
    v_mfma_f32_16x16x32_bf16 v[68:71], v[148:151], v[124:127], v[68:71]
    ds_read_b64_tr_b16 v[196:197], v203 offset:38912
    v_mfma_f32_16x16x32_bf16 v[60:63], v[148:151], v[120:123], v[60:63]
    ds_read_b64_tr_b16 v[198:199], v203 offset:45056
    v_mfma_f32_16x16x32_bf16 v[88:91], v[120:123], v[152:155], v[88:91]
    v_mfma_f32_16x16x32_bf16 v[104:107], v[120:123], v[156:159], v[104:107]
    v_mfma_f32_16x16x32_bf16 v[108:111], v[124:127], v[156:159], v[108:111]
    v_mfma_f32_16x16x32_bf16 v[92:95], v[124:127], v[152:155], v[92:95]
    v_mfma_f32_16x16x32_bf16 v[96:99], v[128:131], v[152:155], v[96:99]
    v_mfma_f32_16x16x32_bf16 v[112:115], v[128:131], v[156:159], v[112:115]
    v_mfma_f32_16x16x32_bf16 v[116:119], v[132:135], v[156:159], v[116:119]
    v_mfma_f32_16x16x32_bf16 v[100:103], v[132:135], v[152:155], v[100:103]
    s_waitcnt lgkmcnt(4)
    v_mfma_f32_16x16x32_bf16 v[24:27], v[176:179], v[160:163], v[24:27]
    s_waitcnt lgkmcnt(0)
    v_mfma_f32_16x16x32_bf16 v[32:35], v[176:179], v[164:167], v[32:35]
    s_barrier
    v_mfma_f32_16x16x32_bf16 v[40:43], v[176:179], v[168:171], v[40:43]
    ds_read_b128 v[120:123], v200 offset:0
    v_mfma_f32_16x16x32_bf16 v[48:51], v[176:179], v[172:175], v[48:51]
    ds_read_b64_tr_b16 v[136:137], v204 offset:0
    v_mfma_f32_16x16x32_bf16 v[52:55], v[180:183], v[172:175], v[52:55]
    ds_read_b64_tr_b16 v[138:139], v204 offset:6144
    v_mfma_f32_16x16x32_bf16 v[44:47], v[180:183], v[168:171], v[44:47]
    ds_read_b128 v[124:127], v200 offset:2048
    v_mfma_f32_16x16x32_bf16 v[36:39], v[180:183], v[164:167], v[36:39]
    ds_read_b128 v[128:131], v200 offset:4096
    v_mfma_f32_16x16x32_bf16 v[28:31], v[180:183], v[160:163], v[28:31]
    ds_read_b128 v[132:135], v200 offset:6144
    v_mfma_f32_16x16x32_bf16 v[56:59], v[184:187], v[160:163], v[56:59]
    ds_read_b64_tr_b16 v[140:141], v205 offset:0
    v_mfma_f32_16x16x32_bf16 v[64:67], v[184:187], v[164:167], v[64:67]
    ds_read_b64_tr_b16 v[142:143], v205 offset:6144
    v_mfma_f32_16x16x32_bf16 v[72:75], v[184:187], v[168:171], v[72:75]
    ds_read_b64_tr_b16 v[144:145], v204 offset:1024
    v_mfma_f32_16x16x32_bf16 v[80:83], v[184:187], v[172:175], v[80:83]
    ds_read_b64_tr_b16 v[146:147], v204 offset:7168
    v_mfma_f32_16x16x32_bf16 v[84:87], v[188:191], v[172:175], v[84:87]
    ds_read_b64_tr_b16 v[148:149], v205 offset:1024
    v_mfma_f32_16x16x32_bf16 v[76:79], v[188:191], v[168:171], v[76:79]
    ds_read_b64_tr_b16 v[150:151], v205 offset:7168
    v_mfma_f32_16x16x32_bf16 v[68:71], v[188:191], v[164:167], v[68:71]
    ds_read_b64_tr_b16 v[152:153], v204 offset:2048
    v_mfma_f32_16x16x32_bf16 v[60:63], v[188:191], v[160:163], v[60:63]
    ds_read_b64_tr_b16 v[154:155], v204 offset:8192
    v_mfma_f32_16x16x32_bf16 v[88:91], v[160:163], v[192:195], v[88:91]
    ds_read_b64_tr_b16 v[156:157], v205 offset:2048
    v_mfma_f32_16x16x32_bf16 v[104:107], v[160:163], v[196:199], v[104:107]
    ds_read_b64_tr_b16 v[158:159], v205 offset:8192
    v_mfma_f32_16x16x32_bf16 v[108:111], v[164:167], v[196:199], v[108:111]
    v_mfma_f32_16x16x32_bf16 v[92:95], v[164:167], v[192:195], v[92:95]
    v_mfma_f32_16x16x32_bf16 v[96:99], v[168:171], v[192:195], v[96:99]
    v_mfma_f32_16x16x32_bf16 v[112:115], v[168:171], v[196:199], v[112:115]
    v_mfma_f32_16x16x32_bf16 v[116:119], v[172:175], v[196:199], v[116:119]
    s_waitcnt lgkmcnt(4)
    v_mfma_f32_16x16x32_bf16 v[100:103], v[172:175], v[192:195], v[100:103]
    v_mfma_f32_16x16x32_bf16 v[24:27], v[136:139], v[120:123], v[24:27]
    ds_read_b128 v[160:163], v201 offset:0
    v_mfma_f32_16x16x32_bf16 v[32:35], v[136:139], v[124:127], v[32:35]
    ds_read_b64_tr_b16 v[176:177], v204 offset:12288
    v_mfma_f32_16x16x32_bf16 v[40:43], v[136:139], v[128:131], v[40:43]
    ds_read_b64_tr_b16 v[178:179], v204 offset:18432
    v_mfma_f32_16x16x32_bf16 v[48:51], v[136:139], v[132:135], v[48:51]
    ds_read_b128 v[164:167], v201 offset:2048
    v_mfma_f32_16x16x32_bf16 v[52:55], v[140:143], v[132:135], v[52:55]
    ds_read_b128 v[168:171], v201 offset:4096
    v_mfma_f32_16x16x32_bf16 v[44:47], v[140:143], v[128:131], v[44:47]
    ds_read_b128 v[172:175], v201 offset:6144
    v_mfma_f32_16x16x32_bf16 v[36:39], v[140:143], v[124:127], v[36:39]
    ds_read_b64_tr_b16 v[180:181], v205 offset:12288
    v_mfma_f32_16x16x32_bf16 v[28:31], v[140:143], v[120:123], v[28:31]
    ds_read_b64_tr_b16 v[182:183], v205 offset:18432
    s_waitcnt lgkmcnt(8)
    v_mfma_f32_16x16x32_bf16 v[56:59], v[144:147], v[120:123], v[56:59]
    ds_read_b64_tr_b16 v[184:185], v204 offset:13312
    v_mfma_f32_16x16x32_bf16 v[64:67], v[144:147], v[124:127], v[64:67]
    ds_read_b64_tr_b16 v[186:187], v204 offset:19456
    v_mfma_f32_16x16x32_bf16 v[72:75], v[144:147], v[128:131], v[72:75]
    ds_read_b64_tr_b16 v[188:189], v205 offset:13312
    v_mfma_f32_16x16x32_bf16 v[80:83], v[144:147], v[132:135], v[80:83]
    ds_read_b64_tr_b16 v[190:191], v205 offset:19456
    v_mfma_f32_16x16x32_bf16 v[84:87], v[148:151], v[132:135], v[84:87]
    ds_read_b64_tr_b16 v[192:193], v204 offset:14336
    v_mfma_f32_16x16x32_bf16 v[76:79], v[148:151], v[128:131], v[76:79]
    ds_read_b64_tr_b16 v[194:195], v204 offset:20480
    v_mfma_f32_16x16x32_bf16 v[68:71], v[148:151], v[124:127], v[68:71]
    ds_read_b64_tr_b16 v[196:197], v205 offset:14336
    v_mfma_f32_16x16x32_bf16 v[60:63], v[148:151], v[120:123], v[60:63]
    ds_read_b64_tr_b16 v[198:199], v205 offset:20480
    v_mfma_f32_16x16x32_bf16 v[88:91], v[120:123], v[152:155], v[88:91]
    v_mfma_f32_16x16x32_bf16 v[104:107], v[120:123], v[156:159], v[104:107]
    v_mfma_f32_16x16x32_bf16 v[108:111], v[124:127], v[156:159], v[108:111]
    v_mfma_f32_16x16x32_bf16 v[92:95], v[124:127], v[152:155], v[92:95]
    v_mfma_f32_16x16x32_bf16 v[96:99], v[128:131], v[152:155], v[96:99]
    v_mfma_f32_16x16x32_bf16 v[112:115], v[128:131], v[156:159], v[112:115]
    v_mfma_f32_16x16x32_bf16 v[116:119], v[132:135], v[156:159], v[116:119]
    v_mfma_f32_16x16x32_bf16 v[100:103], v[132:135], v[152:155], v[100:103]
    s_waitcnt lgkmcnt(4)
    v_mfma_f32_16x16x32_bf16 v[24:27], v[176:179], v[160:163], v[24:27]
    s_waitcnt lgkmcnt(0)
    v_mfma_f32_16x16x32_bf16 v[32:35], v[176:179], v[164:167], v[32:35]
    s_barrier
    v_mfma_f32_16x16x32_bf16 v[40:43], v[176:179], v[168:171], v[40:43]
    ds_read_b128 v[120:123], v200 offset:16384
    v_mfma_f32_16x16x32_bf16 v[48:51], v[176:179], v[172:175], v[48:51]
    ds_read_b64_tr_b16 v[136:137], v202 offset:0
    v_mfma_f32_16x16x32_bf16 v[52:55], v[180:183], v[172:175], v[52:55]
    ds_read_b64_tr_b16 v[138:139], v202 offset:6144
    v_mfma_f32_16x16x32_bf16 v[44:47], v[180:183], v[168:171], v[44:47]
    ds_read_b128 v[124:127], v200 offset:18432
    v_mfma_f32_16x16x32_bf16 v[36:39], v[180:183], v[164:167], v[36:39]
    ds_read_b128 v[128:131], v200 offset:20480
    v_mfma_f32_16x16x32_bf16 v[28:31], v[180:183], v[160:163], v[28:31]
    ds_read_b128 v[132:135], v200 offset:22528
    v_mfma_f32_16x16x32_bf16 v[56:59], v[184:187], v[160:163], v[56:59]
    ds_read_b64_tr_b16 v[140:141], v203 offset:0
    v_mfma_f32_16x16x32_bf16 v[64:67], v[184:187], v[164:167], v[64:67]
    ds_read_b64_tr_b16 v[142:143], v203 offset:6144
    v_mfma_f32_16x16x32_bf16 v[72:75], v[184:187], v[168:171], v[72:75]
    ds_read_b64_tr_b16 v[144:145], v202 offset:1024
    v_mfma_f32_16x16x32_bf16 v[80:83], v[184:187], v[172:175], v[80:83]
    ds_read_b64_tr_b16 v[146:147], v202 offset:7168
    v_mfma_f32_16x16x32_bf16 v[84:87], v[188:191], v[172:175], v[84:87]
    ds_read_b64_tr_b16 v[148:149], v203 offset:1024
    v_mfma_f32_16x16x32_bf16 v[76:79], v[188:191], v[168:171], v[76:79]
    ds_read_b64_tr_b16 v[150:151], v203 offset:7168
    v_mfma_f32_16x16x32_bf16 v[68:71], v[188:191], v[164:167], v[68:71]
    ds_read_b64_tr_b16 v[152:153], v202 offset:2048
    v_mfma_f32_16x16x32_bf16 v[60:63], v[188:191], v[160:163], v[60:63]
    ds_read_b64_tr_b16 v[154:155], v202 offset:8192
    v_mfma_f32_16x16x32_bf16 v[88:91], v[160:163], v[192:195], v[88:91]
    ds_read_b64_tr_b16 v[156:157], v203 offset:2048
    v_mfma_f32_16x16x32_bf16 v[104:107], v[160:163], v[196:199], v[104:107]
    ds_read_b64_tr_b16 v[158:159], v203 offset:8192
    v_mfma_f32_16x16x32_bf16 v[108:111], v[164:167], v[196:199], v[108:111]
    v_mfma_f32_16x16x32_bf16 v[92:95], v[164:167], v[192:195], v[92:95]
    v_mfma_f32_16x16x32_bf16 v[96:99], v[168:171], v[192:195], v[96:99]
    v_mfma_f32_16x16x32_bf16 v[112:115], v[168:171], v[196:199], v[112:115]
    v_mfma_f32_16x16x32_bf16 v[116:119], v[172:175], v[196:199], v[116:119]
    s_waitcnt lgkmcnt(4)
    v_mfma_f32_16x16x32_bf16 v[100:103], v[172:175], v[192:195], v[100:103]
    v_mfma_f32_16x16x32_bf16 v[24:27], v[136:139], v[120:123], v[24:27]
    ds_read_b128 v[160:163], v201 offset:16384
    v_mfma_f32_16x16x32_bf16 v[32:35], v[136:139], v[124:127], v[32:35]
    ds_read_b64_tr_b16 v[176:177], v202 offset:12288
    v_mfma_f32_16x16x32_bf16 v[40:43], v[136:139], v[128:131], v[40:43]
    ds_read_b64_tr_b16 v[178:179], v202 offset:18432
    v_mfma_f32_16x16x32_bf16 v[48:51], v[136:139], v[132:135], v[48:51]
    ds_read_b128 v[164:167], v201 offset:18432
    v_mfma_f32_16x16x32_bf16 v[52:55], v[140:143], v[132:135], v[52:55]
    ds_read_b128 v[168:171], v201 offset:20480
    v_mfma_f32_16x16x32_bf16 v[44:47], v[140:143], v[128:131], v[44:47]
    ds_read_b128 v[172:175], v201 offset:22528
    v_mfma_f32_16x16x32_bf16 v[36:39], v[140:143], v[124:127], v[36:39]
    ds_read_b64_tr_b16 v[180:181], v203 offset:12288
    v_mfma_f32_16x16x32_bf16 v[28:31], v[140:143], v[120:123], v[28:31]
    ds_read_b64_tr_b16 v[182:183], v203 offset:18432
    s_waitcnt lgkmcnt(8)
    v_mfma_f32_16x16x32_bf16 v[56:59], v[144:147], v[120:123], v[56:59]
    ds_read_b64_tr_b16 v[184:185], v202 offset:13312
    v_mfma_f32_16x16x32_bf16 v[64:67], v[144:147], v[124:127], v[64:67]
    ds_read_b64_tr_b16 v[186:187], v202 offset:19456
    v_mfma_f32_16x16x32_bf16 v[72:75], v[144:147], v[128:131], v[72:75]
    ds_read_b64_tr_b16 v[188:189], v203 offset:13312
    v_mfma_f32_16x16x32_bf16 v[80:83], v[144:147], v[132:135], v[80:83]
    ds_read_b64_tr_b16 v[190:191], v203 offset:19456
    v_mfma_f32_16x16x32_bf16 v[84:87], v[148:151], v[132:135], v[84:87]
    ds_read_b64_tr_b16 v[192:193], v202 offset:14336
    v_mfma_f32_16x16x32_bf16 v[76:79], v[148:151], v[128:131], v[76:79]
    ds_read_b64_tr_b16 v[194:195], v202 offset:20480
    v_mfma_f32_16x16x32_bf16 v[68:71], v[148:151], v[124:127], v[68:71]
    ds_read_b64_tr_b16 v[196:197], v203 offset:14336
    v_mfma_f32_16x16x32_bf16 v[60:63], v[148:151], v[120:123], v[60:63]
    ds_read_b64_tr_b16 v[198:199], v203 offset:20480
    v_mfma_f32_16x16x32_bf16 v[88:91], v[120:123], v[152:155], v[88:91]
    v_mfma_f32_16x16x32_bf16 v[104:107], v[120:123], v[156:159], v[104:107]
    v_mfma_f32_16x16x32_bf16 v[108:111], v[124:127], v[156:159], v[108:111]
    v_mfma_f32_16x16x32_bf16 v[92:95], v[124:127], v[152:155], v[92:95]
    v_mfma_f32_16x16x32_bf16 v[96:99], v[128:131], v[152:155], v[96:99]
    v_mfma_f32_16x16x32_bf16 v[112:115], v[128:131], v[156:159], v[112:115]
    v_mfma_f32_16x16x32_bf16 v[116:119], v[132:135], v[156:159], v[116:119]
    v_mfma_f32_16x16x32_bf16 v[100:103], v[132:135], v[152:155], v[100:103]
    s_waitcnt lgkmcnt(4)
    v_mfma_f32_16x16x32_bf16 v[24:27], v[176:179], v[160:163], v[24:27]
    s_waitcnt lgkmcnt(0)
    v_mfma_f32_16x16x32_bf16 v[32:35], v[176:179], v[164:167], v[32:35]
    s_barrier
    v_mfma_f32_16x16x32_bf16 v[40:43], v[176:179], v[168:171], v[40:43]
    ds_read_b128 v[120:123], v200 offset:32768
    v_mfma_f32_16x16x32_bf16 v[48:51], v[176:179], v[172:175], v[48:51]
    ds_read_b64_tr_b16 v[136:137], v202 offset:24576
    v_mfma_f32_16x16x32_bf16 v[52:55], v[180:183], v[172:175], v[52:55]
    ds_read_b64_tr_b16 v[138:139], v202 offset:30720
    v_mfma_f32_16x16x32_bf16 v[44:47], v[180:183], v[168:171], v[44:47]
    ds_read_b128 v[124:127], v200 offset:34816
    v_mfma_f32_16x16x32_bf16 v[36:39], v[180:183], v[164:167], v[36:39]
    ds_read_b128 v[128:131], v200 offset:36864
    v_mfma_f32_16x16x32_bf16 v[28:31], v[180:183], v[160:163], v[28:31]
    ds_read_b128 v[132:135], v200 offset:38912
    v_mfma_f32_16x16x32_bf16 v[56:59], v[184:187], v[160:163], v[56:59]
    ds_read_b64_tr_b16 v[140:141], v203 offset:24576
    v_mfma_f32_16x16x32_bf16 v[64:67], v[184:187], v[164:167], v[64:67]
    ds_read_b64_tr_b16 v[142:143], v203 offset:30720
    v_mfma_f32_16x16x32_bf16 v[72:75], v[184:187], v[168:171], v[72:75]
    ds_read_b64_tr_b16 v[144:145], v202 offset:25600
    v_mfma_f32_16x16x32_bf16 v[80:83], v[184:187], v[172:175], v[80:83]
    ds_read_b64_tr_b16 v[146:147], v202 offset:31744
    v_mfma_f32_16x16x32_bf16 v[84:87], v[188:191], v[172:175], v[84:87]
    ds_read_b64_tr_b16 v[148:149], v203 offset:25600
    v_mfma_f32_16x16x32_bf16 v[76:79], v[188:191], v[168:171], v[76:79]
    ds_read_b64_tr_b16 v[150:151], v203 offset:31744
    v_mfma_f32_16x16x32_bf16 v[68:71], v[188:191], v[164:167], v[68:71]
    ds_read_b64_tr_b16 v[152:153], v202 offset:26624
    v_mfma_f32_16x16x32_bf16 v[60:63], v[188:191], v[160:163], v[60:63]
    ds_read_b64_tr_b16 v[154:155], v202 offset:32768
    v_mfma_f32_16x16x32_bf16 v[88:91], v[160:163], v[192:195], v[88:91]
    ds_read_b64_tr_b16 v[156:157], v203 offset:26624
    v_mfma_f32_16x16x32_bf16 v[104:107], v[160:163], v[196:199], v[104:107]
    ds_read_b64_tr_b16 v[158:159], v203 offset:32768
    v_mfma_f32_16x16x32_bf16 v[108:111], v[164:167], v[196:199], v[108:111]
    v_mfma_f32_16x16x32_bf16 v[92:95], v[164:167], v[192:195], v[92:95]
    s_add_u32 s74, s74, 1
    v_mfma_f32_16x16x32_bf16 v[96:99], v[168:171], v[192:195], v[96:99]
    s_cmp_lt_u32 s74, 4
    v_mfma_f32_16x16x32_bf16 v[112:115], v[168:171], v[196:199], v[112:115]
    v_mfma_f32_16x16x32_bf16 v[116:119], v[172:175], v[196:199], v[116:119]
    s_waitcnt lgkmcnt(4)
    v_mfma_f32_16x16x32_bf16 v[100:103], v[172:175], v[192:195], v[100:103]
    s_cbranch_scc1 L_cloop
    v_mfma_f32_16x16x32_bf16 v[24:27], v[136:139], v[120:123], v[24:27]
    ds_read_b128 v[160:163], v201 offset:32768
    v_mfma_f32_16x16x32_bf16 v[32:35], v[136:139], v[124:127], v[32:35]
    ds_read_b64_tr_b16 v[176:177], v202 offset:36864
    v_mfma_f32_16x16x32_bf16 v[40:43], v[136:139], v[128:131], v[40:43]
    ds_read_b64_tr_b16 v[178:179], v202 offset:43008
    v_mfma_f32_16x16x32_bf16 v[48:51], v[136:139], v[132:135], v[48:51]
    ds_read_b128 v[164:167], v201 offset:34816
    v_mfma_f32_16x16x32_bf16 v[52:55], v[140:143], v[132:135], v[52:55]
    ds_read_b128 v[168:171], v201 offset:36864
    v_mfma_f32_16x16x32_bf16 v[44:47], v[140:143], v[128:131], v[44:47]
    ds_read_b128 v[172:175], v201 offset:38912
    v_mfma_f32_16x16x32_bf16 v[36:39], v[140:143], v[124:127], v[36:39]
    ds_read_b64_tr_b16 v[180:181], v203 offset:36864
    v_mfma_f32_16x16x32_bf16 v[28:31], v[140:143], v[120:123], v[28:31]
    ds_read_b64_tr_b16 v[182:183], v203 offset:43008
    s_waitcnt lgkmcnt(8)
    v_mfma_f32_16x16x32_bf16 v[56:59], v[144:147], v[120:123], v[56:59]
    ds_read_b64_tr_b16 v[184:185], v202 offset:37888
    v_mfma_f32_16x16x32_bf16 v[64:67], v[144:147], v[124:127], v[64:67]
    ds_read_b64_tr_b16 v[186:187], v202 offset:44032
    v_mfma_f32_16x16x32_bf16 v[72:75], v[144:147], v[128:131], v[72:75]
    ds_read_b64_tr_b16 v[188:189], v203 offset:37888
    v_mfma_f32_16x16x32_bf16 v[80:83], v[144:147], v[132:135], v[80:83]
    ds_read_b64_tr_b16 v[190:191], v203 offset:44032
    v_mfma_f32_16x16x32_bf16 v[84:87], v[148:151], v[132:135], v[84:87]
    ds_read_b64_tr_b16 v[192:193], v202 offset:38912
    v_mfma_f32_16x16x32_bf16 v[76:79], v[148:151], v[128:131], v[76:79]
    ds_read_b64_tr_b16 v[194:195], v202 offset:45056
    v_mfma_f32_16x16x32_bf16 v[68:71], v[148:151], v[124:127], v[68:71]
    ds_read_b64_tr_b16 v[196:197], v203 offset:38912
    v_mfma_f32_16x16x32_bf16 v[60:63], v[148:151], v[120:123], v[60:63]
    ds_read_b64_tr_b16 v[198:199], v203 offset:45056
    v_mfma_f32_16x16x32_bf16 v[88:91], v[120:123], v[152:155], v[88:91]
    v_mov_b32 v252, 132864
    v_mfma_f32_16x16x32_bf16 v[104:107], v[120:123], v[156:159], v[104:107]
    ds_read_b32 v252, v252
    v_mfma_f32_16x16x32_bf16 v[108:111], v[124:127], v[156:159], v[108:111]
    v_mfma_f32_16x16x32_bf16 v[92:95], v[124:127], v[152:155], v[92:95]
    v_mfma_f32_16x16x32_bf16 v[96:99], v[128:131], v[152:155], v[96:99]
    v_mfma_f32_16x16x32_bf16 v[112:115], v[128:131], v[156:159], v[112:115]
    v_mfma_f32_16x16x32_bf16 v[116:119], v[132:135], v[156:159], v[116:119]
    v_mfma_f32_16x16x32_bf16 v[100:103], v[132:135], v[152:155], v[100:103]
    s_waitcnt lgkmcnt(4)
    v_mfma_f32_16x16x32_bf16 v[24:27], v[176:179], v[160:163], v[24:27]
    s_waitcnt lgkmcnt(0)
    v_mfma_f32_16x16x32_bf16 v[32:35], v[176:179], v[164:167], v[32:35]
    s_barrier
    v_mfma_f32_16x16x32_bf16 v[40:43], v[176:179], v[168:171], v[40:43]
    ds_read_b128 v[120:123], v200 offset:0
    v_mfma_f32_16x16x32_bf16 v[48:51], v[176:179], v[172:175], v[48:51]
    ds_read_b64_tr_b16 v[136:137], v204 offset:0
    v_mfma_f32_16x16x32_bf16 v[52:55], v[180:183], v[172:175], v[52:55]
    ds_read_b64_tr_b16 v[138:139], v204 offset:6144
    v_mfma_f32_16x16x32_bf16 v[44:47], v[180:183], v[168:171], v[44:47]
    ds_read_b128 v[124:127], v200 offset:2048
    v_mfma_f32_16x16x32_bf16 v[36:39], v[180:183], v[164:167], v[36:39]
    ds_read_b128 v[128:131], v200 offset:4096
    v_mfma_f32_16x16x32_bf16 v[28:31], v[180:183], v[160:163], v[28:31]
    ds_read_b128 v[132:135], v200 offset:6144
    v_mfma_f32_16x16x32_bf16 v[56:59], v[184:187], v[160:163], v[56:59]
    ds_read_b64_tr_b16 v[140:141], v205 offset:0
    v_mfma_f32_16x16x32_bf16 v[64:67], v[184:187], v[164:167], v[64:67]
    ds_read_b64_tr_b16 v[142:143], v205 offset:6144
    v_mfma_f32_16x16x32_bf16 v[72:75], v[184:187], v[168:171], v[72:75]
    ds_read_b64_tr_b16 v[144:145], v204 offset:1024
    v_mfma_f32_16x16x32_bf16 v[80:83], v[184:187], v[172:175], v[80:83]
    ds_read_b64_tr_b16 v[146:147], v204 offset:7168
    v_mfma_f32_16x16x32_bf16 v[84:87], v[188:191], v[172:175], v[84:87]
    ds_read_b64_tr_b16 v[148:149], v205 offset:1024
    v_mfma_f32_16x16x32_bf16 v[76:79], v[188:191], v[168:171], v[76:79]
    ds_read_b64_tr_b16 v[150:151], v205 offset:7168
    v_mfma_f32_16x16x32_bf16 v[68:71], v[188:191], v[164:167], v[68:71]
    ds_read_b64_tr_b16 v[152:153], v204 offset:2048
    v_mfma_f32_16x16x32_bf16 v[60:63], v[188:191], v[160:163], v[60:63]
    ds_read_b64_tr_b16 v[154:155], v204 offset:8192
    v_mfma_f32_16x16x32_bf16 v[88:91], v[160:163], v[192:195], v[88:91]
    ds_read_b64_tr_b16 v[156:157], v205 offset:2048
    v_mfma_f32_16x16x32_bf16 v[104:107], v[160:163], v[196:199], v[104:107]
    ds_read_b64_tr_b16 v[158:159], v205 offset:8192
    s_cmp_eq_u32 s22, 0
    s_cbranch_scc0 Lw_102
    v_readfirstlane_b32 s47, v252
    s_nop 0
    s_and_b32 s23, s47, 1
    s_lshr_b32 s27, s47, 2
    s_and_b32 s27, s27, 8192
    s_add_u32 s73, s73, s27
    s_lshr_b32 s27, s47, 1
    s_and_b32 s27, s27, 8192
    s_add_u32 s87, s87, s27
    s_lshr_b32 s27, s47, 0
    s_and_b32 s27, s27, 8192
    s_add_u32 s34, s34, s27
Lw_102:
    v_mfma_f32_16x16x32_bf16 v[108:111], v[164:167], v[196:199], v[108:111]
    s_lshl_b32 s28, s84, 14
    s_add_u32 s28, s28, s33
    v_mfma_f32_16x16x32_bf16 v[92:95], v[164:167], v[192:195], v[92:95]
    s_add_u32 s28, s28, s73
    s_sub_u32 s27, s28, 16384
    v_mfma_f32_16x16x32_bf16 v[96:99], v[168:171], v[192:195], v[96:99]
    v_mfma_f32_16x16x32_bf16 v[112:115], v[168:171], v[196:199], v[112:115]
    v_mfma_f32_16x16x32_bf16 v[116:119], v[172:175], v[196:199], v[116:119]
    s_waitcnt lgkmcnt(4)
    v_mfma_f32_16x16x32_bf16 v[100:103], v[172:175], v[192:195], v[100:103]
    v_mfma_f32_16x16x32_bf16 v[56:59], v[144:147], v[120:123], v[56:59]
    ds_read_b128 v[160:163], v201 offset:0
    v_mfma_f32_16x16x32_bf16 v[64:67], v[144:147], v[124:127], v[64:67]
    ds_read_b64_tr_b16 v[184:185], v204 offset:13312
    v_mfma_f32_16x16x32_bf16 v[72:75], v[144:147], v[128:131], v[72:75]
    ds_read_b64_tr_b16 v[186:187], v204 offset:19456
    v_mfma_f32_16x16x32_bf16 v[80:83], v[144:147], v[132:135], v[80:83]
    ds_read_b128 v[164:167], v201 offset:2048
    v_mfma_f32_16x16x32_bf16 v[84:87], v[148:151], v[132:135], v[84:87]
    ds_read_b128 v[168:171], v201 offset:4096
    v_mfma_f32_16x16x32_bf16 v[76:79], v[148:151], v[128:131], v[76:79]
    ds_read_b128 v[172:175], v201 offset:6144
    v_mfma_f32_16x16x32_bf16 v[68:71], v[148:151], v[124:127], v[68:71]
    ds_read_b64_tr_b16 v[188:189], v205 offset:13312
    v_mfma_f32_16x16x32_bf16 v[60:63], v[148:151], v[120:123], v[60:63]
    ds_read_b64_tr_b16 v[190:191], v205 offset:19456
    s_waitcnt lgkmcnt(8)
    v_mfma_f32_16x16x32_bf16 v[88:91], v[120:123], v[152:155], v[88:91]
    ds_read_b64_tr_b16 v[192:193], v204 offset:14336
    v_mfma_f32_16x16x32_bf16 v[104:107], v[120:123], v[156:159], v[104:107]
    ds_read_b64_tr_b16 v[194:195], v204 offset:20480
    v_mfma_f32_16x16x32_bf16 v[108:111], v[124:127], v[156:159], v[108:111]
    ds_read_b64_tr_b16 v[196:197], v205 offset:14336
    v_mfma_f32_16x16x32_bf16 v[92:95], v[124:127], v[152:155], v[92:95]
    ds_read_b64_tr_b16 v[198:199], v205 offset:20480
    v_mfma_f32_16x16x32_bf16 v[96:99], v[128:131], v[152:155], v[96:99]
    ds_read_b64_tr_b16 v[176:177], v204 offset:12288
    v_mfma_f32_16x16x32_bf16 v[112:115], v[128:131], v[156:159], v[112:115]
    ds_read_b64_tr_b16 v[178:179], v204 offset:18432
    v_mfma_f32_16x16x32_bf16 v[116:119], v[132:135], v[156:159], v[116:119]
    ds_read_b64_tr_b16 v[180:181], v205 offset:12288
    v_mfma_f32_16x16x32_bf16 v[100:103], v[132:135], v[152:155], v[100:103]
    ds_read_b64_tr_b16 v[182:183], v205 offset:18432
    s_waitcnt lgkmcnt(8)
    v_mfma_f32_16x16x32_bf16 v[56:59], v[184:187], v[160:163], v[56:59]
    ds_read2_b32 v[212:213], v248 offset0:48 offset1:176
    v_mfma_f32_16x16x32_bf16 v[64:67], v[184:187], v[164:167], v[64:67]
    ds_read_b128 v[214:217], v250 offset:256
    v_mfma_f32_16x16x32_bf16 v[72:75], v[184:187], v[168:171], v[72:75]
    ds_read_b128 v[218:221], v250 offset:320
    v_mfma_f32_16x16x32_bf16 v[80:83], v[184:187], v[172:175], v[80:83]
    ds_read2_b32 v[230:231], v251 offset0:128 offset1:144
    v_mfma_f32_16x16x32_bf16 v[84:87], v[188:191], v[172:175], v[84:87]
    ds_read_b128 v[232:235], v249 offset:192
    s_waitcnt lgkmcnt(5)
    v_mfma_f32_16x16x32_bf16 v[76:79], v[188:191], v[168:171], v[76:79]
    ds_read_b128 v[236:239], v249 offset:704
    s_barrier
    v_mfma_f32_16x16x32_bf16 v[68:71], v[188:191], v[164:167], v[68:71]
    ds_read2_b32 v[210:211], v248 offset0:32 offset1:160
    v_mfma_f32_16x16x32_bf16 v[60:63], v[188:191], v[160:163], v[60:63]
    ds_read_b128 v[240:243], v249 offset:128
    v_mfma_f32_16x16x32_bf16 v[88:91], v[160:163], v[192:195], v[88:91]
    ds_read_b128 v[244:247], v249 offset:640
    v_mfma_f32_16x16x32_bf16 v[104:107], v[160:163], v[196:199], v[104:107]
    ds_read2_b32 v[208:209], v248 offset0:16 offset1:144
    v_mfma_f32_16x16x32_bf16 v[108:111], v[164:167], v[196:199], v[108:111]
    ds_read_b128 v[144:147], v249 offset:64
    v_mfma_f32_16x16x32_bf16 v[92:95], v[164:167], v[192:195], v[92:95]
    ds_read_b128 v[148:151], v249 offset:576
    v_mfma_f32_16x16x32_bf16 v[96:99], v[168:171], v[192:195], v[96:99]
    ds_read2_b32 v[206:207], v248 offset0:0 offset1:128
    s_bitcmp1_b32 s22, 0
    v_mfma_f32_16x16x32_bf16 v[112:115], v[168:171], v[196:199], v[112:115]
    ds_read_b128 v[152:155], v249 offset:0
    v_mfma_f32_16x16x32_bf16 v[116:119], v[172:175], v[196:199], v[116:119]
    ds_read_b128 v[156:159], v249 offset:512
    v_mfma_f32_16x16x32_bf16 v[100:103], v[172:175], v[192:195], v[100:103]
    ds_read_b128 v[192:195], v250 offset:0
    ds_read_b128 v[196:199], v250 offset:64
    s_cbranch_scc1 L_tailB
    s_waitcnt lgkmcnt(8)
    v_pk_mul_f32 v[184:185], v[214:215], v[212:213] op_sel:[0,1] op_sel_hi:[1,1]
    v_pk_fma_f32 v[184:185], v[80:81], v[212:213], v[184:185] op_sel_hi:[1,0,1]
    v_cvt_pk_bf16_f32 v80, v184, v185
    v_pk_mul_f32 v[186:187], v[216:217], v[212:213] op_sel:[0,1] op_sel_hi:[1,1]
    v_pk_fma_f32 v[186:187], v[82:83], v[212:213], v[186:187] op_sel_hi:[1,0,1]
    v_cvt_pk_bf16_f32 v81, v186, v187
    v_pk_mul_f32 v[188:189], v[218:219], v[212:213] op_sel:[0,1] op_sel_hi:[1,1]
    v_pk_fma_f32 v[188:189], v[84:85], v[212:213], v[188:189] op_sel_hi:[1,0,1]
    v_cvt_pk_bf16_f32 v82, v188, v189
    v_pk_mul_f32 v[190:191], v[220:221], v[212:213] op_sel:[0,1] op_sel_hi:[1,1]
    v_pk_fma_f32 v[190:191], v[86:87], v[212:213], v[190:191] op_sel_hi:[1,0,1]
    v_cvt_pk_bf16_f32 v83, v190, v191
    buffer_store_dwordx4 v[80:83], v0, s[12:15], s28 offen offset:1024 sc1
    v_pk_mul_f32 v[186:187], v[238:239], v[230:231] op_sel:[0,0] op_sel_hi:[1,0]
    v_pk_fma_f32 v[186:187], v[102:103], v[234:235], v[186:187]
    v_cvt_pk_bf16_f32 v103, v186, v187
    v_pk_mul_f32 v[184:185], v[236:237], v[230:231] op_sel:[0,0] op_sel_hi:[1,0]
    v_pk_fma_f32 v[184:185], v[100:101], v[232:233], v[184:185]
    v_cvt_pk_bf16_f32 v102, v184, v185
    v_pk_mul_f32 v[190:191], v[238:239], v[230:231] op_sel:[0,1] op_sel_hi:[1,1]
    v_pk_fma_f32 v[190:191], v[118:119], v[234:235], v[190:191]
    v_cvt_pk_bf16_f32 v119, v190, v191
    v_pk_mul_f32 v[188:189], v[236:237], v[230:231] op_sel:[0,1] op_sel_hi:[1,1]
    v_pk_fma_f32 v[188:189], v[116:117], v[232:233], v[188:189]
    v_cvt_pk_bf16_f32 v118, v188, v189
    v_pk_mul_f32 v[184:185], v[214:215], v[210:211] op_sel:[0,1] op_sel_hi:[1,1]
    v_pk_fma_f32 v[184:185], v[72:73], v[210:211], v[184:185] op_sel_hi:[1,0,1]
    v_cvt_pk_bf16_f32 v72, v184, v185
    v_pk_mul_f32 v[186:187], v[216:217], v[210:211] op_sel:[0,1] op_sel_hi:[1,1]
    v_pk_fma_f32 v[186:187], v[74:75], v[210:211], v[186:187] op_sel_hi:[1,0,1]
    v_cvt_pk_bf16_f32 v73, v186, v187
    v_pk_mul_f32 v[188:189], v[218:219], v[210:211] op_sel:[0,1] op_sel_hi:[1,1]
    v_pk_fma_f32 v[188:189], v[76:77], v[210:211], v[188:189] op_sel_hi:[1,0,1]
    v_cvt_pk_bf16_f32 v74, v188, v189
    v_pk_mul_f32 v[190:191], v[220:221], v[210:211] op_sel:[0,1] op_sel_hi:[1,1]
    v_pk_fma_f32 v[190:191], v[78:79], v[210:211], v[190:191] op_sel_hi:[1,0,1]
    v_cvt_pk_bf16_f32 v75, v190, v191
    buffer_store_dwordx4 v[72:75], v0, s[12:15], s28 offen offset:0 sc1
    v_pk_mul_f32 v[186:187], v[246:247], v[230:231] op_sel:[0,0] op_sel_hi:[1,0]
    v_pk_fma_f32 v[186:187], v[98:99], v[242:243], v[186:187]
    v_cvt_pk_bf16_f32 v101, v186, v187
    v_pk_mul_f32 v[184:185], v[244:245], v[230:231] op_sel:[0,0] op_sel_hi:[1,0]
    v_pk_fma_f32 v[184:185], v[96:97], v[240:241], v[184:185]
    v_cvt_pk_bf16_f32 v100, v184, v185
    buffer_store_dwordx4 v[100:103], v0, s[12:15], s28 offen offset:2048 sc1
    v_pk_mul_f32 v[190:191], v[246:247], v[230:231] op_sel:[0,1] op_sel_hi:[1,1]
    v_pk_fma_f32 v[190:191], v[114:115], v[242:243], v[190:191]
    v_cvt_pk_bf16_f32 v117, v190, v191
    v_pk_mul_f32 v[188:189], v[244:245], v[230:231] op_sel:[0,1] op_sel_hi:[1,1]
    v_pk_fma_f32 v[188:189], v[112:113], v[240:241], v[188:189]
    v_cvt_pk_bf16_f32 v116, v188, v189
    buffer_store_dwordx4 v[116:119], v0, s[12:15], s28 offen offset:3072 sc1
    s_waitcnt lgkmcnt(0)
    v_pk_mul_f32 v[184:185], v[214:215], v[208:209] op_sel:[0,1] op_sel_hi:[1,1]
    v_pk_fma_f32 v[184:185], v[64:65], v[208:209], v[184:185] op_sel_hi:[1,0,1]
    v_cvt_pk_bf16_f32 v64, v184, v185
    v_pk_mul_f32 v[186:187], v[216:217], v[208:209] op_sel:[0,1] op_sel_hi:[1,1]
    v_pk_fma_f32 v[186:187], v[66:67], v[208:209], v[186:187] op_sel_hi:[1,0,1]
    v_cvt_pk_bf16_f32 v65, v186, v187
    v_pk_mul_f32 v[188:189], v[218:219], v[208:209] op_sel:[0,1] op_sel_hi:[1,1]
    v_pk_fma_f32 v[188:189], v[68:69], v[208:209], v[188:189] op_sel_hi:[1,0,1]
    v_cvt_pk_bf16_f32 v66, v188, v189
    v_pk_mul_f32 v[190:191], v[220:221], v[208:209] op_sel:[0,1] op_sel_hi:[1,1]
    v_pk_fma_f32 v[190:191], v[70:71], v[208:209], v[190:191] op_sel_hi:[1,0,1]
    v_cvt_pk_bf16_f32 v67, v190, v191
    buffer_store_dwordx4 v[64:67], v0, s[12:15], s27 offen offset:1024 sc1
    v_pk_mul_f32 v[186:187], v[150:151], v[230:231] op_sel:[0,0] op_sel_hi:[1,0]
    v_pk_fma_f32 v[186:187], v[94:95], v[146:147], v[186:187]
    v_cvt_pk_bf16_f32 v99, v186, v187
    v_pk_mul_f32 v[184:185], v[148:149], v[230:231] op_sel:[0,0] op_sel_hi:[1,0]
    v_pk_fma_f32 v[184:185], v[92:93], v[144:145], v[184:185]
    v_cvt_pk_bf16_f32 v98, v184, v185
    v_pk_mul_f32 v[190:191], v[150:151], v[230:231] op_sel:[0,1] op_sel_hi:[1,1]
    v_pk_fma_f32 v[190:191], v[110:111], v[146:147], v[190:191]
    v_cvt_pk_bf16_f32 v115, v190, v191
    v_pk_mul_f32 v[188:189], v[148:149], v[230:231] op_sel:[0,1] op_sel_hi:[1,1]
    v_pk_fma_f32 v[188:189], v[108:109], v[144:145], v[188:189]
    v_cvt_pk_bf16_f32 v114, v188, v189
    v_pk_mul_f32 v[184:185], v[214:215], v[206:207] op_sel:[0,1] op_sel_hi:[1,1]
    v_pk_fma_f32 v[184:185], v[56:57], v[206:207], v[184:185] op_sel_hi:[1,0,1]
    v_cvt_pk_bf16_f32 v56, v184, v185
    v_pk_mul_f32 v[186:187], v[216:217], v[206:207] op_sel:[0,1] op_sel_hi:[1,1]
    v_pk_fma_f32 v[186:187], v[58:59], v[206:207], v[186:187] op_sel_hi:[1,0,1]
    v_cvt_pk_bf16_f32 v57, v186, v187
    v_pk_mul_f32 v[188:189], v[218:219], v[206:207] op_sel:[0,1] op_sel_hi:[1,1]
    v_pk_fma_f32 v[188:189], v[60:61], v[206:207], v[188:189] op_sel_hi:[1,0,1]
    v_cvt_pk_bf16_f32 v58, v188, v189
    v_pk_mul_f32 v[190:191], v[220:221], v[206:207] op_sel:[0,1] op_sel_hi:[1,1]
    v_pk_fma_f32 v[190:191], v[62:63], v[206:207], v[190:191] op_sel_hi:[1,0,1]
    v_cvt_pk_bf16_f32 v59, v190, v191
    buffer_store_dwordx4 v[56:59], v0, s[12:15], s27 offen offset:0 sc1
    v_pk_mul_f32 v[186:187], v[158:159], v[230:231] op_sel:[0,0] op_sel_hi:[1,0]
    v_pk_fma_f32 v[186:187], v[90:91], v[154:155], v[186:187]
    v_cvt_pk_bf16_f32 v97, v186, v187
    v_pk_mul_f32 v[184:185], v[156:157], v[230:231] op_sel:[0,0] op_sel_hi:[1,0]
    v_pk_fma_f32 v[184:185], v[88:89], v[152:153], v[184:185]
    v_cvt_pk_bf16_f32 v96, v184, v185
    buffer_store_dwordx4 v[96:99], v0, s[12:15], s27 offen offset:2048 sc1
    v_pk_mul_f32 v[190:191], v[158:159], v[230:231] op_sel:[0,1] op_sel_hi:[1,1]
    v_pk_fma_f32 v[190:191], v[106:107], v[154:155], v[190:191]
    v_cvt_pk_bf16_f32 v113, v190, v191
    v_pk_mul_f32 v[188:189], v[156:157], v[230:231] op_sel:[0,1] op_sel_hi:[1,1]
    v_pk_fma_f32 v[188:189], v[104:105], v[152:153], v[188:189]
    v_cvt_pk_bf16_f32 v112, v188, v189
    buffer_store_dwordx4 v[112:115], v0, s[12:15], s27 offen offset:3072 sc1
    s_lshl_b32 s27, s84, 13
    s_and_b32 s28, s33, 4096
    s_add_u32 s27, s27, s28
    s_add_u32 s27, s27, 57344
    v_add_u32 v253, s27, v0
    s_cmp_ge_u32 s3, 2
    s_cbranch_scc1 L_tailA3
    v_mfma_f32_16x16x32_bf16 v[24:27], v[136:139], v[120:123], v[24:27]
    ds_write_b128 v253, v[56:59] offset:0
    v_mfma_f32_16x16x32_bf16 v[32:35], v[136:139], v[124:127], v[32:35]
    s_mov_b32 s35, 1048744942
    v_mul_f32 v206, s35, v206
    v_mul_f32 v207, s35, v207
    v_mfma_f32_16x16x32_bf16 v[40:43], v[136:139], v[128:131], v[40:43]
    ds_write_b128 v253, v[64:67] offset:1024
    v_mfma_f32_16x16x32_bf16 v[48:51], v[136:139], v[132:135], v[48:51]
    v_mul_f32 v208, s35, v208
    v_mul_f32 v209, s35, v209
    v_mul_f32 v210, s35, v210
    v_mfma_f32_16x16x32_bf16 v[52:55], v[140:143], v[132:135], v[52:55]
    ds_write_b128 v253, v[96:99] offset:2048
    v_mfma_f32_16x16x32_bf16 v[44:47], v[140:143], v[128:131], v[44:47]
    v_mul_f32 v211, s35, v211
    v_mul_f32 v212, s35, v212
    v_mul_f32 v213, s35, v213
    v_mfma_f32_16x16x32_bf16 v[36:39], v[140:143], v[124:127], v[36:39]
    ds_write_b128 v253, v[112:115] offset:3072
    v_mfma_f32_16x16x32_bf16 v[28:31], v[140:143], v[120:123], v[28:31]
    s_xor_b32 s28, s3, 2
    s_lshl_b32 s28, s28, 11
    s_add_u32 s28, s28, 49152
    v_mfma_f32_16x16x32_bf16 v[24:27], v[176:179], v[160:163], v[24:27]
    ds_write_b128 v253, v[72:75] offset:8192
    v_mfma_f32_16x16x32_bf16 v[32:35], v[176:179], v[164:167], v[32:35]
    v_add_u32 v254, s28, v0
    s_lshl_b32 s27, s22, 3
    s_add_u32 s27, s27, s3
    v_mfma_f32_16x16x32_bf16 v[40:43], v[176:179], v[168:171], v[40:43]
    ds_write_b128 v253, v[80:83] offset:9216
    v_mfma_f32_16x16x32_bf16 v[48:51], v[176:179], v[172:175], v[48:51]
    s_lshl_b32 s27, s27, 3
    s_add_u32 s27, s27, 147456
    s_add_u32 s27, s27, s73
    v_mfma_f32_16x16x32_bf16 v[52:55], v[180:183], v[172:175], v[52:55]
    ds_write_b128 v253, v[100:103] offset:10240
    v_mfma_f32_16x16x32_bf16 v[44:47], v[180:183], v[168:171], v[44:47]
    v_mov_b32 v245, s27
    v_mov_b32 v246, s24
    v_mov_b32 v247, s25
    v_mfma_f32_16x16x32_bf16 v[36:39], v[180:183], v[164:167], v[36:39]
    ds_write_b128 v253, v[116:119] offset:11264
    v_mfma_f32_16x16x32_bf16 v[28:31], v[180:183], v[160:163], v[28:31]
    v_pk_mul_f32 v[184:185], v[192:193], v[206:207] op_sel:[0,1] op_sel_hi:[1,1]
    v_pk_fma_f32 v[184:185], v[24:25], v[206:207], v[184:185] op_sel_hi:[1,0,1]
    v_cvt_pk_bf16_f32 v24, v184, v185
    v_pk_mul_f32 v[186:187], v[194:195], v[206:207] op_sel:[0,1] op_sel_hi:[1,1]
    v_pk_fma_f32 v[186:187], v[26:27], v[206:207], v[186:187] op_sel_hi:[1,0,1]
    v_cvt_pk_bf16_f32 v25, v186, v187
    v_pk_mul_f32 v[188:189], v[196:197], v[206:207] op_sel:[0,1] op_sel_hi:[1,1]
    s_nop 0
    v_pk_fma_f32 v[188:189], v[28:29], v[206:207], v[188:189] op_sel_hi:[1,0,1]
    v_cvt_pk_bf16_f32 v26, v188, v189
    v_pk_mul_f32 v[190:191], v[198:199], v[206:207] op_sel:[0,1] op_sel_hi:[1,1]
    v_pk_fma_f32 v[190:191], v[30:31], v[206:207], v[190:191] op_sel_hi:[1,0,1]
    v_cvt_pk_bf16_f32 v27, v190, v191
    ds_write_b128 v254, v[24:27] offset:0
    v_pk_mul_f32 v[184:185], v[192:193], v[208:209] op_sel:[0,1] op_sel_hi:[1,1]
    v_pk_fma_f32 v[184:185], v[32:33], v[208:209], v[184:185] op_sel_hi:[1,0,1]
    v_cvt_pk_bf16_f32 v32, v184, v185
    v_pk_mul_f32 v[186:187], v[194:195], v[208:209] op_sel:[0,1] op_sel_hi:[1,1]
    v_pk_fma_f32 v[186:187], v[34:35], v[208:209], v[186:187] op_sel_hi:[1,0,1]
    v_cvt_pk_bf16_f32 v33, v186, v187
    v_pk_mul_f32 v[188:189], v[196:197], v[208:209] op_sel:[0,1] op_sel_hi:[1,1]
    v_pk_fma_f32 v[188:189], v[36:37], v[208:209], v[188:189] op_sel_hi:[1,0,1]
    v_cvt_pk_bf16_f32 v34, v188, v189
    v_pk_mul_f32 v[190:191], v[198:199], v[208:209] op_sel:[0,1] op_sel_hi:[1,1]
    v_pk_fma_f32 v[190:191], v[38:39], v[208:209], v[190:191] op_sel_hi:[1,0,1]
    v_cvt_pk_bf16_f32 v35, v190, v191
    ds_write_b128 v254, v[32:35] offset:1024
    v_pk_mul_f32 v[184:185], v[192:193], v[210:211] op_sel:[0,1] op_sel_hi:[1,1]
    v_pk_fma_f32 v[184:185], v[40:41], v[210:211], v[184:185] op_sel_hi:[1,0,1]
    v_cvt_pk_bf16_f32 v40, v184, v185
    v_pk_mul_f32 v[186:187], v[194:195], v[210:211] op_sel:[0,1] op_sel_hi:[1,1]
    v_pk_fma_f32 v[186:187], v[42:43], v[210:211], v[186:187] op_sel_hi:[1,0,1]
    v_cvt_pk_bf16_f32 v41, v186, v187
    v_pk_mul_f32 v[188:189], v[196:197], v[210:211] op_sel:[0,1] op_sel_hi:[1,1]
    v_pk_fma_f32 v[188:189], v[44:45], v[210:211], v[188:189] op_sel_hi:[1,0,1]
    v_cvt_pk_bf16_f32 v42, v188, v189
    v_pk_mul_f32 v[190:191], v[198:199], v[210:211] op_sel:[0,1] op_sel_hi:[1,1]
    v_pk_fma_f32 v[190:191], v[46:47], v[210:211], v[190:191] op_sel_hi:[1,0,1]
    v_cvt_pk_bf16_f32 v43, v190, v191
    v_pk_mul_f32 v[184:185], v[192:193], v[212:213] op_sel:[0,1] op_sel_hi:[1,1]
    v_pk_fma_f32 v[184:185], v[48:49], v[212:213], v[184:185] op_sel_hi:[1,0,1]
    v_cvt_pk_bf16_f32 v48, v184, v185
    v_pk_mul_f32 v[186:187], v[194:195], v[212:213] op_sel:[0,1] op_sel_hi:[1,1]
    v_pk_fma_f32 v[186:187], v[50:51], v[212:213], v[186:187] op_sel_hi:[1,0,1]
    v_cvt_pk_bf16_f32 v49, v186, v187
    v_pk_mul_f32 v[188:189], v[196:197], v[212:213] op_sel:[0,1] op_sel_hi:[1,1]
    v_pk_fma_f32 v[188:189], v[52:53], v[212:213], v[188:189] op_sel_hi:[1,0,1]
    v_cvt_pk_bf16_f32 v50, v188, v189
    v_pk_mul_f32 v[190:191], v[198:199], v[212:213] op_sel:[0,1] op_sel_hi:[1,1]
    v_pk_fma_f32 v[190:191], v[54:55], v[212:213], v[190:191] op_sel_hi:[1,0,1]
    v_cvt_pk_bf16_f32 v51, v190, v191
    s_waitcnt lgkmcnt(0)
    s_barrier
    v_mfma_f32_16x16x32_bf16 v[120:123], v[72:75], v[40:43], v[222:225]
    v_mfma_f32_16x16x32_bf16 v[128:131], v[72:75], v[48:51], 0
    s_nop 6
    v_exp_f32 v120, v120
    v_mfma_f32_16x16x32_bf16 v[132:135], v[80:83], v[48:51], v[222:225]
    v_exp_f32 v121, v121
    v_mov_b32 v139, 0
    v_exp_f32 v122, v122
    v_cvt_pk_bf16_f32 v136, v120, v121
    v_exp_f32 v123, v123
    v_mov_b32 v138, 0
    v_cvt_pk_bf16_f32 v137, v122, v123
    v_mfma_f32_16x16x32_bf16 v[120:123], v[56:59], v[40:43], 0
    v_exp_f32 v128, v128
    v_exp_f32 v129, v129
    v_mfma_f32_16x16x32_bf16 v[124:127], v[64:67], v[40:43], 0
    v_exp_f32 v130, v130
    v_cvt_pk_bf16_f32 v140, v128, v129
    v_mfma_f32_16x16x32_bf16 v[144:147], v[100:103], v[136:139], 0
    v_exp_f32 v131, v131
    v_exp_f32 v132, v132
    v_cvt_pk_bf16_f32 v141, v130, v131
    v_mfma_f32_16x16x32_bf16 v[148:151], v[116:119], v[136:139], 0
    v_exp_f32 v133, v133
    v_exp_f32 v134, v134
    v_cvt_pk_bf16_f32 v142, v132, v133
    v_exp_f32 v135, v135
    v_mfma_f32_16x16x32_bf16 v[160:163], v[226:229], v[136:139], 0
    v_cvt_pk_bf16_f32 v143, v134, v135
    v_mfma_f32_16x16x32_bf16 v[128:131], v[56:59], v[48:51], 0
    v_exp_f32 v120, v120
    v_exp_f32 v121, v121
    v_mfma_f32_16x16x32_bf16 v[132:135], v[64:67], v[48:51], 0
    v_exp_f32 v122, v122
    v_cvt_pk_bf16_f32 v136, v120, v121
    v_mfma_f32_16x16x32_bf16 v[152:155], v[100:103], v[140:143], 0
    v_exp_f32 v123, v123
    v_exp_f32 v124, v124
    v_cvt_pk_bf16_f32 v137, v122, v123
    v_mfma_f32_16x16x32_bf16 v[156:159], v[116:119], v[140:143], 0
    v_exp_f32 v125, v125
    v_exp_f32 v126, v126
    v_cvt_pk_bf16_f32 v138, v124, v125
    v_exp_f32 v127, v127
    v_mfma_f32_16x16x32_bf16 v[164:167], v[226:229], v[140:143], 0
    v_cvt_pk_bf16_f32 v139, v126, v127
    s_waitcnt lgkmcnt(0)
    s_nop 0
    v_mfma_f32_16x16x32_bf16 v[144:147], v[96:99], v[136:139], v[144:147]
    v_exp_f32 v128, v128
    v_exp_f32 v129, v129
    v_mfma_f32_16x16x32_bf16 v[148:151], v[112:115], v[136:139], v[148:151]
    v_exp_f32 v130, v130
    v_cvt_pk_bf16_f32 v140, v128, v129
    v_mfma_f32_16x16x32_bf16 v[160:163], v[226:229], v[136:139], v[160:163]
    v_exp_f32 v131, v131
    v_exp_f32 v132, v132
    v_cvt_pk_bf16_f32 v141, v130, v131
    v_exp_f32 v133, v133
    v_exp_f32 v134, v134
    v_cvt_pk_bf16_f32 v142, v132, v133
    v_exp_f32 v135, v135
    s_nop 0
    v_cvt_pk_bf16_f32 v143, v134, v135
    s_waitcnt vmcnt(0)
    s_mov_b64 exec, 1
    buffer_store_dwordx2 v[246:247], v245, s[12:15], 0 offen offset:0 sc1
    s_mov_b64 exec, -1
    s_and_b32 s27, s33, 4096
    s_add_u32 s27, s27, 98304
    v_add_u32 v244, s27, v0
    v_xor_b32 v236, 4048155338, v222
    v_xor_b32 v237, 4048155338, v223
    v_xor_b32 v238, 4048155338, v224
    v_xor_b32 v239, 4048155338, v225
    s_barrier
    ds_read_b128 v[72:75], v244 offset:0
    ds_read_b128 v[80:83], v244 offset:1024
    ds_read_b128 v[100:103], v244 offset:2048
    ds_read_b128 v[116:119], v244 offset:3072
    s_waitcnt lgkmcnt(2)
    v_mfma_f32_16x16x32_bf16 v[120:123], v[72:75], v[40:43], 0
    v_mfma_f32_16x16x32_bf16 v[124:127], v[80:83], v[40:43], 0
    v_mfma_f32_16x16x32_bf16 v[128:131], v[72:75], v[48:51], 0
    ds_read_b128 v[56:59], v244 offset:8192
    s_nop 4
    v_exp_f32 v120, v120
    v_exp_f32 v121, v121
    v_mfma_f32_16x16x32_bf16 v[132:135], v[80:83], v[48:51], 0
    ds_read_b128 v[64:67], v244 offset:9216
    v_exp_f32 v122, v122
    v_cvt_pk_bf16_f32 v136, v120, v121
    v_mfma_f32_16x16x32_bf16 v[152:155], v[96:99], v[140:143], v[152:155]
    v_exp_f32 v123, v123
    v_exp_f32 v124, v124
    v_cvt_pk_bf16_f32 v137, v122, v123
    v_mfma_f32_16x16x32_bf16 v[156:159], v[112:115], v[140:143], v[156:159]
    v_exp_f32 v125, v125
    v_exp_f32 v126, v126
    v_cvt_pk_bf16_f32 v138, v124, v125
    v_exp_f32 v127, v127
    v_mfma_f32_16x16x32_bf16 v[164:167], v[226:229], v[140:143], v[164:167]
    v_cvt_pk_bf16_f32 v139, v126, v127
    s_cmp_eq_u32 s20, 0
    s_cbranch_scc0 Lw_103
    v_mov_b32 v226, 0
    v_mov_b32 v227, 0
    v_mov_b32 v228, 0
    v_mov_b32 v229, 0
Lw_103:
    s_waitcnt lgkmcnt(0)
    v_mfma_f32_16x16x32_bf16 v[120:123], v[56:59], v[40:43], 0
    v_exp_f32 v128, v128
    v_exp_f32 v129, v129
    v_mfma_f32_16x16x32_bf16 v[124:127], v[64:67], v[40:43], 0
    v_exp_f32 v130, v130
    v_cvt_pk_bf16_f32 v140, v128, v129
    v_mfma_f32_16x16x32_bf16 v[144:147], v[100:103], v[136:139], v[144:147]
    v_exp_f32 v131, v131
    v_exp_f32 v132, v132
    v_cvt_pk_bf16_f32 v141, v130, v131
    v_mfma_f32_16x16x32_bf16 v[148:151], v[116:119], v[136:139], v[148:151]
    ds_read_b128 v[96:99], v244 offset:10240
    v_exp_f32 v133, v133
    v_exp_f32 v134, v134
    v_cvt_pk_bf16_f32 v142, v132, v133
    v_exp_f32 v135, v135
    v_mfma_f32_16x16x32_bf16 v[160:163], v[226:229], v[136:139], v[160:163]
    ds_read_b128 v[112:115], v244 offset:11264
    v_cvt_pk_bf16_f32 v143, v134, v135
    s_barrier
    v_mfma_f32_16x16x32_bf16 v[128:131], v[56:59], v[48:51], 0
    ds_read_b128 v[72:75], v244 offset:16384
    v_exp_f32 v120, v120
    v_exp_f32 v121, v121
    v_mfma_f32_16x16x32_bf16 v[132:135], v[64:67], v[48:51], 0
    ds_read_b128 v[80:83], v244 offset:17408
    v_exp_f32 v122, v122
    v_cvt_pk_bf16_f32 v136, v120, v121
    v_mfma_f32_16x16x32_bf16 v[152:155], v[100:103], v[140:143], v[152:155]
    v_exp_f32 v123, v123
    v_exp_f32 v124, v124
    v_cvt_pk_bf16_f32 v137, v122, v123
    v_mfma_f32_16x16x32_bf16 v[156:159], v[116:119], v[140:143], v[156:159]
    v_exp_f32 v125, v125
    v_exp_f32 v126, v126
    v_cvt_pk_bf16_f32 v138, v124, v125
    v_exp_f32 v127, v127
    v_mfma_f32_16x16x32_bf16 v[164:167], v[226:229], v[140:143], v[164:167]
    v_cvt_pk_bf16_f32 v139, v126, v127
    s_waitcnt lgkmcnt(0)
    v_mfma_f32_16x16x32_bf16 v[120:123], v[72:75], v[40:43], 0
    v_exp_f32 v128, v128
    v_exp_f32 v129, v129
    v_mfma_f32_16x16x32_bf16 v[124:127], v[80:83], v[40:43], 0
    v_exp_f32 v130, v130
    v_cvt_pk_bf16_f32 v140, v128, v129
    v_mfma_f32_16x16x32_bf16 v[144:147], v[96:99], v[136:139], v[144:147]
    v_exp_f32 v131, v131
    v_exp_f32 v132, v132
    v_cvt_pk_bf16_f32 v141, v130, v131
    v_mfma_f32_16x16x32_bf16 v[148:151], v[112:115], v[136:139], v[148:151]
    ds_read_b128 v[100:103], v244 offset:18432
    v_exp_f32 v133, v133
    v_exp_f32 v134, v134
    v_cvt_pk_bf16_f32 v142, v132, v133
    v_exp_f32 v135, v135
    v_mfma_f32_16x16x32_bf16 v[160:163], v[226:229], v[136:139], v[160:163]
    ds_read_b128 v[116:119], v244 offset:19456
    v_cvt_pk_bf16_f32 v143, v134, v135
    v_mfma_f32_16x16x32_bf16 v[128:131], v[72:75], v[48:51], 0
    ds_read_b128 v[56:59], v244 offset:24576
    v_exp_f32 v120, v120
    v_exp_f32 v121, v121
    v_mfma_f32_16x16x32_bf16 v[132:135], v[80:83], v[48:51], 0
    ds_read_b128 v[64:67], v244 offset:25600
    v_exp_f32 v122, v122
    v_cvt_pk_bf16_f32 v136, v120, v121
    v_mfma_f32_16x16x32_bf16 v[152:155], v[96:99], v[140:143], v[152:155]
    v_exp_f32 v123, v123
    v_exp_f32 v124, v124
    v_cvt_pk_bf16_f32 v137, v122, v123
    v_mfma_f32_16x16x32_bf16 v[156:159], v[112:115], v[140:143], v[156:159]
    v_exp_f32 v125, v125
    v_exp_f32 v126, v126
    v_cvt_pk_bf16_f32 v138, v124, v125
    v_exp_f32 v127, v127
    v_mfma_f32_16x16x32_bf16 v[164:167], v[226:229], v[140:143], v[164:167]
    v_cvt_pk_bf16_f32 v139, v126, v127
    s_waitcnt lgkmcnt(0)
    v_mfma_f32_16x16x32_bf16 v[120:123], v[56:59], v[40:43], 0
    v_exp_f32 v128, v128
    v_exp_f32 v129, v129
    v_mfma_f32_16x16x32_bf16 v[124:127], v[64:67], v[40:43], 0
    v_exp_f32 v130, v130
    v_cvt_pk_bf16_f32 v140, v128, v129
    v_mfma_f32_16x16x32_bf16 v[144:147], v[100:103], v[136:139], v[144:147]
    v_exp_f32 v131, v131
    v_exp_f32 v132, v132
    v_cvt_pk_bf16_f32 v141, v130, v131
    v_mfma_f32_16x16x32_bf16 v[148:151], v[116:119], v[136:139], v[148:151]
    ds_read_b128 v[96:99], v244 offset:26624
    v_exp_f32 v133, v133
    v_exp_f32 v134, v134
    v_cvt_pk_bf16_f32 v142, v132, v133
    v_exp_f32 v135, v135
    v_mfma_f32_16x16x32_bf16 v[160:163], v[226:229], v[136:139], v[160:163]
    ds_read_b128 v[112:115], v244 offset:27648
    v_cvt_pk_bf16_f32 v143, v134, v135
    s_barrier
    v_mfma_f32_16x16x32_bf16 v[128:131], v[56:59], v[48:51], 0
    ds_read_b128 v[72:75], v244 offset:32768
    v_exp_f32 v120, v120
    v_exp_f32 v121, v121
    v_mfma_f32_16x16x32_bf16 v[132:135], v[64:67], v[48:51], 0
    ds_read_b128 v[80:83], v244 offset:33792
    v_exp_f32 v122, v122
    v_cvt_pk_bf16_f32 v136, v120, v121
    v_mfma_f32_16x16x32_bf16 v[152:155], v[100:103], v[140:143], v[152:155]
    v_exp_f32 v123, v123
    v_exp_f32 v124, v124
    v_cvt_pk_bf16_f32 v137, v122, v123
    v_mfma_f32_16x16x32_bf16 v[156:159], v[116:119], v[140:143], v[156:159]
    v_exp_f32 v125, v125
    v_exp_f32 v126, v126
    v_cvt_pk_bf16_f32 v138, v124, v125
    v_exp_f32 v127, v127
    v_mfma_f32_16x16x32_bf16 v[164:167], v[226:229], v[140:143], v[164:167]
    v_cvt_pk_bf16_f32 v139, v126, v127
    s_waitcnt lgkmcnt(0)
    v_mfma_f32_16x16x32_bf16 v[120:123], v[72:75], v[40:43], 0
    v_exp_f32 v128, v128
    v_exp_f32 v129, v129
    v_mfma_f32_16x16x32_bf16 v[124:127], v[80:83], v[40:43], 0
    v_exp_f32 v130, v130
    v_cvt_pk_bf16_f32 v140, v128, v129
    v_mfma_f32_16x16x32_bf16 v[144:147], v[96:99], v[136:139], v[144:147]
    v_exp_f32 v131, v131
    v_exp_f32 v132, v132
    v_cvt_pk_bf16_f32 v141, v130, v131
    v_mfma_f32_16x16x32_bf16 v[148:151], v[112:115], v[136:139], v[148:151]
    ds_read_b128 v[100:103], v244 offset:34816
    v_exp_f32 v133, v133
    v_exp_f32 v134, v134
    v_cvt_pk_bf16_f32 v142, v132, v133
    v_exp_f32 v135, v135
    v_mfma_f32_16x16x32_bf16 v[160:163], v[226:229], v[136:139], v[160:163]
    ds_read_b128 v[116:119], v244 offset:35840
    v_cvt_pk_bf16_f32 v143, v134, v135
    v_mfma_f32_16x16x32_bf16 v[128:131], v[72:75], v[48:51], 0
    ds_read_b128 v[56:59], v244 offset:40960
    v_exp_f32 v120, v120
    v_exp_f32 v121, v121
    v_mfma_f32_16x16x32_bf16 v[132:135], v[80:83], v[48:51], 0
    ds_read_b128 v[64:67], v244 offset:41984
    v_exp_f32 v122, v122
    v_cvt_pk_bf16_f32 v136, v120, v121
    v_mfma_f32_16x16x32_bf16 v[152:155], v[96:99], v[140:143], v[152:155]
    v_exp_f32 v123, v123
    v_exp_f32 v124, v124
    v_cvt_pk_bf16_f32 v137, v122, v123
    v_mfma_f32_16x16x32_bf16 v[156:159], v[112:115], v[140:143], v[156:159]
    v_exp_f32 v125, v125
    v_exp_f32 v126, v126
    v_cvt_pk_bf16_f32 v138, v124, v125
    v_exp_f32 v127, v127
    v_mfma_f32_16x16x32_bf16 v[164:167], v[226:229], v[140:143], v[164:167]
    v_cvt_pk_bf16_f32 v139, v126, v127
    s_cmp_eq_u32 s20, 1
    s_cbranch_scc0 Lw_104
    v_mov_b32 v226, 0
    v_mov_b32 v227, 0
    v_mov_b32 v228, 0
    v_mov_b32 v229, 0
Lw_104:
    s_waitcnt lgkmcnt(0)
    v_mfma_f32_16x16x32_bf16 v[120:123], v[56:59], v[40:43], 0
    v_exp_f32 v128, v128
    v_exp_f32 v129, v129
    v_mfma_f32_16x16x32_bf16 v[124:127], v[64:67], v[40:43], 0
    v_exp_f32 v130, v130
    v_cvt_pk_bf16_f32 v140, v128, v129
    v_mfma_f32_16x16x32_bf16 v[144:147], v[100:103], v[136:139], v[144:147]
    v_exp_f32 v131, v131
    v_exp_f32 v132, v132
    v_cvt_pk_bf16_f32 v141, v130, v131
    v_mfma_f32_16x16x32_bf16 v[148:151], v[116:119], v[136:139], v[148:151]
    ds_read_b128 v[96:99], v244 offset:43008
    v_exp_f32 v133, v133
    v_exp_f32 v134, v134
    v_cvt_pk_bf16_f32 v142, v132, v133
    v_exp_f32 v135, v135
    v_mfma_f32_16x16x32_bf16 v[160:163], v[226:229], v[136:139], v[160:163]
    ds_read_b128 v[112:115], v244 offset:44032
    v_cvt_pk_bf16_f32 v143, v134, v135
    v_mfma_f32_16x16x32_bf16 v[128:131], v[56:59], v[48:51], 0
    ds_read_b128 v[72:75], v244 offset:49152
    v_exp_f32 v120, v120
    v_exp_f32 v121, v121
    v_mfma_f32_16x16x32_bf16 v[132:135], v[64:67], v[48:51], 0
    ds_read_b128 v[80:83], v244 offset:50176
    v_exp_f32 v122, v122
    v_cvt_pk_bf16_f32 v136, v120, v121
    v_mfma_f32_16x16x32_bf16 v[152:155], v[100:103], v[140:143], v[152:155]
    v_exp_f32 v123, v123
    v_exp_f32 v124, v124
    v_cvt_pk_bf16_f32 v137, v122, v123
    v_mfma_f32_16x16x32_bf16 v[156:159], v[116:119], v[140:143], v[156:159]
    v_exp_f32 v125, v125
    v_exp_f32 v126, v126
    v_cvt_pk_bf16_f32 v138, v124, v125
    v_exp_f32 v127, v127
    v_mfma_f32_16x16x32_bf16 v[164:167], v[226:229], v[140:143], v[164:167]
    v_cvt_pk_bf16_f32 v139, v126, v127
    s_waitcnt lgkmcnt(0)
    v_mfma_f32_16x16x32_bf16 v[120:123], v[72:75], v[40:43], v[236:239]
    v_exp_f32 v128, v128
    v_exp_f32 v129, v129
    v_mfma_f32_16x16x32_bf16 v[124:127], v[80:83], v[40:43], 0
    v_exp_f32 v130, v130
    v_cvt_pk_bf16_f32 v140, v128, v129
    v_mfma_f32_16x16x32_bf16 v[144:147], v[96:99], v[136:139], v[144:147]
    v_exp_f32 v131, v131
    v_exp_f32 v132, v132
    v_cvt_pk_bf16_f32 v141, v130, v131
    v_mfma_f32_16x16x32_bf16 v[148:151], v[112:115], v[136:139], v[148:151]
    ds_read_b128 v[100:103], v244 offset:51200
    v_exp_f32 v133, v133
    v_exp_f32 v134, v134
    v_cvt_pk_bf16_f32 v142, v132, v133
    v_exp_f32 v135, v135
    v_mfma_f32_16x16x32_bf16 v[160:163], v[226:229], v[136:139], v[160:163]
    ds_read_b128 v[116:119], v244 offset:52224
    v_cvt_pk_bf16_f32 v143, v134, v135
    v_mfma_f32_16x16x32_bf16 v[132:135], v[80:83], v[48:51], v[236:239]
    v_exp_f32 v120, v120
    v_exp_f32 v121, v121
    v_mfma_f32_16x16x32_bf16 v[152:155], v[96:99], v[140:143], v[152:155]
    v_exp_f32 v122, v122
    v_cvt_pk_bf16_f32 v136, v120, v121
    v_mfma_f32_16x16x32_bf16 v[156:159], v[112:115], v[140:143], v[156:159]
    v_exp_f32 v123, v123
    v_exp_f32 v124, v124
    v_cvt_pk_bf16_f32 v137, v122, v123
    v_mfma_f32_16x16x32_bf16 v[164:167], v[226:229], v[140:143], v[164:167]
    v_exp_f32 v125, v125
    v_exp_f32 v126, v126
    v_cvt_pk_bf16_f32 v138, v124, v125
    v_exp_f32 v127, v127
    s_nop 0
    v_cvt_pk_bf16_f32 v139, v126, v127
    s_waitcnt lgkmcnt(0)
    s_nop 0
    v_mfma_f32_16x16x32_bf16 v[144:147], v[100:103], v[136:139], v[144:147]
    v_exp_f32 v132, v132
    v_mfma_f32_16x16x32_bf16 v[148:151], v[116:119], v[136:139], v[148:151]
    v_exp_f32 v133, v133
    v_mov_b32 v141, 0
    v_mfma_f32_16x16x32_bf16 v[160:163], v[226:229], v[136:139], v[160:163]
    v_exp_f32 v134, v134
    v_cvt_pk_bf16_f32 v142, v132, v133
    v_exp_f32 v135, v135
    v_mov_b32 v140, 0
    v_cvt_pk_bf16_f32 v143, v134, v135
    s_branch L_afin
L_tailA3:
    v_mfma_f32_16x16x32_bf16 v[24:27], v[136:139], v[120:123], v[24:27]
    ds_write_b128 v253, v[56:59] offset:0
    v_mfma_f32_16x16x32_bf16 v[32:35], v[136:139], v[124:127], v[32:35]
    s_mov_b32 s35, 1048744942
    v_mul_f32 v206, s35, v206
    v_mfma_f32_16x16x32_bf16 v[40:43], v[136:139], v[128:131], v[40:43]
    ds_write_b128 v253, v[64:67] offset:1024
    v_mfma_f32_16x16x32_bf16 v[48:51], v[136:139], v[132:135], v[48:51]
    v_mul_f32 v207, s35, v207
    v_mul_f32 v208, s35, v208
    v_mfma_f32_16x16x32_bf16 v[52:55], v[140:143], v[132:135], v[52:55]
    ds_write_b128 v253, v[96:99] offset:2048
    v_mfma_f32_16x16x32_bf16 v[44:47], v[140:143], v[128:131], v[44:47]
    v_mul_f32 v209, s35, v209
    v_mul_f32 v210, s35, v210
    v_mfma_f32_16x16x32_bf16 v[36:39], v[140:143], v[124:127], v[36:39]
    ds_write_b128 v253, v[112:115] offset:3072
    v_mfma_f32_16x16x32_bf16 v[28:31], v[140:143], v[120:123], v[28:31]
    v_mul_f32 v211, s35, v211
    v_mul_f32 v212, s35, v212
    v_mfma_f32_16x16x32_bf16 v[24:27], v[176:179], v[160:163], v[24:27]
    v_mul_f32 v213, s35, v213
    s_xor_b32 s28, s3, 2
    v_mfma_f32_16x16x32_bf16 v[32:35], v[176:179], v[164:167], v[32:35]
    s_lshl_b32 s28, s28, 11
    s_add_u32 s28, s28, 49152
    v_mfma_f32_16x16x32_bf16 v[40:43], v[176:179], v[168:171], v[40:43]
    v_add_u32 v254, s28, v0
    s_lshl_b32 s27, s22, 3
    v_mfma_f32_16x16x32_bf16 v[48:51], v[176:179], v[172:175], v[48:51]
    s_add_u32 s27, s27, s3
    s_lshl_b32 s27, s27, 3
    v_mfma_f32_16x16x32_bf16 v[52:55], v[180:183], v[172:175], v[52:55]
    s_add_u32 s27, s27, 147456
    s_add_u32 s27, s27, s73
    v_mfma_f32_16x16x32_bf16 v[44:47], v[180:183], v[168:171], v[44:47]
    v_mov_b32 v245, s27
    v_mov_b32 v246, s24
    v_mfma_f32_16x16x32_bf16 v[36:39], v[180:183], v[164:167], v[36:39]
    v_mov_b32 v247, s25
    v_mfma_f32_16x16x32_bf16 v[28:31], v[180:183], v[160:163], v[28:31]
    v_pk_mul_f32 v[184:185], v[192:193], v[206:207] op_sel:[0,1] op_sel_hi:[1,1]
    v_pk_fma_f32 v[184:185], v[24:25], v[206:207], v[184:185] op_sel_hi:[1,0,1]
    v_cvt_pk_bf16_f32 v24, v184, v185
    v_pk_mul_f32 v[186:187], v[194:195], v[206:207] op_sel:[0,1] op_sel_hi:[1,1]
    v_pk_fma_f32 v[186:187], v[26:27], v[206:207], v[186:187] op_sel_hi:[1,0,1]
    v_cvt_pk_bf16_f32 v25, v186, v187
    v_pk_mul_f32 v[188:189], v[196:197], v[206:207] op_sel:[0,1] op_sel_hi:[1,1]
    s_nop 0
    v_pk_fma_f32 v[188:189], v[28:29], v[206:207], v[188:189] op_sel_hi:[1,0,1]
    v_cvt_pk_bf16_f32 v26, v188, v189
    v_pk_mul_f32 v[190:191], v[198:199], v[206:207] op_sel:[0,1] op_sel_hi:[1,1]
    v_pk_fma_f32 v[190:191], v[30:31], v[206:207], v[190:191] op_sel_hi:[1,0,1]
    v_cvt_pk_bf16_f32 v27, v190, v191
    ds_write_b128 v254, v[24:27] offset:0
    v_pk_mul_f32 v[184:185], v[192:193], v[208:209] op_sel:[0,1] op_sel_hi:[1,1]
    v_pk_fma_f32 v[184:185], v[32:33], v[208:209], v[184:185] op_sel_hi:[1,0,1]
    v_cvt_pk_bf16_f32 v32, v184, v185
    v_pk_mul_f32 v[186:187], v[194:195], v[208:209] op_sel:[0,1] op_sel_hi:[1,1]
    v_pk_fma_f32 v[186:187], v[34:35], v[208:209], v[186:187] op_sel_hi:[1,0,1]
    v_cvt_pk_bf16_f32 v33, v186, v187
    v_pk_mul_f32 v[188:189], v[196:197], v[208:209] op_sel:[0,1] op_sel_hi:[1,1]
    v_pk_fma_f32 v[188:189], v[36:37], v[208:209], v[188:189] op_sel_hi:[1,0,1]
    v_cvt_pk_bf16_f32 v34, v188, v189
    v_pk_mul_f32 v[190:191], v[198:199], v[208:209] op_sel:[0,1] op_sel_hi:[1,1]
    v_pk_fma_f32 v[190:191], v[38:39], v[208:209], v[190:191] op_sel_hi:[1,0,1]
    v_cvt_pk_bf16_f32 v35, v190, v191
    ds_write_b128 v254, v[32:35] offset:1024
    v_pk_mul_f32 v[184:185], v[192:193], v[210:211] op_sel:[0,1] op_sel_hi:[1,1]
    v_pk_fma_f32 v[184:185], v[40:41], v[210:211], v[184:185] op_sel_hi:[1,0,1]
    v_cvt_pk_bf16_f32 v40, v184, v185
    v_pk_mul_f32 v[186:187], v[194:195], v[210:211] op_sel:[0,1] op_sel_hi:[1,1]
    v_pk_fma_f32 v[186:187], v[42:43], v[210:211], v[186:187] op_sel_hi:[1,0,1]
    v_cvt_pk_bf16_f32 v41, v186, v187
    v_pk_mul_f32 v[188:189], v[196:197], v[210:211] op_sel:[0,1] op_sel_hi:[1,1]
    v_pk_fma_f32 v[188:189], v[44:45], v[210:211], v[188:189] op_sel_hi:[1,0,1]
    v_cvt_pk_bf16_f32 v42, v188, v189
    v_pk_mul_f32 v[190:191], v[198:199], v[210:211] op_sel:[0,1] op_sel_hi:[1,1]
    v_pk_fma_f32 v[190:191], v[46:47], v[210:211], v[190:191] op_sel_hi:[1,0,1]
    v_cvt_pk_bf16_f32 v43, v190, v191
    v_subrev_u32 v244, 16384, v253
    v_pk_mul_f32 v[184:185], v[192:193], v[212:213] op_sel:[0,1] op_sel_hi:[1,1]
    v_pk_fma_f32 v[184:185], v[48:49], v[212:213], v[184:185] op_sel_hi:[1,0,1]
    v_cvt_pk_bf16_f32 v48, v184, v185
    v_pk_mul_f32 v[186:187], v[194:195], v[212:213] op_sel:[0,1] op_sel_hi:[1,1]
    v_pk_fma_f32 v[186:187], v[50:51], v[212:213], v[186:187] op_sel_hi:[1,0,1]
    v_cvt_pk_bf16_f32 v49, v186, v187
    v_pk_mul_f32 v[188:189], v[196:197], v[212:213] op_sel:[0,1] op_sel_hi:[1,1]
    v_pk_fma_f32 v[188:189], v[52:53], v[212:213], v[188:189] op_sel_hi:[1,0,1]
    v_cvt_pk_bf16_f32 v50, v188, v189
    v_pk_mul_f32 v[190:191], v[198:199], v[212:213] op_sel:[0,1] op_sel_hi:[1,1]
    v_pk_fma_f32 v[190:191], v[54:55], v[212:213], v[190:191] op_sel_hi:[1,0,1]
    v_cvt_pk_bf16_f32 v51, v190, v191
    s_waitcnt lgkmcnt(0)
    s_barrier
    v_mfma_f32_16x16x32_bf16 v[120:123], v[72:75], v[40:43], v[222:225]
    v_mfma_f32_16x16x32_bf16 v[128:131], v[72:75], v[48:51], 0
    s_nop 6
    v_exp_f32 v120, v120
    v_mfma_f32_16x16x32_bf16 v[132:135], v[80:83], v[48:51], v[222:225]
    v_exp_f32 v121, v121
    v_mov_b32 v139, 0
    v_exp_f32 v122, v122
    v_cvt_pk_bf16_f32 v136, v120, v121
    v_exp_f32 v123, v123
    v_mov_b32 v138, 0
    v_cvt_pk_bf16_f32 v137, v122, v123
    v_mfma_f32_16x16x32_bf16 v[120:123], v[56:59], v[40:43], 0
    v_exp_f32 v128, v128
    v_exp_f32 v129, v129
    v_mfma_f32_16x16x32_bf16 v[124:127], v[64:67], v[40:43], 0
    v_exp_f32 v130, v130
    v_cvt_pk_bf16_f32 v140, v128, v129
    v_mfma_f32_16x16x32_bf16 v[144:147], v[100:103], v[136:139], 0
    v_exp_f32 v131, v131
    v_exp_f32 v132, v132
    v_cvt_pk_bf16_f32 v141, v130, v131
    v_mfma_f32_16x16x32_bf16 v[148:151], v[116:119], v[136:139], 0
    v_exp_f32 v133, v133
    v_exp_f32 v134, v134
    v_cvt_pk_bf16_f32 v142, v132, v133
    v_exp_f32 v135, v135
    v_mfma_f32_16x16x32_bf16 v[160:163], v[226:229], v[136:139], 0
    v_cvt_pk_bf16_f32 v143, v134, v135
    v_mfma_f32_16x16x32_bf16 v[128:131], v[56:59], v[48:51], 0
    ds_read_b128 v[72:75], v244 offset:8192
    v_exp_f32 v120, v120
    v_exp_f32 v121, v121
    v_mfma_f32_16x16x32_bf16 v[132:135], v[64:67], v[48:51], 0
    ds_read_b128 v[80:83], v244 offset:9216
    v_exp_f32 v122, v122
    v_cvt_pk_bf16_f32 v136, v120, v121
    v_mfma_f32_16x16x32_bf16 v[152:155], v[100:103], v[140:143], 0
    v_exp_f32 v123, v123
    v_exp_f32 v124, v124
    v_cvt_pk_bf16_f32 v137, v122, v123
    v_mfma_f32_16x16x32_bf16 v[156:159], v[116:119], v[140:143], 0
    v_exp_f32 v125, v125
    v_exp_f32 v126, v126
    v_cvt_pk_bf16_f32 v138, v124, v125
    v_exp_f32 v127, v127
    v_mfma_f32_16x16x32_bf16 v[164:167], v[226:229], v[140:143], 0
    v_cvt_pk_bf16_f32 v139, v126, v127
    s_waitcnt lgkmcnt(0)
    v_mfma_f32_16x16x32_bf16 v[120:123], v[72:75], v[40:43], 0
    v_exp_f32 v128, v128
    v_exp_f32 v129, v129
    v_mfma_f32_16x16x32_bf16 v[124:127], v[80:83], v[40:43], 0
    v_exp_f32 v130, v130
    v_cvt_pk_bf16_f32 v140, v128, v129
    v_mfma_f32_16x16x32_bf16 v[144:147], v[96:99], v[136:139], v[144:147]
    v_exp_f32 v131, v131
    v_exp_f32 v132, v132
    v_cvt_pk_bf16_f32 v141, v130, v131
    v_mfma_f32_16x16x32_bf16 v[148:151], v[112:115], v[136:139], v[148:151]
    ds_read_b128 v[100:103], v244 offset:10240
    v_exp_f32 v133, v133
    v_exp_f32 v134, v134
    v_cvt_pk_bf16_f32 v142, v132, v133
    v_exp_f32 v135, v135
    v_mfma_f32_16x16x32_bf16 v[160:163], v[226:229], v[136:139], v[160:163]
    ds_read_b128 v[116:119], v244 offset:11264
    v_cvt_pk_bf16_f32 v143, v134, v135
    s_waitcnt vmcnt(0)
    s_mov_b64 exec, 1
    buffer_store_dwordx2 v[246:247], v245, s[12:15], 0 offen offset:0 sc1
    s_mov_b64 exec, -1
    v_mfma_f32_16x16x32_bf16 v[128:131], v[72:75], v[48:51], 0
    ds_read_b128 v[56:59], v244 offset:0
    v_exp_f32 v120, v120
    v_exp_f32 v121, v121
    v_mfma_f32_16x16x32_bf16 v[132:135], v[80:83], v[48:51], 0
    ds_read_b128 v[64:67], v244 offset:1024
    v_exp_f32 v122, v122
    v_cvt_pk_bf16_f32 v136, v120, v121
    v_mfma_f32_16x16x32_bf16 v[152:155], v[96:99], v[140:143], v[152:155]
    v_exp_f32 v123, v123
    v_exp_f32 v124, v124
    v_cvt_pk_bf16_f32 v137, v122, v123
    v_mfma_f32_16x16x32_bf16 v[156:159], v[112:115], v[140:143], v[156:159]
    v_exp_f32 v125, v125
    v_exp_f32 v126, v126
    v_cvt_pk_bf16_f32 v138, v124, v125
    v_exp_f32 v127, v127
    v_mfma_f32_16x16x32_bf16 v[164:167], v[226:229], v[140:143], v[164:167]
    v_cvt_pk_bf16_f32 v139, v126, v127
    s_waitcnt lgkmcnt(0)
    v_mfma_f32_16x16x32_bf16 v[120:123], v[56:59], v[40:43], 0
    v_exp_f32 v128, v128
    v_exp_f32 v129, v129
    v_mfma_f32_16x16x32_bf16 v[124:127], v[64:67], v[40:43], 0
    v_exp_f32 v130, v130
    v_cvt_pk_bf16_f32 v140, v128, v129
    v_mfma_f32_16x16x32_bf16 v[144:147], v[100:103], v[136:139], v[144:147]
    v_exp_f32 v131, v131
    v_exp_f32 v132, v132
    v_cvt_pk_bf16_f32 v141, v130, v131
    v_mfma_f32_16x16x32_bf16 v[148:151], v[116:119], v[136:139], v[148:151]
    ds_read_b128 v[96:99], v244 offset:2048
    v_exp_f32 v133, v133
    v_exp_f32 v134, v134
    v_cvt_pk_bf16_f32 v142, v132, v133
    v_exp_f32 v135, v135
    v_mfma_f32_16x16x32_bf16 v[160:163], v[226:229], v[136:139], v[160:163]
    ds_read_b128 v[112:115], v244 offset:3072
    v_cvt_pk_bf16_f32 v143, v134, v135
    v_mfma_f32_16x16x32_bf16 v[128:131], v[56:59], v[48:51], 0
    v_exp_f32 v120, v120
    v_exp_f32 v121, v121
    v_mfma_f32_16x16x32_bf16 v[132:135], v[64:67], v[48:51], 0
    v_exp_f32 v122, v122
    v_cvt_pk_bf16_f32 v136, v120, v121
    v_mfma_f32_16x16x32_bf16 v[152:155], v[100:103], v[140:143], v[152:155]
    v_exp_f32 v123, v123
    v_exp_f32 v124, v124
    v_cvt_pk_bf16_f32 v137, v122, v123
    v_mfma_f32_16x16x32_bf16 v[156:159], v[116:119], v[140:143], v[156:159]
    v_exp_f32 v125, v125
    v_exp_f32 v126, v126
    v_cvt_pk_bf16_f32 v138, v124, v125
    v_exp_f32 v127, v127
    v_mfma_f32_16x16x32_bf16 v[164:167], v[226:229], v[140:143], v[164:167]
    v_cvt_pk_bf16_f32 v139, v126, v127
    s_waitcnt lgkmcnt(0)
    s_nop 0
    v_mfma_f32_16x16x32_bf16 v[144:147], v[96:99], v[136:139], v[144:147]
    v_exp_f32 v128, v128
    v_exp_f32 v129, v129
    v_mfma_f32_16x16x32_bf16 v[148:151], v[112:115], v[136:139], v[148:151]
    v_exp_f32 v130, v130
    v_cvt_pk_bf16_f32 v140, v128, v129
    v_mfma_f32_16x16x32_bf16 v[160:163], v[226:229], v[136:139], v[160:163]
    v_exp_f32 v131, v131
    v_exp_f32 v132, v132
    v_cvt_pk_bf16_f32 v141, v130, v131
    v_exp_f32 v133, v133
    v_exp_f32 v134, v134
    v_cvt_pk_bf16_f32 v142, v132, v133
    v_exp_f32 v135, v135
    s_nop 0
    v_cvt_pk_bf16_f32 v143, v134, v135
    s_and_b32 s27, s33, 4096
    s_add_u32 s27, s27, 98304
    v_add_u32 v244, s27, v0
    v_xor_b32 v236, 4048155338, v222
    v_xor_b32 v237, 4048155338, v223
    v_xor_b32 v238, 4048155338, v224
    v_xor_b32 v239, 4048155338, v225
    s_barrier
    ds_read_b128 v[72:75], v244 offset:0
    ds_read_b128 v[80:83], v244 offset:1024
    ds_read_b128 v[100:103], v244 offset:2048
    ds_read_b128 v[116:119], v244 offset:3072
    v_add_u32 v245, s34, v0
    s_and_b32 s28, s33, 4096
    s_add_u32 m0, s28, 139264
    s_add_u32 s27, s33, 32768
    buffer_load_dwordx4 v245, s[12:15], s27 offen offset:0 sc1 lds
    buffer_load_dwordx4 v245, s[12:15], s27 offen offset:1024 sc1 lds
    buffer_load_dwordx4 v245, s[12:15], s27 offen offset:2048 sc1 lds
    buffer_load_dwordx4 v245, s[12:15], s27 offen offset:3072 sc1 lds
    s_waitcnt lgkmcnt(2)
    v_mfma_f32_16x16x32_bf16 v[120:123], v[72:75], v[40:43], 0
    v_mfma_f32_16x16x32_bf16 v[124:127], v[80:83], v[40:43], 0
    v_mfma_f32_16x16x32_bf16 v[128:131], v[72:75], v[48:51], 0
    ds_read_b128 v[56:59], v244 offset:8192
    s_nop 4
    v_exp_f32 v120, v120
    v_exp_f32 v121, v121
    v_mfma_f32_16x16x32_bf16 v[132:135], v[80:83], v[48:51], 0
    ds_read_b128 v[64:67], v244 offset:9216
    v_exp_f32 v122, v122
    v_cvt_pk_bf16_f32 v136, v120, v121
    v_mfma_f32_16x16x32_bf16 v[152:155], v[96:99], v[140:143], v[152:155]
    s_add_u32 m0, s28, 155648
    s_add_u32 s27, s33, 0
    buffer_load_dwordx4 v245, s[12:15], s27 offen offset:0 sc1 lds
    v_exp_f32 v123, v123
    v_exp_f32 v124, v124
    v_cvt_pk_bf16_f32 v137, v122, v123
    v_mfma_f32_16x16x32_bf16 v[156:159], v[112:115], v[140:143], v[156:159]
    buffer_load_dwordx4 v245, s[12:15], s27 offen offset:1024 sc1 lds
    v_exp_f32 v125, v125
    v_exp_f32 v126, v126
    v_cvt_pk_bf16_f32 v138, v124, v125
    v_exp_f32 v127, v127
    v_mfma_f32_16x16x32_bf16 v[164:167], v[226:229], v[140:143], v[164:167]
    v_cvt_pk_bf16_f32 v139, v126, v127
    s_cmp_eq_u32 s20, 0
    s_cbranch_scc0 Lw_105
    v_mov_b32 v226, 0
    v_mov_b32 v227, 0
    v_mov_b32 v228, 0
    v_mov_b32 v229, 0
Lw_105:
    s_waitcnt lgkmcnt(0)
    v_mfma_f32_16x16x32_bf16 v[120:123], v[56:59], v[40:43], 0
    buffer_load_dwordx4 v245, s[12:15], s27 offen offset:2048 sc1 lds
    v_exp_f32 v128, v128
    v_exp_f32 v129, v129
    v_mfma_f32_16x16x32_bf16 v[124:127], v[64:67], v[40:43], 0
    buffer_load_dwordx4 v245, s[12:15], s27 offen offset:3072 sc1 lds
    v_exp_f32 v130, v130
    v_cvt_pk_bf16_f32 v140, v128, v129
    v_mfma_f32_16x16x32_bf16 v[144:147], v[100:103], v[136:139], v[144:147]
    v_exp_f32 v131, v131
    v_exp_f32 v132, v132
    v_cvt_pk_bf16_f32 v141, v130, v131
    v_mfma_f32_16x16x32_bf16 v[148:151], v[116:119], v[136:139], v[148:151]
    ds_read_b128 v[96:99], v244 offset:10240
    v_exp_f32 v133, v133
    v_exp_f32 v134, v134
    v_cvt_pk_bf16_f32 v142, v132, v133
    v_exp_f32 v135, v135
    v_mfma_f32_16x16x32_bf16 v[160:163], v[226:229], v[136:139], v[160:163]
    ds_read_b128 v[112:115], v244 offset:11264
    v_cvt_pk_bf16_f32 v143, v134, v135
    s_barrier
    v_mfma_f32_16x16x32_bf16 v[128:131], v[56:59], v[48:51], 0
    ds_read_b128 v[72:75], v244 offset:16384
    v_exp_f32 v120, v120
    v_exp_f32 v121, v121
    v_mfma_f32_16x16x32_bf16 v[132:135], v[64:67], v[48:51], 0
    ds_read_b128 v[80:83], v244 offset:17408
    v_exp_f32 v122, v122
    v_cvt_pk_bf16_f32 v136, v120, v121
    v_mfma_f32_16x16x32_bf16 v[152:155], v[100:103], v[140:143], v[152:155]
    s_add_u32 m0, s85, 49152
    s_add_u32 s36, s86, 786432
    s_and_b32 s36, s36, 0x1fffff
    buffer_load_dwordx4 v3, s[8:11], s36 offen lds
    v_exp_f32 v123, v123
    v_exp_f32 v124, v124
    v_cvt_pk_bf16_f32 v137, v122, v123
    v_mfma_f32_16x16x32_bf16 v[156:159], v[116:119], v[140:143], v[156:159]
    s_add_u32 m0, s85, 53248
    s_add_u32 s36, s86, 851968
    s_and_b32 s36, s36, 0x1fffff
    buffer_load_dwordx4 v3, s[8:11], s36 offen lds
    v_exp_f32 v125, v125
    v_exp_f32 v126, v126
    v_cvt_pk_bf16_f32 v138, v124, v125
    v_exp_f32 v127, v127
    v_mfma_f32_16x16x32_bf16 v[164:167], v[226:229], v[140:143], v[164:167]
    s_add_u32 m0, s85, 65536
    s_add_u32 s36, s86, 1048576
    s_and_b32 s36, s36, 0x1fffff
    buffer_load_dwordx4 v3, s[8:11], s36 offen lds
    v_cvt_pk_bf16_f32 v139, v126, v127
    s_waitcnt lgkmcnt(0)
    v_mfma_f32_16x16x32_bf16 v[120:123], v[72:75], v[40:43], 0
    s_add_u32 m0, s85, 69632
    s_add_u32 s36, s86, 1114112
    s_and_b32 s36, s36, 0x1fffff
    buffer_load_dwordx4 v3, s[8:11], s36 offen lds
    v_exp_f32 v128, v128
    v_exp_f32 v129, v129
    v_mfma_f32_16x16x32_bf16 v[124:127], v[80:83], v[40:43], 0
    s_add_u32 m0, s85, 73728
    s_add_u32 s36, s86, 1179648
    s_and_b32 s36, s36, 0x1fffff
    buffer_load_dwordx4 v3, s[8:11], s36 offen lds
    v_exp_f32 v130, v130
    v_cvt_pk_bf16_f32 v140, v128, v129
    v_mfma_f32_16x16x32_bf16 v[144:147], v[96:99], v[136:139], v[144:147]
    v_exp_f32 v131, v131
    v_exp_f32 v132, v132
    v_cvt_pk_bf16_f32 v141, v130, v131
    v_mfma_f32_16x16x32_bf16 v[148:151], v[112:115], v[136:139], v[148:151]
    ds_read_b128 v[100:103], v244 offset:18432
    v_exp_f32 v133, v133
    v_exp_f32 v134, v134
    v_cvt_pk_bf16_f32 v142, v132, v133
    v_exp_f32 v135, v135
    v_mfma_f32_16x16x32_bf16 v[160:163], v[226:229], v[136:139], v[160:163]
    ds_read_b128 v[116:119], v244 offset:19456
    v_cvt_pk_bf16_f32 v143, v134, v135
    v_mfma_f32_16x16x32_bf16 v[128:131], v[72:75], v[48:51], 0
    ds_read_b128 v[56:59], v244 offset:24576
    v_exp_f32 v120, v120
    v_exp_f32 v121, v121
    v_mfma_f32_16x16x32_bf16 v[132:135], v[80:83], v[48:51], 0
    ds_read_b128 v[64:67], v244 offset:25600
    v_exp_f32 v122, v122
    v_cvt_pk_bf16_f32 v136, v120, v121
    v_mfma_f32_16x16x32_bf16 v[152:155], v[96:99], v[140:143], v[152:155]
    s_add_u32 m0, s85, 77824
    s_add_u32 s36, s86, 1245184
    s_and_b32 s36, s36, 0x1fffff
    buffer_load_dwordx4 v3, s[8:11], s36 offen lds
    v_exp_f32 v123, v123
    v_exp_f32 v124, v124
    v_cvt_pk_bf16_f32 v137, v122, v123
    v_mfma_f32_16x16x32_bf16 v[156:159], v[112:115], v[140:143], v[156:159]
    s_add_u32 m0, s85, 81920
    s_add_u32 s36, s86, 1310720
    s_and_b32 s36, s36, 0x1fffff
    buffer_load_dwordx4 v3, s[8:11], s36 offen lds
    v_exp_f32 v125, v125
    v_exp_f32 v126, v126
    v_cvt_pk_bf16_f32 v138, v124, v125
    v_exp_f32 v127, v127
    v_mfma_f32_16x16x32_bf16 v[164:167], v[226:229], v[140:143], v[164:167]
    s_add_u32 m0, s85, 86016
    s_add_u32 s36, s86, 1376256
    s_and_b32 s36, s36, 0x1fffff
    buffer_load_dwordx4 v3, s[8:11], s36 offen lds
    v_cvt_pk_bf16_f32 v139, v126, v127
    s_waitcnt lgkmcnt(0)
    v_mfma_f32_16x16x32_bf16 v[120:123], v[56:59], v[40:43], 0
    s_add_u32 m0, s85, 98304
    s_add_u32 s36, s86, 1572864
    s_and_b32 s36, s36, 0x1fffff
    buffer_load_dwordx4 v3, s[8:11], s36 offen lds
    v_exp_f32 v128, v128
    v_exp_f32 v129, v129
    v_mfma_f32_16x16x32_bf16 v[124:127], v[64:67], v[40:43], 0
    s_add_u32 m0, s85, 102400
    s_add_u32 s36, s86, 1638400
    s_and_b32 s36, s36, 0x1fffff
    buffer_load_dwordx4 v3, s[8:11], s36 offen lds
    v_exp_f32 v130, v130
    v_cvt_pk_bf16_f32 v140, v128, v129
    v_mfma_f32_16x16x32_bf16 v[144:147], v[100:103], v[136:139], v[144:147]
    v_exp_f32 v131, v131
    v_exp_f32 v132, v132
    v_cvt_pk_bf16_f32 v141, v130, v131
    v_mfma_f32_16x16x32_bf16 v[148:151], v[116:119], v[136:139], v[148:151]
    ds_read_b128 v[96:99], v244 offset:26624
    v_exp_f32 v133, v133
    v_exp_f32 v134, v134
    v_cvt_pk_bf16_f32 v142, v132, v133
    v_exp_f32 v135, v135
    v_mfma_f32_16x16x32_bf16 v[160:163], v[226:229], v[136:139], v[160:163]
    ds_read_b128 v[112:115], v244 offset:27648
    v_cvt_pk_bf16_f32 v143, v134, v135
    s_waitcnt vmcnt(10)
    s_barrier
    v_mfma_f32_16x16x32_bf16 v[128:131], v[56:59], v[48:51], 0
    ds_read_b128 v[72:75], v244 offset:32768
    v_exp_f32 v120, v120
    v_exp_f32 v121, v121
    v_mfma_f32_16x16x32_bf16 v[132:135], v[64:67], v[48:51], 0
    ds_read_b128 v[80:83], v244 offset:33792
    v_exp_f32 v122, v122
    v_cvt_pk_bf16_f32 v136, v120, v121
    v_mfma_f32_16x16x32_bf16 v[152:155], v[100:103], v[140:143], v[152:155]
    s_add_u32 m0, s85, 106496
    s_add_u32 s36, s86, 1703936
    s_and_b32 s36, s36, 0x1fffff
    buffer_load_dwordx4 v3, s[8:11], s36 offen lds
    v_exp_f32 v123, v123
    v_exp_f32 v124, v124
    v_cvt_pk_bf16_f32 v137, v122, v123
    v_mfma_f32_16x16x32_bf16 v[156:159], v[116:119], v[140:143], v[156:159]
    s_add_u32 m0, s85, 110592
    s_add_u32 s36, s86, 1769472
    s_and_b32 s36, s36, 0x1fffff
    buffer_load_dwordx4 v3, s[8:11], s36 offen lds
    v_exp_f32 v125, v125
    v_exp_f32 v126, v126
    v_cvt_pk_bf16_f32 v138, v124, v125
    v_exp_f32 v127, v127
    v_mfma_f32_16x16x32_bf16 v[164:167], v[226:229], v[140:143], v[164:167]
    v_cvt_pk_bf16_f32 v139, v126, v127
    s_waitcnt lgkmcnt(0)
    v_mfma_f32_16x16x32_bf16 v[120:123], v[72:75], v[40:43], v[236:239]
    s_add_u32 m0, s85, 114688
    s_add_u32 s36, s86, 1835008
    s_and_b32 s36, s36, 0x1fffff
    buffer_load_dwordx4 v3, s[8:11], s36 offen lds
    v_exp_f32 v128, v128
    v_exp_f32 v129, v129
    v_mfma_f32_16x16x32_bf16 v[124:127], v[80:83], v[40:43], 0
    v_exp_f32 v130, v130
    v_cvt_pk_bf16_f32 v140, v128, v129
    v_mfma_f32_16x16x32_bf16 v[144:147], v[96:99], v[136:139], v[144:147]
    v_exp_f32 v131, v131
    v_exp_f32 v132, v132
    v_cvt_pk_bf16_f32 v141, v130, v131
    v_mfma_f32_16x16x32_bf16 v[148:151], v[112:115], v[136:139], v[148:151]
    ds_read_b128 v[100:103], v244 offset:34816
    v_exp_f32 v133, v133
    v_exp_f32 v134, v134
    v_cvt_pk_bf16_f32 v142, v132, v133
    v_exp_f32 v135, v135
    v_mfma_f32_16x16x32_bf16 v[160:163], v[226:229], v[136:139], v[160:163]
    ds_read_b128 v[116:119], v244 offset:35840
    v_cvt_pk_bf16_f32 v143, v134, v135
    v_mfma_f32_16x16x32_bf16 v[132:135], v[80:83], v[48:51], v[236:239]
    v_exp_f32 v120, v120
    v_exp_f32 v121, v121
    v_mfma_f32_16x16x32_bf16 v[152:155], v[96:99], v[140:143], v[152:155]
    v_exp_f32 v122, v122
    v_cvt_pk_bf16_f32 v136, v120, v121
    v_mfma_f32_16x16x32_bf16 v[156:159], v[112:115], v[140:143], v[156:159]
    s_add_u32 m0, s85, 118784
    s_add_u32 s36, s86, 1900544
    s_and_b32 s36, s36, 0x1fffff
    buffer_load_dwordx4 v3, s[8:11], s36 offen lds
    v_exp_f32 v123, v123
    v_exp_f32 v124, v124
    v_cvt_pk_bf16_f32 v137, v122, v123
    v_mfma_f32_16x16x32_bf16 v[164:167], v[226:229], v[140:143], v[164:167]
    v_exp_f32 v125, v125
    v_exp_f32 v126, v126
    v_cvt_pk_bf16_f32 v138, v124, v125
    v_exp_f32 v127, v127
    s_nop 0
    v_cvt_pk_bf16_f32 v139, v126, v127
    s_cmp_eq_u32 s20, 1
    s_cbranch_scc0 Lw_106
    v_mov_b32 v226, 0
    v_mov_b32 v227, 0
    v_mov_b32 v228, 0
    v_mov_b32 v229, 0
Lw_106:
    s_waitcnt lgkmcnt(0)
    v_mfma_f32_16x16x32_bf16 v[144:147], v[100:103], v[136:139], v[144:147]
    v_exp_f32 v132, v132
    v_mfma_f32_16x16x32_bf16 v[148:151], v[116:119], v[136:139], v[148:151]
    v_exp_f32 v133, v133
    v_mov_b32 v141, 0
    v_mfma_f32_16x16x32_bf16 v[160:163], v[226:229], v[136:139], v[160:163]
    v_exp_f32 v134, v134
    v_cvt_pk_bf16_f32 v142, v132, v133
    v_exp_f32 v135, v135
    v_mov_b32 v140, 0
    v_cvt_pk_bf16_f32 v143, v134, v135
    s_branch L_afin
L_afin:
    s_nop 0
    v_mfma_f32_16x16x32_bf16 v[152:155], v[100:103], v[140:143], v[152:155]
    v_mfma_f32_16x16x32_bf16 v[156:159], v[116:119], v[140:143], v[156:159]
    v_mfma_f32_16x16x32_bf16 v[164:167], v[226:229], v[140:143], v[164:167]
    v_rcp_f32 v245, v160
    s_nop 0
    v_mul_f32 v144, v144, v245
    v_mul_f32 v145, v145, v245
    v_mul_f32 v146, v146, v245
    v_mul_f32 v147, v147, v245
    v_mul_f32 v148, v148, v245
    v_mul_f32 v149, v149, v245
    v_mul_f32 v150, v150, v245
    v_mul_f32 v151, v151, v245
    v_add_u32 v247, 0x10000, v144
    v_cvt_pk_bf16_f32 v144, v144, v145
    v_cvt_pk_bf16_f32 v145, v146, v147
    v_and_b32_sdwa v144, v247, -2 dst_sel:WORD_0 dst_unused:UNUSED_PRESERVE src0_sel:WORD_1 src1_sel:DWORD
    v_cvt_pk_bf16_f32 v146, v148, v149
    v_cvt_pk_bf16_f32 v147, v150, v151
    s_nop 1
    v_mfma_f32_16x16x32_bf16 v[120:123], v[226:229], v[144:147], 0
    v_rcp_f32 v246, v164
    s_nop 0
    v_mul_f32 v152, v152, v246
    v_mul_f32 v153, v153, v246
    v_mul_f32 v154, v154, v246
    v_mul_f32 v155, v155, v246
    v_mul_f32 v156, v156, v246
    v_mul_f32 v157, v157, v246
    v_mul_f32 v158, v158, v246
    v_mul_f32 v159, v159, v246
    v_add_u32 v247, 0x10000, v152
    v_cvt_pk_bf16_f32 v152, v152, v153
    v_cvt_pk_bf16_f32 v153, v154, v155
    v_and_b32_sdwa v152, v247, -2 dst_sel:WORD_0 dst_unused:UNUSED_PRESERVE src0_sel:WORD_1 src1_sel:DWORD
    v_cvt_pk_bf16_f32 v154, v156, v157
    v_cvt_pk_bf16_f32 v155, v158, v159
    s_nop 1
    v_mfma_f32_16x16x32_bf16 v[120:123], v[226:229], v[152:155], v[120:123]
    v_max_f32 v245, v160, v164
    v_min_f32 v246, v160, v164
    v_cmp_nge_f32 vcc, 0x5d800000, v245
    s_nop 0
    s_mov_b64 s[28:29], vcc
    v_cmp_nle_f32 vcc, 0x21800000, v246
    s_nop 0
    s_or_b64 s[28:29], vcc, s[28:29]
    v_mov_b32 v245, 0x207
    v_cmp_class_f32 vcc, v120, v245
    s_nop 0
    s_or_b64 vcc, vcc, s[28:29]
    s_cbranch_vccnz L_exact
L_ostore:
    s_waitcnt vmcnt(0)
    s_cmp_eq_u32 s23, 0
    s_cbranch_scc1 Lslow_107
    buffer_store_dwordx4 v[144:147], v0, s[12:15], s72 offen offset:0
    buffer_store_dwordx4 v[152:155], v0, s[12:15], s72 offen offset:1024
Lback_108:
    s_setprio 0
    s_add_u32 s33, s33, 65536
    s_barrier
    s_cmp_lt_u32 s3, 4
    s_cbranch_scc1 L_g2
    s_cmp_eq_u32 s22, 0
    s_cbranch_scc1 L_between0
    s_branch L_between2
L_tailB:
    s_and_b32 s27, s22, 2
    s_waitcnt lgkmcnt(8)
    v_pk_mul_f32 v[184:185], v[214:215], v[212:213] op_sel:[0,1] op_sel_hi:[1,1]
    v_pk_fma_f32 v[184:185], v[80:81], v[212:213], v[184:185] op_sel_hi:[1,0,1]
    v_cvt_pk_bf16_f32 v80, v184, v185
    v_pk_mul_f32 v[186:187], v[216:217], v[212:213] op_sel:[0,1] op_sel_hi:[1,1]
    v_pk_fma_f32 v[186:187], v[82:83], v[212:213], v[186:187] op_sel_hi:[1,0,1]
    v_cvt_pk_bf16_f32 v81, v186, v187
    v_pk_mul_f32 v[188:189], v[218:219], v[212:213] op_sel:[0,1] op_sel_hi:[1,1]
    v_pk_fma_f32 v[188:189], v[84:85], v[212:213], v[188:189] op_sel_hi:[1,0,1]
    v_cvt_pk_bf16_f32 v82, v188, v189
    v_pk_mul_f32 v[190:191], v[220:221], v[212:213] op_sel:[0,1] op_sel_hi:[1,1]
    v_pk_fma_f32 v[190:191], v[86:87], v[212:213], v[190:191] op_sel_hi:[1,0,1]
    v_cvt_pk_bf16_f32 v83, v190, v191
    s_and_b32 s28, s3, 1
    s_add_u32 s27, s27, s28
    s_lshl_b32 s27, s27, 11
    s_add_u32 s27, s27, 131072
    v_pk_mul_f32 v[186:187], v[238:239], v[230:231] op_sel:[0,0] op_sel_hi:[1,0]
    v_pk_fma_f32 v[186:187], v[102:103], v[234:235], v[186:187]
    v_cvt_pk_bf16_f32 v103, v186, v187
    v_pk_mul_f32 v[184:185], v[236:237], v[230:231] op_sel:[0,0] op_sel_hi:[1,0]
    v_pk_fma_f32 v[184:185], v[100:101], v[232:233], v[184:185]
    v_cvt_pk_bf16_f32 v102, v184, v185
    v_pk_mul_f32 v[190:191], v[238:239], v[230:231] op_sel:[0,1] op_sel_hi:[1,1]
    v_pk_fma_f32 v[190:191], v[118:119], v[234:235], v[190:191]
    v_cvt_pk_bf16_f32 v119, v190, v191
    v_pk_mul_f32 v[188:189], v[236:237], v[230:231] op_sel:[0,1] op_sel_hi:[1,1]
    v_pk_fma_f32 v[188:189], v[116:117], v[232:233], v[188:189]
    v_cvt_pk_bf16_f32 v118, v188, v189
    v_min_u32 v80, -2, v80
    v_min_u32 v232, -2, v102
    v_mov_b32 v233, v103
    v_mov_b32 v234, v118
    v_mov_b32 v235, v119
    s_lshl_b32 s28, s28, 11
    s_add_u32 s28, s28, 133120
    v_add_u32 v253, s28, v0
    s_cmp_ge_u32 s3, 2
    s_cbranch_scc1 Lup_109
    ds_write_b128 v253, v[80:83]
    ds_write_b128 v253, v[232:235] offset:1024
    s_add_u32 s74, s27, s87
    s_cmp_eq_u32 s20, 0
    s_cselect_b32 s29, 4048155338, 0
    s_branch Lon_110
Lup_109:
    s_add_u32 s27, s27, s73
    buffer_store_dwordx4 v[80:83], v0, s[12:15], s27 offen sc1
    buffer_store_dwordx4 v[232:235], v0, s[12:15], s27 offen offset:1024 sc1
    s_mov_b32 s29, 0
Lon_110:
    v_pk_mul_f32 v[186:187], v[246:247], v[230:231] op_sel:[0,0] op_sel_hi:[1,0]
    v_pk_fma_f32 v[186:187], v[98:99], v[242:243], v[186:187]
    v_cvt_pk_bf16_f32 v101, v186, v187
    v_pk_mul_f32 v[184:185], v[244:245], v[230:231] op_sel:[0,0] op_sel_hi:[1,0]
    v_pk_fma_f32 v[184:185], v[96:97], v[240:241], v[184:185]
    v_cvt_pk_bf16_f32 v100, v184, v185
    v_pk_mul_f32 v[190:191], v[246:247], v[230:231] op_sel:[0,1] op_sel_hi:[1,1]
    v_pk_fma_f32 v[190:191], v[114:115], v[242:243], v[190:191]
    v_cvt_pk_bf16_f32 v117, v190, v191
    v_pk_mul_f32 v[188:189], v[244:245], v[230:231] op_sel:[0,1] op_sel_hi:[1,1]
    v_pk_fma_f32 v[188:189], v[112:113], v[240:241], v[188:189]
    v_cvt_pk_bf16_f32 v116, v188, v189
    v_pk_mul_f32 v[184:185], v[214:215], v[210:211] op_sel:[0,1] op_sel_hi:[1,1]
    v_pk_fma_f32 v[184:185], v[72:73], v[210:211], v[184:185] op_sel_hi:[1,0,1]
    v_cvt_pk_bf16_f32 v72, v184, v185
    v_pk_mul_f32 v[186:187], v[216:217], v[210:211] op_sel:[0,1] op_sel_hi:[1,1]
    v_pk_fma_f32 v[186:187], v[74:75], v[210:211], v[186:187] op_sel_hi:[1,0,1]
    v_cvt_pk_bf16_f32 v73, v186, v187
    v_pk_mul_f32 v[188:189], v[218:219], v[210:211] op_sel:[0,1] op_sel_hi:[1,1]
    v_pk_fma_f32 v[188:189], v[76:77], v[210:211], v[188:189] op_sel_hi:[1,0,1]
    v_cvt_pk_bf16_f32 v74, v188, v189
    v_pk_mul_f32 v[190:191], v[220:221], v[210:211] op_sel:[0,1] op_sel_hi:[1,1]
    v_pk_fma_f32 v[190:191], v[78:79], v[210:211], v[190:191] op_sel_hi:[1,0,1]
    v_cvt_pk_bf16_f32 v75, v190, v191
    s_waitcnt lgkmcnt(0)
    v_pk_mul_f32 v[184:185], v[214:215], v[208:209] op_sel:[0,1] op_sel_hi:[1,1]
    v_pk_fma_f32 v[184:185], v[64:65], v[208:209], v[184:185] op_sel_hi:[1,0,1]
    v_cvt_pk_bf16_f32 v64, v184, v185
    v_pk_mul_f32 v[186:187], v[216:217], v[208:209] op_sel:[0,1] op_sel_hi:[1,1]
    v_pk_fma_f32 v[186:187], v[66:67], v[208:209], v[186:187] op_sel_hi:[1,0,1]
    v_cvt_pk_bf16_f32 v65, v186, v187
    v_pk_mul_f32 v[188:189], v[218:219], v[208:209] op_sel:[0,1] op_sel_hi:[1,1]
    v_pk_fma_f32 v[188:189], v[68:69], v[208:209], v[188:189] op_sel_hi:[1,0,1]
    v_cvt_pk_bf16_f32 v66, v188, v189
    v_pk_mul_f32 v[190:191], v[220:221], v[208:209] op_sel:[0,1] op_sel_hi:[1,1]
    v_pk_fma_f32 v[190:191], v[70:71], v[208:209], v[190:191] op_sel_hi:[1,0,1]
    v_cvt_pk_bf16_f32 v67, v190, v191
    v_pk_mul_f32 v[186:187], v[150:151], v[230:231] op_sel:[0,0] op_sel_hi:[1,0]
    v_pk_fma_f32 v[186:187], v[94:95], v[146:147], v[186:187]
    v_cvt_pk_bf16_f32 v99, v186, v187
    v_pk_mul_f32 v[184:185], v[148:149], v[230:231] op_sel:[0,0] op_sel_hi:[1,0]
    v_pk_fma_f32 v[184:185], v[92:93], v[144:145], v[184:185]
    v_cvt_pk_bf16_f32 v98, v184, v185
    v_pk_mul_f32 v[190:191], v[150:151], v[230:231] op_sel:[0,1] op_sel_hi:[1,1]
    v_pk_fma_f32 v[190:191], v[110:111], v[146:147], v[190:191]
    v_cvt_pk_bf16_f32 v115, v190, v191
    v_pk_mul_f32 v[188:189], v[148:149], v[230:231] op_sel:[0,1] op_sel_hi:[1,1]
    v_pk_fma_f32 v[188:189], v[108:109], v[144:145], v[188:189]
    v_cvt_pk_bf16_f32 v114, v188, v189
    v_pk_mul_f32 v[184:185], v[214:215], v[206:207] op_sel:[0,1] op_sel_hi:[1,1]
    v_pk_fma_f32 v[184:185], v[56:57], v[206:207], v[184:185] op_sel_hi:[1,0,1]
    v_cvt_pk_bf16_f32 v56, v184, v185
    v_pk_mul_f32 v[186:187], v[216:217], v[206:207] op_sel:[0,1] op_sel_hi:[1,1]
    v_pk_fma_f32 v[186:187], v[58:59], v[206:207], v[186:187] op_sel_hi:[1,0,1]
    v_cvt_pk_bf16_f32 v57, v186, v187
    v_pk_mul_f32 v[188:189], v[218:219], v[206:207] op_sel:[0,1] op_sel_hi:[1,1]
    v_pk_fma_f32 v[188:189], v[60:61], v[206:207], v[188:189] op_sel_hi:[1,0,1]
    v_cvt_pk_bf16_f32 v58, v188, v189
    v_pk_mul_f32 v[190:191], v[220:221], v[206:207] op_sel:[0,1] op_sel_hi:[1,1]
    v_pk_fma_f32 v[190:191], v[62:63], v[206:207], v[190:191] op_sel_hi:[1,0,1]
    v_cvt_pk_bf16_f32 v59, v190, v191
    v_pk_mul_f32 v[186:187], v[158:159], v[230:231] op_sel:[0,0] op_sel_hi:[1,0]
    v_pk_fma_f32 v[186:187], v[90:91], v[154:155], v[186:187]
    v_cvt_pk_bf16_f32 v97, v186, v187
    v_pk_mul_f32 v[184:185], v[156:157], v[230:231] op_sel:[0,0] op_sel_hi:[1,0]
    v_pk_fma_f32 v[184:185], v[88:89], v[152:153], v[184:185]
    v_cvt_pk_bf16_f32 v96, v184, v185
    v_pk_mul_f32 v[190:191], v[158:159], v[230:231] op_sel:[0,1] op_sel_hi:[1,1]
    v_pk_fma_f32 v[190:191], v[106:107], v[154:155], v[190:191]
    v_cvt_pk_bf16_f32 v113, v190, v191
    v_pk_mul_f32 v[188:189], v[156:157], v[230:231] op_sel:[0,1] op_sel_hi:[1,1]
    v_pk_fma_f32 v[188:189], v[104:105], v[152:153], v[188:189]
    v_cvt_pk_bf16_f32 v112, v188, v189
    v_mfma_f32_16x16x32_bf16 v[24:27], v[136:139], v[120:123], v[24:27]
    s_mov_b32 s35, 1048744942
    v_mul_f32 v206, s35, v206
    v_mfma_f32_16x16x32_bf16 v[32:35], v[136:139], v[124:127], v[32:35]
    v_mul_f32 v207, s35, v207
    v_mul_f32 v208, s35, v208
    v_mfma_f32_16x16x32_bf16 v[40:43], v[136:139], v[128:131], v[40:43]
    v_mul_f32 v209, s35, v209
    v_mul_f32 v210, s35, v210
    v_mfma_f32_16x16x32_bf16 v[48:51], v[136:139], v[132:135], v[48:51]
    v_mul_f32 v211, s35, v211
    v_mul_f32 v212, s35, v212
    v_mfma_f32_16x16x32_bf16 v[52:55], v[140:143], v[132:135], v[52:55]
    v_mul_f32 v213, s35, v213
    v_mov_b32 v236, s29
    v_mfma_f32_16x16x32_bf16 v[44:47], v[140:143], v[128:131], v[44:47]
    v_mov_b32 v237, s29
    v_mov_b32 v238, s29
    v_mfma_f32_16x16x32_bf16 v[36:39], v[140:143], v[124:127], v[36:39]
    v_mov_b32 v239, s29
    v_mov_b32 v234, 0xffff
    v_mfma_f32_16x16x32_bf16 v[28:31], v[140:143], v[120:123], v[28:31]
    v_mov_b32 v235, 0xffff0000
    v_cndmask_b32 v235, v234, v235, s[92:93]
    v_mfma_f32_16x16x32_bf16 v[24:27], v[176:179], v[160:163], v[24:27]
    v_cndmask_b32 v232, 0, v235, s[96:97]
    v_cndmask_b32 v233, 0, v235, s[98:99]
    v_mfma_f32_16x16x32_bf16 v[32:35], v[176:179], v[164:167], v[32:35]
    v_xor_b32 v234, v232, v235
    v_xor_b32 v235, v233, v235
    v_mfma_f32_16x16x32_bf16 v[40:43], v[176:179], v[168:171], v[40:43]
    s_sub_u32 s28, s72, 65536
    v_mfma_f32_16x16x32_bf16 v[48:51], v[176:179], v[172:175], v[48:51]
    v_mfma_f32_16x16x32_bf16 v[52:55], v[180:183], v[172:175], v[52:55]
    v_mfma_f32_16x16x32_bf16 v[44:47], v[180:183], v[168:171], v[44:47]
    v_mfma_f32_16x16x32_bf16 v[36:39], v[180:183], v[164:167], v[36:39]
    s_barrier
    v_mfma_f32_16x16x32_bf16 v[28:31], v[180:183], v[160:163], v[28:31]
    s_cmp_ge_u32 s3, 2
    s_cbranch_scc1 Lup_111
    buffer_load_dwordx4 v[244:247], v0, s[12:15], s74 offen sc1
    buffer_load_dwordx4 v[240:243], v0, s[12:15], s74 offen offset:1024 sc1
    s_branch Lon_112
Lup_111:
    ds_read_b128 v[244:247], v253
    ds_read_b128 v[240:243], v253 offset:1024
Lon_112:
    v_pk_mul_f32 v[184:185], v[192:193], v[212:213] op_sel:[0,1] op_sel_hi:[1,1]
    v_pk_fma_f32 v[184:185], v[48:49], v[212:213], v[184:185] op_sel_hi:[1,0,1]
    v_cvt_pk_bf16_f32 v48, v184, v185
    v_pk_mul_f32 v[186:187], v[194:195], v[212:213] op_sel:[0,1] op_sel_hi:[1,1]
    v_pk_fma_f32 v[186:187], v[50:51], v[212:213], v[186:187] op_sel_hi:[1,0,1]
    v_cvt_pk_bf16_f32 v49, v186, v187
    v_pk_mul_f32 v[188:189], v[196:197], v[212:213] op_sel:[0,1] op_sel_hi:[1,1]
    v_pk_fma_f32 v[188:189], v[52:53], v[212:213], v[188:189] op_sel_hi:[1,0,1]
    v_cvt_pk_bf16_f32 v50, v188, v189
    v_pk_mul_f32 v[190:191], v[198:199], v[212:213] op_sel:[0,1] op_sel_hi:[1,1]
    v_pk_fma_f32 v[190:191], v[54:55], v[212:213], v[190:191] op_sel_hi:[1,0,1]
    v_cvt_pk_bf16_f32 v51, v190, v191
    v_pk_mul_f32 v[184:185], v[192:193], v[210:211] op_sel:[0,1] op_sel_hi:[1,1]
    v_pk_fma_f32 v[184:185], v[40:41], v[210:211], v[184:185] op_sel_hi:[1,0,1]
    v_cvt_pk_bf16_f32 v40, v184, v185
    v_pk_mul_f32 v[186:187], v[194:195], v[210:211] op_sel:[0,1] op_sel_hi:[1,1]
    v_pk_fma_f32 v[186:187], v[42:43], v[210:211], v[186:187] op_sel_hi:[1,0,1]
    v_cvt_pk_bf16_f32 v41, v186, v187
    v_pk_mul_f32 v[188:189], v[196:197], v[210:211] op_sel:[0,1] op_sel_hi:[1,1]
    v_pk_fma_f32 v[188:189], v[44:45], v[210:211], v[188:189] op_sel_hi:[1,0,1]
    v_cvt_pk_bf16_f32 v42, v188, v189
    v_pk_mul_f32 v[190:191], v[198:199], v[210:211] op_sel:[0,1] op_sel_hi:[1,1]
    v_pk_fma_f32 v[190:191], v[46:47], v[210:211], v[190:191] op_sel_hi:[1,0,1]
    v_cvt_pk_bf16_f32 v43, v190, v191
    v_pk_mul_f32 v[184:185], v[192:193], v[208:209] op_sel:[0,1] op_sel_hi:[1,1]
    v_pk_fma_f32 v[184:185], v[32:33], v[208:209], v[184:185] op_sel_hi:[1,0,1]
    v_cvt_pk_bf16_f32 v32, v184, v185
    v_pk_mul_f32 v[186:187], v[194:195], v[208:209] op_sel:[0,1] op_sel_hi:[1,1]
    v_pk_fma_f32 v[186:187], v[34:35], v[208:209], v[186:187] op_sel_hi:[1,0,1]
    v_cvt_pk_bf16_f32 v33, v186, v187
    v_pk_mul_f32 v[188:189], v[196:197], v[208:209] op_sel:[0,1] op_sel_hi:[1,1]
    v_pk_fma_f32 v[188:189], v[36:37], v[208:209], v[188:189] op_sel_hi:[1,0,1]
    v_cvt_pk_bf16_f32 v34, v188, v189
    v_pk_mul_f32 v[190:191], v[198:199], v[208:209] op_sel:[0,1] op_sel_hi:[1,1]
    v_pk_fma_f32 v[190:191], v[38:39], v[208:209], v[190:191] op_sel_hi:[1,0,1]
    v_cvt_pk_bf16_f32 v35, v190, v191
    v_pk_mul_f32 v[184:185], v[192:193], v[206:207] op_sel:[0,1] op_sel_hi:[1,1]
    v_pk_fma_f32 v[184:185], v[24:25], v[206:207], v[184:185] op_sel_hi:[1,0,1]
    v_cvt_pk_bf16_f32 v24, v184, v185
    v_pk_mul_f32 v[186:187], v[194:195], v[206:207] op_sel:[0,1] op_sel_hi:[1,1]
    v_pk_fma_f32 v[186:187], v[26:27], v[206:207], v[186:187] op_sel_hi:[1,0,1]
    v_cvt_pk_bf16_f32 v25, v186, v187
    v_pk_mul_f32 v[188:189], v[196:197], v[206:207] op_sel:[0,1] op_sel_hi:[1,1]
    v_pk_fma_f32 v[188:189], v[28:29], v[206:207], v[188:189] op_sel_hi:[1,0,1]
    v_cvt_pk_bf16_f32 v26, v188, v189
    v_pk_mul_f32 v[190:191], v[198:199], v[206:207] op_sel:[0,1] op_sel_hi:[1,1]
    v_pk_fma_f32 v[190:191], v[30:31], v[206:207], v[190:191] op_sel_hi:[1,0,1]
    v_cvt_pk_bf16_f32 v27, v190, v191
    v_mfma_f32_16x16x32_bf16 v[168:171], v[80:83], v[48:51], 0
    v_mfma_f32_16x16x32_bf16 v[172:175], v[72:75], v[48:51], 0
    v_mfma_f32_16x16x32_bf16 v[152:155], v[72:75], v[40:43], 0
    v_mfma_f32_16x16x32_bf16 v[156:159], v[64:67], v[40:43], 0
    v_mfma_f32_16x16x32_bf16 v[136:139], v[64:67], v[32:35], 0
    v_mfma_f32_16x16x32_bf16 v[140:143], v[56:59], v[32:35], 0
    s_nop 2
    v_cndmask_b32 v168, v168, v169, s[92:93]
    s_nop 0
    v_cndmask_b32 v152, v152, v153, s[92:93]
    s_nop 0
    v_cndmask_b32 v136, v136, v137, s[92:93]
    v_cndmask_b32 v170, v170, v171, s[92:93]
    v_cndmask_b32 v154, v154, v155, s[92:93]
    v_cndmask_b32 v138, v138, v139, s[92:93]
    v_cndmask_b32 v172, v172, v173, s[92:93]
    v_cndmask_b32 v156, v156, v157, s[92:93]
    v_cndmask_b32 v140, v140, v141, s[92:93]
    v_cndmask_b32 v174, v174, v175, s[92:93]
    v_cndmask_b32 v158, v158, v159, s[92:93]
    v_cndmask_b32 v142, v142, v143, s[92:93]
    v_cndmask_b32 v176, v168, v172, s[96:97]
    v_cndmask_b32 v160, v152, v156, s[96:97]
    v_cndmask_b32 v144, v136, v140, s[96:97]
    v_cndmask_b32 v177, v170, v174, s[98:99]
    v_cndmask_b32 v161, v154, v158, s[98:99]
    v_cndmask_b32 v145, v138, v142, s[98:99]
    v_max_f32 v178, v176, v177
    v_max_f32 v162, v160, v161
    v_max_f32 v146, v144, v145
    v_mov_b32 v179, v178
    v_mov_b32 v163, v162
    v_mov_b32 v147, v146
    v_permlane32_swap_b32 v178, v179
    v_permlane32_swap_b32 v162, v163
    v_permlane32_swap_b32 v146, v147
    v_max_f32 v178, v178, v179
    v_max_f32 v162, v162, v163
    v_max_f32 v146, v146, v147
    v_mov_b32 v179, v178
    v_mov_b32 v163, v162
    v_mov_b32 v147, v146
    v_permlane16_swap_b32 v178, v179
    v_permlane16_swap_b32 v162, v163
    v_permlane16_swap_b32 v146, v147
    v_max_f32 v178, v178, v179
    v_max_f32 v162, v162, v163
    v_max_f32 v146, v146, v147
    v_sub_f32 v176, v176, v178
    v_sub_f32 v160, v160, v162
    v_sub_f32 v144, v144, v146
    v_sub_f32 v177, v177, v178
    v_sub_f32 v161, v161, v162
    v_sub_f32 v145, v145, v146
    v_exp_f32 v176, v176
    v_exp_f32 v160, v160
    v_exp_f32 v144, v144
    v_exp_f32 v177, v177
    v_exp_f32 v161, v161
    v_exp_f32 v145, v145
    v_cvt_pk_bf16_f32 v176, v176, v176
    v_cvt_pk_bf16_f32 v160, v160, v160
    v_cvt_pk_bf16_f32 v144, v144, v144
    v_cvt_pk_bf16_f32 v177, v177, v177
    v_cvt_pk_bf16_f32 v161, v161, v161
    v_cvt_pk_bf16_f32 v145, v145, v145
    v_and_b32 v168, v232, v176
    v_and_b32 v152, v232, v160
    v_and_b32 v136, v232, v144
    v_and_b32 v169, v233, v177
    v_and_b32 v153, v233, v161
    v_and_b32 v137, v233, v145
    v_and_b32 v170, v234, v176
    v_and_b32 v154, v234, v160
    v_and_b32 v138, v234, v144
    v_and_b32 v171, v235, v177
    v_and_b32 v155, v235, v161
    v_and_b32 v139, v235, v145
    v_mfma_f32_16x16x32_bf16 v[172:175], v[226:229], v[168:171], 0
    v_mfma_f32_16x16x32_bf16 v[176:179], v[100:103], v[168:171], 0
    v_mfma_f32_16x16x32_bf16 v[180:183], v[116:119], v[168:171], 0
    v_mfma_f32_16x16x32_bf16 v[156:159], v[226:229], v[152:155], 0
    v_mfma_f32_16x16x32_bf16 v[160:163], v[98:101], v[152:155], 0
    v_mfma_f32_16x16x32_bf16 v[164:167], v[114:117], v[152:155], 0
    v_mfma_f32_16x16x32_bf16 v[140:143], v[226:229], v[136:139], 0
    v_mfma_f32_16x16x32_bf16 v[144:147], v[96:99], v[136:139], 0
    v_mfma_f32_16x16x32_bf16 v[148:151], v[112:115], v[136:139], 0
    v_rcp_f32 v172, v172
    s_nop 1
    v_rcp_f32 v156, v156
    s_nop 1
    v_rcp_f32 v140, v140
    v_mul_f32 v176, v176, v172
    v_mul_f32 v160, v160, v156
    v_mul_f32 v144, v144, v140
    v_mul_f32 v177, v177, v172
    v_mul_f32 v161, v161, v156
    v_mul_f32 v145, v145, v140
    v_mul_f32 v178, v178, v172
    v_mul_f32 v162, v162, v156
    v_mul_f32 v146, v146, v140
    v_mul_f32 v179, v179, v172
    v_mul_f32 v163, v163, v156
    v_mul_f32 v147, v147, v140
    v_mul_f32 v180, v180, v172
    v_mul_f32 v164, v164, v156
    v_mul_f32 v148, v148, v140
    v_mul_f32 v181, v181, v172
    v_mul_f32 v165, v165, v156
    v_mul_f32 v149, v149, v140
    v_mul_f32 v182, v182, v172
    v_mul_f32 v166, v166, v156
    v_mul_f32 v150, v150, v140
    v_mul_f32 v183, v183, v172
    v_mul_f32 v167, v167, v156
    v_mul_f32 v151, v151, v140
    v_cvt_pk_bf16_f32 v168, v176, v177
    v_cvt_pk_bf16_f32 v152, v160, v161
    v_cvt_pk_bf16_f32 v136, v144, v145
    v_cvt_pk_bf16_f32 v169, v178, v179
    v_cvt_pk_bf16_f32 v153, v162, v163
    v_cvt_pk_bf16_f32 v137, v146, v147
    v_or_b32_sdwa v168, v176, 1 dst_sel:WORD_0 dst_unused:UNUSED_PRESERVE src0_sel:WORD_1 src1_sel:DWORD
    v_or_b32_sdwa v152, v160, 1 dst_sel:WORD_0 dst_unused:UNUSED_PRESERVE src0_sel:WORD_1 src1_sel:DWORD
    v_or_b32_sdwa v136, v144, 1 dst_sel:WORD_0 dst_unused:UNUSED_PRESERVE src0_sel:WORD_1 src1_sel:DWORD
    v_cvt_pk_bf16_f32 v170, v180, v181
    v_cvt_pk_bf16_f32 v154, v164, v165
    v_cvt_pk_bf16_f32 v138, v148, v149
    v_cvt_pk_bf16_f32 v171, v182, v183
    v_cvt_pk_bf16_f32 v155, v166, v167
    v_cvt_pk_bf16_f32 v139, v150, v151
    s_cmp_eq_u32 s23, 0
    s_cbranch_scc1 Lslow_113
    buffer_store_dwordx4 v[168:171], v0, s[12:15], s72 offen offset:1024
    buffer_store_dwordx4 v[152:155], v0, s[12:15], s72 offen offset:0
    buffer_store_dwordx4 v[136:139], v0, s[12:15], s28 offen offset:1024
Lback_114:
    s_mov_b32 s26, 0
    s_waitcnt vmcnt(3) lgkmcnt(0)
Lhck_115:
    v_max_u32 v120, v244, v240
    v_cmp_eq_u32 vcc, -1, v120
    s_nop 0
    s_cbranch_vccnz Lhrt_117
Lhok_116:
    v_mfma_f32_16x16x32_bf16 v[120:123], v[56:59], v[24:27], 0
    v_mfma_f32_16x16x32_bf16 v[124:127], v[244:247], v[24:27], v[236:239]
    v_mov_b32 v94, v240
    v_mov_b32 v95, v241
    v_mov_b32 v110, v242
    v_mov_b32 v111, v243
    s_nop 2
    v_cndmask_b32 v120, v120, v121, s[92:93]
    v_cndmask_b32 v122, v122, v123, s[92:93]
    v_cndmask_b32 v124, v124, v125, s[92:93]
    v_cndmask_b32 v126, v126, v127, s[92:93]
    v_cndmask_b32 v128, v120, v124, s[96:97]
    v_cndmask_b32 v129, v122, v126, s[98:99]
    v_max_f32 v130, v128, v129
    v_mov_b32 v131, v130
    s_nop 1
    v_permlane32_swap_b32 v130, v131
    v_max_f32 v130, v130, v131
    v_mov_b32 v131, v130
    s_nop 1
    v_permlane16_swap_b32 v130, v131
    v_max_f32 v130, v130, v131
    v_sub_f32 v128, v128, v130
    v_sub_f32 v129, v129, v130
    v_exp_f32 v128, v128
    v_exp_f32 v129, v129
    v_cvt_pk_bf16_f32 v128, v128, v128
    v_cvt_pk_bf16_f32 v129, v129, v129
    v_and_b32 v120, v232, v128
    v_and_b32 v121, v233, v129
    v_and_b32 v122, v234, v128
    v_and_b32 v123, v235, v129
    s_nop 1
    v_mfma_f32_16x16x32_bf16 v[124:127], v[226:229], v[120:123], 0
    v_mfma_f32_16x16x32_bf16 v[128:131], v[94:97], v[120:123], 0
    v_mfma_f32_16x16x32_bf16 v[132:135], v[110:113], v[120:123], 0
    s_nop 5
    v_rcp_f32 v124, v124
    s_nop 0
    v_mul_f32 v128, v128, v124
    v_mul_f32 v129, v129, v124
    v_mul_f32 v130, v130, v124
    v_mul_f32 v131, v131, v124
    v_mul_f32 v132, v132, v124
    v_mul_f32 v133, v133, v124
    v_mul_f32 v134, v134, v124
    v_mul_f32 v135, v135, v124
    v_cvt_pk_bf16_f32 v120, v128, v129
    v_cvt_pk_bf16_f32 v121, v130, v131
    v_or_b32_sdwa v120, v128, 1 dst_sel:WORD_0 dst_unused:UNUSED_PRESERVE src0_sel:WORD_1 src1_sel:DWORD
    v_cvt_pk_bf16_f32 v122, v132, v133
    v_cvt_pk_bf16_f32 v123, v134, v135
    s_cmp_eq_u32 s23, 0
    s_cbranch_scc1 Lslow_118
    buffer_store_dwordx4 v[120:123], v0, s[12:15], s28 offen offset:0
Lback_119:
L_g2:
    s_and_b32 s27, s71, 0xffff0000
    s_add_u32 s27, s27, 2097152
    v_add_u32 v214, s27, v0
    s_and_b32 s55, s71, 0xffff
    buffer_load_dwordx4 v[104:107], v214, s[12:15], s55 offen offset:0 sc1
    buffer_load_dwordx4 v[108:111], v214, s[12:15], s55 offen offset:1024 sc1
    buffer_load_dwordx4 v[112:115], v214, s[12:15], s55 offen offset:2048 sc1
    buffer_load_dwordx4 v[116:119], v214, s[12:15], s55 offen offset:3072 sc1
    v_lshrrev_b32 v207, 5, v1
    v_lshl_add_u32 v206, v207, 10, v2
    v_xor_b32 v207, 32, v206
    v_xor_b32 v208, 64, v206
    v_xor_b32 v209, 96, v206
    ds_read_b64_tr_b16 v[56:57], v206 offset:0
    ds_read_b64_tr_b16 v[58:59], v206 offset:2048
    ds_read_b64_tr_b16 v[60:61], v207 offset:0
    ds_read_b64_tr_b16 v[62:63], v207 offset:2048
    ds_read_b64_tr_b16 v[64:65], v208 offset:0
    ds_read_b64_tr_b16 v[66:67], v208 offset:2048
    ds_read_b64_tr_b16 v[68:69], v209 offset:0
    ds_read_b64_tr_b16 v[70:71], v209 offset:2048
    s_add_u32 s55, s55, 4096
    s_and_b32 s55, s55, 0xffff
    buffer_load_dwordx4 v[120:123], v214, s[12:15], s55 offen offset:0 sc1
    buffer_load_dwordx4 v[124:127], v214, s[12:15], s55 offen offset:1024 sc1
    buffer_load_dwordx4 v[128:131], v214, s[12:15], s55 offen offset:2048 sc1
    buffer_load_dwordx4 v[132:135], v214, s[12:15], s55 offen offset:3072 sc1
    ds_read_b64_tr_b16 v[72:73], v206 offset:4096
    ds_read_b64_tr_b16 v[74:75], v206 offset:6144
    ds_read_b64_tr_b16 v[76:77], v207 offset:4096
    ds_read_b64_tr_b16 v[78:79], v207 offset:6144
    ds_read_b64_tr_b16 v[80:81], v208 offset:4096
    ds_read_b64_tr_b16 v[82:83], v208 offset:6144
    ds_read_b64_tr_b16 v[84:85], v209 offset:4096
    ds_read_b64_tr_b16 v[86:87], v209 offset:6144
    v_lshlrev_b32 v24, 16, v8
    v_and_b32 v25, 0xffff0000, v8
    v_lshlrev_b32 v26, 16, v9
    v_and_b32 v27, 0xffff0000, v9
    v_lshlrev_b32 v28, 16, v10
    v_and_b32 v29, 0xffff0000, v10
    v_lshlrev_b32 v30, 16, v11
    v_and_b32 v31, 0xffff0000, v11
    v_lshlrev_b32 v32, 16, v12
    v_and_b32 v33, 0xffff0000, v12
    v_lshlrev_b32 v34, 16, v13
    v_and_b32 v35, 0xffff0000, v13
    v_lshlrev_b32 v36, 16, v14
    v_and_b32 v37, 0xffff0000, v14
    v_lshlrev_b32 v38, 16, v15
    v_and_b32 v39, 0xffff0000, v15
    v_lshlrev_b32 v40, 16, v16
    v_and_b32 v41, 0xffff0000, v16
    v_lshlrev_b32 v42, 16, v17
    v_and_b32 v43, 0xffff0000, v17
    v_lshlrev_b32 v44, 16, v18
    v_and_b32 v45, 0xffff0000, v18
    v_lshlrev_b32 v46, 16, v19
    v_and_b32 v47, 0xffff0000, v19
    v_lshlrev_b32 v48, 16, v20
    v_and_b32 v49, 0xffff0000, v20
    v_lshlrev_b32 v50, 16, v21
    v_and_b32 v51, 0xffff0000, v21
    v_lshlrev_b32 v52, 16, v22
    v_and_b32 v53, 0xffff0000, v22
    v_lshlrev_b32 v54, 16, v23
    v_and_b32 v55, 0xffff0000, v23
    v_add_u32 v210, 65536, v206
    v_add_u32 v211, 65536, v207
    v_add_u32 v212, 65536, v208
    v_add_u32 v213, 65536, v209
    v_mov_b32 v226, 0x3f803f80
    v_mov_b32 v227, 0x3f803f80
    v_mov_b32 v228, 0x3f803f80
    v_mov_b32 v229, 0x3f803f80
    s_lshr_b32 s27, s3, 1
    s_lshl_b32 s27, s27, 13
    s_add_u32 s27, s27, 49152
    v_add_u32 v200, s27, v0
    v_add_u32 v201, 1024, v200
    s_lshl_b32 s27, s3, 12
    s_add_u32 s27, s27, 49152
    v_add_u32 v240, s27, v0
    s_waitcnt vmcnt(4)
    v_bitop3_b32 v216, v104, v108, s22 bitop3:0x7e
    v_bitop3_b32 v217, v112, v116, s22 bitop3:0x7e
    v_bitop3_b32 v216, v216, v217, 1 bitop3:0xa8
    v_cmp_ne_u32 vcc, 0, v216
    s_waitcnt lgkmcnt(8)
    s_cbranch_vccnz Lock_120
Look_121:
    v_mfma_f32_16x16x32_bf16 v[24:27], v[56:59], v[104:107], v[24:27]
    ds_read_b64_tr_b16 v[88:89], v206 offset:8192
    s_add_u32 s55, s55, 4096
    s_and_b32 s55, s55, 0xffff
    buffer_load_dwordx4 v[136:139], v214, s[12:15], s55 offen offset:0 sc1
    v_mfma_f32_16x16x32_bf16 v[40:43], v[56:59], v[108:111], v[40:43]
    ds_read_b64_tr_b16 v[90:91], v206 offset:10240
    buffer_load_dwordx4 v[140:143], v214, s[12:15], s55 offen offset:1024 sc1
    v_mfma_f32_16x16x32_bf16 v[44:47], v[60:63], v[108:111], v[44:47]
    ds_read_b64_tr_b16 v[92:93], v207 offset:8192
    buffer_load_dwordx4 v[144:147], v214, s[12:15], s55 offen offset:2048 sc1
    v_mfma_f32_16x16x32_bf16 v[28:31], v[60:63], v[104:107], v[28:31]
    ds_read_b64_tr_b16 v[94:95], v207 offset:10240
    buffer_load_dwordx4 v[148:151], v214, s[12:15], s55 offen offset:3072 sc1
    v_mfma_f32_16x16x32_bf16 v[32:35], v[64:67], v[104:107], v[32:35]
    ds_read_b64_tr_b16 v[96:97], v208 offset:8192
    s_add_u32 s55, s55, 4096
    s_and_b32 s55, s55, 0xffff
    v_mfma_f32_16x16x32_bf16 v[48:51], v[64:67], v[108:111], v[48:51]
    ds_read_b64_tr_b16 v[98:99], v208 offset:10240
    buffer_load_dwordx4 v[152:155], v214, s[12:15], s55 offen offset:0 sc1
    v_mfma_f32_16x16x32_bf16 v[52:55], v[68:71], v[108:111], v[52:55]
    ds_read_b64_tr_b16 v[100:101], v209 offset:8192
    buffer_load_dwordx4 v[156:159], v214, s[12:15], s55 offen offset:1024 sc1
    v_mfma_f32_16x16x32_bf16 v[36:39], v[68:71], v[104:107], v[36:39]
    ds_read_b64_tr_b16 v[102:103], v209 offset:10240
    s_waitcnt lgkmcnt(8)
    buffer_load_dwordx4 v[160:163], v214, s[12:15], s55 offen offset:2048 sc1
    v_mfma_f32_16x16x32_bf16 v[24:27], v[72:75], v[112:115], v[24:27]
    ds_read_b64_tr_b16 v[56:57], v206 offset:12288
    buffer_load_dwordx4 v[164:167], v214, s[12:15], s55 offen offset:3072 sc1
    v_mfma_f32_16x16x32_bf16 v[40:43], v[72:75], v[116:119], v[40:43]
    ds_read_b64_tr_b16 v[58:59], v206 offset:14336
    s_waitcnt vmcnt(8)
    v_mfma_f32_16x16x32_bf16 v[44:47], v[76:79], v[116:119], v[44:47]
    ds_read_b64_tr_b16 v[60:61], v207 offset:12288
    v_bitop3_b32 v216, v120, v124, s22 bitop3:0x7e
    v_mfma_f32_16x16x32_bf16 v[28:31], v[76:79], v[112:115], v[28:31]
    ds_read_b64_tr_b16 v[62:63], v207 offset:14336
    v_bitop3_b32 v217, v128, v132, s22 bitop3:0x7e
    v_mfma_f32_16x16x32_bf16 v[32:35], v[80:83], v[112:115], v[32:35]
    ds_read_b64_tr_b16 v[64:65], v208 offset:12288
    v_bitop3_b32 v216, v216, v217, 1 bitop3:0xa8
    v_mfma_f32_16x16x32_bf16 v[48:51], v[80:83], v[116:119], v[48:51]
    ds_read_b64_tr_b16 v[66:67], v208 offset:14336
    v_cmp_ne_u32 vcc, 0, v216
    v_mfma_f32_16x16x32_bf16 v[52:55], v[84:87], v[116:119], v[52:55]
    ds_read_b64_tr_b16 v[68:69], v209 offset:12288
    v_mfma_f32_16x16x32_bf16 v[36:39], v[84:87], v[112:115], v[36:39]
    ds_read_b64_tr_b16 v[70:71], v209 offset:14336
    s_waitcnt lgkmcnt(8)
    s_cbranch_vccnz Lock_122
Look_123:
    v_mfma_f32_16x16x32_bf16 v[24:27], v[88:91], v[120:123], v[24:27]
    ds_read_b64_tr_b16 v[72:73], v206 offset:16384
    s_add_u32 s55, s55, 4096
    v_mfma_f32_16x16x32_bf16 v[40:43], v[88:91], v[124:127], v[40:43]
    ds_read_b64_tr_b16 v[74:75], v206 offset:18432
    s_and_b32 s55, s55, 0xffff
    v_mfma_f32_16x16x32_bf16 v[44:47], v[92:95], v[124:127], v[44:47]
    ds_read_b64_tr_b16 v[76:77], v207 offset:16384
    buffer_load_dwordx4 v[168:171], v214, s[12:15], s55 offen offset:0 sc1
    v_mfma_f32_16x16x32_bf16 v[28:31], v[92:95], v[120:123], v[28:31]
    ds_read_b64_tr_b16 v[78:79], v207 offset:18432
    v_mfma_f32_16x16x32_bf16 v[32:35], v[96:99], v[120:123], v[32:35]
    ds_read_b64_tr_b16 v[80:81], v208 offset:16384
    buffer_load_dwordx4 v[172:175], v214, s[12:15], s55 offen offset:1024 sc1
    v_mfma_f32_16x16x32_bf16 v[48:51], v[96:99], v[124:127], v[48:51]
    ds_read_b64_tr_b16 v[82:83], v208 offset:18432
    v_mfma_f32_16x16x32_bf16 v[52:55], v[100:103], v[124:127], v[52:55]
    ds_read_b64_tr_b16 v[84:85], v209 offset:16384
    buffer_load_dwordx4 v[176:179], v214, s[12:15], s55 offen offset:2048 sc1
    v_mfma_f32_16x16x32_bf16 v[36:39], v[100:103], v[120:123], v[36:39]
    ds_read_b64_tr_b16 v[86:87], v209 offset:18432
    s_waitcnt lgkmcnt(8)
    v_mfma_f32_16x16x32_bf16 v[24:27], v[56:59], v[128:131], v[24:27]
    ds_read_b64_tr_b16 v[88:89], v206 offset:20480
    buffer_load_dwordx4 v[180:183], v214, s[12:15], s55 offen offset:3072 sc1
    v_mfma_f32_16x16x32_bf16 v[40:43], v[56:59], v[132:135], v[40:43]
    ds_read_b64_tr_b16 v[90:91], v206 offset:22528
    s_waitcnt vmcnt(8)
    v_mfma_f32_16x16x32_bf16 v[44:47], v[60:63], v[132:135], v[44:47]
    ds_read_b64_tr_b16 v[92:93], v207 offset:20480
    v_bitop3_b32 v216, v136, v140, s22 bitop3:0x7e
    v_mfma_f32_16x16x32_bf16 v[28:31], v[60:63], v[128:131], v[28:31]
    ds_read_b64_tr_b16 v[94:95], v207 offset:22528
    v_bitop3_b32 v217, v144, v148, s22 bitop3:0x7e
    v_mfma_f32_16x16x32_bf16 v[32:35], v[64:67], v[128:131], v[32:35]
    ds_read_b64_tr_b16 v[96:97], v208 offset:20480
    v_bitop3_b32 v216, v216, v217, 1 bitop3:0xa8
    v_mfma_f32_16x16x32_bf16 v[48:51], v[64:67], v[132:135], v[48:51]
    ds_read_b64_tr_b16 v[98:99], v208 offset:22528
    v_cmp_ne_u32 vcc, 0, v216
    v_mfma_f32_16x16x32_bf16 v[52:55], v[68:71], v[132:135], v[52:55]
    ds_read_b64_tr_b16 v[100:101], v209 offset:20480
    v_mfma_f32_16x16x32_bf16 v[36:39], v[68:71], v[128:131], v[36:39]
    ds_read_b64_tr_b16 v[102:103], v209 offset:22528
    s_waitcnt lgkmcnt(8)
    s_cbranch_vccnz Lock_124
Look_125:
    v_mfma_f32_16x16x32_bf16 v[24:27], v[72:75], v[136:139], v[24:27]
    ds_read_b64_tr_b16 v[56:57], v206 offset:24576
    s_add_u32 s55, s55, 4096
    s_and_b32 s55, s55, 0xffff
    buffer_load_dwordx4 v[104:107], v214, s[12:15], s55 offen offset:0 sc1
    v_mfma_f32_16x16x32_bf16 v[40:43], v[72:75], v[140:143], v[40:43]
    ds_read_b64_tr_b16 v[58:59], v206 offset:26624
    buffer_load_dwordx4 v[108:111], v214, s[12:15], s55 offen offset:1024 sc1
    v_mfma_f32_16x16x32_bf16 v[44:47], v[76:79], v[140:143], v[44:47]
    ds_read_b64_tr_b16 v[60:61], v207 offset:24576
    buffer_load_dwordx4 v[112:115], v214, s[12:15], s55 offen offset:2048 sc1
    v_mfma_f32_16x16x32_bf16 v[28:31], v[76:79], v[136:139], v[28:31]
    ds_read_b64_tr_b16 v[62:63], v207 offset:26624
    buffer_load_dwordx4 v[116:119], v214, s[12:15], s55 offen offset:3072 sc1
    v_mfma_f32_16x16x32_bf16 v[32:35], v[80:83], v[136:139], v[32:35]
    ds_read_b64_tr_b16 v[64:65], v208 offset:24576
    s_add_u32 s55, s55, 4096
    s_and_b32 s55, s55, 0xffff
    v_mfma_f32_16x16x32_bf16 v[48:51], v[80:83], v[140:143], v[48:51]
    ds_read_b64_tr_b16 v[66:67], v208 offset:26624
    buffer_load_dwordx4 v[120:123], v214, s[12:15], s55 offen offset:0 sc1
    v_mfma_f32_16x16x32_bf16 v[52:55], v[84:87], v[140:143], v[52:55]
    ds_read_b64_tr_b16 v[68:69], v209 offset:24576
    buffer_load_dwordx4 v[124:127], v214, s[12:15], s55 offen offset:1024 sc1
    v_mfma_f32_16x16x32_bf16 v[36:39], v[84:87], v[136:139], v[36:39]
    ds_read_b64_tr_b16 v[70:71], v209 offset:26624
    s_waitcnt lgkmcnt(8)
    buffer_load_dwordx4 v[128:131], v214, s[12:15], s55 offen offset:2048 sc1
    v_mfma_f32_16x16x32_bf16 v[24:27], v[88:91], v[144:147], v[24:27]
    ds_read_b64_tr_b16 v[72:73], v206 offset:28672
    buffer_load_dwordx4 v[132:135], v214, s[12:15], s55 offen offset:3072 sc1
    v_mfma_f32_16x16x32_bf16 v[40:43], v[88:91], v[148:151], v[40:43]
    ds_read_b64_tr_b16 v[74:75], v206 offset:30720
    s_waitcnt vmcnt(12)
    v_mfma_f32_16x16x32_bf16 v[44:47], v[92:95], v[148:151], v[44:47]
    ds_read_b64_tr_b16 v[76:77], v207 offset:28672
    v_bitop3_b32 v216, v152, v156, s22 bitop3:0x7e
    v_mfma_f32_16x16x32_bf16 v[28:31], v[92:95], v[144:147], v[28:31]
    ds_read_b64_tr_b16 v[78:79], v207 offset:30720
    v_bitop3_b32 v217, v160, v164, s22 bitop3:0x7e
    v_mfma_f32_16x16x32_bf16 v[32:35], v[96:99], v[144:147], v[32:35]
    ds_read_b64_tr_b16 v[80:81], v208 offset:28672
    v_bitop3_b32 v216, v216, v217, 1 bitop3:0xa8
    v_mfma_f32_16x16x32_bf16 v[48:51], v[96:99], v[148:151], v[48:51]
    ds_read_b64_tr_b16 v[82:83], v208 offset:30720
    v_cmp_ne_u32 vcc, 0, v216
    v_mfma_f32_16x16x32_bf16 v[52:55], v[100:103], v[148:151], v[52:55]
    ds_read_b64_tr_b16 v[84:85], v209 offset:28672
    v_mfma_f32_16x16x32_bf16 v[36:39], v[100:103], v[144:147], v[36:39]
    ds_read_b64_tr_b16 v[86:87], v209 offset:30720
    s_waitcnt lgkmcnt(8)
    s_cbranch_vccnz Lock_126
Look_127:
    v_mfma_f32_16x16x32_bf16 v[24:27], v[56:59], v[152:155], v[24:27]
    ds_read_b64_tr_b16 v[88:89], v206 offset:32768
    s_add_u32 s55, s55, 4096
    v_mfma_f32_16x16x32_bf16 v[40:43], v[56:59], v[156:159], v[40:43]
    ds_read_b64_tr_b16 v[90:91], v206 offset:34816
    s_and_b32 s55, s55, 0xffff
    v_mfma_f32_16x16x32_bf16 v[44:47], v[60:63], v[156:159], v[44:47]
    ds_read_b64_tr_b16 v[92:93], v207 offset:32768
    buffer_load_dwordx4 v[136:139], v214, s[12:15], s55 offen offset:0 sc1
    v_mfma_f32_16x16x32_bf16 v[28:31], v[60:63], v[152:155], v[28:31]
    ds_read_b64_tr_b16 v[94:95], v207 offset:34816
    v_mfma_f32_16x16x32_bf16 v[32:35], v[64:67], v[152:155], v[32:35]
    ds_read_b64_tr_b16 v[96:97], v208 offset:32768
    buffer_load_dwordx4 v[140:143], v214, s[12:15], s55 offen offset:1024 sc1
    v_mfma_f32_16x16x32_bf16 v[48:51], v[64:67], v[156:159], v[48:51]
    ds_read_b64_tr_b16 v[98:99], v208 offset:34816
    v_mfma_f32_16x16x32_bf16 v[52:55], v[68:71], v[156:159], v[52:55]
    ds_read_b64_tr_b16 v[100:101], v209 offset:32768
    buffer_load_dwordx4 v[144:147], v214, s[12:15], s55 offen offset:2048 sc1
    v_mfma_f32_16x16x32_bf16 v[36:39], v[68:71], v[152:155], v[36:39]
    ds_read_b64_tr_b16 v[102:103], v209 offset:34816
    s_waitcnt lgkmcnt(8)
    v_mfma_f32_16x16x32_bf16 v[24:27], v[72:75], v[160:163], v[24:27]
    ds_read_b64_tr_b16 v[56:57], v206 offset:36864
    buffer_load_dwordx4 v[148:151], v214, s[12:15], s55 offen offset:3072 sc1
    v_mfma_f32_16x16x32_bf16 v[40:43], v[72:75], v[164:167], v[40:43]
    ds_read_b64_tr_b16 v[58:59], v206 offset:38912
    s_waitcnt vmcnt(12)
    v_mfma_f32_16x16x32_bf16 v[44:47], v[76:79], v[164:167], v[44:47]
    ds_read_b64_tr_b16 v[60:61], v207 offset:36864
    v_bitop3_b32 v216, v168, v172, s22 bitop3:0x7e
    v_mfma_f32_16x16x32_bf16 v[28:31], v[76:79], v[160:163], v[28:31]
    ds_read_b64_tr_b16 v[62:63], v207 offset:38912
    v_bitop3_b32 v217, v176, v180, s22 bitop3:0x7e
    v_mfma_f32_16x16x32_bf16 v[32:35], v[80:83], v[160:163], v[32:35]
    ds_read_b64_tr_b16 v[64:65], v208 offset:36864
    v_bitop3_b32 v216, v216, v217, 1 bitop3:0xa8
    v_mfma_f32_16x16x32_bf16 v[48:51], v[80:83], v[164:167], v[48:51]
    ds_read_b64_tr_b16 v[66:67], v208 offset:38912
    v_cmp_ne_u32 vcc, 0, v216
    v_mfma_f32_16x16x32_bf16 v[52:55], v[84:87], v[164:167], v[52:55]
    ds_read_b64_tr_b16 v[68:69], v209 offset:36864
    v_mfma_f32_16x16x32_bf16 v[36:39], v[84:87], v[160:163], v[36:39]
    ds_read_b64_tr_b16 v[70:71], v209 offset:38912
    s_waitcnt lgkmcnt(8)
    s_cbranch_vccnz Lock_128
Look_129:
    v_mfma_f32_16x16x32_bf16 v[24:27], v[88:91], v[168:171], v[24:27]
    ds_read_b64_tr_b16 v[72:73], v206 offset:40960
    s_add_u32 s55, s55, 4096
    v_mfma_f32_16x16x32_bf16 v[40:43], v[88:91], v[172:175], v[40:43]
    ds_read_b64_tr_b16 v[74:75], v206 offset:43008
    s_and_b32 s55, s55, 0xffff
    v_mfma_f32_16x16x32_bf16 v[44:47], v[92:95], v[172:175], v[44:47]
    ds_read_b64_tr_b16 v[76:77], v207 offset:40960
    buffer_load_dwordx4 v[152:155], v214, s[12:15], s55 offen offset:0 sc1
    v_mfma_f32_16x16x32_bf16 v[28:31], v[92:95], v[168:171], v[28:31]
    ds_read_b64_tr_b16 v[78:79], v207 offset:43008
    v_mfma_f32_16x16x32_bf16 v[32:35], v[96:99], v[168:171], v[32:35]
    ds_read_b64_tr_b16 v[80:81], v208 offset:40960
    buffer_load_dwordx4 v[156:159], v214, s[12:15], s55 offen offset:1024 sc1
    v_mfma_f32_16x16x32_bf16 v[48:51], v[96:99], v[172:175], v[48:51]
    ds_read_b64_tr_b16 v[82:83], v208 offset:43008
    v_mfma_f32_16x16x32_bf16 v[52:55], v[100:103], v[172:175], v[52:55]
    ds_read_b64_tr_b16 v[84:85], v209 offset:40960
    buffer_load_dwordx4 v[160:163], v214, s[12:15], s55 offen offset:2048 sc1
    v_mfma_f32_16x16x32_bf16 v[36:39], v[100:103], v[168:171], v[36:39]
    ds_read_b64_tr_b16 v[86:87], v209 offset:43008
    s_waitcnt lgkmcnt(8)
    v_mfma_f32_16x16x32_bf16 v[24:27], v[56:59], v[176:179], v[24:27]
    ds_read_b64_tr_b16 v[88:89], v206 offset:45056
    buffer_load_dwordx4 v[164:167], v214, s[12:15], s55 offen offset:3072 sc1
    v_mfma_f32_16x16x32_bf16 v[40:43], v[56:59], v[180:183], v[40:43]
    ds_read_b64_tr_b16 v[90:91], v206 offset:47104
    s_waitcnt vmcnt(12)
    v_mfma_f32_16x16x32_bf16 v[44:47], v[60:63], v[180:183], v[44:47]
    ds_read_b64_tr_b16 v[92:93], v207 offset:45056
    v_bitop3_b32 v216, v104, v108, s22 bitop3:0x7e
    v_mfma_f32_16x16x32_bf16 v[28:31], v[60:63], v[176:179], v[28:31]
    ds_read_b64_tr_b16 v[94:95], v207 offset:47104
    v_bitop3_b32 v217, v112, v116, s22 bitop3:0x7e
    v_mfma_f32_16x16x32_bf16 v[32:35], v[64:67], v[176:179], v[32:35]
    ds_read_b64_tr_b16 v[96:97], v208 offset:45056
    v_bitop3_b32 v216, v216, v217, 1 bitop3:0xa8
    v_mfma_f32_16x16x32_bf16 v[48:51], v[64:67], v[180:183], v[48:51]
    ds_read_b64_tr_b16 v[98:99], v208 offset:47104
    v_cmp_ne_u32 vcc, 0, v216
    v_mfma_f32_16x16x32_bf16 v[52:55], v[68:71], v[180:183], v[52:55]
    ds_read_b64_tr_b16 v[100:101], v209 offset:45056
    s_barrier
    v_mfma_f32_16x16x32_bf16 v[36:39], v[68:71], v[176:179], v[36:39]
    ds_read_b64_tr_b16 v[102:103], v209 offset:47104
    s_waitcnt lgkmcnt(8)
    s_cbranch_vccnz Lock_130
Look_131:
    v_mfma_f32_16x16x32_bf16 v[24:27], v[72:75], v[104:107], v[24:27]
    ds_read_b64_tr_b16 v[56:57], v206 offset:49152
    s_add_u32 s55, s55, 4096
    v_mfma_f32_16x16x32_bf16 v[40:43], v[72:75], v[108:111], v[40:43]
    ds_read_b64_tr_b16 v[58:59], v206 offset:51200
    s_and_b32 s55, s55, 0xffff
    v_mfma_f32_16x16x32_bf16 v[44:47], v[76:79], v[108:111], v[44:47]
    ds_read_b64_tr_b16 v[60:61], v207 offset:49152
    buffer_load_dwordx4 v[168:171], v214, s[12:15], s55 offen offset:0 sc1
    v_mfma_f32_16x16x32_bf16 v[28:31], v[76:79], v[104:107], v[28:31]
    ds_read_b64_tr_b16 v[62:63], v207 offset:51200
    v_mfma_f32_16x16x32_bf16 v[32:35], v[80:83], v[104:107], v[32:35]
    ds_read_b64_tr_b16 v[64:65], v208 offset:49152
    buffer_load_dwordx4 v[172:175], v214, s[12:15], s55 offen offset:1024 sc1
    v_mfma_f32_16x16x32_bf16 v[48:51], v[80:83], v[108:111], v[48:51]
    ds_read_b64_tr_b16 v[66:67], v208 offset:51200
    v_mfma_f32_16x16x32_bf16 v[52:55], v[84:87], v[108:111], v[52:55]
    ds_read_b64_tr_b16 v[68:69], v209 offset:49152
    buffer_load_dwordx4 v[176:179], v214, s[12:15], s55 offen offset:2048 sc1
    v_mfma_f32_16x16x32_bf16 v[36:39], v[84:87], v[104:107], v[36:39]
    ds_read_b64_tr_b16 v[70:71], v209 offset:51200
    s_waitcnt lgkmcnt(8)
    v_mfma_f32_16x16x32_bf16 v[24:27], v[88:91], v[112:115], v[24:27]
    ds_read_b64_tr_b16 v[72:73], v206 offset:53248
    buffer_load_dwordx4 v[180:183], v214, s[12:15], s55 offen offset:3072 sc1
    v_mfma_f32_16x16x32_bf16 v[40:43], v[88:91], v[116:119], v[40:43]
    ds_read_b64_tr_b16 v[74:75], v206 offset:55296
    s_waitcnt vmcnt(12)
    v_mfma_f32_16x16x32_bf16 v[44:47], v[92:95], v[116:119], v[44:47]
    ds_read_b64_tr_b16 v[76:77], v207 offset:53248
    v_bitop3_b32 v216, v120, v124, s22 bitop3:0x7e
    v_mfma_f32_16x16x32_bf16 v[28:31], v[92:95], v[112:115], v[28:31]
    ds_read_b64_tr_b16 v[78:79], v207 offset:55296
    v_bitop3_b32 v217, v128, v132, s22 bitop3:0x7e
    v_mfma_f32_16x16x32_bf16 v[32:35], v[96:99], v[112:115], v[32:35]
    ds_read_b64_tr_b16 v[80:81], v208 offset:53248
    v_bitop3_b32 v216, v216, v217, 1 bitop3:0xa8
    v_mfma_f32_16x16x32_bf16 v[48:51], v[96:99], v[116:119], v[48:51]
    ds_read_b64_tr_b16 v[82:83], v208 offset:55296
    v_cmp_ne_u32 vcc, 0, v216
    v_mfma_f32_16x16x32_bf16 v[52:55], v[100:103], v[116:119], v[52:55]
    ds_read_b64_tr_b16 v[84:85], v209 offset:53248
    v_mfma_f32_16x16x32_bf16 v[36:39], v[100:103], v[112:115], v[36:39]
    ds_read_b64_tr_b16 v[86:87], v209 offset:55296
    s_waitcnt lgkmcnt(8)
    s_cbranch_vccnz Lock_132
Look_133:
    v_mfma_f32_16x16x32_bf16 v[24:27], v[56:59], v[120:123], v[24:27]
    ds_read_b64_tr_b16 v[88:89], v206 offset:57344
    s_add_u32 s55, s55, 4096
    v_mfma_f32_16x16x32_bf16 v[40:43], v[56:59], v[124:127], v[40:43]
    ds_read_b64_tr_b16 v[90:91], v206 offset:59392
    s_and_b32 s55, s55, 0xffff
    v_mfma_f32_16x16x32_bf16 v[44:47], v[60:63], v[124:127], v[44:47]
    ds_read_b64_tr_b16 v[92:93], v207 offset:57344
    buffer_load_dwordx4 v[104:107], v214, s[12:15], s55 offen offset:0 sc1
    v_mfma_f32_16x16x32_bf16 v[28:31], v[60:63], v[120:123], v[28:31]
    ds_read_b64_tr_b16 v[94:95], v207 offset:59392
    v_mfma_f32_16x16x32_bf16 v[32:35], v[64:67], v[120:123], v[32:35]
    ds_read_b64_tr_b16 v[96:97], v208 offset:57344
    buffer_load_dwordx4 v[108:111], v214, s[12:15], s55 offen offset:1024 sc1
    v_mfma_f32_16x16x32_bf16 v[48:51], v[64:67], v[124:127], v[48:51]
    ds_read_b64_tr_b16 v[98:99], v208 offset:59392
    v_mfma_f32_16x16x32_bf16 v[52:55], v[68:71], v[124:127], v[52:55]
    ds_read_b64_tr_b16 v[100:101], v209 offset:57344
    buffer_load_dwordx4 v[112:115], v214, s[12:15], s55 offen offset:2048 sc1
    v_mfma_f32_16x16x32_bf16 v[36:39], v[68:71], v[120:123], v[36:39]
    ds_read_b64_tr_b16 v[102:103], v209 offset:59392
    s_waitcnt lgkmcnt(8)
    v_mfma_f32_16x16x32_bf16 v[24:27], v[72:75], v[128:131], v[24:27]
    ds_read_b64_tr_b16 v[56:57], v206 offset:61440
    buffer_load_dwordx4 v[116:119], v214, s[12:15], s55 offen offset:3072 sc1
    v_mfma_f32_16x16x32_bf16 v[40:43], v[72:75], v[132:135], v[40:43]
    ds_read_b64_tr_b16 v[58:59], v206 offset:63488
    s_waitcnt vmcnt(12)
    v_mfma_f32_16x16x32_bf16 v[44:47], v[76:79], v[132:135], v[44:47]
    ds_read_b64_tr_b16 v[60:61], v207 offset:61440
    v_bitop3_b32 v216, v136, v140, s22 bitop3:0x7e
    v_mfma_f32_16x16x32_bf16 v[28:31], v[76:79], v[128:131], v[28:31]
    ds_read_b64_tr_b16 v[62:63], v207 offset:63488
    v_bitop3_b32 v217, v144, v148, s22 bitop3:0x7e
    v_mfma_f32_16x16x32_bf16 v[32:35], v[80:83], v[128:131], v[32:35]
    ds_read_b64_tr_b16 v[64:65], v208 offset:61440
    v_bitop3_b32 v216, v216, v217, 1 bitop3:0xa8
    v_mfma_f32_16x16x32_bf16 v[48:51], v[80:83], v[132:135], v[48:51]
    ds_read_b64_tr_b16 v[66:67], v208 offset:63488
    v_cmp_ne_u32 vcc, 0, v216
    v_mfma_f32_16x16x32_bf16 v[52:55], v[84:87], v[132:135], v[52:55]
    ds_read_b64_tr_b16 v[68:69], v209 offset:61440
    v_mfma_f32_16x16x32_bf16 v[36:39], v[84:87], v[128:131], v[36:39]
    ds_read_b64_tr_b16 v[70:71], v209 offset:63488
    s_waitcnt lgkmcnt(8)
    s_cbranch_vccnz Lock_134
Look_135:
    v_mfma_f32_16x16x32_bf16 v[24:27], v[88:91], v[136:139], v[24:27]
    ds_read_b64_tr_b16 v[72:73], v210 offset:0
    s_add_u32 s55, s55, 4096
    v_mfma_f32_16x16x32_bf16 v[40:43], v[88:91], v[140:143], v[40:43]
    ds_read_b64_tr_b16 v[74:75], v210 offset:2048
    s_and_b32 s55, s55, 0xffff
    v_mfma_f32_16x16x32_bf16 v[44:47], v[92:95], v[140:143], v[44:47]
    ds_read_b64_tr_b16 v[76:77], v211 offset:0
    buffer_load_dwordx4 v[120:123], v214, s[12:15], s55 offen offset:0 sc1
    v_mfma_f32_16x16x32_bf16 v[28:31], v[92:95], v[136:139], v[28:31]
    ds_read_b64_tr_b16 v[78:79], v211 offset:2048
    v_mfma_f32_16x16x32_bf16 v[32:35], v[96:99], v[136:139], v[32:35]
    ds_read_b64_tr_b16 v[80:81], v212 offset:0
    buffer_load_dwordx4 v[124:127], v214, s[12:15], s55 offen offset:1024 sc1
    v_mfma_f32_16x16x32_bf16 v[48:51], v[96:99], v[140:143], v[48:51]
    ds_read_b64_tr_b16 v[82:83], v212 offset:2048
    v_mfma_f32_16x16x32_bf16 v[52:55], v[100:103], v[140:143], v[52:55]
    ds_read_b64_tr_b16 v[84:85], v213 offset:0
    buffer_load_dwordx4 v[128:131], v214, s[12:15], s55 offen offset:2048 sc1
    v_mfma_f32_16x16x32_bf16 v[36:39], v[100:103], v[136:139], v[36:39]
    ds_read_b64_tr_b16 v[86:87], v213 offset:2048
    s_waitcnt lgkmcnt(8)
    v_mfma_f32_16x16x32_bf16 v[24:27], v[56:59], v[144:147], v[24:27]
    ds_read_b64_tr_b16 v[88:89], v210 offset:4096
    buffer_load_dwordx4 v[132:135], v214, s[12:15], s55 offen offset:3072 sc1
    v_mfma_f32_16x16x32_bf16 v[40:43], v[56:59], v[148:151], v[40:43]
    ds_read_b64_tr_b16 v[90:91], v210 offset:6144
    s_waitcnt vmcnt(12)
    v_mfma_f32_16x16x32_bf16 v[44:47], v[60:63], v[148:151], v[44:47]
    ds_read_b64_tr_b16 v[92:93], v211 offset:4096
    v_bitop3_b32 v216, v152, v156, s22 bitop3:0x7e
    v_mfma_f32_16x16x32_bf16 v[28:31], v[60:63], v[144:147], v[28:31]
    ds_read_b64_tr_b16 v[94:95], v211 offset:6144
    v_bitop3_b32 v217, v160, v164, s22 bitop3:0x7e
    v_mfma_f32_16x16x32_bf16 v[32:35], v[64:67], v[144:147], v[32:35]
    ds_read_b64_tr_b16 v[96:97], v212 offset:4096
    v_bitop3_b32 v216, v216, v217, 1 bitop3:0xa8
    v_mfma_f32_16x16x32_bf16 v[48:51], v[64:67], v[148:151], v[48:51]
    ds_read_b64_tr_b16 v[98:99], v212 offset:6144
    v_cmp_ne_u32 vcc, 0, v216
    v_mfma_f32_16x16x32_bf16 v[52:55], v[68:71], v[148:151], v[52:55]
    ds_read_b64_tr_b16 v[100:101], v213 offset:4096
    v_mfma_f32_16x16x32_bf16 v[36:39], v[68:71], v[144:147], v[36:39]
    ds_read_b64_tr_b16 v[102:103], v213 offset:6144
    s_waitcnt lgkmcnt(8)
    s_cbranch_vccnz Lock_136
Look_137:
    v_mfma_f32_16x16x32_bf16 v[24:27], v[72:75], v[152:155], v[24:27]
    ds_read_b64_tr_b16 v[56:57], v210 offset:8192
    s_add_u32 s55, s55, 4096
    v_mfma_f32_16x16x32_bf16 v[40:43], v[72:75], v[156:159], v[40:43]
    ds_read_b64_tr_b16 v[58:59], v210 offset:10240
    s_and_b32 s55, s55, 0xffff
    v_mfma_f32_16x16x32_bf16 v[44:47], v[76:79], v[156:159], v[44:47]
    ds_read_b64_tr_b16 v[60:61], v211 offset:8192
    buffer_load_dwordx4 v[136:139], v214, s[12:15], s55 offen offset:0 sc1
    v_mfma_f32_16x16x32_bf16 v[28:31], v[76:79], v[152:155], v[28:31]
    ds_read_b64_tr_b16 v[62:63], v211 offset:10240
    v_mfma_f32_16x16x32_bf16 v[32:35], v[80:83], v[152:155], v[32:35]
    ds_read_b64_tr_b16 v[64:65], v212 offset:8192
    buffer_load_dwordx4 v[140:143], v214, s[12:15], s55 offen offset:1024 sc1
    v_mfma_f32_16x16x32_bf16 v[48:51], v[80:83], v[156:159], v[48:51]
    ds_read_b64_tr_b16 v[66:67], v212 offset:10240
    v_mfma_f32_16x16x32_bf16 v[52:55], v[84:87], v[156:159], v[52:55]
    ds_read_b64_tr_b16 v[68:69], v213 offset:8192
    buffer_load_dwordx4 v[144:147], v214, s[12:15], s55 offen offset:2048 sc1
    v_mfma_f32_16x16x32_bf16 v[36:39], v[84:87], v[152:155], v[36:39]
    ds_read_b64_tr_b16 v[70:71], v213 offset:10240
    s_waitcnt lgkmcnt(8)
    v_mfma_f32_16x16x32_bf16 v[24:27], v[88:91], v[160:163], v[24:27]
    ds_read_b64_tr_b16 v[72:73], v210 offset:12288
    buffer_load_dwordx4 v[148:151], v214, s[12:15], s55 offen offset:3072 sc1
    v_mfma_f32_16x16x32_bf16 v[40:43], v[88:91], v[164:167], v[40:43]
    ds_read_b64_tr_b16 v[74:75], v210 offset:14336
    s_waitcnt vmcnt(12)
    v_mfma_f32_16x16x32_bf16 v[44:47], v[92:95], v[164:167], v[44:47]
    ds_read_b64_tr_b16 v[76:77], v211 offset:12288
    v_bitop3_b32 v216, v168, v172, s22 bitop3:0x7e
    v_mfma_f32_16x16x32_bf16 v[28:31], v[92:95], v[160:163], v[28:31]
    ds_read_b64_tr_b16 v[78:79], v211 offset:14336
    v_bitop3_b32 v217, v176, v180, s22 bitop3:0x7e
    v_mfma_f32_16x16x32_bf16 v[32:35], v[96:99], v[160:163], v[32:35]
    ds_read_b64_tr_b16 v[80:81], v212 offset:12288
    v_bitop3_b32 v216, v216, v217, 1 bitop3:0xa8
    v_mfma_f32_16x16x32_bf16 v[48:51], v[96:99], v[164:167], v[48:51]
    ds_read_b64_tr_b16 v[82:83], v212 offset:14336
    v_cmp_ne_u32 vcc, 0, v216
    v_mfma_f32_16x16x32_bf16 v[52:55], v[100:103], v[164:167], v[52:55]
    ds_read_b64_tr_b16 v[84:85], v213 offset:12288
    v_mfma_f32_16x16x32_bf16 v[36:39], v[100:103], v[160:163], v[36:39]
    ds_read_b64_tr_b16 v[86:87], v213 offset:14336
    s_waitcnt lgkmcnt(8)
    s_cbranch_vccnz Lock_138
Look_139:
    v_mfma_f32_16x16x32_bf16 v[24:27], v[56:59], v[168:171], v[24:27]
    ds_read_b64_tr_b16 v[88:89], v210 offset:16384
    s_add_u32 s55, s55, 4096
    v_mfma_f32_16x16x32_bf16 v[40:43], v[56:59], v[172:175], v[40:43]
    ds_read_b64_tr_b16 v[90:91], v210 offset:18432
    s_and_b32 s55, s55, 0xffff
    v_mfma_f32_16x16x32_bf16 v[44:47], v[60:63], v[172:175], v[44:47]
    ds_read_b64_tr_b16 v[92:93], v211 offset:16384
    buffer_load_dwordx4 v[152:155], v214, s[12:15], s55 offen offset:0 sc1
    v_mfma_f32_16x16x32_bf16 v[28:31], v[60:63], v[168:171], v[28:31]
    ds_read_b64_tr_b16 v[94:95], v211 offset:18432
    v_mfma_f32_16x16x32_bf16 v[32:35], v[64:67], v[168:171], v[32:35]
    ds_read_b64_tr_b16 v[96:97], v212 offset:16384
    buffer_load_dwordx4 v[156:159], v214, s[12:15], s55 offen offset:1024 sc1
    v_mfma_f32_16x16x32_bf16 v[48:51], v[64:67], v[172:175], v[48:51]
    ds_read_b64_tr_b16 v[98:99], v212 offset:18432
    v_mfma_f32_16x16x32_bf16 v[52:55], v[68:71], v[172:175], v[52:55]
    ds_read_b64_tr_b16 v[100:101], v213 offset:16384
    buffer_load_dwordx4 v[160:163], v214, s[12:15], s55 offen offset:2048 sc1
    v_mfma_f32_16x16x32_bf16 v[36:39], v[68:71], v[168:171], v[36:39]
    ds_read_b64_tr_b16 v[102:103], v213 offset:18432
    s_waitcnt lgkmcnt(8)
    v_mfma_f32_16x16x32_bf16 v[24:27], v[72:75], v[176:179], v[24:27]
    ds_read_b64_tr_b16 v[56:57], v210 offset:20480
    buffer_load_dwordx4 v[164:167], v214, s[12:15], s55 offen offset:3072 sc1
    v_mfma_f32_16x16x32_bf16 v[40:43], v[72:75], v[180:183], v[40:43]
    ds_read_b64_tr_b16 v[58:59], v210 offset:22528
    s_waitcnt vmcnt(12)
    v_mfma_f32_16x16x32_bf16 v[44:47], v[76:79], v[180:183], v[44:47]
    ds_read_b64_tr_b16 v[60:61], v211 offset:20480
    v_bitop3_b32 v216, v104, v108, s22 bitop3:0x7e
    v_mfma_f32_16x16x32_bf16 v[28:31], v[76:79], v[176:179], v[28:31]
    ds_read_b64_tr_b16 v[62:63], v211 offset:22528
    v_bitop3_b32 v217, v112, v116, s22 bitop3:0x7e
    v_mfma_f32_16x16x32_bf16 v[32:35], v[80:83], v[176:179], v[32:35]
    ds_read_b64_tr_b16 v[64:65], v212 offset:20480
    v_bitop3_b32 v216, v216, v217, 1 bitop3:0xa8
    v_mfma_f32_16x16x32_bf16 v[48:51], v[80:83], v[180:183], v[48:51]
    ds_read_b64_tr_b16 v[66:67], v212 offset:22528
    v_cmp_ne_u32 vcc, 0, v216
    v_mfma_f32_16x16x32_bf16 v[52:55], v[84:87], v[180:183], v[52:55]
    ds_read_b64_tr_b16 v[68:69], v213 offset:20480
    v_mfma_f32_16x16x32_bf16 v[36:39], v[84:87], v[176:179], v[36:39]
    ds_read_b64_tr_b16 v[70:71], v213 offset:22528
    s_waitcnt lgkmcnt(8)
    s_cbranch_vccnz Lock_140
Look_141:
    v_mfma_f32_16x16x32_bf16 v[24:27], v[88:91], v[104:107], v[24:27]
    ds_read_b64_tr_b16 v[72:73], v210 offset:24576
    s_add_u32 s55, s55, 4096
    v_mfma_f32_16x16x32_bf16 v[40:43], v[88:91], v[108:111], v[40:43]
    ds_read_b64_tr_b16 v[74:75], v210 offset:26624
    s_and_b32 s55, s55, 0xffff
    v_mfma_f32_16x16x32_bf16 v[44:47], v[92:95], v[108:111], v[44:47]
    ds_read_b64_tr_b16 v[76:77], v211 offset:24576
    buffer_load_dwordx4 v[168:171], v214, s[12:15], s55 offen offset:0 sc1
    v_mfma_f32_16x16x32_bf16 v[28:31], v[92:95], v[104:107], v[28:31]
    ds_read_b64_tr_b16 v[78:79], v211 offset:26624
    v_mfma_f32_16x16x32_bf16 v[32:35], v[96:99], v[104:107], v[32:35]
    ds_read_b64_tr_b16 v[80:81], v212 offset:24576
    buffer_load_dwordx4 v[172:175], v214, s[12:15], s55 offen offset:1024 sc1
    v_mfma_f32_16x16x32_bf16 v[48:51], v[96:99], v[108:111], v[48:51]
    ds_read_b64_tr_b16 v[82:83], v212 offset:26624
    s_barrier
    v_mfma_f32_16x16x32_bf16 v[52:55], v[100:103], v[108:111], v[52:55]
    ds_read_b64_tr_b16 v[84:85], v213 offset:24576
    buffer_load_dwordx4 v[176:179], v214, s[12:15], s55 offen offset:2048 sc1
    v_mfma_f32_16x16x32_bf16 v[36:39], v[100:103], v[104:107], v[36:39]
    ds_read_b64_tr_b16 v[86:87], v213 offset:26624
    s_waitcnt lgkmcnt(8)
    v_mfma_f32_16x16x32_bf16 v[24:27], v[56:59], v[112:115], v[24:27]
    ds_read_b64_tr_b16 v[88:89], v210 offset:28672
    buffer_load_dwordx4 v[180:183], v214, s[12:15], s55 offen offset:3072 sc1
    v_mfma_f32_16x16x32_bf16 v[40:43], v[56:59], v[116:119], v[40:43]
    ds_read_b64_tr_b16 v[90:91], v210 offset:30720
    s_waitcnt vmcnt(12)
    v_mfma_f32_16x16x32_bf16 v[44:47], v[60:63], v[116:119], v[44:47]
    ds_read_b64_tr_b16 v[92:93], v211 offset:28672
    v_bitop3_b32 v216, v120, v124, s22 bitop3:0x7e
    v_mfma_f32_16x16x32_bf16 v[28:31], v[60:63], v[112:115], v[28:31]
    ds_read_b64_tr_b16 v[94:95], v211 offset:30720
    v_bitop3_b32 v217, v128, v132, s22 bitop3:0x7e
    v_mfma_f32_16x16x32_bf16 v[32:35], v[64:67], v[112:115], v[32:35]
    ds_read_b64_tr_b16 v[96:97], v212 offset:28672
    v_bitop3_b32 v216, v216, v217, 1 bitop3:0xa8
    v_mfma_f32_16x16x32_bf16 v[48:51], v[64:67], v[116:119], v[48:51]
    ds_read_b64_tr_b16 v[98:99], v212 offset:30720
    v_cmp_ne_u32 vcc, 0, v216
    v_mfma_f32_16x16x32_bf16 v[52:55], v[68:71], v[116:119], v[52:55]
    ds_read_b64_tr_b16 v[100:101], v213 offset:28672
    v_mfma_f32_16x16x32_bf16 v[36:39], v[68:71], v[112:115], v[36:39]
    ds_read_b64_tr_b16 v[102:103], v213 offset:30720
    s_waitcnt lgkmcnt(8)
    s_cbranch_vccnz Lock_142
Look_143:
    v_mfma_f32_16x16x32_bf16 v[24:27], v[72:75], v[120:123], v[24:27]
    ds_read_b64_tr_b16 v[56:57], v210 offset:32768
    s_add_u32 s55, s55, 4096
    v_mfma_f32_16x16x32_bf16 v[40:43], v[72:75], v[124:127], v[40:43]
    ds_read_b64_tr_b16 v[58:59], v210 offset:34816
    s_and_b32 s55, s55, 0xffff
    v_mfma_f32_16x16x32_bf16 v[44:47], v[76:79], v[124:127], v[44:47]
    ds_read_b64_tr_b16 v[60:61], v211 offset:32768
    buffer_load_dwordx4 v[104:107], v214, s[12:15], s55 offen offset:0 sc1
    v_mfma_f32_16x16x32_bf16 v[28:31], v[76:79], v[120:123], v[28:31]
    ds_read_b64_tr_b16 v[62:63], v211 offset:34816
    v_mfma_f32_16x16x32_bf16 v[32:35], v[80:83], v[120:123], v[32:35]
    ds_read_b64_tr_b16 v[64:65], v212 offset:32768
    buffer_load_dwordx4 v[108:111], v214, s[12:15], s55 offen offset:1024 sc1
    v_mfma_f32_16x16x32_bf16 v[48:51], v[80:83], v[124:127], v[48:51]
    ds_read_b64_tr_b16 v[66:67], v212 offset:34816
    v_mfma_f32_16x16x32_bf16 v[52:55], v[84:87], v[124:127], v[52:55]
    ds_read_b64_tr_b16 v[68:69], v213 offset:32768
    buffer_load_dwordx4 v[112:115], v214, s[12:15], s55 offen offset:2048 sc1
    v_mfma_f32_16x16x32_bf16 v[36:39], v[84:87], v[120:123], v[36:39]
    ds_read_b64_tr_b16 v[70:71], v213 offset:34816
    s_waitcnt lgkmcnt(8)
    v_mfma_f32_16x16x32_bf16 v[24:27], v[88:91], v[128:131], v[24:27]
    ds_read_b64_tr_b16 v[72:73], v210 offset:36864
    buffer_load_dwordx4 v[116:119], v214, s[12:15], s55 offen offset:3072 sc1
    v_mfma_f32_16x16x32_bf16 v[40:43], v[88:91], v[132:135], v[40:43]
    ds_read_b64_tr_b16 v[74:75], v210 offset:38912
    s_waitcnt vmcnt(12)
    v_mfma_f32_16x16x32_bf16 v[44:47], v[92:95], v[132:135], v[44:47]
    ds_read_b64_tr_b16 v[76:77], v211 offset:36864
    v_bitop3_b32 v216, v136, v140, s22 bitop3:0x7e
    v_mfma_f32_16x16x32_bf16 v[28:31], v[92:95], v[128:131], v[28:31]
    ds_read_b64_tr_b16 v[78:79], v211 offset:38912
    v_bitop3_b32 v217, v144, v148, s22 bitop3:0x7e
    v_mfma_f32_16x16x32_bf16 v[32:35], v[96:99], v[128:131], v[32:35]
    ds_read_b64_tr_b16 v[80:81], v212 offset:36864
    v_bitop3_b32 v216, v216, v217, 1 bitop3:0xa8
    v_mfma_f32_16x16x32_bf16 v[48:51], v[96:99], v[132:135], v[48:51]
    ds_read_b64_tr_b16 v[82:83], v212 offset:38912
    v_cmp_ne_u32 vcc, 0, v216
    v_mfma_f32_16x16x32_bf16 v[52:55], v[100:103], v[132:135], v[52:55]
    ds_read_b64_tr_b16 v[84:85], v213 offset:36864
    v_mfma_f32_16x16x32_bf16 v[36:39], v[100:103], v[128:131], v[36:39]
    ds_read_b64_tr_b16 v[86:87], v213 offset:38912
    s_waitcnt lgkmcnt(8)
    s_cbranch_vccnz Lock_144
Look_145:
    v_mfma_f32_16x16x32_bf16 v[24:27], v[56:59], v[136:139], v[24:27]
    ds_read_b64_tr_b16 v[88:89], v210 offset:40960
    v_mfma_f32_16x16x32_bf16 v[40:43], v[56:59], v[140:143], v[40:43]
    ds_read_b64_tr_b16 v[90:91], v210 offset:43008
    v_mfma_f32_16x16x32_bf16 v[44:47], v[60:63], v[140:143], v[44:47]
    ds_read_b64_tr_b16 v[92:93], v211 offset:40960
    v_mfma_f32_16x16x32_bf16 v[28:31], v[60:63], v[136:139], v[28:31]
    ds_read_b64_tr_b16 v[94:95], v211 offset:43008
    v_mfma_f32_16x16x32_bf16 v[32:35], v[64:67], v[136:139], v[32:35]
    ds_read_b64_tr_b16 v[96:97], v212 offset:40960
    v_mfma_f32_16x16x32_bf16 v[48:51], v[64:67], v[140:143], v[48:51]
    ds_read_b64_tr_b16 v[98:99], v212 offset:43008
    v_mfma_f32_16x16x32_bf16 v[52:55], v[68:71], v[140:143], v[52:55]
    ds_read_b64_tr_b16 v[100:101], v213 offset:40960
    v_mfma_f32_16x16x32_bf16 v[36:39], v[68:71], v[136:139], v[36:39]
    ds_read_b64_tr_b16 v[102:103], v213 offset:43008
    s_waitcnt lgkmcnt(8)
    v_mfma_f32_16x16x32_bf16 v[24:27], v[72:75], v[144:147], v[24:27]
    ds_read_b64_tr_b16 v[56:57], v210 offset:45056
    v_mfma_f32_16x16x32_bf16 v[40:43], v[72:75], v[148:151], v[40:43]
    ds_read_b64_tr_b16 v[58:59], v210 offset:47104
    s_waitcnt vmcnt(8)
    v_mfma_f32_16x16x32_bf16 v[44:47], v[76:79], v[148:151], v[44:47]
    ds_read_b64_tr_b16 v[60:61], v211 offset:45056
    v_bitop3_b32 v216, v152, v156, s22 bitop3:0x7e
    v_mfma_f32_16x16x32_bf16 v[28:31], v[76:79], v[144:147], v[28:31]
    ds_read_b64_tr_b16 v[62:63], v211 offset:47104
    v_bitop3_b32 v217, v160, v164, s22 bitop3:0x7e
    v_mfma_f32_16x16x32_bf16 v[32:35], v[80:83], v[144:147], v[32:35]
    ds_read_b64_tr_b16 v[64:65], v212 offset:45056
    v_bitop3_b32 v216, v216, v217, 1 bitop3:0xa8
    v_mfma_f32_16x16x32_bf16 v[48:51], v[80:83], v[148:151], v[48:51]
    ds_read_b64_tr_b16 v[66:67], v212 offset:47104
    v_cmp_ne_u32 vcc, 0, v216
    v_mfma_f32_16x16x32_bf16 v[52:55], v[84:87], v[148:151], v[52:55]
    ds_read_b64_tr_b16 v[68:69], v213 offset:45056
    v_mfma_f32_16x16x32_bf16 v[36:39], v[84:87], v[144:147], v[36:39]
    ds_read_b64_tr_b16 v[70:71], v213 offset:47104
    s_waitcnt lgkmcnt(8)
    s_cbranch_vccnz Lock_146
Look_147:
    v_mfma_f32_16x16x32_bf16 v[24:27], v[88:91], v[152:155], v[24:27]
    ds_read_b64_tr_b16 v[72:73], v210 offset:49152
    v_mfma_f32_16x16x32_bf16 v[40:43], v[88:91], v[156:159], v[40:43]
    ds_read_b64_tr_b16 v[74:75], v210 offset:51200
    v_mfma_f32_16x16x32_bf16 v[44:47], v[92:95], v[156:159], v[44:47]
    ds_read_b64_tr_b16 v[76:77], v211 offset:49152
    v_mfma_f32_16x16x32_bf16 v[28:31], v[92:95], v[152:155], v[28:31]
    ds_read_b64_tr_b16 v[78:79], v211 offset:51200
    v_mfma_f32_16x16x32_bf16 v[32:35], v[96:99], v[152:155], v[32:35]
    ds_read_b64_tr_b16 v[80:81], v212 offset:49152
    v_mfma_f32_16x16x32_bf16 v[48:51], v[96:99], v[156:159], v[48:51]
    ds_read_b64_tr_b16 v[82:83], v212 offset:51200
    v_mfma_f32_16x16x32_bf16 v[52:55], v[100:103], v[156:159], v[52:55]
    ds_read_b64_tr_b16 v[84:85], v213 offset:49152
    v_mfma_f32_16x16x32_bf16 v[36:39], v[100:103], v[152:155], v[36:39]
    ds_read_b64_tr_b16 v[86:87], v213 offset:51200
    s_waitcnt lgkmcnt(8)
    v_mfma_f32_16x16x32_bf16 v[24:27], v[56:59], v[160:163], v[24:27]
    ds_read_b64_tr_b16 v[88:89], v210 offset:53248
    v_mfma_f32_16x16x32_bf16 v[40:43], v[56:59], v[164:167], v[40:43]
    ds_read_b64_tr_b16 v[90:91], v210 offset:55296
    s_waitcnt vmcnt(4)
    v_mfma_f32_16x16x32_bf16 v[44:47], v[60:63], v[164:167], v[44:47]
    ds_read_b64_tr_b16 v[92:93], v211 offset:53248
    v_bitop3_b32 v216, v168, v172, s22 bitop3:0x7e
    v_mfma_f32_16x16x32_bf16 v[28:31], v[60:63], v[160:163], v[28:31]
    ds_read_b64_tr_b16 v[94:95], v211 offset:55296
    v_bitop3_b32 v217, v176, v180, s22 bitop3:0x7e
    v_mfma_f32_16x16x32_bf16 v[32:35], v[64:67], v[160:163], v[32:35]
    ds_read_b64_tr_b16 v[96:97], v212 offset:53248
    v_bitop3_b32 v216, v216, v217, 1 bitop3:0xa8
    v_mfma_f32_16x16x32_bf16 v[48:51], v[64:67], v[164:167], v[48:51]
    ds_read_b64_tr_b16 v[98:99], v212 offset:55296
    v_cmp_ne_u32 vcc, 0, v216
    v_mfma_f32_16x16x32_bf16 v[52:55], v[68:71], v[164:167], v[52:55]
    ds_read_b64_tr_b16 v[100:101], v213 offset:53248
    v_mfma_f32_16x16x32_bf16 v[36:39], v[68:71], v[160:163], v[36:39]
    ds_read_b64_tr_b16 v[102:103], v213 offset:55296
    s_waitcnt lgkmcnt(8)
    s_cbranch_vccnz Lock_148
Look_149:
    v_mfma_f32_16x16x32_bf16 v[24:27], v[72:75], v[168:171], v[24:27]
    ds_read_b64_tr_b16 v[56:57], v210 offset:57344
    v_mfma_f32_16x16x32_bf16 v[40:43], v[72:75], v[172:175], v[40:43]
    ds_read_b64_tr_b16 v[58:59], v210 offset:59392
    v_mfma_f32_16x16x32_bf16 v[44:47], v[76:79], v[172:175], v[44:47]
    ds_read_b64_tr_b16 v[60:61], v211 offset:57344
    v_mfma_f32_16x16x32_bf16 v[28:31], v[76:79], v[168:171], v[28:31]
    ds_read_b64_tr_b16 v[62:63], v211 offset:59392
    v_mfma_f32_16x16x32_bf16 v[32:35], v[80:83], v[168:171], v[32:35]
    ds_read_b64_tr_b16 v[64:65], v212 offset:57344
    v_mfma_f32_16x16x32_bf16 v[48:51], v[80:83], v[172:175], v[48:51]
    ds_read_b64_tr_b16 v[66:67], v212 offset:59392
    v_mfma_f32_16x16x32_bf16 v[52:55], v[84:87], v[172:175], v[52:55]
    ds_read_b64_tr_b16 v[68:69], v213 offset:57344
    v_mfma_f32_16x16x32_bf16 v[36:39], v[84:87], v[168:171], v[36:39]
    ds_read_b64_tr_b16 v[70:71], v213 offset:59392
    s_waitcnt lgkmcnt(8)
    v_mfma_f32_16x16x32_bf16 v[24:27], v[88:91], v[176:179], v[24:27]
    ds_read_b64_tr_b16 v[72:73], v210 offset:61440
    v_mfma_f32_16x16x32_bf16 v[40:43], v[88:91], v[180:183], v[40:43]
    ds_read_b64_tr_b16 v[74:75], v210 offset:63488
    s_waitcnt vmcnt(0)
    v_mfma_f32_16x16x32_bf16 v[44:47], v[92:95], v[180:183], v[44:47]
    ds_read_b64_tr_b16 v[76:77], v211 offset:61440
    v_bitop3_b32 v216, v104, v108, s22 bitop3:0x7e
    v_mfma_f32_16x16x32_bf16 v[28:31], v[92:95], v[176:179], v[28:31]
    ds_read_b64_tr_b16 v[78:79], v211 offset:63488
    v_bitop3_b32 v217, v112, v116, s22 bitop3:0x7e
    v_mfma_f32_16x16x32_bf16 v[32:35], v[96:99], v[176:179], v[32:35]
    ds_read_b64_tr_b16 v[80:81], v212 offset:61440
    v_bitop3_b32 v216, v216, v217, 1 bitop3:0xa8
    v_mfma_f32_16x16x32_bf16 v[48:51], v[96:99], v[180:183], v[48:51]
    ds_read_b64_tr_b16 v[82:83], v212 offset:63488
    v_cmp_ne_u32 vcc, 0, v216
    v_mfma_f32_16x16x32_bf16 v[52:55], v[100:103], v[180:183], v[52:55]
    ds_read_b64_tr_b16 v[84:85], v213 offset:61440
    v_mfma_f32_16x16x32_bf16 v[36:39], v[100:103], v[176:179], v[36:39]
    ds_read_b64_tr_b16 v[86:87], v213 offset:63488
    s_waitcnt lgkmcnt(8)
    s_cbranch_vccnz Lock_150
Look_151:
    v_mfma_f32_16x16x32_bf16 v[24:27], v[56:59], v[104:107], v[24:27]
    v_mfma_f32_16x16x32_bf16 v[40:43], v[56:59], v[108:111], v[40:43]
    v_mfma_f32_16x16x32_bf16 v[44:47], v[60:63], v[108:111], v[44:47]
    v_mfma_f32_16x16x32_bf16 v[28:31], v[60:63], v[104:107], v[28:31]
    v_mfma_f32_16x16x32_bf16 v[32:35], v[64:67], v[104:107], v[32:35]
    v_mfma_f32_16x16x32_bf16 v[48:51], v[64:67], v[108:111], v[48:51]
    v_mfma_f32_16x16x32_bf16 v[52:55], v[68:71], v[108:111], v[52:55]
    v_mfma_f32_16x16x32_bf16 v[36:39], v[68:71], v[104:107], v[36:39]
    s_waitcnt lgkmcnt(0)
    v_mfma_f32_16x16x32_bf16 v[24:27], v[72:75], v[112:115], v[24:27]
    v_mfma_f32_16x16x32_bf16 v[40:43], v[72:75], v[116:119], v[40:43]
    v_mfma_f32_16x16x32_bf16 v[44:47], v[76:79], v[116:119], v[44:47]
    v_mfma_f32_16x16x32_bf16 v[28:31], v[76:79], v[112:115], v[28:31]
    v_mfma_f32_16x16x32_bf16 v[32:35], v[80:83], v[112:115], v[32:35]
    v_mfma_f32_16x16x32_bf16 v[48:51], v[80:83], v[116:119], v[48:51]
    v_mfma_f32_16x16x32_bf16 v[52:55], v[84:87], v[116:119], v[52:55]
    v_mfma_f32_16x16x32_bf16 v[36:39], v[84:87], v[112:115], v[36:39]
    s_bitcmp1_b32 s22, 0
    s_cbranch_scc1 L_xodd
    s_cmp_eq_u32 s23, 0
    s_cbranch_scc1 Lslow_152
    v_add_u32 v241, 0x10000, v24
    v_cvt_pk_bf16_f32 v8, v24, v25
    v_cvt_pk_bf16_f32 v9, v26, v27
    v_and_b32_sdwa v8, v241, -2 dst_sel:WORD_0 dst_unused:UNUSED_PRESERVE src0_sel:WORD_1 src1_sel:DWORD
    v_cvt_pk_bf16_f32 v10, v28, v29
    v_cvt_pk_bf16_f32 v11, v30, v31
    buffer_store_dwordx4 v[8:11], v0, s[16:19], s71 offen offset:0
    ds_write_b128 v240, v[8:11] offset:0
    v_add_u32 v241, 0x10000, v40
    v_cvt_pk_bf16_f32 v16, v40, v41
    v_cvt_pk_bf16_f32 v17, v42, v43
    v_and_b32_sdwa v16, v241, -2 dst_sel:WORD_0 dst_unused:UNUSED_PRESERVE src0_sel:WORD_1 src1_sel:DWORD
    v_cvt_pk_bf16_f32 v18, v44, v45
    v_cvt_pk_bf16_f32 v19, v46, v47
    buffer_store_dwordx4 v[16:19], v0, s[16:19], s71 offen offset:2048
    ds_write_b128 v240, v[16:19] offset:2048
    v_add_u32 v241, 0x10000, v32
    v_cvt_pk_bf16_f32 v12, v32, v33
    v_cvt_pk_bf16_f32 v13, v34, v35
    v_and_b32_sdwa v12, v241, -2 dst_sel:WORD_0 dst_unused:UNUSED_PRESERVE src0_sel:WORD_1 src1_sel:DWORD
    v_cvt_pk_bf16_f32 v14, v36, v37
    v_cvt_pk_bf16_f32 v15, v38, v39
    buffer_store_dwordx4 v[12:15], v0, s[16:19], s71 offen offset:1024
    ds_write_b128 v240, v[12:15] offset:1024
    v_add_u32 v241, 0x10000, v48
    v_cvt_pk_bf16_f32 v20, v48, v49
    v_cvt_pk_bf16_f32 v21, v50, v51
    v_and_b32_sdwa v20, v241, -2 dst_sel:WORD_0 dst_unused:UNUSED_PRESERVE src0_sel:WORD_1 src1_sel:DWORD
    v_cvt_pk_bf16_f32 v22, v52, v53
    v_cvt_pk_bf16_f32 v23, v54, v55
    buffer_store_dwordx4 v[20:23], v0, s[16:19], s71 offen offset:3072
    ds_write_b128 v240, v[20:23] offset:3072
Lback_153:
    v_cvt_pk_bf16_f32 v8, v24, v25
    v_cvt_pk_bf16_f32 v16, v40, v41
    v_cvt_pk_bf16_f32 v12, v32, v33
    v_cvt_pk_bf16_f32 v20, v48, v49
    v_mfma_f32_16x16x32_bf16 v[206:209], v[226:229], v[8:11], 0
    v_mfma_f32_16x16x32_bf16 v[210:213], v[8:11], v[8:11], 0
    v_mfma_f32_16x16x32_bf16 v[214:217], v[226:229], v[16:19], 0
    v_mfma_f32_16x16x32_bf16 v[218:221], v[16:19], v[16:19], 0
    v_mfma_f32_16x16x32_bf16 v[206:209], v[226:229], v[12:15], v[206:209]
    v_mfma_f32_16x16x32_bf16 v[210:213], v[12:15], v[12:15], v[210:213]
    v_mfma_f32_16x16x32_bf16 v[214:217], v[226:229], v[20:23], v[214:217]
    v_mfma_f32_16x16x32_bf16 v[218:221], v[20:23], v[20:23], v[218:221]
    s_add_u32 s22, s22, 1
    s_waitcnt lgkmcnt(0)
    s_branch L_cgo
L_xodd:
    s_cmp_eq_u32 s22, 3
    s_cbranch_scc1 L_final
    s_cmp_eq_u32 s23, 0
    s_cbranch_scc1 Lslow_154
    v_cvt_pk_bf16_f32 v8, v24, v25
    v_cvt_pk_bf16_f32 v9, v26, v27
    v_or_b32_sdwa v8, v24, 1 dst_sel:WORD_0 dst_unused:UNUSED_PRESERVE src0_sel:WORD_1 src1_sel:DWORD
    v_cvt_pk_bf16_f32 v10, v28, v29
    v_cvt_pk_bf16_f32 v11, v30, v31
    buffer_store_dwordx4 v[8:11], v0, s[16:19], s71 offen offset:0
    ds_write_b128 v240, v[8:11] offset:0
    v_cvt_pk_bf16_f32 v16, v40, v41
    v_cvt_pk_bf16_f32 v17, v42, v43
    v_or_b32_sdwa v16, v40, 1 dst_sel:WORD_0 dst_unused:UNUSED_PRESERVE src0_sel:WORD_1 src1_sel:DWORD
    v_cvt_pk_bf16_f32 v18, v44, v45
    v_cvt_pk_bf16_f32 v19, v46, v47
    buffer_store_dwordx4 v[16:19], v0, s[16:19], s71 offen offset:2048
    ds_write_b128 v240, v[16:19] offset:2048
    v_cvt_pk_bf16_f32 v12, v32, v33
    v_cvt_pk_bf16_f32 v13, v34, v35
    v_or_b32_sdwa v12, v32, 1 dst_sel:WORD_0 dst_unused:UNUSED_PRESERVE src0_sel:WORD_1 src1_sel:DWORD
    v_cvt_pk_bf16_f32 v14, v36, v37
    v_cvt_pk_bf16_f32 v15, v38, v39
    buffer_store_dwordx4 v[12:15], v0, s[16:19], s71 offen offset:1024
    ds_write_b128 v240, v[12:15] offset:1024
    v_cvt_pk_bf16_f32 v20, v48, v49
    v_cvt_pk_bf16_f32 v21, v50, v51
    v_or_b32_sdwa v20, v48, 1 dst_sel:WORD_0 dst_unused:UNUSED_PRESERVE src0_sel:WORD_1 src1_sel:DWORD
    v_cvt_pk_bf16_f32 v22, v52, v53
    v_cvt_pk_bf16_f32 v23, v54, v55
    buffer_store_dwordx4 v[20:23], v0, s[16:19], s71 offen offset:3072
    ds_write_b128 v240, v[20:23] offset:3072
Lback_155:
    v_cvt_pk_bf16_f32 v8, v24, v25
    v_cvt_pk_bf16_f32 v16, v40, v41
    v_cvt_pk_bf16_f32 v12, v32, v33
    v_cvt_pk_bf16_f32 v20, v48, v49
    v_mfma_f32_16x16x32_bf16 v[206:209], v[226:229], v[8:11], 0
    v_mfma_f32_16x16x32_bf16 v[210:213], v[8:11], v[8:11], 0
    v_mfma_f32_16x16x32_bf16 v[214:217], v[226:229], v[16:19], 0
    v_mfma_f32_16x16x32_bf16 v[218:221], v[16:19], v[16:19], 0
    v_mfma_f32_16x16x32_bf16 v[206:209], v[226:229], v[12:15], v[206:209]
    v_mfma_f32_16x16x32_bf16 v[210:213], v[12:15], v[12:15], v[210:213]
    v_mfma_f32_16x16x32_bf16 v[214:217], v[226:229], v[20:23], v[214:217]
    v_mfma_f32_16x16x32_bf16 v[218:221], v[20:23], v[20:23], v[218:221]
    s_add_u32 s22, s22, 1
    s_waitcnt lgkmcnt(0)
    s_branch L_cgo
L_final:
    s_lshl_b32 s27, s20, 2
    s_add_u32 s27, s27, s3
    s_lshl_b32 s27, s27, 16
    s_lshl_b32 s28, s21, 7
    s_add_u32 s27, s27, s28
    v_and_b32 v160, 15, v1
    v_lshlrev_b32 v160, 11, v160
    v_and_b32 v161, 48, v1
    v_add3_u32 v160, v160, v161, s27
    v_add_u32 v161, 32768, v160
    v_cvt_pk_bf16_f32 v8, v24, v25
    v_cvt_pk_bf16_f32 v9, v26, v27
    v_cvt_pk_bf16_f32 v10, v28, v29
    v_cvt_pk_bf16_f32 v11, v30, v31
    v_cvt_pk_bf16_f32 v16, v40, v41
    v_cvt_pk_bf16_f32 v17, v42, v43
    v_cvt_pk_bf16_f32 v18, v44, v45
    v_cvt_pk_bf16_f32 v19, v46, v47
    v_cvt_pk_bf16_f32 v12, v32, v33
    v_cvt_pk_bf16_f32 v13, v34, v35
    v_cvt_pk_bf16_f32 v14, v36, v37
    v_cvt_pk_bf16_f32 v15, v38, v39
    v_cvt_pk_bf16_f32 v20, v48, v49
    v_cvt_pk_bf16_f32 v21, v50, v51
    v_cvt_pk_bf16_f32 v22, v52, v53
    v_cvt_pk_bf16_f32 v23, v54, v55
    v_permlane32_swap_b32 v8, v10
    v_permlane32_swap_b32 v9, v11
    v_permlane32_swap_b32 v16, v18
    v_permlane32_swap_b32 v17, v19
    v_permlane32_swap_b32 v12, v14
    v_permlane32_swap_b32 v13, v15
    v_permlane32_swap_b32 v20, v22
    v_permlane32_swap_b32 v21, v23
    v_permlane16_swap_b32 v8, v10
    v_permlane16_swap_b32 v9, v11
    buffer_store_dwordx4 v[8:11], v160, s[16:19], 0 offen offset:0
    v_permlane16_swap_b32 v12, v14
    v_permlane16_swap_b32 v13, v15
    buffer_store_dwordx4 v[12:15], v160, s[16:19], 0 offen offset:64
    v_permlane16_swap_b32 v16, v18
    v_permlane16_swap_b32 v17, v19
    buffer_store_dwordx4 v[16:19], v161, s[16:19], 0 offen offset:0
    v_permlane16_swap_b32 v20, v22
    v_permlane16_swap_b32 v21, v23
    buffer_store_dwordx4 v[20:23], v161, s[16:19], 0 offen offset:64
L_out:
    s_endpgm
Lslow_3:
    buffer_store_dwordx4 v[24:27], v0, s[12:15], s27 offen sc1
    s_branch Lback_4
Lslow_6:
    buffer_store_dwordx2 v[44:45], v46, s[12:15], 0 offen offset:0 sc1
    s_branch Lback_7
Lxrt_15:
    s_mov_b32 s26, 0
    s_add_u32 s76, s55, 1
    s_cmp_ge_u32 s76, 16
    s_addc_u32 s76, s76, s21
    s_and_b32 s76, s76, 15
    s_lshl_b32 s76, s76, 12
Lxrt_15a:
    s_add_u32 m0, s78, 65536
    s_nop 0
    buffer_load_dwordx4 v8, s[16:19], s76 offen offset:0 sc1 lds
    buffer_load_dwordx4 v8, s[16:19], s76 offen offset:1024 sc1 lds
    buffer_load_dwordx4 v8, s[16:19], s76 offen offset:2048 sc1 lds
    buffer_load_dwordx4 v8, s[16:19], s76 offen offset:3072 sc1 lds
    s_waitcnt vmcnt(0)
    ds_read2st64_b32 v[40:41], v169 offset0:64 offset1:68
    ds_read2st64_b32 v[42:43], v169 offset0:72 offset1:76
    s_waitcnt lgkmcnt(0)
    v_or3_b32 v40, v40, v41, v42
    v_bitop3_b32 v40, v40, v43, 1 bitop3:0xa8
    v_cmp_ne_u32 vcc, 0, v40
    s_nop 0
    s_cbranch_vccz Lxok_14
    s_add_u32 s26, s26, 1
    s_cmp_lt_u32 s26, 262144
    s_cbranch_scc1 Lxrt_15a
    s_branch Lxok_14
Lxrt_18:
    s_mov_b32 s26, 0
    s_add_u32 s76, s55, 2
    s_cmp_ge_u32 s76, 16
    s_addc_u32 s76, s76, s21
    s_and_b32 s76, s76, 15
    s_lshl_b32 s76, s76, 12
Lxrt_18a:
    s_add_u32 m0, s78, 81920
    s_nop 0
    buffer_load_dwordx4 v8, s[16:19], s76 offen offset:0 sc1 lds
    buffer_load_dwordx4 v8, s[16:19], s76 offen offset:1024 sc1 lds
    buffer_load_dwordx4 v8, s[16:19], s76 offen offset:2048 sc1 lds
    buffer_load_dwordx4 v8, s[16:19], s76 offen offset:3072 sc1 lds
    s_waitcnt vmcnt(0)
    ds_read2st64_b32 v[40:41], v169 offset0:128 offset1:132
    ds_read2st64_b32 v[42:43], v169 offset0:136 offset1:140
    s_waitcnt lgkmcnt(0)
    v_or3_b32 v40, v40, v41, v42
    v_bitop3_b32 v40, v40, v43, 1 bitop3:0xa8
    v_cmp_ne_u32 vcc, 0, v40
    s_nop 0
    s_cbranch_vccz Lxok_17
    s_add_u32 s26, s26, 1
    s_cmp_lt_u32 s26, 262144
    s_cbranch_scc1 Lxrt_18a
    s_branch Lxok_17
Lslow_19:
    buffer_store_dwordx4 v[24:27], v0, s[12:15], s27 offen sc1
    s_branch Lback_20
Lxrt_23:
    s_mov_b32 s26, 0
    s_add_u32 s76, s55, 3
    s_cmp_ge_u32 s76, 16
    s_addc_u32 s76, s76, s21
    s_and_b32 s76, s76, 15
    s_lshl_b32 s76, s76, 12
Lxrt_23a:
    s_add_u32 m0, s78, 49152
    s_nop 0
    buffer_load_dwordx4 v8, s[16:19], s76 offen offset:0 sc1 lds
    buffer_load_dwordx4 v8, s[16:19], s76 offen offset:1024 sc1 lds
    buffer_load_dwordx4 v8, s[16:19], s76 offen offset:2048 sc1 lds
    buffer_load_dwordx4 v8, s[16:19], s76 offen offset:3072 sc1 lds
    s_waitcnt vmcnt(0)
    ds_read2st64_b32 v[40:41], v169 offset0:0 offset1:4
    ds_read2st64_b32 v[42:43], v169 offset0:8 offset1:12
    s_waitcnt lgkmcnt(0)
    v_or3_b32 v40, v40, v41, v42
    v_bitop3_b32 v40, v40, v43, 1 bitop3:0xa8
    v_cmp_ne_u32 vcc, 0, v40
    s_nop 0
    s_cbranch_vccz Lxok_22
    s_add_u32 s26, s26, 1
    s_cmp_lt_u32 s26, 262144
    s_cbranch_scc1 Lxrt_23a
    s_branch Lxok_22
Lslow_24:
    buffer_store_dwordx2 v[44:45], v46, s[12:15], 0 offen offset:0 sc1
    s_branch Lback_25
Lxrt_28:
    s_mov_b32 s26, 0
    s_add_u32 s76, s55, 4
    s_cmp_ge_u32 s76, 16
    s_addc_u32 s76, s76, s21
    s_and_b32 s76, s76, 15
    s_lshl_b32 s76, s76, 12
Lxrt_28a:
    s_add_u32 m0, s78, 65536
    s_nop 0
    buffer_load_dwordx4 v8, s[16:19], s76 offen offset:0 sc1 lds
    buffer_load_dwordx4 v8, s[16:19], s76 offen offset:1024 sc1 lds
    buffer_load_dwordx4 v8, s[16:19], s76 offen offset:2048 sc1 lds
    buffer_load_dwordx4 v8, s[16:19], s76 offen offset:3072 sc1 lds
    s_waitcnt vmcnt(0)
    ds_read2st64_b32 v[40:41], v169 offset0:64 offset1:68
    ds_read2st64_b32 v[42:43], v169 offset0:72 offset1:76
    s_waitcnt lgkmcnt(0)
    v_or3_b32 v40, v40, v41, v42
    v_bitop3_b32 v40, v40, v43, 1 bitop3:0xa8
    v_cmp_ne_u32 vcc, 0, v40
    s_nop 0
    s_cbranch_vccz Lxok_27
    s_add_u32 s26, s26, 1
    s_cmp_lt_u32 s26, 262144
    s_cbranch_scc1 Lxrt_28a
    s_branch Lxok_27
Lxrt_30:
    s_mov_b32 s26, 0
    s_add_u32 s76, s55, 5
    s_cmp_ge_u32 s76, 16
    s_addc_u32 s76, s76, s21
    s_and_b32 s76, s76, 15
    s_lshl_b32 s76, s76, 12
Lxrt_30a:
    s_add_u32 m0, s78, 81920
    s_nop 0
    buffer_load_dwordx4 v8, s[16:19], s76 offen offset:0 sc1 lds
    buffer_load_dwordx4 v8, s[16:19], s76 offen offset:1024 sc1 lds
    buffer_load_dwordx4 v8, s[16:19], s76 offen offset:2048 sc1 lds
    buffer_load_dwordx4 v8, s[16:19], s76 offen offset:3072 sc1 lds
    s_waitcnt vmcnt(0)
    ds_read2st64_b32 v[40:41], v169 offset0:128 offset1:132
    ds_read2st64_b32 v[42:43], v169 offset0:136 offset1:140
    s_waitcnt lgkmcnt(0)
    v_or3_b32 v40, v40, v41, v42
    v_bitop3_b32 v40, v40, v43, 1 bitop3:0xa8
    v_cmp_ne_u32 vcc, 0, v40
    s_nop 0
    s_cbranch_vccz Lxok_29
    s_add_u32 s26, s26, 1
    s_cmp_lt_u32 s26, 262144
    s_cbranch_scc1 Lxrt_30a
    s_branch Lxok_29
Lxrt_32:
    s_mov_b32 s26, 0
    s_add_u32 s76, s55, 6
    s_cmp_ge_u32 s76, 16
    s_addc_u32 s76, s76, s21
    s_and_b32 s76, s76, 15
    s_lshl_b32 s76, s76, 12
Lxrt_32a:
    s_add_u32 m0, s78, 49152
    s_nop 0
    buffer_load_dwordx4 v8, s[16:19], s76 offen offset:0 sc1 lds
    buffer_load_dwordx4 v8, s[16:19], s76 offen offset:1024 sc1 lds
    buffer_load_dwordx4 v8, s[16:19], s76 offen offset:2048 sc1 lds
    buffer_load_dwordx4 v8, s[16:19], s76 offen offset:3072 sc1 lds
    s_waitcnt vmcnt(0)
    ds_read2st64_b32 v[40:41], v169 offset0:0 offset1:4
    ds_read2st64_b32 v[42:43], v169 offset0:8 offset1:12
    s_waitcnt lgkmcnt(0)
    v_or3_b32 v40, v40, v41, v42
    v_bitop3_b32 v40, v40, v43, 1 bitop3:0xa8
    v_cmp_ne_u32 vcc, 0, v40
    s_nop 0
    s_cbranch_vccz Lxok_31
    s_add_u32 s26, s26, 1
    s_cmp_lt_u32 s26, 262144
    s_cbranch_scc1 Lxrt_32a
    s_branch Lxok_31
Lxrt_34:
    s_mov_b32 s26, 0
    s_add_u32 s76, s55, 7
    s_cmp_ge_u32 s76, 16
    s_addc_u32 s76, s76, s21
    s_and_b32 s76, s76, 15
    s_lshl_b32 s76, s76, 12
Lxrt_34a:
    s_add_u32 m0, s78, 65536
    s_nop 0
    buffer_load_dwordx4 v8, s[16:19], s76 offen offset:0 sc1 lds
    buffer_load_dwordx4 v8, s[16:19], s76 offen offset:1024 sc1 lds
    buffer_load_dwordx4 v8, s[16:19], s76 offen offset:2048 sc1 lds
    buffer_load_dwordx4 v8, s[16:19], s76 offen offset:3072 sc1 lds
    s_waitcnt vmcnt(0)
    ds_read2st64_b32 v[40:41], v169 offset0:64 offset1:68
    ds_read2st64_b32 v[42:43], v169 offset0:72 offset1:76
    s_waitcnt lgkmcnt(0)
    v_or3_b32 v40, v40, v41, v42
    v_bitop3_b32 v40, v40, v43, 1 bitop3:0xa8
    v_cmp_ne_u32 vcc, 0, v40
    s_nop 0
    s_cbranch_vccz Lxok_33
    s_add_u32 s26, s26, 1
    s_cmp_lt_u32 s26, 262144
    s_cbranch_scc1 Lxrt_34a
    s_branch Lxok_33
Lxrt_39:
    s_mov_b32 s26, 0
    s_add_u32 s76, s55, 8
    s_cmp_ge_u32 s76, 16
    s_addc_u32 s76, s76, s21
    s_and_b32 s76, s76, 15
    s_lshl_b32 s76, s76, 12
Lxrt_39a:
    s_add_u32 m0, s78, 81920
    s_nop 0
    buffer_load_dwordx4 v8, s[16:19], s76 offen offset:0 sc1 lds
    buffer_load_dwordx4 v8, s[16:19], s76 offen offset:1024 sc1 lds
    buffer_load_dwordx4 v8, s[16:19], s76 offen offset:2048 sc1 lds
    buffer_load_dwordx4 v8, s[16:19], s76 offen offset:3072 sc1 lds
    s_waitcnt vmcnt(0)
    ds_read2st64_b32 v[40:41], v169 offset0:128 offset1:132
    ds_read2st64_b32 v[42:43], v169 offset0:136 offset1:140
    s_waitcnt lgkmcnt(0)
    v_or3_b32 v40, v40, v41, v42
    v_bitop3_b32 v40, v40, v43, 1 bitop3:0xa8
    v_cmp_ne_u32 vcc, 0, v40
    s_nop 0
    s_cbranch_vccz Lxok_38
    s_add_u32 s26, s26, 1
    s_cmp_lt_u32 s26, 262144
    s_cbranch_scc1 Lxrt_39a
    s_branch Lxok_38
Lxrt_44:
    s_mov_b32 s26, 0
    s_add_u32 s76, s21, 1
    s_and_b32 s76, s76, 15
    s_lshl_b32 s76, s76, 12
Lxrt_44a:
    s_add_u32 m0, s78, 65536
    s_nop 0
    buffer_load_dwordx4 v8, s[16:19], s76 offen offset:0 sc1 lds
    buffer_load_dwordx4 v8, s[16:19], s76 offen offset:1024 sc1 lds
    buffer_load_dwordx4 v8, s[16:19], s76 offen offset:2048 sc1 lds
    buffer_load_dwordx4 v8, s[16:19], s76 offen offset:3072 sc1 lds
    s_waitcnt vmcnt(0)
    ds_read2st64_b32 v[40:41], v169 offset0:64 offset1:68
    ds_read2st64_b32 v[42:43], v169 offset0:72 offset1:76
    s_waitcnt lgkmcnt(0)
    v_bitop3_b32 v40, v40, v41, v42 bitop3:0x80
    v_bitop3_b32 v40, v40, v43, 1 bitop3:0x80
    v_cmp_eq_u32 vcc, 0, v40
    s_nop 0
    s_cbranch_vccz Lxok_43
    s_add_u32 s26, s26, 1
    s_cmp_lt_u32 s26, 262144
    s_cbranch_scc1 Lxrt_44a
    s_branch Lxok_43
Lxrt_46:
    s_mov_b32 s26, 0
    s_add_u32 s76, s21, 2
    s_and_b32 s76, s76, 15
    s_lshl_b32 s76, s76, 12
Lxrt_46a:
    s_add_u32 m0, s78, 81920
    s_nop 0
    buffer_load_dwordx4 v8, s[16:19], s76 offen offset:0 sc1 lds
    buffer_load_dwordx4 v8, s[16:19], s76 offen offset:1024 sc1 lds
    buffer_load_dwordx4 v8, s[16:19], s76 offen offset:2048 sc1 lds
    buffer_load_dwordx4 v8, s[16:19], s76 offen offset:3072 sc1 lds
    s_waitcnt vmcnt(0)
    ds_read2st64_b32 v[40:41], v169 offset0:128 offset1:132
    ds_read2st64_b32 v[42:43], v169 offset0:136 offset1:140
    s_waitcnt lgkmcnt(0)
    v_bitop3_b32 v40, v40, v41, v42 bitop3:0x80
    v_bitop3_b32 v40, v40, v43, 1 bitop3:0x80
    v_cmp_eq_u32 vcc, 0, v40
    s_nop 0
    s_cbranch_vccz Lxok_45
    s_add_u32 s26, s26, 1
    s_cmp_lt_u32 s26, 262144
    s_cbranch_scc1 Lxrt_46a
    s_branch Lxok_45
Lslow_47:
    buffer_store_dwordx4 v[24:27], v0, s[12:15], s27 offen sc1
    s_branch Lback_48
Lxrt_50:
    s_mov_b32 s26, 0
    s_add_u32 s76, s21, 3
    s_and_b32 s76, s76, 15
    s_lshl_b32 s76, s76, 12
Lxrt_50a:
    s_add_u32 m0, s78, 49152
    s_nop 0
    buffer_load_dwordx4 v8, s[16:19], s76 offen offset:0 sc1 lds
    buffer_load_dwordx4 v8, s[16:19], s76 offen offset:1024 sc1 lds
    buffer_load_dwordx4 v8, s[16:19], s76 offen offset:2048 sc1 lds
    buffer_load_dwordx4 v8, s[16:19], s76 offen offset:3072 sc1 lds
    s_waitcnt vmcnt(0)
    ds_read2st64_b32 v[40:41], v169 offset0:0 offset1:4
    ds_read2st64_b32 v[42:43], v169 offset0:8 offset1:12
    s_waitcnt lgkmcnt(0)
    v_bitop3_b32 v40, v40, v41, v42 bitop3:0x80
    v_bitop3_b32 v40, v40, v43, 1 bitop3:0x80
    v_cmp_eq_u32 vcc, 0, v40
    s_nop 0
    s_cbranch_vccz Lxok_49
    s_add_u32 s26, s26, 1
    s_cmp_lt_u32 s26, 262144
    s_cbranch_scc1 Lxrt_50a
    s_branch Lxok_49
Lslow_51:
    buffer_store_dwordx2 v[44:45], v46, s[12:15], 0 offen offset:0 sc1
    s_branch Lback_52
Lxrt_54:
    s_mov_b32 s26, 0
    s_add_u32 s76, s21, 4
    s_and_b32 s76, s76, 15
    s_lshl_b32 s76, s76, 12
Lxrt_54a:
    s_add_u32 m0, s78, 65536
    s_nop 0
    buffer_load_dwordx4 v8, s[16:19], s76 offen offset:0 sc1 lds
    buffer_load_dwordx4 v8, s[16:19], s76 offen offset:1024 sc1 lds
    buffer_load_dwordx4 v8, s[16:19], s76 offen offset:2048 sc1 lds
    buffer_load_dwordx4 v8, s[16:19], s76 offen offset:3072 sc1 lds
    s_waitcnt vmcnt(0)
    ds_read2st64_b32 v[40:41], v169 offset0:64 offset1:68
    ds_read2st64_b32 v[42:43], v169 offset0:72 offset1:76
    s_waitcnt lgkmcnt(0)
    v_bitop3_b32 v40, v40, v41, v42 bitop3:0x80
    v_bitop3_b32 v40, v40, v43, 1 bitop3:0x80
    v_cmp_eq_u32 vcc, 0, v40
    s_nop 0
    s_cbranch_vccz Lxok_53
    s_add_u32 s26, s26, 1
    s_cmp_lt_u32 s26, 262144
    s_cbranch_scc1 Lxrt_54a
    s_branch Lxok_53
Lxrt_56:
    s_mov_b32 s26, 0
    s_add_u32 s76, s21, 5
    s_and_b32 s76, s76, 15
    s_lshl_b32 s76, s76, 12
Lxrt_56a:
    s_add_u32 m0, s78, 81920
    s_nop 0
    buffer_load_dwordx4 v8, s[16:19], s76 offen offset:0 sc1 lds
    buffer_load_dwordx4 v8, s[16:19], s76 offen offset:1024 sc1 lds
    buffer_load_dwordx4 v8, s[16:19], s76 offen offset:2048 sc1 lds
    buffer_load_dwordx4 v8, s[16:19], s76 offen offset:3072 sc1 lds
    s_waitcnt vmcnt(0)
    ds_read2st64_b32 v[40:41], v169 offset0:128 offset1:132
    ds_read2st64_b32 v[42:43], v169 offset0:136 offset1:140
    s_waitcnt lgkmcnt(0)
    v_bitop3_b32 v40, v40, v41, v42 bitop3:0x80
    v_bitop3_b32 v40, v40, v43, 1 bitop3:0x80
    v_cmp_eq_u32 vcc, 0, v40
    s_nop 0
    s_cbranch_vccz Lxok_55
    s_add_u32 s26, s26, 1
    s_cmp_lt_u32 s26, 262144
    s_cbranch_scc1 Lxrt_56a
    s_branch Lxok_55
Lxrt_58:
    s_mov_b32 s26, 0
    s_add_u32 s76, s21, 6
    s_and_b32 s76, s76, 15
    s_lshl_b32 s76, s76, 12
Lxrt_58a:
    s_add_u32 m0, s78, 49152
    s_nop 0
    buffer_load_dwordx4 v8, s[16:19], s76 offen offset:0 sc1 lds
    buffer_load_dwordx4 v8, s[16:19], s76 offen offset:1024 sc1 lds
    buffer_load_dwordx4 v8, s[16:19], s76 offen offset:2048 sc1 lds
    buffer_load_dwordx4 v8, s[16:19], s76 offen offset:3072 sc1 lds
    s_waitcnt vmcnt(0)
    ds_read2st64_b32 v[40:41], v169 offset0:0 offset1:4
    ds_read2st64_b32 v[42:43], v169 offset0:8 offset1:12
    s_waitcnt lgkmcnt(0)
    v_bitop3_b32 v40, v40, v41, v42 bitop3:0x80
    v_bitop3_b32 v40, v40, v43, 1 bitop3:0x80
    v_cmp_eq_u32 vcc, 0, v40
    s_nop 0
    s_cbranch_vccz Lxok_57
    s_add_u32 s26, s26, 1
    s_cmp_lt_u32 s26, 262144
    s_cbranch_scc1 Lxrt_58a
    s_branch Lxok_57
Lxrt_60:
    s_mov_b32 s26, 0
    s_add_u32 s76, s21, 7
    s_and_b32 s76, s76, 15
    s_lshl_b32 s76, s76, 12
Lxrt_60a:
    s_add_u32 m0, s78, 65536
    s_nop 0
    buffer_load_dwordx4 v8, s[16:19], s76 offen offset:0 sc1 lds
    buffer_load_dwordx4 v8, s[16:19], s76 offen offset:1024 sc1 lds
    buffer_load_dwordx4 v8, s[16:19], s76 offen offset:2048 sc1 lds
    buffer_load_dwordx4 v8, s[16:19], s76 offen offset:3072 sc1 lds
    s_waitcnt vmcnt(0)
    ds_read2st64_b32 v[40:41], v169 offset0:64 offset1:68
    ds_read2st64_b32 v[42:43], v169 offset0:72 offset1:76
    s_waitcnt lgkmcnt(0)
    v_bitop3_b32 v40, v40, v41, v42 bitop3:0x80
    v_bitop3_b32 v40, v40, v43, 1 bitop3:0x80
    v_cmp_eq_u32 vcc, 0, v40
    s_nop 0
    s_cbranch_vccz Lxok_59
    s_add_u32 s26, s26, 1
    s_cmp_lt_u32 s26, 262144
    s_cbranch_scc1 Lxrt_60a
    s_branch Lxok_59
Lxrt_65:
    s_mov_b32 s26, 0
    s_add_u32 s76, s21, 8
    s_and_b32 s76, s76, 15
    s_lshl_b32 s76, s76, 12
Lxrt_65a:
    s_add_u32 m0, s78, 81920
    s_nop 0
    buffer_load_dwordx4 v8, s[16:19], s76 offen offset:0 sc1 lds
    buffer_load_dwordx4 v8, s[16:19], s76 offen offset:1024 sc1 lds
    buffer_load_dwordx4 v8, s[16:19], s76 offen offset:2048 sc1 lds
    buffer_load_dwordx4 v8, s[16:19], s76 offen offset:3072 sc1 lds
    s_waitcnt vmcnt(0)
    ds_read2st64_b32 v[40:41], v169 offset0:128 offset1:132
    ds_read2st64_b32 v[42:43], v169 offset0:136 offset1:140
    s_waitcnt lgkmcnt(0)
    v_bitop3_b32 v40, v40, v41, v42 bitop3:0x80
    v_bitop3_b32 v40, v40, v43, 1 bitop3:0x80
    v_cmp_eq_u32 vcc, 0, v40
    s_nop 0
    s_cbranch_vccz Lxok_64
    s_add_u32 s26, s26, 1
    s_cmp_lt_u32 s26, 262144
    s_cbranch_scc1 Lxrt_65a
    s_branch Lxok_64
Lxrt_67:
    s_mov_b32 s26, 0
    s_add_u32 s76, s21, 1
    s_and_b32 s76, s76, 15
    s_lshl_b32 s76, s76, 12
Lxrt_67a:
    s_add_u32 m0, s78, 65536
    s_nop 0
    buffer_load_dwordx4 v8, s[16:19], s76 offen offset:0 sc1 lds
    buffer_load_dwordx4 v8, s[16:19], s76 offen offset:1024 sc1 lds
    buffer_load_dwordx4 v8, s[16:19], s76 offen offset:2048 sc1 lds
    buffer_load_dwordx4 v8, s[16:19], s76 offen offset:3072 sc1 lds
    s_waitcnt vmcnt(0)
    ds_read2st64_b32 v[40:41], v169 offset0:64 offset1:68
    ds_read2st64_b32 v[42:43], v169 offset0:72 offset1:76
    s_waitcnt lgkmcnt(0)
    v_or3_b32 v40, v40, v41, v42
    v_bitop3_b32 v40, v40, v43, 1 bitop3:0xa8
    v_cmp_ne_u32 vcc, 0, v40
    s_nop 0
    s_cbranch_vccz Lxok_66
    s_add_u32 s26, s26, 1
    s_cmp_lt_u32 s26, 262144
    s_cbranch_scc1 Lxrt_67a
    s_branch Lxok_66
Lxrt_69:
    s_mov_b32 s26, 0
    s_add_u32 s76, s21, 2
    s_and_b32 s76, s76, 15
    s_lshl_b32 s76, s76, 12
Lxrt_69a:
    s_add_u32 m0, s78, 81920
    s_nop 0
    buffer_load_dwordx4 v8, s[16:19], s76 offen offset:0 sc1 lds
    buffer_load_dwordx4 v8, s[16:19], s76 offen offset:1024 sc1 lds
    buffer_load_dwordx4 v8, s[16:19], s76 offen offset:2048 sc1 lds
    buffer_load_dwordx4 v8, s[16:19], s76 offen offset:3072 sc1 lds
    s_waitcnt vmcnt(0)
    ds_read2st64_b32 v[40:41], v169 offset0:128 offset1:132
    ds_read2st64_b32 v[42:43], v169 offset0:136 offset1:140
    s_waitcnt lgkmcnt(0)
    v_or3_b32 v40, v40, v41, v42
    v_bitop3_b32 v40, v40, v43, 1 bitop3:0xa8
    v_cmp_ne_u32 vcc, 0, v40
    s_nop 0
    s_cbranch_vccz Lxok_68
    s_add_u32 s26, s26, 1
    s_cmp_lt_u32 s26, 262144
    s_cbranch_scc1 Lxrt_69a
    s_branch Lxok_68
Lslow_70:
    buffer_store_dwordx4 v[24:27], v0, s[12:15], s27 offen sc1
    s_branch Lback_71
Lxrt_73:
    s_mov_b32 s26, 0
    s_add_u32 s76, s21, 3
    s_and_b32 s76, s76, 15
    s_lshl_b32 s76, s76, 12
Lxrt_73a:
    s_add_u32 m0, s78, 49152
    s_nop 0
    buffer_load_dwordx4 v8, s[16:19], s76 offen offset:0 sc1 lds
    buffer_load_dwordx4 v8, s[16:19], s76 offen offset:1024 sc1 lds
    buffer_load_dwordx4 v8, s[16:19], s76 offen offset:2048 sc1 lds
    buffer_load_dwordx4 v8, s[16:19], s76 offen offset:3072 sc1 lds
    s_waitcnt vmcnt(0)
    ds_read2st64_b32 v[40:41], v169 offset0:0 offset1:4
    ds_read2st64_b32 v[42:43], v169 offset0:8 offset1:12
    s_waitcnt lgkmcnt(0)
    v_or3_b32 v40, v40, v41, v42
    v_bitop3_b32 v40, v40, v43, 1 bitop3:0xa8
    v_cmp_ne_u32 vcc, 0, v40
    s_nop 0
    s_cbranch_vccz Lxok_72
    s_add_u32 s26, s26, 1
    s_cmp_lt_u32 s26, 262144
    s_cbranch_scc1 Lxrt_73a
    s_branch Lxok_72
Lslow_74:
    buffer_store_dwordx2 v[44:45], v46, s[12:15], 0 offen offset:0 sc1
    s_branch Lback_75
Lxrt_77:
    s_mov_b32 s26, 0
    s_add_u32 s76, s21, 4
    s_and_b32 s76, s76, 15
    s_lshl_b32 s76, s76, 12
Lxrt_77a:
    s_add_u32 m0, s78, 65536
    s_nop 0
    buffer_load_dwordx4 v8, s[16:19], s76 offen offset:0 sc1 lds
    buffer_load_dwordx4 v8, s[16:19], s76 offen offset:1024 sc1 lds
    buffer_load_dwordx4 v8, s[16:19], s76 offen offset:2048 sc1 lds
    buffer_load_dwordx4 v8, s[16:19], s76 offen offset:3072 sc1 lds
    s_waitcnt vmcnt(0)
    ds_read2st64_b32 v[40:41], v169 offset0:64 offset1:68
    ds_read2st64_b32 v[42:43], v169 offset0:72 offset1:76
    s_waitcnt lgkmcnt(0)
    v_or3_b32 v40, v40, v41, v42
    v_bitop3_b32 v40, v40, v43, 1 bitop3:0xa8
    v_cmp_ne_u32 vcc, 0, v40
    s_nop 0
    s_cbranch_vccz Lxok_76
    s_add_u32 s26, s26, 1
    s_cmp_lt_u32 s26, 262144
    s_cbranch_scc1 Lxrt_77a
    s_branch Lxok_76
Lxrt_79:
    s_mov_b32 s26, 0
    s_add_u32 s76, s21, 5
    s_and_b32 s76, s76, 15
    s_lshl_b32 s76, s76, 12
Lxrt_79a:
    s_add_u32 m0, s78, 81920
    s_nop 0
    buffer_load_dwordx4 v8, s[16:19], s76 offen offset:0 sc1 lds
    buffer_load_dwordx4 v8, s[16:19], s76 offen offset:1024 sc1 lds
    buffer_load_dwordx4 v8, s[16:19], s76 offen offset:2048 sc1 lds
    buffer_load_dwordx4 v8, s[16:19], s76 offen offset:3072 sc1 lds
    s_waitcnt vmcnt(0)
    ds_read2st64_b32 v[40:41], v169 offset0:128 offset1:132
    ds_read2st64_b32 v[42:43], v169 offset0:136 offset1:140
    s_waitcnt lgkmcnt(0)
    v_or3_b32 v40, v40, v41, v42
    v_bitop3_b32 v40, v40, v43, 1 bitop3:0xa8
    v_cmp_ne_u32 vcc, 0, v40
    s_nop 0
    s_cbranch_vccz Lxok_78
    s_add_u32 s26, s26, 1
    s_cmp_lt_u32 s26, 262144
    s_cbranch_scc1 Lxrt_79a
    s_branch Lxok_78
Lxrt_81:
    s_mov_b32 s26, 0
    s_add_u32 s76, s21, 6
    s_and_b32 s76, s76, 15
    s_lshl_b32 s76, s76, 12
Lxrt_81a:
    s_add_u32 m0, s78, 49152
    s_nop 0
    buffer_load_dwordx4 v8, s[16:19], s76 offen offset:0 sc1 lds
    buffer_load_dwordx4 v8, s[16:19], s76 offen offset:1024 sc1 lds
    buffer_load_dwordx4 v8, s[16:19], s76 offen offset:2048 sc1 lds
    buffer_load_dwordx4 v8, s[16:19], s76 offen offset:3072 sc1 lds
    s_waitcnt vmcnt(0)
    ds_read2st64_b32 v[40:41], v169 offset0:0 offset1:4
    ds_read2st64_b32 v[42:43], v169 offset0:8 offset1:12
    s_waitcnt lgkmcnt(0)
    v_or3_b32 v40, v40, v41, v42
    v_bitop3_b32 v40, v40, v43, 1 bitop3:0xa8
    v_cmp_ne_u32 vcc, 0, v40
    s_nop 0
    s_cbranch_vccz Lxok_80
    s_add_u32 s26, s26, 1
    s_cmp_lt_u32 s26, 262144
    s_cbranch_scc1 Lxrt_81a
    s_branch Lxok_80
Lxrt_83:
    s_mov_b32 s26, 0
    s_add_u32 s76, s21, 7
    s_and_b32 s76, s76, 15
    s_lshl_b32 s76, s76, 12
Lxrt_83a:
    s_add_u32 m0, s78, 65536
    s_nop 0
    buffer_load_dwordx4 v8, s[16:19], s76 offen offset:0 sc1 lds
    buffer_load_dwordx4 v8, s[16:19], s76 offen offset:1024 sc1 lds
    buffer_load_dwordx4 v8, s[16:19], s76 offen offset:2048 sc1 lds
    buffer_load_dwordx4 v8, s[16:19], s76 offen offset:3072 sc1 lds
    s_waitcnt vmcnt(0)
    ds_read2st64_b32 v[40:41], v169 offset0:64 offset1:68
    ds_read2st64_b32 v[42:43], v169 offset0:72 offset1:76
    s_waitcnt lgkmcnt(0)
    v_or3_b32 v40, v40, v41, v42
    v_bitop3_b32 v40, v40, v43, 1 bitop3:0xa8
    v_cmp_ne_u32 vcc, 0, v40
    s_nop 0
    s_cbranch_vccz Lxok_82
    s_add_u32 s26, s26, 1
    s_cmp_lt_u32 s26, 262144
    s_cbranch_scc1 Lxrt_83a
    s_branch Lxok_82
Lxrt_88:
    s_mov_b32 s26, 0
    s_add_u32 s76, s21, 8
    s_and_b32 s76, s76, 15
    s_lshl_b32 s76, s76, 12
Lxrt_88a:
    s_add_u32 m0, s78, 81920
    s_nop 0
    buffer_load_dwordx4 v8, s[16:19], s76 offen offset:0 sc1 lds
    buffer_load_dwordx4 v8, s[16:19], s76 offen offset:1024 sc1 lds
    buffer_load_dwordx4 v8, s[16:19], s76 offen offset:2048 sc1 lds
    buffer_load_dwordx4 v8, s[16:19], s76 offen offset:3072 sc1 lds
    s_waitcnt vmcnt(0)
    ds_read2st64_b32 v[40:41], v169 offset0:128 offset1:132
    ds_read2st64_b32 v[42:43], v169 offset0:136 offset1:140
    s_waitcnt lgkmcnt(0)
    v_or3_b32 v40, v40, v41, v42
    v_bitop3_b32 v40, v40, v43, 1 bitop3:0xa8
    v_cmp_ne_u32 vcc, 0, v40
    s_nop 0
    s_cbranch_vccz Lxok_87
    s_add_u32 s26, s26, 1
    s_cmp_lt_u32 s26, 262144
    s_cbranch_scc1 Lxrt_88a
    s_branch Lxok_87
Lslow_107:
    buffer_store_dwordx4 v[144:147], v0, s[12:15], s72 offen offset:0 sc1
    buffer_store_dwordx4 v[152:155], v0, s[12:15], s72 offen offset:1024 sc1
    s_branch Lback_108
L_exact:
    s_lshl_b32 s38, s20, 2
    s_add_u32 s38, s38, s84
    s_mov_b32 s37, 0
    v_mov_b32 v226, 0x3f803f80
    v_mov_b32 v227, 0x3f803f80
    v_mov_b32 v228, 0x3f803f80
    v_mov_b32 v229, 0x3f803f80
    v_mov_b32 v180, 4048155338
    v_mov_b32 v245, 4048155338
    v_mov_b32 v246, 4048155338
    v_mov_b32 v144, 0
    v_mov_b32 v145, 0
    v_mov_b32 v146, 0
    v_mov_b32 v147, 0
    v_mov_b32 v148, 0
    v_mov_b32 v149, 0
    v_mov_b32 v150, 0
    v_mov_b32 v151, 0
    v_mov_b32 v152, 0
    v_mov_b32 v153, 0
    v_mov_b32 v154, 0
    v_mov_b32 v155, 0
    v_mov_b32 v156, 0
    v_mov_b32 v157, 0
    v_mov_b32 v158, 0
    v_mov_b32 v159, 0
    v_mov_b32 v160, 0
    v_mov_b32 v161, 0
    v_mov_b32 v162, 0
    v_mov_b32 v163, 0
    v_mov_b32 v164, 0
    v_mov_b32 v165, 0
    v_mov_b32 v166, 0
    v_mov_b32 v167, 0
L_expass:
    s_mov_b32 s39, 0
    v_mov_b32 v247, v4
L_exstep:
    s_sub_u32 s27, s84, s39
    s_cmp_lt_i32 s27, 0
    s_cselect_b32 s28, s87, s73
    s_cmp_lt_i32 s27, -4
    s_cselect_b32 s28, s34, s28
    s_and_b32 s27, s27, 3
    s_lshl_b32 s27, s27, 14
    s_add_u32 s27, s27, s28
    s_add_u32 s27, s27, s33
    buffer_load_dwordx4 v[72:75], v0, s[12:15], s27 offen offset:0 sc1
    buffer_load_dwordx4 v[80:83], v0, s[12:15], s27 offen offset:1024 sc1
    buffer_load_dwordx4 v[100:103], v0, s[12:15], s27 offen offset:2048 sc1
    buffer_load_dwordx4 v[116:119], v0, s[12:15], s27 offen offset:3072 sc1
    s_waitcnt vmcnt(0)
    v_mfma_f32_16x16x32_bf16 v[120:123], v[72:75], v[40:43], 0
    v_mfma_f32_16x16x32_bf16 v[124:127], v[80:83], v[40:43], 0
    v_mfma_f32_16x16x32_bf16 v[128:131], v[72:75], v[48:51], 0
    v_mfma_f32_16x16x32_bf16 v[132:135], v[80:83], v[48:51], 0
    v_add_u32 v181, 0, v247
    v_cmp_gt_u32 vcc, 0x100, v181
    s_nop 2
    v_cndmask_b32 v120, v180, v120, vcc
    v_add_u32 v181, -1, v247
    v_cmp_gt_u32 vcc, 0x100, v181
    s_nop 1
    v_cndmask_b32 v121, v180, v121, vcc
    v_add_u32 v181, -2, v247
    v_cmp_gt_u32 vcc, 0x100, v181
    s_nop 1
    v_cndmask_b32 v122, v180, v122, vcc
    v_add_u32 v181, -3, v247
    v_cmp_gt_u32 vcc, 0x100, v181
    s_nop 1
    v_cndmask_b32 v123, v180, v123, vcc
    v_add_u32 v181, -16, v247
    v_cmp_gt_u32 vcc, 0x100, v181
    s_nop 1
    v_cndmask_b32 v124, v180, v124, vcc
    v_add_u32 v181, 4294967279, v247
    v_cmp_gt_u32 vcc, 0x100, v181
    s_nop 1
    v_cndmask_b32 v125, v180, v125, vcc
    v_add_u32 v181, 4294967278, v247
    v_cmp_gt_u32 vcc, 0x100, v181
    s_nop 1
    v_cndmask_b32 v126, v180, v126, vcc
    v_add_u32 v181, 4294967277, v247
    v_cmp_gt_u32 vcc, 0x100, v181
    s_nop 1
    v_cndmask_b32 v127, v180, v127, vcc
    v_add_u32 v181, 16, v247
    v_cmp_gt_u32 vcc, 0x100, v181
    s_nop 1
    v_cndmask_b32 v128, v180, v128, vcc
    v_add_u32 v181, 15, v247
    v_cmp_gt_u32 vcc, 0x100, v181
    s_nop 1
    v_cndmask_b32 v129, v180, v129, vcc
    v_add_u32 v181, 14, v247
    v_cmp_gt_u32 vcc, 0x100, v181
    s_nop 1
    v_cndmask_b32 v130, v180, v130, vcc
    v_add_u32 v181, 13, v247
    v_cmp_gt_u32 vcc, 0x100, v181
    s_nop 1
    v_cndmask_b32 v131, v180, v131, vcc
    v_add_u32 v181, 0, v247
    v_cmp_gt_u32 vcc, 0x100, v181
    s_nop 1
    v_cndmask_b32 v132, v180, v132, vcc
    v_add_u32 v181, -1, v247
    v_cmp_gt_u32 vcc, 0x100, v181
    s_nop 1
    v_cndmask_b32 v133, v180, v133, vcc
    v_add_u32 v181, -2, v247
    v_cmp_gt_u32 vcc, 0x100, v181
    s_nop 1
    v_cndmask_b32 v134, v180, v134, vcc
    v_add_u32 v181, -3, v247
    v_cmp_gt_u32 vcc, 0x100, v181
    s_nop 1
    v_cndmask_b32 v135, v180, v135, vcc
    s_cmp_lg_u32 s37, 0
    s_cbranch_scc1 L_exp2
    v_max3_f32 v245, v245, v120, v121
    v_max3_f32 v245, v245, v122, v123
    v_max3_f32 v245, v245, v124, v125
    v_max3_f32 v245, v245, v126, v127
    v_max3_f32 v246, v246, v128, v129
    v_max3_f32 v246, v246, v130, v131
    v_max3_f32 v246, v246, v132, v133
    v_max3_f32 v246, v246, v134, v135
    s_branch L_exnext
L_exp2:
    v_sub_f32 v120, v120, v245
    v_sub_f32 v121, v121, v245
    v_sub_f32 v122, v122, v245
    v_sub_f32 v123, v123, v245
    v_sub_f32 v124, v124, v245
    v_sub_f32 v125, v125, v245
    v_sub_f32 v126, v126, v245
    v_sub_f32 v127, v127, v245
    v_sub_f32 v128, v128, v246
    v_sub_f32 v129, v129, v246
    v_sub_f32 v130, v130, v246
    v_sub_f32 v131, v131, v246
    v_sub_f32 v132, v132, v246
    v_sub_f32 v133, v133, v246
    v_sub_f32 v134, v134, v246
    v_sub_f32 v135, v135, v246
    v_exp_f32 v120, v120
    v_exp_f32 v121, v121
    v_exp_f32 v122, v122
    v_exp_f32 v123, v123
    v_exp_f32 v124, v124
    v_exp_f32 v125, v125
    v_exp_f32 v126, v126
    v_exp_f32 v127, v127
    v_exp_f32 v128, v128
    v_exp_f32 v129, v129
    v_exp_f32 v130, v130
    v_exp_f32 v131, v131
    v_exp_f32 v132, v132
    v_exp_f32 v133, v133
    v_exp_f32 v134, v134
    v_exp_f32 v135, v135
    v_cvt_pk_bf16_f32 v136, v120, v121
    v_cvt_pk_bf16_f32 v137, v122, v123
    v_cvt_pk_bf16_f32 v138, v124, v125
    v_cvt_pk_bf16_f32 v139, v126, v127
    v_cvt_pk_bf16_f32 v140, v128, v129
    v_cvt_pk_bf16_f32 v141, v130, v131
    v_cvt_pk_bf16_f32 v142, v132, v133
    v_cvt_pk_bf16_f32 v143, v134, v135
    v_mfma_f32_16x16x32_bf16 v[144:147], v[100:103], v[136:139], v[144:147]
    v_mfma_f32_16x16x32_bf16 v[148:151], v[116:119], v[136:139], v[148:151]
    v_mfma_f32_16x16x32_bf16 v[160:163], v[226:229], v[136:139], v[160:163]
    v_mfma_f32_16x16x32_bf16 v[152:155], v[100:103], v[140:143], v[152:155]
    v_mfma_f32_16x16x32_bf16 v[156:159], v[116:119], v[140:143], v[156:159]
    v_mfma_f32_16x16x32_bf16 v[164:167], v[226:229], v[140:143], v[164:167]
L_exnext:
    v_add_u32 v247, 32, v247
    s_add_u32 s39, s39, 1
    s_min_u32 s27, s38, 8
    s_cmp_le_u32 s39, s27
    s_cbranch_scc1 L_exstep
    v_mov_b32 v181, v245
    s_nop 1
    v_permlane32_swap_b32 v245, v181
    v_max_f32 v245, v245, v181
    v_mov_b32 v181, v246
    s_nop 1
    v_permlane32_swap_b32 v246, v181
    v_max_f32 v246, v246, v181
    v_mov_b32 v181, v245
    s_nop 1
    v_permlane16_swap_b32 v245, v181
    v_max_f32 v245, v245, v181
    v_mov_b32 v181, v246
    s_nop 1
    v_permlane16_swap_b32 v246, v181
    v_max_f32 v246, v246, v181
    s_add_u32 s37, s37, 1
    s_cmp_lt_u32 s37, 2
    s_cbranch_scc1 L_expass
    v_rcp_f32 v245, v160
    s_nop 0
    v_mul_f32 v144, v144, v245
    v_mul_f32 v145, v145, v245
    v_mul_f32 v146, v146, v245
    v_mul_f32 v147, v147, v245
    v_mul_f32 v148, v148, v245
    v_mul_f32 v149, v149, v245
    v_mul_f32 v150, v150, v245
    v_mul_f32 v151, v151, v245
    v_add_u32 v247, 0x10000, v144
    v_cvt_pk_bf16_f32 v144, v144, v145
    v_cvt_pk_bf16_f32 v145, v146, v147
    v_and_b32_sdwa v144, v247, -2 dst_sel:WORD_0 dst_unused:UNUSED_PRESERVE src0_sel:WORD_1 src1_sel:DWORD
    v_cvt_pk_bf16_f32 v146, v148, v149
    v_cvt_pk_bf16_f32 v147, v150, v151
    v_rcp_f32 v246, v164
    s_nop 0
    v_mul_f32 v152, v152, v246
    v_mul_f32 v153, v153, v246
    v_mul_f32 v154, v154, v246
    v_mul_f32 v155, v155, v246
    v_mul_f32 v156, v156, v246
    v_mul_f32 v157, v157, v246
    v_mul_f32 v158, v158, v246
    v_mul_f32 v159, v159, v246
    v_add_u32 v247, 0x10000, v152
    v_cvt_pk_bf16_f32 v152, v152, v153
    v_cvt_pk_bf16_f32 v153, v154, v155
    v_and_b32_sdwa v152, v247, -2 dst_sel:WORD_0 dst_unused:UNUSED_PRESERVE src0_sel:WORD_1 src1_sel:DWORD
    v_cvt_pk_bf16_f32 v154, v156, v157
    v_cvt_pk_bf16_f32 v155, v158, v159
    s_branch L_ostore
Lslow_113:
    buffer_store_dwordx4 v[168:171], v0, s[12:15], s72 offen offset:1024 sc1
    buffer_store_dwordx4 v[152:155], v0, s[12:15], s72 offen offset:0 sc1
    buffer_store_dwordx4 v[136:139], v0, s[12:15], s28 offen offset:1024 sc1
    s_branch Lback_114
Lhrt_117:
    s_add_u32 s26, s26, 1
    s_cmp_ge_u32 s26, 262144
    s_cbranch_scc1 Lhok_116
    buffer_load_dwordx4 v[244:247], v0, s[12:15], s74 offen sc1
    buffer_load_dwordx4 v[240:243], v0, s[12:15], s74 offen offset:1024 sc1
    s_waitcnt vmcnt(0)
    s_branch Lhck_115
Lslow_118:
    buffer_store_dwordx4 v[120:123], v0, s[12:15], s28 offen offset:0 sc1
    s_branch Lback_119
Lock_120:
    s_mov_b32 s26, 0
    s_add_u32 s27, s21, 0
    s_and_b32 s27, s27, 15
    s_lshl_b32 s27, s27, 12
Lock_120a:
    buffer_load_dwordx4 v[104:107], v214, s[12:15], s27 offen offset:0 sc1
    buffer_load_dwordx4 v[108:111], v214, s[12:15], s27 offen offset:1024 sc1
    buffer_load_dwordx4 v[112:115], v214, s[12:15], s27 offen offset:2048 sc1
    buffer_load_dwordx4 v[116:119], v214, s[12:15], s27 offen offset:3072 sc1
    s_waitcnt vmcnt(0)
    v_bitop3_b32 v216, v104, v108, s22 bitop3:0x7e
    v_bitop3_b32 v217, v112, v116, s22 bitop3:0x7e
    v_bitop3_b32 v216, v216, v217, 1 bitop3:0xa8
    v_cmp_ne_u32 vcc, 0, v216
    s_nop 0
    s_cbranch_vccz Look_121
    s_add_u32 s26, s26, 1
    s_cmp_lt_u32 s26, 262144
    s_cbranch_scc1 Lock_120a
    s_branch Look_121
Lock_122:
    s_mov_b32 s26, 0
    s_add_u32 s27, s21, 1
    s_and_b32 s27, s27, 15
    s_lshl_b32 s27, s27, 12
Lock_122a:
    buffer_load_dwordx4 v[120:123], v214, s[12:15], s27 offen offset:0 sc1
    buffer_load_dwordx4 v[124:127], v214, s[12:15], s27 offen offset:1024 sc1
    buffer_load_dwordx4 v[128:131], v214, s[12:15], s27 offen offset:2048 sc1
    buffer_load_dwordx4 v[132:135], v214, s[12:15], s27 offen offset:3072 sc1
    s_waitcnt vmcnt(0)
    v_bitop3_b32 v216, v120, v124, s22 bitop3:0x7e
    v_bitop3_b32 v217, v128, v132, s22 bitop3:0x7e
    v_bitop3_b32 v216, v216, v217, 1 bitop3:0xa8
    v_cmp_ne_u32 vcc, 0, v216
    s_nop 0
    s_cbranch_vccz Look_123
    s_add_u32 s26, s26, 1
    s_cmp_lt_u32 s26, 262144
    s_cbranch_scc1 Lock_122a
    s_branch Look_123
Lock_124:
    s_mov_b32 s26, 0
    s_add_u32 s27, s21, 2
    s_and_b32 s27, s27, 15
    s_lshl_b32 s27, s27, 12
Lock_124a:
    buffer_load_dwordx4 v[136:139], v214, s[12:15], s27 offen offset:0 sc1
    buffer_load_dwordx4 v[140:143], v214, s[12:15], s27 offen offset:1024 sc1
    buffer_load_dwordx4 v[144:147], v214, s[12:15], s27 offen offset:2048 sc1
    buffer_load_dwordx4 v[148:151], v214, s[12:15], s27 offen offset:3072 sc1
    s_waitcnt vmcnt(0)
    v_bitop3_b32 v216, v136, v140, s22 bitop3:0x7e
    v_bitop3_b32 v217, v144, v148, s22 bitop3:0x7e
    v_bitop3_b32 v216, v216, v217, 1 bitop3:0xa8
    v_cmp_ne_u32 vcc, 0, v216
    s_nop 0
    s_cbranch_vccz Look_125
    s_add_u32 s26, s26, 1
    s_cmp_lt_u32 s26, 262144
    s_cbranch_scc1 Lock_124a
    s_branch Look_125
Lock_126:
    s_mov_b32 s26, 0
    s_add_u32 s27, s21, 3
    s_and_b32 s27, s27, 15
    s_lshl_b32 s27, s27, 12
Lock_126a:
    buffer_load_dwordx4 v[152:155], v214, s[12:15], s27 offen offset:0 sc1
    buffer_load_dwordx4 v[156:159], v214, s[12:15], s27 offen offset:1024 sc1
    buffer_load_dwordx4 v[160:163], v214, s[12:15], s27 offen offset:2048 sc1
    buffer_load_dwordx4 v[164:167], v214, s[12:15], s27 offen offset:3072 sc1
    s_waitcnt vmcnt(0)
    v_bitop3_b32 v216, v152, v156, s22 bitop3:0x7e
    v_bitop3_b32 v217, v160, v164, s22 bitop3:0x7e
    v_bitop3_b32 v216, v216, v217, 1 bitop3:0xa8
    v_cmp_ne_u32 vcc, 0, v216
    s_nop 0
    s_cbranch_vccz Look_127
    s_add_u32 s26, s26, 1
    s_cmp_lt_u32 s26, 262144
    s_cbranch_scc1 Lock_126a
    s_branch Look_127
Lock_128:
    s_mov_b32 s26, 0
    s_add_u32 s27, s21, 4
    s_and_b32 s27, s27, 15
    s_lshl_b32 s27, s27, 12
Lock_128a:
    buffer_load_dwordx4 v[168:171], v214, s[12:15], s27 offen offset:0 sc1
    buffer_load_dwordx4 v[172:175], v214, s[12:15], s27 offen offset:1024 sc1
    buffer_load_dwordx4 v[176:179], v214, s[12:15], s27 offen offset:2048 sc1
    buffer_load_dwordx4 v[180:183], v214, s[12:15], s27 offen offset:3072 sc1
    s_waitcnt vmcnt(0)
    v_bitop3_b32 v216, v168, v172, s22 bitop3:0x7e
    v_bitop3_b32 v217, v176, v180, s22 bitop3:0x7e
    v_bitop3_b32 v216, v216, v217, 1 bitop3:0xa8
    v_cmp_ne_u32 vcc, 0, v216
    s_nop 0
    s_cbranch_vccz Look_129
    s_add_u32 s26, s26, 1
    s_cmp_lt_u32 s26, 262144
    s_cbranch_scc1 Lock_128a
    s_branch Look_129
Lock_130:
    s_mov_b32 s26, 0
    s_add_u32 s27, s21, 5
    s_and_b32 s27, s27, 15
    s_lshl_b32 s27, s27, 12
Lock_130a:
    buffer_load_dwordx4 v[104:107], v214, s[12:15], s27 offen offset:0 sc1
    buffer_load_dwordx4 v[108:111], v214, s[12:15], s27 offen offset:1024 sc1
    buffer_load_dwordx4 v[112:115], v214, s[12:15], s27 offen offset:2048 sc1
    buffer_load_dwordx4 v[116:119], v214, s[12:15], s27 offen offset:3072 sc1
    s_waitcnt vmcnt(0)
    v_bitop3_b32 v216, v104, v108, s22 bitop3:0x7e
    v_bitop3_b32 v217, v112, v116, s22 bitop3:0x7e
    v_bitop3_b32 v216, v216, v217, 1 bitop3:0xa8
    v_cmp_ne_u32 vcc, 0, v216
    s_nop 0
    s_cbranch_vccz Look_131
    s_add_u32 s26, s26, 1
    s_cmp_lt_u32 s26, 262144
    s_cbranch_scc1 Lock_130a
    s_branch Look_131
Lock_132:
    s_mov_b32 s26, 0
    s_add_u32 s27, s21, 6
    s_and_b32 s27, s27, 15
    s_lshl_b32 s27, s27, 12
Lock_132a:
    buffer_load_dwordx4 v[120:123], v214, s[12:15], s27 offen offset:0 sc1
    buffer_load_dwordx4 v[124:127], v214, s[12:15], s27 offen offset:1024 sc1
    buffer_load_dwordx4 v[128:131], v214, s[12:15], s27 offen offset:2048 sc1
    buffer_load_dwordx4 v[132:135], v214, s[12:15], s27 offen offset:3072 sc1
    s_waitcnt vmcnt(0)
    v_bitop3_b32 v216, v120, v124, s22 bitop3:0x7e
    v_bitop3_b32 v217, v128, v132, s22 bitop3:0x7e
    v_bitop3_b32 v216, v216, v217, 1 bitop3:0xa8
    v_cmp_ne_u32 vcc, 0, v216
    s_nop 0
    s_cbranch_vccz Look_133
    s_add_u32 s26, s26, 1
    s_cmp_lt_u32 s26, 262144
    s_cbranch_scc1 Lock_132a
    s_branch Look_133
Lock_134:
    s_mov_b32 s26, 0
    s_add_u32 s27, s21, 7
    s_and_b32 s27, s27, 15
    s_lshl_b32 s27, s27, 12
Lock_134a:
    buffer_load_dwordx4 v[136:139], v214, s[12:15], s27 offen offset:0 sc1
    buffer_load_dwordx4 v[140:143], v214, s[12:15], s27 offen offset:1024 sc1
    buffer_load_dwordx4 v[144:147], v214, s[12:15], s27 offen offset:2048 sc1
    buffer_load_dwordx4 v[148:151], v214, s[12:15], s27 offen offset:3072 sc1
    s_waitcnt vmcnt(0)
    v_bitop3_b32 v216, v136, v140, s22 bitop3:0x7e
    v_bitop3_b32 v217, v144, v148, s22 bitop3:0x7e
    v_bitop3_b32 v216, v216, v217, 1 bitop3:0xa8
    v_cmp_ne_u32 vcc, 0, v216
    s_nop 0
    s_cbranch_vccz Look_135
    s_add_u32 s26, s26, 1
    s_cmp_lt_u32 s26, 262144
    s_cbranch_scc1 Lock_134a
    s_branch Look_135
Lock_136:
    s_mov_b32 s26, 0
    s_add_u32 s27, s21, 8
    s_and_b32 s27, s27, 15
    s_lshl_b32 s27, s27, 12
Lock_136a:
    buffer_load_dwordx4 v[152:155], v214, s[12:15], s27 offen offset:0 sc1
    buffer_load_dwordx4 v[156:159], v214, s[12:15], s27 offen offset:1024 sc1
    buffer_load_dwordx4 v[160:163], v214, s[12:15], s27 offen offset:2048 sc1
    buffer_load_dwordx4 v[164:167], v214, s[12:15], s27 offen offset:3072 sc1
    s_waitcnt vmcnt(0)
    v_bitop3_b32 v216, v152, v156, s22 bitop3:0x7e
    v_bitop3_b32 v217, v160, v164, s22 bitop3:0x7e
    v_bitop3_b32 v216, v216, v217, 1 bitop3:0xa8
    v_cmp_ne_u32 vcc, 0, v216
    s_nop 0
    s_cbranch_vccz Look_137
    s_add_u32 s26, s26, 1
    s_cmp_lt_u32 s26, 262144
    s_cbranch_scc1 Lock_136a
    s_branch Look_137
Lock_138:
    s_mov_b32 s26, 0
    s_add_u32 s27, s21, 9
    s_and_b32 s27, s27, 15
    s_lshl_b32 s27, s27, 12
Lock_138a:
    buffer_load_dwordx4 v[168:171], v214, s[12:15], s27 offen offset:0 sc1
    buffer_load_dwordx4 v[172:175], v214, s[12:15], s27 offen offset:1024 sc1
    buffer_load_dwordx4 v[176:179], v214, s[12:15], s27 offen offset:2048 sc1
    buffer_load_dwordx4 v[180:183], v214, s[12:15], s27 offen offset:3072 sc1
    s_waitcnt vmcnt(0)
    v_bitop3_b32 v216, v168, v172, s22 bitop3:0x7e
    v_bitop3_b32 v217, v176, v180, s22 bitop3:0x7e
    v_bitop3_b32 v216, v216, v217, 1 bitop3:0xa8
    v_cmp_ne_u32 vcc, 0, v216
    s_nop 0
    s_cbranch_vccz Look_139
    s_add_u32 s26, s26, 1
    s_cmp_lt_u32 s26, 262144
    s_cbranch_scc1 Lock_138a
    s_branch Look_139
Lock_140:
    s_mov_b32 s26, 0
    s_add_u32 s27, s21, 10
    s_and_b32 s27, s27, 15
    s_lshl_b32 s27, s27, 12
Lock_140a:
    buffer_load_dwordx4 v[104:107], v214, s[12:15], s27 offen offset:0 sc1
    buffer_load_dwordx4 v[108:111], v214, s[12:15], s27 offen offset:1024 sc1
    buffer_load_dwordx4 v[112:115], v214, s[12:15], s27 offen offset:2048 sc1
    buffer_load_dwordx4 v[116:119], v214, s[12:15], s27 offen offset:3072 sc1
    s_waitcnt vmcnt(0)
    v_bitop3_b32 v216, v104, v108, s22 bitop3:0x7e
    v_bitop3_b32 v217, v112, v116, s22 bitop3:0x7e
    v_bitop3_b32 v216, v216, v217, 1 bitop3:0xa8
    v_cmp_ne_u32 vcc, 0, v216
    s_nop 0
    s_cbranch_vccz Look_141
    s_add_u32 s26, s26, 1
    s_cmp_lt_u32 s26, 262144
    s_cbranch_scc1 Lock_140a
    s_branch Look_141
Lock_142:
    s_mov_b32 s26, 0
    s_add_u32 s27, s21, 11
    s_and_b32 s27, s27, 15
    s_lshl_b32 s27, s27, 12
Lock_142a:
    buffer_load_dwordx4 v[120:123], v214, s[12:15], s27 offen offset:0 sc1
    buffer_load_dwordx4 v[124:127], v214, s[12:15], s27 offen offset:1024 sc1
    buffer_load_dwordx4 v[128:131], v214, s[12:15], s27 offen offset:2048 sc1
    buffer_load_dwordx4 v[132:135], v214, s[12:15], s27 offen offset:3072 sc1
    s_waitcnt vmcnt(0)
    v_bitop3_b32 v216, v120, v124, s22 bitop3:0x7e
    v_bitop3_b32 v217, v128, v132, s22 bitop3:0x7e
    v_bitop3_b32 v216, v216, v217, 1 bitop3:0xa8
    v_cmp_ne_u32 vcc, 0, v216
    s_nop 0
    s_cbranch_vccz Look_143
    s_add_u32 s26, s26, 1
    s_cmp_lt_u32 s26, 262144
    s_cbranch_scc1 Lock_142a
    s_branch Look_143
Lock_144:
    s_mov_b32 s26, 0
    s_add_u32 s27, s21, 12
    s_and_b32 s27, s27, 15
    s_lshl_b32 s27, s27, 12
Lock_144a:
    buffer_load_dwordx4 v[136:139], v214, s[12:15], s27 offen offset:0 sc1
    buffer_load_dwordx4 v[140:143], v214, s[12:15], s27 offen offset:1024 sc1
    buffer_load_dwordx4 v[144:147], v214, s[12:15], s27 offen offset:2048 sc1
    buffer_load_dwordx4 v[148:151], v214, s[12:15], s27 offen offset:3072 sc1
    s_waitcnt vmcnt(0)
    v_bitop3_b32 v216, v136, v140, s22 bitop3:0x7e
    v_bitop3_b32 v217, v144, v148, s22 bitop3:0x7e
    v_bitop3_b32 v216, v216, v217, 1 bitop3:0xa8
    v_cmp_ne_u32 vcc, 0, v216
    s_nop 0
    s_cbranch_vccz Look_145
    s_add_u32 s26, s26, 1
    s_cmp_lt_u32 s26, 262144
    s_cbranch_scc1 Lock_144a
    s_branch Look_145
Lock_146:
    s_mov_b32 s26, 0
    s_add_u32 s27, s21, 13
    s_and_b32 s27, s27, 15
    s_lshl_b32 s27, s27, 12
Lock_146a:
    buffer_load_dwordx4 v[152:155], v214, s[12:15], s27 offen offset:0 sc1
    buffer_load_dwordx4 v[156:159], v214, s[12:15], s27 offen offset:1024 sc1
    buffer_load_dwordx4 v[160:163], v214, s[12:15], s27 offen offset:2048 sc1
    buffer_load_dwordx4 v[164:167], v214, s[12:15], s27 offen offset:3072 sc1
    s_waitcnt vmcnt(0)
    v_bitop3_b32 v216, v152, v156, s22 bitop3:0x7e
    v_bitop3_b32 v217, v160, v164, s22 bitop3:0x7e
    v_bitop3_b32 v216, v216, v217, 1 bitop3:0xa8
    v_cmp_ne_u32 vcc, 0, v216
    s_nop 0
    s_cbranch_vccz Look_147
    s_add_u32 s26, s26, 1
    s_cmp_lt_u32 s26, 262144
    s_cbranch_scc1 Lock_146a
    s_branch Look_147
Lock_148:
    s_mov_b32 s26, 0
    s_add_u32 s27, s21, 14
    s_and_b32 s27, s27, 15
    s_lshl_b32 s27, s27, 12
Lock_148a:
    buffer_load_dwordx4 v[168:171], v214, s[12:15], s27 offen offset:0 sc1
    buffer_load_dwordx4 v[172:175], v214, s[12:15], s27 offen offset:1024 sc1
    buffer_load_dwordx4 v[176:179], v214, s[12:15], s27 offen offset:2048 sc1
    buffer_load_dwordx4 v[180:183], v214, s[12:15], s27 offen offset:3072 sc1
    s_waitcnt vmcnt(0)
    v_bitop3_b32 v216, v168, v172, s22 bitop3:0x7e
    v_bitop3_b32 v217, v176, v180, s22 bitop3:0x7e
    v_bitop3_b32 v216, v216, v217, 1 bitop3:0xa8
    v_cmp_ne_u32 vcc, 0, v216
    s_nop 0
    s_cbranch_vccz Look_149
    s_add_u32 s26, s26, 1
    s_cmp_lt_u32 s26, 262144
    s_cbranch_scc1 Lock_148a
    s_branch Look_149
Lock_150:
    s_mov_b32 s26, 0
    s_add_u32 s27, s21, 15
    s_and_b32 s27, s27, 15
    s_lshl_b32 s27, s27, 12
Lock_150a:
    buffer_load_dwordx4 v[104:107], v214, s[12:15], s27 offen offset:0 sc1
    buffer_load_dwordx4 v[108:111], v214, s[12:15], s27 offen offset:1024 sc1
    buffer_load_dwordx4 v[112:115], v214, s[12:15], s27 offen offset:2048 sc1
    buffer_load_dwordx4 v[116:119], v214, s[12:15], s27 offen offset:3072 sc1
    s_waitcnt vmcnt(0)
    v_bitop3_b32 v216, v104, v108, s22 bitop3:0x7e
    v_bitop3_b32 v217, v112, v116, s22 bitop3:0x7e
    v_bitop3_b32 v216, v216, v217, 1 bitop3:0xa8
    v_cmp_ne_u32 vcc, 0, v216
    s_nop 0
    s_cbranch_vccz Look_151
    s_add_u32 s26, s26, 1
    s_cmp_lt_u32 s26, 262144
    s_cbranch_scc1 Lock_150a
    s_branch Look_151
Lslow_152:
    v_add_u32 v241, 0x10000, v24
    v_cvt_pk_bf16_f32 v8, v24, v25
    v_cvt_pk_bf16_f32 v9, v26, v27
    v_and_b32_sdwa v8, v241, -2 dst_sel:WORD_0 dst_unused:UNUSED_PRESERVE src0_sel:WORD_1 src1_sel:DWORD
    v_cvt_pk_bf16_f32 v10, v28, v29
    v_cvt_pk_bf16_f32 v11, v30, v31
    buffer_store_dwordx4 v[8:11], v0, s[16:19], s71 offen offset:0 sc1
    ds_write_b128 v240, v[8:11] offset:0
    v_add_u32 v241, 0x10000, v40
    v_cvt_pk_bf16_f32 v16, v40, v41
    v_cvt_pk_bf16_f32 v17, v42, v43
    v_and_b32_sdwa v16, v241, -2 dst_sel:WORD_0 dst_unused:UNUSED_PRESERVE src0_sel:WORD_1 src1_sel:DWORD
    v_cvt_pk_bf16_f32 v18, v44, v45
    v_cvt_pk_bf16_f32 v19, v46, v47
    buffer_store_dwordx4 v[16:19], v0, s[16:19], s71 offen offset:2048 sc1
    ds_write_b128 v240, v[16:19] offset:2048
    v_add_u32 v241, 0x10000, v32
    v_cvt_pk_bf16_f32 v12, v32, v33
    v_cvt_pk_bf16_f32 v13, v34, v35
    v_and_b32_sdwa v12, v241, -2 dst_sel:WORD_0 dst_unused:UNUSED_PRESERVE src0_sel:WORD_1 src1_sel:DWORD
    v_cvt_pk_bf16_f32 v14, v36, v37
    v_cvt_pk_bf16_f32 v15, v38, v39
    buffer_store_dwordx4 v[12:15], v0, s[16:19], s71 offen offset:1024 sc1
    ds_write_b128 v240, v[12:15] offset:1024
    v_add_u32 v241, 0x10000, v48
    v_cvt_pk_bf16_f32 v20, v48, v49
    v_cvt_pk_bf16_f32 v21, v50, v51
    v_and_b32_sdwa v20, v241, -2 dst_sel:WORD_0 dst_unused:UNUSED_PRESERVE src0_sel:WORD_1 src1_sel:DWORD
    v_cvt_pk_bf16_f32 v22, v52, v53
    v_cvt_pk_bf16_f32 v23, v54, v55
    buffer_store_dwordx4 v[20:23], v0, s[16:19], s71 offen offset:3072 sc1
    ds_write_b128 v240, v[20:23] offset:3072
    s_branch Lback_153
Lslow_154:
    v_cvt_pk_bf16_f32 v8, v24, v25
    v_cvt_pk_bf16_f32 v9, v26, v27
    v_or_b32_sdwa v8, v24, 1 dst_sel:WORD_0 dst_unused:UNUSED_PRESERVE src0_sel:WORD_1 src1_sel:DWORD
    v_cvt_pk_bf16_f32 v10, v28, v29
    v_cvt_pk_bf16_f32 v11, v30, v31
    buffer_store_dwordx4 v[8:11], v0, s[16:19], s71 offen offset:0 sc1
    ds_write_b128 v240, v[8:11] offset:0
    v_cvt_pk_bf16_f32 v16, v40, v41
    v_cvt_pk_bf16_f32 v17, v42, v43
    v_or_b32_sdwa v16, v40, 1 dst_sel:WORD_0 dst_unused:UNUSED_PRESERVE src0_sel:WORD_1 src1_sel:DWORD
    v_cvt_pk_bf16_f32 v18, v44, v45
    v_cvt_pk_bf16_f32 v19, v46, v47
    buffer_store_dwordx4 v[16:19], v0, s[16:19], s71 offen offset:2048 sc1
    ds_write_b128 v240, v[16:19] offset:2048
    v_cvt_pk_bf16_f32 v12, v32, v33
    v_cvt_pk_bf16_f32 v13, v34, v35
    v_or_b32_sdwa v12, v32, 1 dst_sel:WORD_0 dst_unused:UNUSED_PRESERVE src0_sel:WORD_1 src1_sel:DWORD
    v_cvt_pk_bf16_f32 v14, v36, v37
    v_cvt_pk_bf16_f32 v15, v38, v39
    buffer_store_dwordx4 v[12:15], v0, s[16:19], s71 offen offset:1024 sc1
    ds_write_b128 v240, v[12:15] offset:1024
    v_cvt_pk_bf16_f32 v20, v48, v49
    v_cvt_pk_bf16_f32 v21, v50, v51
    v_or_b32_sdwa v20, v48, 1 dst_sel:WORD_0 dst_unused:UNUSED_PRESERVE src0_sel:WORD_1 src1_sel:DWORD
    v_cvt_pk_bf16_f32 v22, v52, v53
    v_cvt_pk_bf16_f32 v23, v54, v55
    buffer_store_dwordx4 v[20:23], v0, s[16:19], s71 offen offset:3072 sc1
    ds_write_b128 v240, v[20:23] offset:3072
    s_branch Lback_155
L_end:
    s_endpgm

.section .rodata,"a"
.p2align 6
.amdhsa_kernel interleave_layers__sliding_block__sliding_local_dilated__prompt_kernel
  .amdhsa_next_free_vgpr 256
  .amdhsa_next_free_sgpr 100
  .amdhsa_accum_offset 256
  .amdhsa_group_segment_fixed_size 0
  .amdhsa_kernarg_size 72
  .amdhsa_user_sgpr_count 2
  .amdhsa_user_sgpr_kernarg_segment_ptr 1
  .amdhsa_system_sgpr_workgroup_id_x 1
.end_amdhsa_kernel
```
